```python
import torch

def _softmax(x, axis=-1):
    return torch.softmax(x, dim=axis)
def _gelu(x):
    return torch.nn.functional.gelu(x, approximate="tanh")
def _silu(x):
    return torch.nn.functional.silu(x)
def _sigmoid(x):
    return torch.sigmoid(x)
def _layernorm(x, axis=-1, eps=1e-5):
    m = x.mean(dim=axis, keepdim=True)
    v = x.var(dim=axis, keepdim=True, unbiased=False)
    return (x - m) / torch.sqrt(v + eps)
def _scatter_add(tgt, idx, src, axis=0):
    return tgt.clone().index_add_(axis, idx, src)
def _segment_sum(src, seg, n):
    out = torch.zeros((n,) + src.shape[1:], dtype=src.dtype)
    return out.index_add_(0, seg, src)
def _pad(x, pw):
    flat = tuple(v for pair in reversed(pw) for v in pair)
    return torch.nn.functional.pad(x, flat)

kernel_name = 'standalone__modern_conv_block_convnext_v2__vision'

def setup_inputs():

    _w = (lambda a: (lambda t: t.to(torch.bfloat16) if t.is_floating_point() else t)(torch.as_tensor(a)))
    H = W = 512
    C = 96
    K = 1
    return {
        "x": _w((lambda *s: torch.randn(*s, dtype=torch.bfloat16) * 0.05)(1, H, W, C)),
        "dw": _w((lambda *s: torch.randn(*s, dtype=torch.bfloat16) * 0.05)(K, K, C)),
        "w1": _w((lambda *s: torch.randn(*s, dtype=torch.bfloat16) * 0.05)(C, 4 * C)),
        "w2": _w((lambda *s: torch.randn(*s, dtype=torch.bfloat16) * 0.05)(4 * C, C)),
        "grn_gamma": _w((lambda *s: torch.randn(*s, dtype=torch.bfloat16) * 0.05)(4 * C)),
        "grn_beta": _w((lambda *s: torch.randn(*s, dtype=torch.bfloat16) * 0.05)(4 * C)),
    }

def reference(x, dw, w1, w2, grn_gamma, grn_beta):
    B, H, W, C = x.shape
    K = dw.shape[0]
    pad = K // 2
    xp = _pad(x, ((0,0),(pad,pad),(pad,pad),(0,0)))
    out = torch.zeros_like(x)
    for i in range(K):
        for j in range(K):
            out = out + xp[:, i:i+H, j:j+W, :] * dw[i, j][None, None, None, :]
    h = _layernorm(out, axis=-1)
    h = torch.einsum('bhwc,ce->bhwe', h, w1)
    h = _gelu(h)
    gx = torch.sqrt((h * h).sum(axis=(1, 2), keepdims=True) + 1e-6)
    nx = gx / (gx.mean(axis=-1, keepdims=True) + 1e-6)
    h = grn_gamma * (h * nx) + grn_beta + h
    h = torch.einsum('bhwe,ec->bhwc', h, w2)
    return x + h
```

```asm
; @launch grid=(256,1,1) block=(256,1,1) lds=163840
.amdgcn_target "amdgcn-amd-amdhsa--gfx950"
.text
.globl standalone__modern_conv_block_convnext_v2__vision_kernel
.p2align 8
.type standalone__modern_conv_block_convnext_v2__vision_kernel,@function
standalone__modern_conv_block_convnext_v2__vision_kernel:
s_cmp_ge_u32 s2, 256
s_cbranch_scc1 L_end
s_load_dwordx16 s[4:19], s[0:1], 0
s_load_dwordx2 s[20:21], s[0:1], 64
s_getpc_b64 s[88:89]
L_pc:
v_lshlrev_b32 v248, 7, v0
v_mov_b32 v249, s89
v_add_co_u32 v248, vcc, s88, v248
s_nop 1
v_addc_co_u32 v249, vcc, 0, v249, vcc
global_load_dword a255, v[248:249], off
v_lshrrev_b32 v227, 6, v0
v_and_b32 v224, 63, v0
v_readfirstlane_b32 s66, v227
v_mov_b32 v239, v0
v_and_b32 v225, 31, v224
v_lshrrev_b32 v226, 5, v224
v_lshlrev_b32 v0, 4, v224
s_lshl_b32 s67, s2, 2
s_add_u32 s67, s67, s66
s_mul_i32 s67, s67, 6144
v_mul_u32_u24 v2, 192, v225
v_lshlrev_b32 v227, 5, v226
v_add3_u32 v2, v2, v227, s67
s_mov_b32 s3, s67
v_bfe_u32 v235, v225, 3, 1
v_and_b32 v227, 3, v225
v_lshl_add_u32 v235, v235, 2, v227
v_bfe_u32 v236, v225, 2, 1
v_lshrrev_b32 v227, 4, v225
v_lshl_add_u32 v237, v227, 3, v235
v_lshl_add_u32 v237, v236, 4, v237
v_lshlrev_b32_e64 v237, 1, v237
v_mul_u32_u24 v227, 12288, v226
v_lshl_add_u32 v238, v225, 4, v227
v_lshl_add_u32 v244, v225, 3, v227
v_add_u32 v244, 512, v244
s_lshr_b32 s94, s2, 3
s_add_u32 s94, s94, s66
s_and_b32 s94, s94, 3
s_cmp_lt_u32 s94, 2
s_cselect_b32 s67, 16, 8
s_cselect_b32 s68, 0, 512
s_cselect_b32 s69, 0, 48
v_mad_u32_u24 v245, v225, s67, v227
v_add_u32 v245, s68, v245
s_and_b32 s70, s94, 1
s_add_u32 s70, s70, 4
s_lshr_b32 s71, s94, 1
s_mul_i32 s71, s71, 24576
s_and_b32 s72, s94, 1
s_mul_i32 s72, s72, 6144
s_add_u32 s90, s71, s72
s_add_u32 s91, s90, 3072
s_lshr_b32 s71, s70, 1
s_mul_i32 s71, s71, 24576
s_and_b32 s72, s70, 1
s_mul_i32 s72, s72, 6144
s_add_u32 s92, s71, s72
s_add_u32 s93, s92, 3072
s_lshr_b32 s71, s94, 1
s_lshl_b32 s71, s71, 11
s_and_b32 s72, s94, 1
s_lshl_b32 s72, s72, 9
s_add_u32 s84, s71, s72
s_add_u32 s85, s84, 49152
s_lshl_b32 s86, s69, 10
s_add_u32 s86, s86, s72
s_add_u32 s86, s86, 4096
s_lshl_b32 s79, s2, 2
s_add_u32 s79, s79, s66
s_mul_i32 s80, s79, 30720
s_add_u32 s80, s80, 2097152
s_lshl_b32 s79, s79, 10
s_add_u32 s79, s79, 524288
s_lshl_b32 s87, s66, 13
s_waitcnt lgkmcnt(0)
s_mov_b32 s48, s6
s_and_b32 s49, s7, 65535
s_mov_b32 s50, 192
s_mov_b32 s51, 131072
s_mov_b32 s24, s4
s_and_b32 s25, s5, 65535
s_mov_b32 s26, 50331648
s_mov_b32 s27, 131072
s_mov_b32 s32, s8
s_and_b32 s33, s9, 65535
s_mov_b32 s34, 73728
s_mov_b32 s35, 131072
buffer_load_ushort v240, v237, s[48:51], 0 offen offset:0
buffer_load_ushort v241, v237, s[48:51], 0 offen offset:64
buffer_load_ushort v242, v237, s[48:51], 0 offen offset:128
buffer_load_dwordx4 v[16:19], v238, s[32:35], s90 offen offset:0
buffer_load_dwordx4 v[20:23], v238, s[32:35], s90 offen offset:768
buffer_load_dwordx4 v[24:27], v238, s[32:35], s90 offen offset:1536
buffer_load_dwordx4 v[28:31], v238, s[32:35], s90 offen offset:2304
buffer_load_dwordx4 v[32:35], v238, s[32:35], s91 offen offset:0
buffer_load_dwordx4 v[36:39], v238, s[32:35], s91 offen offset:768
buffer_load_dwordx4 v[40:43], v238, s[32:35], s91 offen offset:1536
buffer_load_dwordx4 v[44:47], v238, s[32:35], s91 offen offset:2304
buffer_load_dwordx2 v[48:49], v244, s[32:35], s90 offen offset:0
buffer_load_dwordx2 v[50:51], v244, s[32:35], s90 offen offset:768
buffer_load_dwordx2 v[52:53], v244, s[32:35], s90 offen offset:1536
buffer_load_dwordx2 v[54:55], v244, s[32:35], s90 offen offset:2304
buffer_load_dwordx2 v[56:57], v244, s[32:35], s91 offen offset:0
buffer_load_dwordx2 v[58:59], v244, s[32:35], s91 offen offset:768
buffer_load_dwordx2 v[60:61], v244, s[32:35], s91 offen offset:1536
buffer_load_dwordx2 v[62:63], v244, s[32:35], s91 offen offset:2304
buffer_load_dwordx4 v[64:67], v245, s[32:35], s92 offen offset:0
buffer_load_dwordx4 v[68:71], v245, s[32:35], s92 offen offset:768
buffer_load_dwordx4 v[72:75], v245, s[32:35], s92 offen offset:1536
buffer_load_dwordx4 v[76:79], v245, s[32:35], s92 offen offset:2304
buffer_load_dwordx4 v[80:83], v245, s[32:35], s93 offen offset:0
buffer_load_dwordx4 v[84:87], v245, s[32:35], s93 offen offset:768
buffer_load_dwordx4 v[88:91], v245, s[32:35], s93 offen offset:1536
buffer_load_dwordx4 v[92:95], v245, s[32:35], s93 offen offset:2304
s_mov_b32 s64, 0
buffer_load_dwordx4 v[200:203], v2, s[24:27], s64 offen offset:0
buffer_load_dwordx4 v[204:207], v2, s[24:27], s64 offen offset:16
buffer_load_dwordx4 v[208:211], v2, s[24:27], s64 offen offset:64
buffer_load_dwordx4 v[212:215], v2, s[24:27], s64 offen offset:80
buffer_load_dwordx4 v[216:219], v2, s[24:27], s64 offen offset:128
buffer_load_dwordx4 v[220:223], v2, s[24:27], s64 offen offset:144
s_mov_b32 s36, s10
s_and_b32 s37, s11, 65535
s_mov_b32 s38, 73728
s_mov_b32 s39, 131072
s_mov_b32 s52, s12
s_and_b32 s53, s13, 65535
s_mov_b32 s54, 768
s_mov_b32 s55, 131072
s_mov_b32 s56, s14
s_and_b32 s57, s15, 65535
s_mov_b32 s58, 768
s_mov_b32 s59, 131072
s_mov_b32 s28, s16
s_and_b32 s29, s17, 65535
s_mov_b32 s30, 50331648
s_mov_b32 s31, 131072
s_mov_b32 s44, s18
s_and_b32 s45, s19, 65535
s_mov_b32 s46, 256
s_mov_b32 s47, 131072
s_mov_b32 s40, s20
s_and_b32 s41, s21, 65535
s_mov_b32 s42, 33554432
s_mov_b32 s43, 131072
v_lshlrev_b32 v1, 4, v225
v_lshl_add_u32 v1, v226, 10, v1
v_add_u32 v7, 65536, v1
s_lshl_b32 s67, s66, 11
s_add_u32 s67, s67, 147456
v_and_b32 v227, 7, v225
v_lshlrev_b32 v3, 3, v227
v_lshrrev_b32 v227, 3, v225
v_lshl_add_u32 v3, v227, 8, v3
v_xor_b32 v227, v227, v226
v_and_b32 v227, 1, v227
v_lshl_add_u32 v3, v227, 6, v3
v_add_u32 v3, s67, v3
v_bfe_u32 v227, v224, 2, 3
v_lshlrev_b32 v4, 3, v227
v_xor_b32 v227, v224, v226
v_and_b32 v227, 1, v227
v_lshl_add_u32 v4, v227, 6, v4
v_bfe_u32 v227, v224, 1, 1
v_lshl_add_u32 v4, v227, 7, v4
v_lshl_add_u32 v4, v226, 8, v4
v_add_u32 v4, s67, v4
v_lshlrev_b32 v243, 4, v225
v_add_u32 v243, 155648, v243
v_mov_b32 v233, 156160
v_lshrrev_b32 v227, 4, v225
v_xor_b32 v227, 0, v227
v_xor_b32 v5, v236, v226
v_or_b32 v227, v227, v5
v_cmp_eq_u32 vcc, 0, v227
s_nop 1
v_cndmask_b32 v5, v233, v243, vcc
v_lshrrev_b32 v227, 4, v225
v_xor_b32 v227, 1, v227
v_xor_b32 v6, v236, v226
v_or_b32 v227, v227, v6
v_cmp_eq_u32 vcc, 0, v227
s_nop 1
v_cndmask_b32 v6, v233, v243, vcc
v_cmp_eq_u32 vcc, 0, v226
s_nop 1
v_cndmask_b32 v234, v233, v243, vcc
v_and_b32 v227, 1, v235
v_lshlrev_b32 v227, 4, v227
v_mov_b32 v232, 65535
v_lshlrev_b32 v232, v227, v232
v_lshrrev_b32 v227, 1, v235
v_lshl_or_b32 v227, v226, 3, v227
v_cmp_eq_u32 vcc, 0, v227
s_nop 1
v_cndmask_b32 v112, 0, v232, vcc
v_cmp_eq_u32 vcc, 1, v227
s_nop 1
v_cndmask_b32 v113, 0, v232, vcc
v_cmp_eq_u32 vcc, 2, v227
s_nop 1
v_cndmask_b32 v114, 0, v232, vcc
v_cmp_eq_u32 vcc, 3, v227
s_nop 1
v_cndmask_b32 v115, 0, v232, vcc
s_lshl_b32 s21, s66, 14
s_sub_u32 s21, s21, 73728
s_mov_b32 s60, 0xc09d30fc
s_mov_b32 s61, 0xc09d30fc
s_mov_b32 s62, 1.0
s_mov_b32 s63, 1.0
s_mov_b32 s76, 84148480
s_mov_b32 s77, 117834498
s_waitcnt vmcnt(32)
v_lshl_or_b32 v240, v240, 16, v240
v_and_b32 v120, v240, v112
v_and_b32 v121, v240, v113
v_and_b32 v122, v240, v114
v_and_b32 v123, v240, v115
ds_write_b128 v234, v[120:123] offset:0
s_waitcnt vmcnt(31)
v_lshl_or_b32 v241, v241, 16, v241
v_and_b32 v116, v241, v112
v_and_b32 v117, v241, v113
v_and_b32 v118, v241, v114
v_and_b32 v119, v241, v115
ds_write_b128 v234, v[116:119] offset:528
s_waitcnt vmcnt(30)
v_lshl_or_b32 v242, v242, 16, v242
v_and_b32 v120, v242, v112
v_and_b32 v121, v242, v113
v_and_b32 v122, v242, v114
v_and_b32_e64 v123, v242, v115
ds_write_b128 v234, v[120:123] offset:1056
ds_read_b128 v[128:131], v5 offset:0
ds_read_b128 v[132:135], v6 offset:0
ds_read_b128 v[136:139], v5 offset:528
ds_read_b128 v[140:143], v6 offset:528
ds_read_b128 v[144:147], v5 offset:1056
ds_read_b128 v[148:151], v6 offset:1056
v_add_u32_e64 v124, s84, v1
s_waitcnt vmcnt(28)
v_perm_b32 v112, v20, v16, s76
s_waitcnt vmcnt(26)
v_perm_b32 v113, v28, v24, s76
s_waitcnt vmcnt(24)
v_perm_b32 v114, v36, v32, s76
s_waitcnt vmcnt(22)
v_perm_b32 v115, v44, v40, s76
ds_write_b128 v124, v[112:115] offset:0
v_perm_b32 v116, v20, v16, s77
v_perm_b32 v117, v28, v24, s77
v_perm_b32 v118, v36, v32, s77
v_perm_b32 v119, v44, v40, s77
ds_write_b128 v124, v[116:119] offset:6144
v_perm_b32 v120, v21, v17, s76
v_perm_b32 v121, v29, v25, s76
v_perm_b32 v122, v37, v33, s76
v_perm_b32 v123, v45, v41, s76
ds_write_b128 v124, v[120:123] offset:12288
v_perm_b32 v112, v21, v17, s77
v_perm_b32 v113, v29, v25, s77
v_perm_b32 v114, v37, v33, s77
v_perm_b32 v115, v45, v41, s77
ds_write_b128 v124, v[112:115] offset:18432
v_perm_b32 v116, v22, v18, s76
v_perm_b32 v117, v30, v26, s76
v_perm_b32 v118, v38, v34, s76
v_perm_b32 v119, v46, v42, s76
ds_write_b128 v124, v[116:119] offset:24576
v_perm_b32 v120, v22, v18, s77
v_perm_b32 v121, v30, v26, s77
v_perm_b32 v122, v38, v34, s77
v_perm_b32 v123, v46, v42, s77
ds_write_b128 v124, v[120:123] offset:30720
v_perm_b32 v112, v23, v19, s76
v_perm_b32 v113, v31, v27, s76
v_perm_b32 v114, v39, v35, s76
v_perm_b32 v115, v47, v43, s76
ds_write_b128 v124, v[112:115] offset:36864
v_perm_b32 v116, v23, v19, s77
v_perm_b32 v117, v31, v27, s77
v_perm_b32 v118, v39, v35, s77
v_perm_b32 v119, v47, v43, s77
ds_write_b128 v124, v[116:119] offset:43008
v_add_u32_e64 v124, s85, v1
s_waitcnt vmcnt(20)
v_perm_b32 v120, v50, v48, s76
s_waitcnt vmcnt(18)
v_perm_b32 v121, v54, v52, s76
s_waitcnt vmcnt(16)
v_perm_b32 v122, v58, v56, s76
s_waitcnt vmcnt(14)
v_perm_b32 v123, v62, v60, s76
ds_write_b128 v124, v[120:123] offset:0
v_perm_b32 v112, v50, v48, s77
v_perm_b32 v113, v54, v52, s77
v_perm_b32 v114, v58, v56, s77
v_perm_b32 v115, v62, v60, s77
ds_write_b128 v124, v[112:115] offset:6144
v_perm_b32 v116, v51, v49, s76
v_perm_b32 v117, v55, v53, s76
v_perm_b32 v118, v59, v57, s76
v_perm_b32 v119, v63, v61, s76
ds_write_b128 v124, v[116:119] offset:12288
v_perm_b32 v120, v51, v49, s77
v_perm_b32 v121, v55, v53, s77
v_perm_b32 v122, v59, v57, s77
v_perm_b32 v123, v63, v61, s77
ds_write_b128 v124, v[120:123] offset:18432
v_add_u32_e64 v124, s86, v1
s_waitcnt vmcnt(12)
v_perm_b32 v112, v68, v64, s76
s_waitcnt vmcnt(10)
v_perm_b32 v113, v76, v72, s76
s_waitcnt vmcnt(8)
v_perm_b32 v114, v84, v80, s76
s_waitcnt vmcnt(6)
v_perm_b32 v115, v92, v88, s76
ds_write_b128 v124, v[112:115] offset:0
v_perm_b32 v116, v68, v64, s77
v_perm_b32 v117, v76, v72, s77
v_perm_b32 v118, v84, v80, s77
v_perm_b32 v119, v92, v88, s77
ds_write_b128 v124, v[116:119] offset:6144
v_perm_b32 v120, v69, v65, s76
v_perm_b32 v121, v77, v73, s76
v_perm_b32 v122, v85, v81, s76
v_perm_b32 v123, v93, v89, s76
ds_write_b128 v124, v[120:123] offset:12288
v_perm_b32 v112, v69, v65, s77
v_perm_b32 v113, v77, v73, s77
v_perm_b32 v114, v85, v81, s77
v_perm_b32 v115, v93, v89, s77
ds_write_b128 v124, v[112:115] offset:18432
v_perm_b32 v116, v70, v66, s76
v_perm_b32 v117, v78, v74, s76
v_perm_b32 v118, v86, v82, s76
v_perm_b32 v119, v94, v90, s76
ds_write_b128 v124, v[116:119] offset:24576
v_perm_b32 v120, v70, v66, s77
v_perm_b32 v121, v78, v74, s77
v_perm_b32 v122, v86, v82, s77
v_perm_b32 v123, v94, v90, s77
ds_write_b128 v124, v[120:123] offset:30720
v_perm_b32 v112, v71, v67, s76
v_perm_b32 v113, v79, v75, s76
v_perm_b32 v114, v87, v83, s76
v_perm_b32 v115, v95, v91, s76
ds_write_b128 v124, v[112:115] offset:36864
v_perm_b32 v116, v71, v67, s77
v_perm_b32 v117, v79, v75, s77
v_perm_b32 v118, v87, v83, s77
v_perm_b32 v119, v95, v91, s77
ds_write_b128 v124, v[116:119] offset:43008
s_waitcnt vmcnt(5) lgkmcnt(3)
v_mfma_f32_32x32x16_bf16 v[152:167], v[128:131], v[200:203], 0
s_waitcnt vmcnt(4)
v_mfma_f32_32x32x16_bf16 v[152:167], v[132:135], v[204:207], v[152:167]
s_waitcnt vmcnt(3)
v_mfma_f32_32x32x16_bf16 v[168:183], v[136:139], v[208:211], 0
s_waitcnt vmcnt(2)
v_mfma_f32_32x32x16_bf16 v[168:183], v[140:143], v[212:215], v[168:183]
s_waitcnt vmcnt(1)
v_mfma_f32_32x32x16_bf16 v[184:199], v[144:147], v[216:219], 0
s_waitcnt vmcnt(0)
v_mfma_f32_32x32x16_bf16 v[184:199], v[148:151], v[220:223], v[184:199]
s_mov_b32 s64, 6291456
buffer_load_dwordx4 v[200:203], v2, s[24:27], s64 offen offset:0
buffer_load_dwordx4 v[204:207], v2, s[24:27], s64 offen offset:16
buffer_load_dwordx4 v[208:211], v2, s[24:27], s64 offen offset:64
buffer_load_dwordx4 v[212:215], v2, s[24:27], s64 offen offset:80
buffer_load_dwordx4 v[216:219], v2, s[24:27], s64 offen offset:128
buffer_load_dwordx4 v[220:223], v2, s[24:27], s64 offen offset:144
s_waitcnt lgkmcnt(0)
s_barrier
ds_read_b128 a[0:3], v1 offset:0
ds_read_b128 a[4:7], v1 offset:512
ds_read_b128 a[8:11], v1 offset:2048
v_pk_mul_f32 v[10:11], v[152:153], v[152:153]
v_pk_add_f32 v[8:9], v[152:153], v[154:155]
v_pk_fma_f32 v[10:11], v[154:155], v[154:155], v[10:11]
v_pk_add_f32 v[8:9], v[8:9], v[156:157]
v_pk_fma_f32 v[10:11], v[156:157], v[156:157], v[10:11]
v_pk_add_f32 v[8:9], v[8:9], v[158:159]
v_pk_fma_f32 v[10:11], v[158:159], v[158:159], v[10:11]
v_pk_add_f32 v[8:9], v[8:9], v[160:161]
v_pk_fma_f32 v[10:11], v[160:161], v[160:161], v[10:11]
v_pk_add_f32 v[8:9], v[8:9], v[162:163]
v_pk_fma_f32 v[10:11], v[162:163], v[162:163], v[10:11]
v_pk_add_f32 v[8:9], v[8:9], v[164:165]
v_pk_fma_f32 v[10:11], v[164:165], v[164:165], v[10:11]
v_pk_add_f32 v[8:9], v[8:9], v[166:167]
v_pk_fma_f32 v[10:11], v[166:167], v[166:167], v[10:11]
v_pk_add_f32 v[8:9], v[8:9], v[168:169]
v_pk_fma_f32 v[10:11], v[168:169], v[168:169], v[10:11]
v_pk_add_f32 v[8:9], v[8:9], v[170:171]
v_pk_fma_f32 v[10:11], v[170:171], v[170:171], v[10:11]
v_pk_add_f32 v[8:9], v[8:9], v[172:173]
v_pk_fma_f32 v[10:11], v[172:173], v[172:173], v[10:11]
v_pk_add_f32 v[8:9], v[8:9], v[174:175]
v_pk_fma_f32 v[10:11], v[174:175], v[174:175], v[10:11]
v_pk_add_f32 v[8:9], v[8:9], v[176:177]
v_pk_fma_f32 v[10:11], v[176:177], v[176:177], v[10:11]
v_pk_add_f32 v[8:9], v[8:9], v[178:179]
v_pk_fma_f32 v[10:11], v[178:179], v[178:179], v[10:11]
v_pk_add_f32 v[8:9], v[8:9], v[180:181]
v_pk_fma_f32 v[10:11], v[180:181], v[180:181], v[10:11]
v_pk_add_f32 v[8:9], v[8:9], v[182:183]
v_pk_fma_f32 v[10:11], v[182:183], v[182:183], v[10:11]
v_pk_add_f32 v[8:9], v[8:9], v[184:185]
v_pk_fma_f32 v[10:11], v[184:185], v[184:185], v[10:11]
v_pk_add_f32 v[8:9], v[8:9], v[186:187]
v_pk_fma_f32 v[10:11], v[186:187], v[186:187], v[10:11]
v_pk_add_f32 v[8:9], v[8:9], v[188:189]
v_pk_fma_f32 v[10:11], v[188:189], v[188:189], v[10:11]
v_pk_add_f32 v[8:9], v[8:9], v[190:191]
v_pk_fma_f32 v[10:11], v[190:191], v[190:191], v[10:11]
v_pk_add_f32 v[8:9], v[8:9], v[192:193]
v_pk_fma_f32 v[10:11], v[192:193], v[192:193], v[10:11]
v_pk_add_f32 v[8:9], v[8:9], v[194:195]
v_pk_fma_f32 v[10:11], v[194:195], v[194:195], v[10:11]
v_pk_add_f32 v[8:9], v[8:9], v[196:197]
v_pk_fma_f32 v[10:11], v[196:197], v[196:197], v[10:11]
v_pk_add_f32 v[8:9], v[8:9], v[198:199]
v_pk_fma_f32 v[10:11], v[198:199], v[198:199], v[10:11]
v_add_f32 v8, v8, v9
v_add_f32 v10, v10, v11
s_nop 1
v_permlane32_swap_b32 v8, v10
v_add_f32 v8, v8, v10
v_mov_b32 v10, v8
s_nop 1
v_permlane32_swap_b32 v8, v10
v_mul_f32 v13, 0x3c2aaaab, v8
v_mul_f32 v10, 0x3c2aaaab, v10
v_fma_f32 v10, -v13, v13, v10
v_max_f32 v10, 0, v10
v_add_f32 v10, 0x3727c5ac, v10
v_rsq_f32 v12, v10
s_nop 0
v_mul_f32 v12, 0x3eeff558, v12
v_mul_f32 v13, v13, v12
v_lshrrev_b32_e64 v14, 1, v0
v_and_b32 v14, 248, v14
buffer_store_dwordx2 v[12:13], v14, s[40:43], s79 offen offset:0
v_pk_fma_f32 v[152:153], v[152:153], v[12:13], v[12:13] op_sel:[0,0,1] op_sel_hi:[1,0,1] neg_lo:[0,0,1] neg_hi:[0,0,1]
v_pk_fma_f32 v[154:155], v[154:155], v[12:13], v[12:13] op_sel:[0,0,1] op_sel_hi:[1,0,1] neg_lo:[0,0,1] neg_hi:[0,0,1]
v_pk_fma_f32 v[156:157], v[156:157], v[12:13], v[12:13] op_sel:[0,0,1] op_sel_hi:[1,0,1] neg_lo:[0,0,1] neg_hi:[0,0,1]
v_pk_fma_f32 v[158:159], v[158:159], v[12:13], v[12:13] op_sel:[0,0,1] op_sel_hi:[1,0,1] neg_lo:[0,0,1] neg_hi:[0,0,1]
v_pk_fma_f32 v[160:161], v[160:161], v[12:13], v[12:13] op_sel:[0,0,1] op_sel_hi:[1,0,1] neg_lo:[0,0,1] neg_hi:[0,0,1]
v_pk_fma_f32 v[162:163], v[162:163], v[12:13], v[12:13] op_sel:[0,0,1] op_sel_hi:[1,0,1] neg_lo:[0,0,1] neg_hi:[0,0,1]
v_pk_fma_f32 v[164:165], v[164:165], v[12:13], v[12:13] op_sel:[0,0,1] op_sel_hi:[1,0,1] neg_lo:[0,0,1] neg_hi:[0,0,1]
v_pk_fma_f32 v[166:167], v[166:167], v[12:13], v[12:13] op_sel:[0,0,1] op_sel_hi:[1,0,1] neg_lo:[0,0,1] neg_hi:[0,0,1]
v_pk_fma_f32 v[168:169], v[168:169], v[12:13], v[12:13] op_sel:[0,0,1] op_sel_hi:[1,0,1] neg_lo:[0,0,1] neg_hi:[0,0,1]
v_pk_fma_f32 v[170:171], v[170:171], v[12:13], v[12:13] op_sel:[0,0,1] op_sel_hi:[1,0,1] neg_lo:[0,0,1] neg_hi:[0,0,1]
v_pk_fma_f32 v[172:173], v[172:173], v[12:13], v[12:13] op_sel:[0,0,1] op_sel_hi:[1,0,1] neg_lo:[0,0,1] neg_hi:[0,0,1]
v_pk_fma_f32 v[174:175], v[174:175], v[12:13], v[12:13] op_sel:[0,0,1] op_sel_hi:[1,0,1] neg_lo:[0,0,1] neg_hi:[0,0,1]
v_pk_fma_f32 v[176:177], v[176:177], v[12:13], v[12:13] op_sel:[0,0,1] op_sel_hi:[1,0,1] neg_lo:[0,0,1] neg_hi:[0,0,1]
v_pk_fma_f32 v[178:179], v[178:179], v[12:13], v[12:13] op_sel:[0,0,1] op_sel_hi:[1,0,1] neg_lo:[0,0,1] neg_hi:[0,0,1]
v_pk_fma_f32 v[180:181], v[180:181], v[12:13], v[12:13] op_sel:[0,0,1] op_sel_hi:[1,0,1] neg_lo:[0,0,1] neg_hi:[0,0,1]
v_pk_fma_f32 v[182:183], v[182:183], v[12:13], v[12:13] op_sel:[0,0,1] op_sel_hi:[1,0,1] neg_lo:[0,0,1] neg_hi:[0,0,1]
v_pk_fma_f32 v[184:185], v[184:185], v[12:13], v[12:13] op_sel:[0,0,1] op_sel_hi:[1,0,1] neg_lo:[0,0,1] neg_hi:[0,0,1]
v_pk_fma_f32 v[186:187], v[186:187], v[12:13], v[12:13] op_sel:[0,0,1] op_sel_hi:[1,0,1] neg_lo:[0,0,1] neg_hi:[0,0,1]
v_pk_fma_f32 v[188:189], v[188:189], v[12:13], v[12:13] op_sel:[0,0,1] op_sel_hi:[1,0,1] neg_lo:[0,0,1] neg_hi:[0,0,1]
v_pk_fma_f32 v[190:191], v[190:191], v[12:13], v[12:13] op_sel:[0,0,1] op_sel_hi:[1,0,1] neg_lo:[0,0,1] neg_hi:[0,0,1]
v_pk_fma_f32 v[192:193], v[192:193], v[12:13], v[12:13] op_sel:[0,0,1] op_sel_hi:[1,0,1] neg_lo:[0,0,1] neg_hi:[0,0,1]
v_pk_fma_f32 v[194:195], v[194:195], v[12:13], v[12:13] op_sel:[0,0,1] op_sel_hi:[1,0,1] neg_lo:[0,0,1] neg_hi:[0,0,1]
v_pk_fma_f32 v[196:197], v[196:197], v[12:13], v[12:13] op_sel:[0,0,1] op_sel_hi:[1,0,1] neg_lo:[0,0,1] neg_hi:[0,0,1]
v_pk_fma_f32 v[198:199], v[198:199], v[12:13], v[12:13] op_sel:[0,0,1] op_sel_hi:[1,0,1] neg_lo:[0,0,1] neg_hi:[0,0,1]
v_cvt_pk_bf16_f32 v128, v152, v153
v_cvt_pk_bf16_f32 v129, v154, v155
v_cvt_pk_bf16_f32 v130, v156, v157
v_cvt_pk_bf16_f32 v131, v158, v159
v_cvt_pk_bf16_f32 v132, v160, v161
v_cvt_pk_bf16_f32 v133, v162, v163
v_cvt_pk_bf16_f32 v134, v164, v165
v_cvt_pk_bf16_f32 v135, v166, v167
v_cvt_pk_bf16_f32 v136, v168, v169
v_cvt_pk_bf16_f32 v137, v170, v171
v_cvt_pk_bf16_f32 v138, v172, v173
v_cvt_pk_bf16_f32 v139, v174, v175
v_cvt_pk_bf16_f32 v140, v176, v177
v_cvt_pk_bf16_f32 v141, v178, v179
v_cvt_pk_bf16_f32 v142, v180, v181
v_cvt_pk_bf16_f32 v143, v182, v183
v_cvt_pk_bf16_f32 v144, v184, v185
v_cvt_pk_bf16_f32 v145, v186, v187
v_cvt_pk_bf16_f32 v146, v188, v189
v_cvt_pk_bf16_f32 v147, v190, v191
v_cvt_pk_bf16_f32 v148, v192, v193
v_cvt_pk_bf16_f32 v149, v194, v195
v_cvt_pk_bf16_f32 v150, v196, v197
v_cvt_pk_bf16_f32 v151, v198, v199
s_waitcnt lgkmcnt(0)
v_mfma_f32_32x32x16_bf16 v[16:31], v[128:131], a[0:3], 0
ds_read_b128 a[12:15], v1 offset:2560
v_mfma_f32_32x32x16_bf16 v[16:31], v[132:135], a[4:7], v[16:31]
ds_read_b128 a[16:19], v1 offset:4096
v_mfma_f32_32x32x16_bf16 v[16:31], v[136:139], a[8:11], v[16:31]
ds_read_b128 a[20:23], v1 offset:4608
s_waitcnt lgkmcnt(2)
v_mfma_f32_32x32x16_bf16 v[16:31], v[140:143], a[12:15], v[16:31]
ds_read_b128 a[24:27], v1 offset:6144
s_waitcnt lgkmcnt(2)
v_mfma_f32_32x32x16_bf16 v[16:31], v[144:147], a[16:19], v[16:31]
ds_read_b128 a[28:31], v1 offset:6656
s_waitcnt lgkmcnt(2)
v_mfma_f32_32x32x16_bf16 v[16:31], v[148:151], a[20:23], v[16:31]
ds_read_b128 a[32:35], v1 offset:8192
s_nop 10
v_pk_fma_f32 v[48:49], v[16:17], v[16:17], s[60:61] neg_lo:[1,0,0] neg_hi:[1,0,0]
v_pk_fma_f32 v[50:51], v[18:19], v[18:19], s[60:61] neg_lo:[1,0,0] neg_hi:[1,0,0]
v_pk_fma_f32 v[52:53], v[20:21], v[20:21], s[60:61] neg_lo:[1,0,0] neg_hi:[1,0,0]
v_pk_fma_f32 v[54:55], v[22:23], v[22:23], s[60:61] neg_lo:[1,0,0] neg_hi:[1,0,0]
v_pk_fma_f32 v[56:57], v[24:25], v[24:25], s[60:61] neg_lo:[1,0,0] neg_hi:[1,0,0]
v_pk_fma_f32 v[58:59], v[26:27], v[26:27], s[60:61] neg_lo:[1,0,0] neg_hi:[1,0,0]
v_pk_fma_f32 v[60:61], v[28:29], v[28:29], s[60:61] neg_lo:[1,0,0] neg_hi:[1,0,0]
v_pk_fma_f32 v[62:63], v[30:31], v[30:31], s[60:61] neg_lo:[1,0,0] neg_hi:[1,0,0]
v_pk_mul_f32 v[48:49], v[48:49], v[16:17]
v_pk_mul_f32 v[50:51], v[50:51], v[18:19]
v_pk_mul_f32 v[52:53], v[52:53], v[20:21]
v_pk_mul_f32 v[54:55], v[54:55], v[22:23]
v_pk_mul_f32 v[56:57], v[56:57], v[24:25]
v_pk_mul_f32 v[58:59], v[58:59], v[26:27]
v_pk_mul_f32 v[60:61], v[60:61], v[28:29]
v_pk_mul_f32 v[62:63], v[62:63], v[30:31]
L_pf0:
L_b1_0:
s_waitcnt lgkmcnt(0)
v_mfma_f32_32x32x16_bf16 v[32:47], v[128:131], a[24:27], 0
ds_read_b128 a[36:39], v1 offset:8704
ds_read_b128 v[64:67], v5 offset:0
v_exp_f32 v48, v48
v_exp_f32 v49, v49
v_exp_f32_e64 v50, v50
v_mfma_f32_32x32x16_bf16 v[32:47], v[132:135], a[28:31], v[32:47]
ds_read_b128 a[40:43], v1 offset:10240
ds_read_b128 v[68:71], v6 offset:0
v_exp_f32 v51, v51
v_exp_f32 v52, v52
v_mfma_f32_32x32x16_bf16 v[32:47], v[136:139], a[32:35], v[32:47]
ds_read_b128 a[44:47], v1 offset:10752
ds_read_b128 v[72:75], v5 offset:528
v_exp_f32 v53, v53
v_exp_f32 v54, v54
v_exp_f32 v55, v55
v_exp_f32 v56, v56
v_exp_f32 v57, v57
v_exp_f32 v58, v58
v_exp_f32 v59, v59
v_exp_f32 v60, v60
v_exp_f32 v61, v61
v_exp_f32 v62, v62
v_exp_f32_e64 v63, v63
v_pk_add_f32 v[48:49], v[48:49], 1.0 op_sel_hi:[1,0]
v_pk_add_f32 v[50:51], v[50:51], 1.0 op_sel_hi:[1,0]
v_pk_add_f32 v[52:53], v[52:53], 1.0 op_sel_hi:[1,0]
v_pk_add_f32 v[54:55], v[54:55], 1.0 op_sel_hi:[1,0]
v_pk_add_f32 v[56:57], v[56:57], 1.0 op_sel_hi:[1,0]
v_pk_add_f32 v[58:59], v[58:59], 1.0 op_sel_hi:[1,0]
v_pk_add_f32 v[60:61], v[60:61], 1.0 op_sel_hi:[1,0]
v_pk_add_f32 v[62:63], v[62:63], 1.0 op_sel_hi:[1,0]
s_waitcnt lgkmcnt(0)
v_mfma_f32_32x32x16_bf16 v[32:47], v[140:143], a[36:39], v[32:47]
ds_read_b128 a[48:51], v1 offset:12288
ds_read_b128 v[76:79], v6 offset:528
v_rcp_f32 v48, v48
v_rcp_f32 v49, v49
v_rcp_f32 v50, v50
v_mfma_f32_32x32x16_bf16 v[32:47], v[144:147], a[40:43], v[32:47]
ds_read_b128 a[52:55], v1 offset:12800
ds_read_b128 v[80:83], v5 offset:1056
v_rcp_f32 v51, v51
v_rcp_f32 v52, v52
v_mfma_f32_32x32x16_bf16 v[32:47], v[148:151], a[44:47], v[32:47]
ds_read_b128 a[56:59], v1 offset:14336
ds_read_b128 v[84:87], v6 offset:1056
v_rcp_f32 v53, v53
v_rcp_f32 v54, v54
v_rcp_f32 v55, v55
v_rcp_f32 v56, v56
v_rcp_f32 v57, v57
v_rcp_f32 v58, v58
v_rcp_f32 v59, v59
v_rcp_f32 v60, v60
v_rcp_f32 v61, v61
v_rcp_f32 v62, v62
v_rcp_f32_e64 v63, v63
v_pk_mul_f32 v[16:17], v[48:49], v[16:17]
v_pk_mul_f32 v[18:19], v[50:51], v[18:19]
v_pk_mul_f32 v[20:21], v[52:53], v[20:21]
v_pk_mul_f32 v[22:23], v[54:55], v[22:23]
v_pk_mul_f32 v[24:25], v[56:57], v[24:25]
v_pk_mul_f32 v[26:27], v[58:59], v[26:27]
v_pk_mul_f32 v[28:29], v[60:61], v[28:29]
v_pk_mul_f32 v[30:31], v[62:63], v[30:31]
v_pk_mul_f32 v[100:101], v[16:17], v[16:17]
v_pk_fma_f32 v[48:49], v[32:33], v[32:33], s[60:61] neg_lo:[1,0,0] neg_hi:[1,0,0]
v_pk_fma_f32 v[100:101], v[18:19], v[18:19], v[100:101]
v_pk_fma_f32 v[50:51], v[34:35], v[34:35], s[60:61] neg_lo:[1,0,0] neg_hi:[1,0,0]
v_pk_fma_f32 v[100:101], v[20:21], v[20:21], v[100:101]
v_pk_fma_f32 v[52:53], v[36:37], v[36:37], s[60:61] neg_lo:[1,0,0] neg_hi:[1,0,0]
v_pk_fma_f32 v[100:101], v[22:23], v[22:23], v[100:101]
v_pk_fma_f32 v[54:55], v[38:39], v[38:39], s[60:61] neg_lo:[1,0,0] neg_hi:[1,0,0]
v_pk_fma_f32 v[100:101], v[24:25], v[24:25], v[100:101]
v_pk_fma_f32 v[56:57], v[40:41], v[40:41], s[60:61] neg_lo:[1,0,0] neg_hi:[1,0,0]
v_pk_fma_f32 v[100:101], v[26:27], v[26:27], v[100:101]
v_pk_fma_f32 v[58:59], v[42:43], v[42:43], s[60:61] neg_lo:[1,0,0] neg_hi:[1,0,0]
v_pk_fma_f32 v[100:101], v[28:29], v[28:29], v[100:101]
v_pk_fma_f32 v[60:61], v[44:45], v[44:45], s[60:61] neg_lo:[1,0,0] neg_hi:[1,0,0]
v_pk_fma_f32 v[100:101], v[30:31], v[30:31], v[100:101]
v_pk_fma_f32 v[62:63], v[46:47], v[46:47], s[60:61] neg_lo:[1,0,0] neg_hi:[1,0,0]
v_pk_mul_f32 v[48:49], v[48:49], v[32:33]
v_pk_mul_f32 v[50:51], v[50:51], v[34:35]
v_pk_mul_f32 v[52:53], v[52:53], v[36:37]
v_pk_mul_f32 v[54:55], v[54:55], v[38:39]
v_pk_mul_f32 v[56:57], v[56:57], v[40:41]
v_pk_mul_f32 v[58:59], v[58:59], v[42:43]
v_pk_mul_f32 v[60:61], v[60:61], v[44:45]
v_pk_mul_f32 v[62:63], v[62:63], v[46:47]
s_waitcnt lgkmcnt(0)
v_mfma_f32_32x32x16_bf16 v[16:31], v[128:131], a[48:51], 0
ds_read_b128 a[60:63], v1 offset:14848
v_exp_f32 v48, v48
v_exp_f32 v49, v49
v_exp_f32 v50, v50
v_mfma_f32_32x32x16_bf16 v[16:31], v[132:135], a[52:55], v[16:31]
ds_read_b128 a[64:67], v1 offset:16384
v_exp_f32 v51, v51
v_exp_f32 v52, v52
v_exp_f32 v53, v53
v_mfma_f32_32x32x16_bf16 v[16:31], v[136:139], a[56:59], v[16:31]
ds_read_b128 a[68:71], v1 offset:16896
v_exp_f32 v54, v54
v_exp_f32 v55, v55
v_exp_f32 v56, v56
s_waitcnt vmcnt(6)
v_mfma_f32_32x32x16_bf16 v[152:167], v[64:67], v[200:203], 0
v_exp_f32 v57, v57
v_exp_f32 v58, v58
v_exp_f32 v59, v59
s_waitcnt vmcnt(5)
v_mfma_f32_32x32x16_bf16 v[152:167], v[68:71], v[204:207], v[152:167]
v_exp_f32 v60, v60
v_exp_f32 v61, v61
v_exp_f32 v62, v62
v_exp_f32_e64 v63, v63
v_pk_add_f32 v[48:49], v[48:49], 1.0 op_sel_hi:[1,0]
v_pk_add_f32 v[50:51], v[50:51], 1.0 op_sel_hi:[1,0]
v_pk_add_f32 v[52:53], v[52:53], 1.0 op_sel_hi:[1,0]
v_pk_add_f32 v[54:55], v[54:55], 1.0 op_sel_hi:[1,0]
v_pk_add_f32 v[56:57], v[56:57], 1.0 op_sel_hi:[1,0]
v_pk_add_f32 v[58:59], v[58:59], 1.0 op_sel_hi:[1,0]
v_pk_add_f32 v[60:61], v[60:61], 1.0 op_sel_hi:[1,0]
v_pk_add_f32 v[62:63], v[62:63], 1.0 op_sel_hi:[1,0]
s_waitcnt lgkmcnt(0)
v_mfma_f32_32x32x16_bf16 v[16:31], v[140:143], a[60:63], v[16:31]
ds_read_b128 a[72:75], v1 offset:18432
v_rcp_f32 v48, v48
v_rcp_f32 v49, v49
v_rcp_f32 v50, v50
v_mfma_f32_32x32x16_bf16 v[16:31], v[144:147], a[64:67], v[16:31]
ds_read_b128 a[76:79], v1 offset:18944
v_rcp_f32 v51, v51
v_rcp_f32 v52, v52
v_rcp_f32 v53, v53
v_mfma_f32_32x32x16_bf16 v[16:31], v[148:151], a[68:71], v[16:31]
ds_read_b128 a[80:83], v1 offset:20480
v_rcp_f32 v54, v54
v_rcp_f32 v55, v55
v_rcp_f32 v56, v56
s_waitcnt vmcnt(4)
v_mfma_f32_32x32x16_bf16 v[168:183], v[72:75], v[208:211], 0
v_rcp_f32 v57, v57
v_rcp_f32 v58, v58
v_rcp_f32 v59, v59
s_waitcnt vmcnt(3)
v_mfma_f32_32x32x16_bf16 v[168:183], v[76:79], v[212:215], v[168:183]
v_rcp_f32 v60, v60
v_rcp_f32 v61, v61
v_rcp_f32 v62, v62
v_rcp_f32_e64 v63, v63
v_pk_mul_f32 v[32:33], v[48:49], v[32:33]
v_pk_mul_f32 v[34:35], v[50:51], v[34:35]
v_pk_mul_f32 v[36:37], v[52:53], v[36:37]
v_pk_mul_f32 v[38:39], v[54:55], v[38:39]
v_pk_mul_f32 v[40:41], v[56:57], v[40:41]
v_pk_mul_f32 v[42:43], v[58:59], v[42:43]
v_pk_mul_f32 v[44:45], v[60:61], v[44:45]
v_pk_mul_f32 v[46:47], v[62:63], v[46:47]
v_pk_mul_f32 v[102:103], v[32:33], v[32:33]
v_pk_fma_f32 v[48:49], v[16:17], v[16:17], s[60:61] neg_lo:[1,0,0] neg_hi:[1,0,0]
v_pk_fma_f32 v[102:103], v[34:35], v[34:35], v[102:103]
v_pk_fma_f32 v[50:51], v[18:19], v[18:19], s[60:61] neg_lo:[1,0,0] neg_hi:[1,0,0]
v_pk_fma_f32 v[102:103], v[36:37], v[36:37], v[102:103]
v_pk_fma_f32 v[52:53], v[20:21], v[20:21], s[60:61] neg_lo:[1,0,0] neg_hi:[1,0,0]
v_pk_fma_f32 v[102:103], v[38:39], v[38:39], v[102:103]
v_pk_fma_f32 v[54:55], v[22:23], v[22:23], s[60:61] neg_lo:[1,0,0] neg_hi:[1,0,0]
v_pk_fma_f32 v[102:103], v[40:41], v[40:41], v[102:103]
v_pk_fma_f32 v[56:57], v[24:25], v[24:25], s[60:61] neg_lo:[1,0,0] neg_hi:[1,0,0]
v_pk_fma_f32 v[102:103], v[42:43], v[42:43], v[102:103]
v_pk_fma_f32 v[58:59], v[26:27], v[26:27], s[60:61] neg_lo:[1,0,0] neg_hi:[1,0,0]
v_pk_fma_f32 v[102:103], v[44:45], v[44:45], v[102:103]
v_pk_fma_f32 v[60:61], v[28:29], v[28:29], s[60:61] neg_lo:[1,0,0] neg_hi:[1,0,0]
v_pk_fma_f32 v[102:103], v[46:47], v[46:47], v[102:103]
v_pk_fma_f32 v[62:63], v[30:31], v[30:31], s[60:61] neg_lo:[1,0,0] neg_hi:[1,0,0]
v_pk_mul_f32 v[48:49], v[48:49], v[16:17]
v_pk_mul_f32 v[50:51], v[50:51], v[18:19]
v_pk_mul_f32 v[52:53], v[52:53], v[20:21]
v_pk_mul_f32 v[54:55], v[54:55], v[22:23]
v_pk_mul_f32 v[56:57], v[56:57], v[24:25]
v_pk_mul_f32 v[58:59], v[58:59], v[26:27]
v_pk_mul_f32 v[60:61], v[60:61], v[28:29]
v_pk_mul_f32 v[62:63], v[62:63], v[30:31]
s_waitcnt lgkmcnt(0)
v_mfma_f32_32x32x16_bf16 v[32:47], v[128:131], a[72:75], 0
ds_read_b128 a[84:87], v1 offset:20992
v_exp_f32 v48, v48
v_exp_f32 v49, v49
v_exp_f32 v50, v50
v_mfma_f32_32x32x16_bf16 v[32:47], v[132:135], a[76:79], v[32:47]
ds_read_b128 a[88:91], v1 offset:22528
v_exp_f32 v51, v51
v_exp_f32 v52, v52
v_exp_f32 v53, v53
v_mfma_f32_32x32x16_bf16 v[32:47], v[136:139], a[80:83], v[32:47]
ds_read_b128 a[92:95], v1 offset:23040
v_exp_f32 v54, v54
v_exp_f32 v55, v55
v_exp_f32 v56, v56
s_waitcnt vmcnt(2)
v_mfma_f32_32x32x16_bf16 v[184:199], v[80:83], v[216:219], 0
v_exp_f32 v57, v57
v_exp_f32 v58, v58
v_exp_f32 v59, v59
s_waitcnt vmcnt(1)
v_mfma_f32_32x32x16_bf16 v[184:199], v[84:87], v[220:223], v[184:199]
v_exp_f32 v60, v60
v_exp_f32 v61, v61
v_exp_f32 v62, v62
v_exp_f32_e64 v63, v63
v_pk_add_f32 v[48:49], v[48:49], 1.0 op_sel_hi:[1,0]
v_pk_add_f32 v[50:51], v[50:51], 1.0 op_sel_hi:[1,0]
v_pk_add_f32 v[52:53], v[52:53], 1.0 op_sel_hi:[1,0]
v_pk_add_f32 v[54:55], v[54:55], 1.0 op_sel_hi:[1,0]
v_pk_add_f32 v[56:57], v[56:57], 1.0 op_sel_hi:[1,0]
v_pk_add_f32 v[58:59], v[58:59], 1.0 op_sel_hi:[1,0]
v_pk_add_f32 v[60:61], v[60:61], 1.0 op_sel_hi:[1,0]
v_pk_add_f32 v[62:63], v[62:63], 1.0 op_sel_hi:[1,0]
s_waitcnt lgkmcnt(0)
v_mfma_f32_32x32x16_bf16 v[32:47], v[140:143], a[84:87], v[32:47]
ds_read_b128 a[96:99], v1 offset:24576
s_mov_b32 s64, 12582912
v_rcp_f32 v48, v48
v_rcp_f32 v49, v49
v_rcp_f32 v50, v50
v_mfma_f32_32x32x16_bf16 v[32:47], v[144:147], a[88:91], v[32:47]
ds_read_b128 a[100:103], v1 offset:25088
buffer_load_dwordx4 v[200:203], v2, s[24:27], s64 offen offset:0
v_rcp_f32 v51, v51
v_rcp_f32 v52, v52
v_mfma_f32_32x32x16_bf16 v[32:47], v[148:151], a[92:95], v[32:47]
ds_read_b128 a[104:107], v1 offset:26624
buffer_load_dwordx4 v[204:207], v2, s[24:27], s64 offen offset:16
v_rcp_f32 v53, v53
v_rcp_f32 v54, v54
v_rcp_f32 v55, v55
v_rcp_f32 v56, v56
v_rcp_f32 v57, v57
v_rcp_f32 v58, v58
v_rcp_f32 v59, v59
v_rcp_f32 v60, v60
v_rcp_f32 v61, v61
v_rcp_f32 v62, v62
v_rcp_f32_e64 v63, v63
v_pk_mul_f32 v[16:17], v[48:49], v[16:17]
v_pk_mul_f32 v[18:19], v[50:51], v[18:19]
v_pk_mul_f32 v[20:21], v[52:53], v[20:21]
v_pk_mul_f32 v[22:23], v[54:55], v[22:23]
v_pk_mul_f32 v[24:25], v[56:57], v[24:25]
v_pk_mul_f32 v[26:27], v[58:59], v[26:27]
v_pk_mul_f32 v[28:29], v[60:61], v[28:29]
v_pk_mul_f32 v[30:31], v[62:63], v[30:31]
v_pk_mul_f32 v[104:105], v[16:17], v[16:17]
v_pk_fma_f32 v[48:49], v[32:33], v[32:33], s[60:61] neg_lo:[1,0,0] neg_hi:[1,0,0]
v_pk_fma_f32 v[104:105], v[18:19], v[18:19], v[104:105]
v_pk_fma_f32 v[50:51], v[34:35], v[34:35], s[60:61] neg_lo:[1,0,0] neg_hi:[1,0,0]
v_pk_fma_f32 v[104:105], v[20:21], v[20:21], v[104:105]
v_pk_fma_f32 v[52:53], v[36:37], v[36:37], s[60:61] neg_lo:[1,0,0] neg_hi:[1,0,0]
v_pk_fma_f32 v[104:105], v[22:23], v[22:23], v[104:105]
v_pk_fma_f32 v[54:55], v[38:39], v[38:39], s[60:61] neg_lo:[1,0,0] neg_hi:[1,0,0]
v_pk_fma_f32 v[104:105], v[24:25], v[24:25], v[104:105]
v_pk_fma_f32 v[56:57], v[40:41], v[40:41], s[60:61] neg_lo:[1,0,0] neg_hi:[1,0,0]
v_pk_fma_f32 v[104:105], v[26:27], v[26:27], v[104:105]
v_pk_fma_f32 v[58:59], v[42:43], v[42:43], s[60:61] neg_lo:[1,0,0] neg_hi:[1,0,0]
v_pk_fma_f32 v[104:105], v[28:29], v[28:29], v[104:105]
v_pk_fma_f32 v[60:61], v[44:45], v[44:45], s[60:61] neg_lo:[1,0,0] neg_hi:[1,0,0]
v_pk_fma_f32 v[104:105], v[30:31], v[30:31], v[104:105]
v_pk_fma_f32 v[62:63], v[46:47], v[46:47], s[60:61] neg_lo:[1,0,0] neg_hi:[1,0,0]
v_pk_mul_f32 v[48:49], v[48:49], v[32:33]
v_pk_mul_f32 v[50:51], v[50:51], v[34:35]
v_pk_mul_f32 v[52:53], v[52:53], v[36:37]
v_pk_mul_f32 v[54:55], v[54:55], v[38:39]
v_pk_mul_f32 v[56:57], v[56:57], v[40:41]
v_pk_mul_f32 v[58:59], v[58:59], v[42:43]
v_pk_mul_f32 v[60:61], v[60:61], v[44:45]
v_pk_mul_f32 v[62:63], v[62:63], v[46:47]
v_pk_mul_f32 v[10:11], v[152:153], v[152:153]
v_pk_add_f32 v[8:9], v[152:153], v[154:155]
v_pk_fma_f32 v[10:11], v[154:155], v[154:155], v[10:11]
v_pk_add_f32 v[8:9], v[8:9], v[156:157]
v_pk_fma_f32 v[10:11], v[156:157], v[156:157], v[10:11]
v_pk_add_f32 v[8:9], v[8:9], v[158:159]
v_pk_fma_f32 v[10:11], v[158:159], v[158:159], v[10:11]
v_pk_add_f32 v[8:9], v[8:9], v[160:161]
v_pk_fma_f32 v[10:11], v[160:161], v[160:161], v[10:11]
v_pk_add_f32 v[8:9], v[8:9], v[162:163]
v_pk_fma_f32 v[10:11], v[162:163], v[162:163], v[10:11]
v_pk_add_f32 v[8:9], v[8:9], v[164:165]
v_pk_fma_f32 v[10:11], v[164:165], v[164:165], v[10:11]
v_pk_add_f32 v[8:9], v[8:9], v[166:167]
v_pk_fma_f32 v[10:11], v[166:167], v[166:167], v[10:11]
v_pk_add_f32 v[8:9], v[8:9], v[168:169]
v_pk_fma_f32 v[10:11], v[168:169], v[168:169], v[10:11]
v_pk_add_f32 v[8:9], v[8:9], v[170:171]
v_pk_fma_f32 v[10:11], v[170:171], v[170:171], v[10:11]
v_pk_add_f32 v[8:9], v[8:9], v[172:173]
v_pk_fma_f32 v[10:11], v[172:173], v[172:173], v[10:11]
v_pk_add_f32 v[8:9], v[8:9], v[174:175]
v_pk_fma_f32 v[10:11], v[174:175], v[174:175], v[10:11]
v_pk_add_f32 v[8:9], v[8:9], v[176:177]
v_pk_fma_f32 v[10:11], v[176:177], v[176:177], v[10:11]
v_pk_add_f32 v[8:9], v[8:9], v[178:179]
v_pk_fma_f32 v[10:11], v[178:179], v[178:179], v[10:11]
v_pk_add_f32 v[8:9], v[8:9], v[180:181]
v_pk_fma_f32 v[10:11], v[180:181], v[180:181], v[10:11]
v_pk_add_f32 v[8:9], v[8:9], v[182:183]
v_pk_fma_f32 v[10:11], v[182:183], v[182:183], v[10:11]
v_pk_add_f32 v[8:9], v[8:9], v[184:185]
v_pk_fma_f32 v[10:11], v[184:185], v[184:185], v[10:11]
v_pk_add_f32 v[8:9], v[8:9], v[186:187]
v_pk_fma_f32 v[10:11], v[186:187], v[186:187], v[10:11]
v_pk_add_f32 v[8:9], v[8:9], v[188:189]
v_pk_fma_f32 v[10:11], v[188:189], v[188:189], v[10:11]
v_pk_add_f32 v[8:9], v[8:9], v[190:191]
v_pk_fma_f32 v[10:11], v[190:191], v[190:191], v[10:11]
v_pk_add_f32 v[8:9], v[8:9], v[192:193]
v_pk_fma_f32 v[10:11], v[192:193], v[192:193], v[10:11]
v_pk_add_f32 v[8:9], v[8:9], v[194:195]
v_pk_fma_f32 v[10:11], v[194:195], v[194:195], v[10:11]
v_pk_add_f32 v[8:9], v[8:9], v[196:197]
v_pk_fma_f32 v[10:11], v[196:197], v[196:197], v[10:11]
v_pk_add_f32 v[8:9], v[8:9], v[198:199]
v_pk_fma_f32 v[10:11], v[198:199], v[198:199], v[10:11]
s_waitcnt lgkmcnt(0)
v_mfma_f32_32x32x16_bf16 v[16:31], v[128:131], a[96:99], 0
ds_read_b128 a[108:111], v1 offset:27136
buffer_load_dwordx4 v[208:211], v2, s[24:27], s64 offen offset:64
v_exp_f32 v48, v48
v_exp_f32 v49, v49
v_add_f32 v8, v8, v9
v_mfma_f32_32x32x16_bf16 v[16:31], v[132:135], a[100:103], v[16:31]
ds_read_b128 a[112:115], v1 offset:28672
buffer_load_dwordx4 v[212:215], v2, s[24:27], s64 offen offset:80
v_exp_f32 v50, v50
v_add_f32 v10, v10, v11
v_exp_f32 v51, v51
v_mfma_f32_32x32x16_bf16 v[16:31], v[136:139], a[104:107], v[16:31]
ds_read_b128 a[116:119], v1 offset:29184
v_permlane32_swap_b32 v8, v10
v_exp_f32 v52, v52
v_add_f32 v8, v8, v10
v_exp_f32 v53, v53
v_mov_b32 v10, v8
v_exp_f32 v54, v54
s_nop 0
v_permlane32_swap_b32 v8, v10
v_exp_f32 v55, v55
v_mul_f32 v13, 0x3c2aaaab, v8
v_exp_f32 v56, v56
v_exp_f32 v57, v57
v_mul_f32 v10, 0x3c2aaaab, v10
v_exp_f32 v58, v58
v_fma_f32 v10, -v13, v13, v10
v_exp_f32 v59, v59
v_max_f32 v10, 0, v10
v_exp_f32 v60, v60
v_add_f32 v10, 0x3727c5ac, v10
v_exp_f32 v61, v61
v_rsq_f32 v12, v10
v_exp_f32 v62, v62
v_mul_f32 v12, 0x3eeff558, v12
v_exp_f32 v63, v63
v_mul_f32_e64 v13, v13, v12
v_pk_add_f32 v[48:49], v[48:49], 1.0 op_sel_hi:[1,0]
v_pk_add_f32 v[50:51], v[50:51], 1.0 op_sel_hi:[1,0]
v_pk_add_f32 v[52:53], v[52:53], 1.0 op_sel_hi:[1,0]
v_pk_add_f32 v[54:55], v[54:55], 1.0 op_sel_hi:[1,0]
v_pk_add_f32 v[56:57], v[56:57], 1.0 op_sel_hi:[1,0]
v_pk_add_f32 v[58:59], v[58:59], 1.0 op_sel_hi:[1,0]
v_pk_add_f32 v[60:61], v[60:61], 1.0 op_sel_hi:[1,0]
v_pk_add_f32 v[62:63], v[62:63], 1.0 op_sel_hi:[1,0]
s_waitcnt lgkmcnt(0)
v_mfma_f32_32x32x16_bf16 v[16:31], v[140:143], a[108:111], v[16:31]
ds_read_b128 a[120:123], v1 offset:30720
buffer_load_dwordx4 v[216:219], v2, s[24:27], s64 offen offset:128
v_rcp_f32 v48, v48
v_rcp_f32 v49, v49
v_rcp_f32 v50, v50
v_mfma_f32_32x32x16_bf16 v[16:31], v[144:147], a[112:115], v[16:31]
ds_read_b128 a[124:127], v1 offset:31232
buffer_load_dwordx4 v[220:223], v2, s[24:27], s64 offen offset:144
v_rcp_f32 v51, v51
v_rcp_f32 v52, v52
v_mfma_f32_32x32x16_bf16 v[16:31], v[148:151], a[116:119], v[16:31]
ds_read_b128 a[128:131], v1 offset:32768
v_rcp_f32 v53, v53
v_rcp_f32 v54, v54
v_rcp_f32 v55, v55
v_rcp_f32 v56, v56
v_rcp_f32 v57, v57
v_rcp_f32 v58, v58
v_rcp_f32 v59, v59
v_rcp_f32 v60, v60
v_rcp_f32 v61, v61
v_rcp_f32 v62, v62
v_rcp_f32_e64 v63, v63
v_pk_mul_f32 v[32:33], v[48:49], v[32:33]
v_pk_mul_f32 v[34:35], v[50:51], v[34:35]
v_pk_mul_f32 v[36:37], v[52:53], v[36:37]
v_pk_mul_f32 v[38:39], v[54:55], v[38:39]
v_pk_mul_f32 v[40:41], v[56:57], v[40:41]
v_pk_mul_f32 v[42:43], v[58:59], v[42:43]
v_pk_mul_f32 v[44:45], v[60:61], v[44:45]
v_pk_mul_f32 v[46:47], v[62:63], v[46:47]
v_pk_mul_f32 v[106:107], v[32:33], v[32:33]
v_pk_fma_f32 v[48:49], v[16:17], v[16:17], s[60:61] neg_lo:[1,0,0] neg_hi:[1,0,0]
v_pk_fma_f32 v[106:107], v[34:35], v[34:35], v[106:107]
v_pk_fma_f32 v[50:51], v[18:19], v[18:19], s[60:61] neg_lo:[1,0,0] neg_hi:[1,0,0]
v_pk_fma_f32 v[106:107], v[36:37], v[36:37], v[106:107]
v_pk_fma_f32 v[52:53], v[20:21], v[20:21], s[60:61] neg_lo:[1,0,0] neg_hi:[1,0,0]
v_pk_fma_f32 v[106:107], v[38:39], v[38:39], v[106:107]
v_pk_fma_f32 v[54:55], v[22:23], v[22:23], s[60:61] neg_lo:[1,0,0] neg_hi:[1,0,0]
v_pk_fma_f32 v[106:107], v[40:41], v[40:41], v[106:107]
v_pk_fma_f32 v[56:57], v[24:25], v[24:25], s[60:61] neg_lo:[1,0,0] neg_hi:[1,0,0]
v_pk_fma_f32 v[106:107], v[42:43], v[42:43], v[106:107]
v_pk_fma_f32 v[58:59], v[26:27], v[26:27], s[60:61] neg_lo:[1,0,0] neg_hi:[1,0,0]
v_pk_fma_f32 v[106:107], v[44:45], v[44:45], v[106:107]
v_pk_fma_f32 v[60:61], v[28:29], v[28:29], s[60:61] neg_lo:[1,0,0] neg_hi:[1,0,0]
v_pk_fma_f32 v[106:107], v[46:47], v[46:47], v[106:107]
v_pk_fma_f32 v[62:63], v[30:31], v[30:31], s[60:61] neg_lo:[1,0,0] neg_hi:[1,0,0]
v_pk_mul_f32 v[48:49], v[48:49], v[16:17]
v_pk_mul_f32 v[50:51], v[50:51], v[18:19]
v_pk_mul_f32 v[52:53], v[52:53], v[20:21]
v_pk_mul_f32 v[54:55], v[54:55], v[22:23]
v_pk_mul_f32 v[56:57], v[56:57], v[24:25]
v_pk_mul_f32 v[58:59], v[58:59], v[26:27]
v_pk_mul_f32 v[60:61], v[60:61], v[28:29]
v_pk_mul_f32 v[62:63], v[62:63], v[30:31]
v_pk_fma_f32 v[152:153], v[152:153], v[12:13], v[12:13] op_sel:[0,0,1] op_sel_hi:[1,0,1] neg_lo:[0,0,1] neg_hi:[0,0,1]
v_pk_fma_f32 v[154:155], v[154:155], v[12:13], v[12:13] op_sel:[0,0,1] op_sel_hi:[1,0,1] neg_lo:[0,0,1] neg_hi:[0,0,1]
v_pk_fma_f32 v[156:157], v[156:157], v[12:13], v[12:13] op_sel:[0,0,1] op_sel_hi:[1,0,1] neg_lo:[0,0,1] neg_hi:[0,0,1]
v_pk_fma_f32 v[158:159], v[158:159], v[12:13], v[12:13] op_sel:[0,0,1] op_sel_hi:[1,0,1] neg_lo:[0,0,1] neg_hi:[0,0,1]
v_pk_fma_f32 v[160:161], v[160:161], v[12:13], v[12:13] op_sel:[0,0,1] op_sel_hi:[1,0,1] neg_lo:[0,0,1] neg_hi:[0,0,1]
v_pk_fma_f32 v[162:163], v[162:163], v[12:13], v[12:13] op_sel:[0,0,1] op_sel_hi:[1,0,1] neg_lo:[0,0,1] neg_hi:[0,0,1]
v_pk_fma_f32 v[164:165], v[164:165], v[12:13], v[12:13] op_sel:[0,0,1] op_sel_hi:[1,0,1] neg_lo:[0,0,1] neg_hi:[0,0,1]
v_pk_fma_f32 v[166:167], v[166:167], v[12:13], v[12:13] op_sel:[0,0,1] op_sel_hi:[1,0,1] neg_lo:[0,0,1] neg_hi:[0,0,1]
v_pk_fma_f32 v[168:169], v[168:169], v[12:13], v[12:13] op_sel:[0,0,1] op_sel_hi:[1,0,1] neg_lo:[0,0,1] neg_hi:[0,0,1]
v_pk_fma_f32 v[170:171], v[170:171], v[12:13], v[12:13] op_sel:[0,0,1] op_sel_hi:[1,0,1] neg_lo:[0,0,1] neg_hi:[0,0,1]
v_pk_fma_f32 v[172:173], v[172:173], v[12:13], v[12:13] op_sel:[0,0,1] op_sel_hi:[1,0,1] neg_lo:[0,0,1] neg_hi:[0,0,1]
v_pk_fma_f32 v[174:175], v[174:175], v[12:13], v[12:13] op_sel:[0,0,1] op_sel_hi:[1,0,1] neg_lo:[0,0,1] neg_hi:[0,0,1]
v_pk_fma_f32 v[176:177], v[176:177], v[12:13], v[12:13] op_sel:[0,0,1] op_sel_hi:[1,0,1] neg_lo:[0,0,1] neg_hi:[0,0,1]
v_pk_fma_f32 v[178:179], v[178:179], v[12:13], v[12:13] op_sel:[0,0,1] op_sel_hi:[1,0,1] neg_lo:[0,0,1] neg_hi:[0,0,1]
v_pk_fma_f32 v[180:181], v[180:181], v[12:13], v[12:13] op_sel:[0,0,1] op_sel_hi:[1,0,1] neg_lo:[0,0,1] neg_hi:[0,0,1]
v_pk_fma_f32 v[182:183], v[182:183], v[12:13], v[12:13] op_sel:[0,0,1] op_sel_hi:[1,0,1] neg_lo:[0,0,1] neg_hi:[0,0,1]
v_pk_fma_f32 v[184:185], v[184:185], v[12:13], v[12:13] op_sel:[0,0,1] op_sel_hi:[1,0,1] neg_lo:[0,0,1] neg_hi:[0,0,1]
v_pk_fma_f32 v[186:187], v[186:187], v[12:13], v[12:13] op_sel:[0,0,1] op_sel_hi:[1,0,1] neg_lo:[0,0,1] neg_hi:[0,0,1]
v_pk_fma_f32 v[188:189], v[188:189], v[12:13], v[12:13] op_sel:[0,0,1] op_sel_hi:[1,0,1] neg_lo:[0,0,1] neg_hi:[0,0,1]
v_pk_fma_f32 v[190:191], v[190:191], v[12:13], v[12:13] op_sel:[0,0,1] op_sel_hi:[1,0,1] neg_lo:[0,0,1] neg_hi:[0,0,1]
v_pk_fma_f32 v[192:193], v[192:193], v[12:13], v[12:13] op_sel:[0,0,1] op_sel_hi:[1,0,1] neg_lo:[0,0,1] neg_hi:[0,0,1]
v_pk_fma_f32 v[194:195], v[194:195], v[12:13], v[12:13] op_sel:[0,0,1] op_sel_hi:[1,0,1] neg_lo:[0,0,1] neg_hi:[0,0,1]
v_pk_fma_f32 v[196:197], v[196:197], v[12:13], v[12:13] op_sel:[0,0,1] op_sel_hi:[1,0,1] neg_lo:[0,0,1] neg_hi:[0,0,1]
v_pk_fma_f32 v[198:199], v[198:199], v[12:13], v[12:13] op_sel:[0,0,1] op_sel_hi:[1,0,1] neg_lo:[0,0,1] neg_hi:[0,0,1]
s_waitcnt lgkmcnt(0)
v_mfma_f32_32x32x16_bf16 v[32:47], v[128:131], a[120:123], 0
ds_read_b128 a[132:135], v1 offset:33280
v_exp_f32 v48, v48
v_exp_f32 v49, v49
v_lshrrev_b32 v14, 1, v0
v_exp_f32_e64 v50, v50
v_mfma_f32_32x32x16_bf16 v[32:47], v[132:135], a[124:127], v[32:47]
ds_read_b128 a[136:139], v1 offset:34816
v_and_b32 v14, 248, v14
v_exp_f32 v51, v51
v_cvt_pk_bf16_f32 v64, v152, v153
v_exp_f32 v52, v52
v_mfma_f32_32x32x16_bf16 v[32:47], v[136:139], a[128:131], v[32:47]
ds_read_b128 a[140:143], v1 offset:35328
v_cvt_pk_bf16_f32 v65, v154, v155
v_exp_f32 v53, v53
v_cvt_pk_bf16_f32 v66, v156, v157
v_exp_f32 v54, v54
v_cvt_pk_bf16_f32 v67, v158, v159
v_exp_f32 v55, v55
v_cvt_pk_bf16_f32 v68, v160, v161
v_exp_f32 v56, v56
v_exp_f32 v57, v57
v_cvt_pk_bf16_f32 v69, v162, v163
v_exp_f32 v58, v58
v_cvt_pk_bf16_f32 v70, v164, v165
v_exp_f32 v59, v59
v_cvt_pk_bf16_f32 v71, v166, v167
v_exp_f32 v60, v60
v_cvt_pk_bf16_f32 v72, v168, v169
v_exp_f32 v61, v61
v_cvt_pk_bf16_f32 v73, v170, v171
v_exp_f32 v62, v62
v_cvt_pk_bf16_f32 v74, v172, v173
v_exp_f32_e64 v63, v63
v_cvt_pk_bf16_f32 v75, v174, v175
v_pk_add_f32 v[48:49], v[48:49], 1.0 op_sel_hi:[1,0]
v_pk_add_f32 v[50:51], v[50:51], 1.0 op_sel_hi:[1,0]
v_pk_add_f32 v[52:53], v[52:53], 1.0 op_sel_hi:[1,0]
v_pk_add_f32 v[54:55], v[54:55], 1.0 op_sel_hi:[1,0]
v_pk_add_f32 v[56:57], v[56:57], 1.0 op_sel_hi:[1,0]
v_pk_add_f32 v[58:59], v[58:59], 1.0 op_sel_hi:[1,0]
v_pk_add_f32 v[60:61], v[60:61], 1.0 op_sel_hi:[1,0]
v_pk_add_f32 v[62:63], v[62:63], 1.0 op_sel_hi:[1,0]
s_waitcnt lgkmcnt(0)
v_mfma_f32_32x32x16_bf16 v[32:47], v[140:143], a[132:135], v[32:47]
ds_read_b128 a[144:147], v1 offset:36864
buffer_store_dwordx2 v[12:13], v14, s[40:43], s79 offen offset:256
v_rcp_f32 v48, v48
v_rcp_f32_e64 v49, v49
v_cvt_pk_bf16_f32 v76, v176, v177
v_mfma_f32_32x32x16_bf16 v[32:47], v[144:147], a[136:139], v[32:47]
ds_read_b128 a[148:151], v1 offset:37376
v_rcp_f32 v50, v50
v_cvt_pk_bf16_f32 v77, v178, v179
v_rcp_f32 v51, v51
v_cvt_pk_bf16_f32 v78, v180, v181
v_mfma_f32_32x32x16_bf16 v[32:47], v[148:151], a[140:143], v[32:47]
ds_read_b128 a[152:155], v1 offset:38912
v_rcp_f32 v52, v52
v_rcp_f32 v53, v53
v_cvt_pk_bf16_f32 v79, v182, v183
v_rcp_f32 v54, v54
v_cvt_pk_bf16_f32 v80, v184, v185
v_rcp_f32 v55, v55
v_cvt_pk_bf16_f32 v81, v186, v187
v_rcp_f32 v56, v56
v_rcp_f32 v57, v57
v_cvt_pk_bf16_f32 v82, v188, v189
v_rcp_f32 v58, v58
v_cvt_pk_bf16_f32 v83, v190, v191
v_rcp_f32 v59, v59
v_cvt_pk_bf16_f32 v84, v192, v193
v_rcp_f32 v60, v60
v_rcp_f32 v61, v61
v_cvt_pk_bf16_f32 v85, v194, v195
v_rcp_f32 v62, v62
v_cvt_pk_bf16_f32 v86, v196, v197
v_rcp_f32 v63, v63
v_cvt_pk_bf16_f32 v87, v198, v199
v_pk_mul_f32 v[16:17], v[48:49], v[16:17]
v_pk_mul_f32 v[18:19], v[50:51], v[18:19]
v_pk_mul_f32 v[20:21], v[52:53], v[20:21]
v_pk_mul_f32 v[22:23], v[54:55], v[22:23]
v_pk_mul_f32 v[24:25], v[56:57], v[24:25]
v_pk_mul_f32 v[26:27], v[58:59], v[26:27]
v_pk_mul_f32 v[28:29], v[60:61], v[28:29]
v_pk_mul_f32 v[30:31], v[62:63], v[30:31]
v_pk_mul_f32 v[108:109], v[16:17], v[16:17]
v_pk_fma_f32 v[48:49], v[32:33], v[32:33], s[60:61] neg_lo:[1,0,0] neg_hi:[1,0,0]
v_pk_fma_f32 v[108:109], v[18:19], v[18:19], v[108:109]
v_pk_fma_f32 v[50:51], v[34:35], v[34:35], s[60:61] neg_lo:[1,0,0] neg_hi:[1,0,0]
v_pk_fma_f32 v[108:109], v[20:21], v[20:21], v[108:109]
v_pk_fma_f32 v[52:53], v[36:37], v[36:37], s[60:61] neg_lo:[1,0,0] neg_hi:[1,0,0]
v_pk_fma_f32 v[108:109], v[22:23], v[22:23], v[108:109]
v_pk_fma_f32 v[54:55], v[38:39], v[38:39], s[60:61] neg_lo:[1,0,0] neg_hi:[1,0,0]
v_pk_fma_f32 v[108:109], v[24:25], v[24:25], v[108:109]
v_pk_fma_f32 v[56:57], v[40:41], v[40:41], s[60:61] neg_lo:[1,0,0] neg_hi:[1,0,0]
v_pk_fma_f32 v[108:109], v[26:27], v[26:27], v[108:109]
v_pk_fma_f32 v[58:59], v[42:43], v[42:43], s[60:61] neg_lo:[1,0,0] neg_hi:[1,0,0]
v_pk_fma_f32 v[108:109], v[28:29], v[28:29], v[108:109]
v_pk_fma_f32 v[60:61], v[44:45], v[44:45], s[60:61] neg_lo:[1,0,0] neg_hi:[1,0,0]
v_pk_fma_f32 v[108:109], v[30:31], v[30:31], v[108:109]
v_pk_fma_f32 v[62:63], v[46:47], v[46:47], s[60:61] neg_lo:[1,0,0] neg_hi:[1,0,0]
v_pk_mul_f32 v[48:49], v[48:49], v[32:33]
v_pk_mul_f32 v[50:51], v[50:51], v[34:35]
v_pk_mul_f32 v[52:53], v[52:53], v[36:37]
v_pk_mul_f32 v[54:55], v[54:55], v[38:39]
v_pk_mul_f32 v[56:57], v[56:57], v[40:41]
v_pk_mul_f32 v[58:59], v[58:59], v[42:43]
v_pk_mul_f32 v[60:61], v[60:61], v[44:45]
v_pk_mul_f32 v[62:63], v[62:63], v[46:47]
s_waitcnt lgkmcnt(0)
v_mfma_f32_32x32x16_bf16 v[16:31], v[128:131], a[144:147], 0
ds_read_b128 a[156:159], v1 offset:39424
v_exp_f32 v48, v48
v_mov_b32 v228, -1
v_exp_f32 v49, v49
v_mov_b32 v229, -1
v_mfma_f32_32x32x16_bf16 v[16:31], v[132:135], a[148:151], v[16:31]
ds_read_b128 a[160:163], v1 offset:40960
v_mov_b32 v230, -1
v_exp_f32 v50, v50
v_mov_b32 v231, -1
v_exp_f32 v51, v51
v_mfma_f32_32x32x16_bf16 v[16:31], v[136:139], a[152:155], v[16:31]
ds_read_b128 a[164:167], v1 offset:41472
s_cmp_eq_u32 s66, 0
s_cselect_b32 s69, 0, 1073741824
v_exp_f32 v52, v52
v_lshl_add_u32 v232, v0, 8, s69
v_lshrrev_b32 v227, 9, v0
v_exp_f32 v53, v53
v_lshl_add_u32 v233, v227, 30, v232
v_exp_f32 v54, v54
v_add_u32 v233, 262144, v233
s_cmp_lt_u32 s2, 96
v_exp_f32 v55, v55
s_cselect_b32 s70, 64, 0
v_lshlrev_b32 v234, 7, v0
v_exp_f32 v56, v56
s_lshl_b32 s71, s2, 4
v_exp_f32 v57, v57
s_add_u32 s71, s71, s69
v_add_u32 v234, s71, v234
v_exp_f32 v58, v58
v_mov_b32 v235, 1073741824
v_exp_f32 v59, v59
v_cmp_gt_u32 vcc, s70, v0
s_nop 1
v_cndmask_b32 v234, v235, v234, vcc
v_exp_f32 v60, v60
v_mov_b32 v124, 0
v_cmp_eq_u32 vcc, 0, v0
v_exp_f32 v61, v61
s_nop 0
v_cndmask_b32 v124, v235, v124, vcc
v_exp_f32 v62, v62
v_add_u32 v124, s69, v124
v_mov_b32 v127, 1
v_exp_f32_e64 v63, v63
s_lshl_b32 s72, s2, 4
s_mov_b32 s73, 393216
v_pk_add_f32 v[48:49], v[48:49], 1.0 op_sel_hi:[1,0]
v_pk_add_f32 v[50:51], v[50:51], 1.0 op_sel_hi:[1,0]
v_pk_add_f32 v[52:53], v[52:53], 1.0 op_sel_hi:[1,0]
v_pk_add_f32 v[54:55], v[54:55], 1.0 op_sel_hi:[1,0]
v_pk_add_f32 v[56:57], v[56:57], 1.0 op_sel_hi:[1,0]
v_pk_add_f32 v[58:59], v[58:59], 1.0 op_sel_hi:[1,0]
v_pk_add_f32 v[60:61], v[60:61], 1.0 op_sel_hi:[1,0]
v_pk_add_f32 v[62:63], v[62:63], 1.0 op_sel_hi:[1,0]
s_waitcnt lgkmcnt(0)
v_mfma_f32_32x32x16_bf16 v[16:31], v[140:143], a[156:159], v[16:31]
ds_read_b128 a[168:171], v1 offset:43008
buffer_store_dwordx4 v[228:231], v232, s[40:43], s72 offen sc1
v_rcp_f32 v48, v48
v_rcp_f32 v49, v49
v_rcp_f32_e64 v50, v50
v_mfma_f32_32x32x16_bf16 v[16:31], v[144:147], a[160:163], v[16:31]
ds_read_b128 a[172:175], v1 offset:43520
buffer_store_dwordx4 v[228:231], v233, s[40:43], s72 offen sc1
v_rcp_f32 v51, v51
v_rcp_f32 v52, v52
v_mfma_f32_32x32x16_bf16 v[16:31], v[148:151], a[164:167], v[16:31]
ds_read_b128 a[176:179], v1 offset:45056
buffer_store_dwordx4 v[228:231], v234, s[40:43], s73 offen sc1
v_rcp_f32 v53, v53
v_rcp_f32 v54, v54
v_rcp_f32 v55, v55
v_rcp_f32 v56, v56
v_rcp_f32 v57, v57
v_rcp_f32 v58, v58
v_rcp_f32 v59, v59
v_rcp_f32 v60, v60
v_rcp_f32 v61, v61
v_rcp_f32 v62, v62
v_rcp_f32_e64 v63, v63
v_pk_mul_f32 v[32:33], v[48:49], v[32:33]
v_pk_mul_f32 v[34:35], v[50:51], v[34:35]
v_pk_mul_f32 v[36:37], v[52:53], v[36:37]
v_pk_mul_f32 v[38:39], v[54:55], v[38:39]
v_pk_mul_f32 v[40:41], v[56:57], v[40:41]
v_pk_mul_f32 v[42:43], v[58:59], v[42:43]
v_pk_mul_f32 v[44:45], v[60:61], v[44:45]
v_pk_mul_f32 v[46:47], v[62:63], v[46:47]
v_pk_mul_f32 v[110:111], v[32:33], v[32:33]
v_pk_fma_f32 v[48:49], v[16:17], v[16:17], s[60:61] neg_lo:[1,0,0] neg_hi:[1,0,0]
v_pk_fma_f32 v[110:111], v[34:35], v[34:35], v[110:111]
v_pk_fma_f32 v[50:51], v[18:19], v[18:19], s[60:61] neg_lo:[1,0,0] neg_hi:[1,0,0]
v_pk_fma_f32 v[110:111], v[36:37], v[36:37], v[110:111]
v_pk_fma_f32 v[52:53], v[20:21], v[20:21], s[60:61] neg_lo:[1,0,0] neg_hi:[1,0,0]
v_pk_fma_f32 v[110:111], v[38:39], v[38:39], v[110:111]
v_pk_fma_f32 v[54:55], v[22:23], v[22:23], s[60:61] neg_lo:[1,0,0] neg_hi:[1,0,0]
v_pk_fma_f32 v[110:111], v[40:41], v[40:41], v[110:111]
v_pk_fma_f32 v[56:57], v[24:25], v[24:25], s[60:61] neg_lo:[1,0,0] neg_hi:[1,0,0]
v_pk_fma_f32 v[110:111], v[42:43], v[42:43], v[110:111]
v_pk_fma_f32 v[58:59], v[26:27], v[26:27], s[60:61] neg_lo:[1,0,0] neg_hi:[1,0,0]
v_pk_fma_f32 v[110:111], v[44:45], v[44:45], v[110:111]
v_pk_fma_f32 v[60:61], v[28:29], v[28:29], s[60:61] neg_lo:[1,0,0] neg_hi:[1,0,0]
v_pk_fma_f32 v[110:111], v[46:47], v[46:47], v[110:111]
v_pk_fma_f32 v[62:63], v[30:31], v[30:31], s[60:61] neg_lo:[1,0,0] neg_hi:[1,0,0]
v_pk_mul_f32 v[48:49], v[48:49], v[16:17]
v_pk_mul_f32 v[50:51], v[50:51], v[18:19]
v_pk_mul_f32 v[52:53], v[52:53], v[20:21]
v_pk_mul_f32 v[54:55], v[54:55], v[22:23]
v_pk_mul_f32 v[56:57], v[56:57], v[24:25]
v_pk_mul_f32 v[58:59], v[58:59], v[26:27]
v_pk_mul_f32 v[60:61], v[60:61], v[28:29]
v_pk_mul_f32 v[62:63], v[62:63], v[30:31]
s_waitcnt lgkmcnt(0)
v_mfma_f32_32x32x16_bf16 v[32:47], v[128:131], a[168:171], 0
ds_read_b128 a[180:183], v1 offset:45568
v_exp_f32 v48, v48
v_exp_f32 v49, v49
v_exp_f32 v50, v50
v_mfma_f32_32x32x16_bf16 v[32:47], v[132:135], a[172:175], v[32:47]
ds_read_b128 a[184:187], v1 offset:47104
s_add_u32 s74, s87, L_b1_1-L_pc
v_exp_f32 v51, v51
v_exp_f32 v52, v52
v_exp_f32_e64 v53, v53
v_mfma_f32_32x32x16_bf16 v[32:47], v[136:139], a[176:179], v[32:47]
ds_read_b128 a[188:191], v1 offset:47616
v_lshl_add_u32 v14, v0, 3, s74
v_exp_f32 v54, v54
v_exp_f32 v55, v55
v_min_u32 v14, L_pf1-L_pc-4, v14
v_exp_f32 v56, v56
v_exp_f32 v57, v57
v_exp_f32 v58, v58
v_mov_b32 v15, s89
v_exp_f32 v59, v59
v_exp_f32 v60, v60
v_exp_f32 v61, v61
v_add_co_u32 v14, vcc, s88, v14
v_exp_f32 v62, v62
v_exp_f32 v63, v63
v_addc_co_u32_e64 v15, vcc, 0, v15, vcc
v_pk_add_f32 v[48:49], v[48:49], 1.0 op_sel_hi:[1,0]
v_pk_add_f32 v[50:51], v[50:51], 1.0 op_sel_hi:[1,0]
v_pk_add_f32 v[52:53], v[52:53], 1.0 op_sel_hi:[1,0]
v_pk_add_f32 v[54:55], v[54:55], 1.0 op_sel_hi:[1,0]
v_pk_add_f32 v[56:57], v[56:57], 1.0 op_sel_hi:[1,0]
v_pk_add_f32 v[58:59], v[58:59], 1.0 op_sel_hi:[1,0]
v_pk_add_f32 v[60:61], v[60:61], 1.0 op_sel_hi:[1,0]
v_pk_add_f32 v[62:63], v[62:63], 1.0 op_sel_hi:[1,0]
s_waitcnt lgkmcnt(0)
v_mfma_f32_32x32x16_bf16 v[32:47], v[140:143], a[180:183], v[32:47]
ds_read_b128 a[192:195], v1 offset:49152
global_load_dword v126, v[14:15], off
v_rcp_f32 v48, v48
v_rcp_f32 v49, v49
v_rcp_f32 v50, v50
v_mfma_f32_32x32x16_bf16 v[32:47], v[144:147], a[184:187], v[32:47]
ds_read_b128 a[196:199], v1 offset:49664
v_rcp_f32 v51, v51
v_rcp_f32 v52, v52
v_rcp_f32 v53, v53
v_mfma_f32_32x32x16_bf16 v[32:47], v[148:151], a[188:191], v[32:47]
ds_read_b128 a[200:203], v1 offset:51200
v_rcp_f32 v54, v54
v_rcp_f32 v55, v55
v_rcp_f32 v56, v56
v_rcp_f32 v57, v57
v_rcp_f32 v58, v58
v_rcp_f32 v59, v59
v_rcp_f32 v60, v60
v_rcp_f32 v61, v61
v_rcp_f32 v62, v62
v_rcp_f32_e64 v63, v63
v_pk_mul_f32 v[16:17], v[48:49], v[16:17]
v_pk_mul_f32 v[18:19], v[50:51], v[18:19]
v_pk_mul_f32 v[20:21], v[52:53], v[20:21]
v_pk_mul_f32 v[22:23], v[54:55], v[22:23]
v_pk_mul_f32 v[24:25], v[56:57], v[24:25]
v_pk_mul_f32 v[26:27], v[58:59], v[26:27]
v_pk_mul_f32 v[28:29], v[60:61], v[28:29]
v_pk_mul_f32 v[30:31], v[62:63], v[30:31]
v_pk_mul_f32 v[112:113], v[16:17], v[16:17]
v_pk_fma_f32 v[48:49], v[32:33], v[32:33], s[60:61] neg_lo:[1,0,0] neg_hi:[1,0,0]
v_pk_fma_f32 v[112:113], v[18:19], v[18:19], v[112:113]
v_pk_fma_f32 v[50:51], v[34:35], v[34:35], s[60:61] neg_lo:[1,0,0] neg_hi:[1,0,0]
v_pk_fma_f32 v[112:113], v[20:21], v[20:21], v[112:113]
v_pk_fma_f32 v[52:53], v[36:37], v[36:37], s[60:61] neg_lo:[1,0,0] neg_hi:[1,0,0]
v_pk_fma_f32 v[112:113], v[22:23], v[22:23], v[112:113]
v_pk_fma_f32 v[54:55], v[38:39], v[38:39], s[60:61] neg_lo:[1,0,0] neg_hi:[1,0,0]
v_pk_fma_f32 v[112:113], v[24:25], v[24:25], v[112:113]
v_pk_fma_f32 v[56:57], v[40:41], v[40:41], s[60:61] neg_lo:[1,0,0] neg_hi:[1,0,0]
v_pk_fma_f32 v[112:113], v[26:27], v[26:27], v[112:113]
v_pk_fma_f32 v[58:59], v[42:43], v[42:43], s[60:61] neg_lo:[1,0,0] neg_hi:[1,0,0]
v_pk_fma_f32 v[112:113], v[28:29], v[28:29], v[112:113]
v_pk_fma_f32 v[60:61], v[44:45], v[44:45], s[60:61] neg_lo:[1,0,0] neg_hi:[1,0,0]
v_pk_fma_f32 v[112:113], v[30:31], v[30:31], v[112:113]
v_pk_fma_f32 v[62:63], v[46:47], v[46:47], s[60:61] neg_lo:[1,0,0] neg_hi:[1,0,0]
v_pk_mul_f32 v[48:49], v[48:49], v[32:33]
v_pk_mul_f32 v[50:51], v[50:51], v[34:35]
v_pk_mul_f32 v[52:53], v[52:53], v[36:37]
v_pk_mul_f32 v[54:55], v[54:55], v[38:39]
v_pk_mul_f32 v[56:57], v[56:57], v[40:41]
v_pk_mul_f32 v[58:59], v[58:59], v[42:43]
v_pk_mul_f32 v[60:61], v[60:61], v[44:45]
v_pk_mul_f32 v[62:63], v[62:63], v[46:47]
s_waitcnt lgkmcnt(0)
v_mfma_f32_32x32x16_bf16 v[16:31], v[128:131], a[192:195], 0
ds_read_b128 a[204:207], v1 offset:51712
v_exp_f32 v48, v48
v_exp_f32 v49, v49
v_exp_f32 v50, v50
v_mfma_f32_32x32x16_bf16 v[16:31], v[132:135], a[196:199], v[16:31]
ds_read_b128 a[208:211], v1 offset:53248
v_exp_f32 v51, v51
v_exp_f32 v52, v52
v_exp_f32 v53, v53
v_mfma_f32_32x32x16_bf16 v[16:31], v[136:139], a[200:203], v[16:31]
ds_read_b128 a[212:215], v1 offset:53760
v_exp_f32 v54, v54
v_exp_f32 v55, v55
v_exp_f32 v56, v56
v_exp_f32 v57, v57
v_exp_f32 v58, v58
v_exp_f32 v59, v59
v_exp_f32 v60, v60
v_exp_f32 v61, v61
v_exp_f32 v62, v62
v_exp_f32_e64 v63, v63
v_pk_add_f32 v[48:49], v[48:49], 1.0 op_sel_hi:[1,0]
v_pk_add_f32 v[50:51], v[50:51], 1.0 op_sel_hi:[1,0]
v_pk_add_f32 v[52:53], v[52:53], 1.0 op_sel_hi:[1,0]
v_pk_add_f32 v[54:55], v[54:55], 1.0 op_sel_hi:[1,0]
v_pk_add_f32 v[56:57], v[56:57], 1.0 op_sel_hi:[1,0]
v_pk_add_f32 v[58:59], v[58:59], 1.0 op_sel_hi:[1,0]
v_pk_add_f32 v[60:61], v[60:61], 1.0 op_sel_hi:[1,0]
v_pk_add_f32 v[62:63], v[62:63], 1.0 op_sel_hi:[1,0]
s_waitcnt lgkmcnt(0)
v_mfma_f32_32x32x16_bf16 v[16:31], v[140:143], a[204:207], v[16:31]
ds_read_b128 a[216:219], v1 offset:55296
v_rcp_f32 v48, v48
v_rcp_f32 v49, v49
v_rcp_f32 v50, v50
v_mfma_f32_32x32x16_bf16 v[16:31], v[144:147], a[208:211], v[16:31]
ds_read_b128 a[220:223], v1 offset:55808
v_rcp_f32 v51, v51
v_rcp_f32 v52, v52
v_rcp_f32 v53, v53
v_mfma_f32_32x32x16_bf16 v[16:31], v[148:151], a[212:215], v[16:31]
ds_read_b128 a[224:227], v1 offset:57344
v_rcp_f32 v54, v54
v_rcp_f32 v55, v55
v_rcp_f32 v56, v56
v_rcp_f32 v57, v57
v_rcp_f32 v58, v58
v_rcp_f32 v59, v59
v_rcp_f32 v60, v60
v_rcp_f32 v61, v61
v_rcp_f32 v62, v62
v_rcp_f32_e64 v63, v63
v_pk_mul_f32 v[32:33], v[48:49], v[32:33]
v_pk_mul_f32 v[34:35], v[50:51], v[34:35]
v_pk_mul_f32 v[36:37], v[52:53], v[36:37]
v_pk_mul_f32 v[38:39], v[54:55], v[38:39]
v_pk_mul_f32 v[40:41], v[56:57], v[40:41]
v_pk_mul_f32 v[42:43], v[58:59], v[42:43]
v_pk_mul_f32 v[44:45], v[60:61], v[44:45]
v_pk_mul_f32 v[46:47], v[62:63], v[46:47]
v_pk_mul_f32 v[114:115], v[32:33], v[32:33]
v_pk_fma_f32 v[48:49], v[16:17], v[16:17], s[60:61] neg_lo:[1,0,0] neg_hi:[1,0,0]
v_pk_fma_f32 v[114:115], v[34:35], v[34:35], v[114:115]
v_pk_fma_f32 v[50:51], v[18:19], v[18:19], s[60:61] neg_lo:[1,0,0] neg_hi:[1,0,0]
v_pk_fma_f32 v[114:115], v[36:37], v[36:37], v[114:115]
v_pk_fma_f32 v[52:53], v[20:21], v[20:21], s[60:61] neg_lo:[1,0,0] neg_hi:[1,0,0]
v_pk_fma_f32 v[114:115], v[38:39], v[38:39], v[114:115]
v_pk_fma_f32 v[54:55], v[22:23], v[22:23], s[60:61] neg_lo:[1,0,0] neg_hi:[1,0,0]
v_pk_fma_f32 v[114:115], v[40:41], v[40:41], v[114:115]
v_pk_fma_f32 v[56:57], v[24:25], v[24:25], s[60:61] neg_lo:[1,0,0] neg_hi:[1,0,0]
v_pk_fma_f32 v[114:115], v[42:43], v[42:43], v[114:115]
v_pk_fma_f32 v[58:59], v[26:27], v[26:27], s[60:61] neg_lo:[1,0,0] neg_hi:[1,0,0]
v_pk_fma_f32 v[114:115], v[44:45], v[44:45], v[114:115]
v_pk_fma_f32 v[60:61], v[28:29], v[28:29], s[60:61] neg_lo:[1,0,0] neg_hi:[1,0,0]
v_pk_fma_f32 v[114:115], v[46:47], v[46:47], v[114:115]
v_pk_fma_f32 v[62:63], v[30:31], v[30:31], s[60:61] neg_lo:[1,0,0] neg_hi:[1,0,0]
v_pk_mul_f32 v[48:49], v[48:49], v[16:17]
v_pk_mul_f32 v[50:51], v[50:51], v[18:19]
v_pk_mul_f32 v[52:53], v[52:53], v[20:21]
v_pk_mul_f32 v[54:55], v[54:55], v[22:23]
v_pk_mul_f32 v[56:57], v[56:57], v[24:25]
v_pk_mul_f32 v[58:59], v[58:59], v[26:27]
v_pk_mul_f32 v[60:61], v[60:61], v[28:29]
v_pk_mul_f32 v[62:63], v[62:63], v[30:31]
s_waitcnt lgkmcnt(0)
v_mfma_f32_32x32x16_bf16 v[32:47], v[128:131], a[216:219], 0
ds_read_b128 a[228:231], v1 offset:57856
v_exp_f32 v48, v48
v_exp_f32 v49, v49
v_exp_f32 v50, v50
v_mfma_f32_32x32x16_bf16 v[32:47], v[132:135], a[220:223], v[32:47]
ds_read_b128 a[232:235], v1 offset:59392
v_exp_f32 v51, v51
v_exp_f32 v52, v52
v_exp_f32 v53, v53
v_mfma_f32_32x32x16_bf16 v[32:47], v[136:139], a[224:227], v[32:47]
ds_read_b128 a[236:239], v1 offset:59904
v_exp_f32 v54, v54
v_exp_f32 v55, v55
v_exp_f32 v56, v56
v_exp_f32 v57, v57
v_exp_f32 v58, v58
v_exp_f32 v59, v59
v_exp_f32 v60, v60
v_exp_f32 v61, v61
v_exp_f32 v62, v62
v_exp_f32_e64 v63, v63
v_pk_add_f32 v[48:49], v[48:49], 1.0 op_sel_hi:[1,0]
v_pk_add_f32 v[50:51], v[50:51], 1.0 op_sel_hi:[1,0]
v_pk_add_f32 v[52:53], v[52:53], 1.0 op_sel_hi:[1,0]
v_pk_add_f32 v[54:55], v[54:55], 1.0 op_sel_hi:[1,0]
v_pk_add_f32 v[56:57], v[56:57], 1.0 op_sel_hi:[1,0]
v_pk_add_f32 v[58:59], v[58:59], 1.0 op_sel_hi:[1,0]
v_pk_add_f32 v[60:61], v[60:61], 1.0 op_sel_hi:[1,0]
v_pk_add_f32 v[62:63], v[62:63], 1.0 op_sel_hi:[1,0]
s_waitcnt lgkmcnt(0)
v_mfma_f32_32x32x16_bf16 v[32:47], v[140:143], a[228:231], v[32:47]
ds_read_b128 a[240:243], v1 offset:61440
v_rcp_f32 v48, v48
v_rcp_f32 v49, v49
v_rcp_f32 v50, v50
v_mfma_f32_32x32x16_bf16 v[32:47], v[144:147], a[232:235], v[32:47]
ds_read_b128 a[244:247], v1 offset:61952
v_rcp_f32 v51, v51
v_rcp_f32 v52, v52
v_rcp_f32 v53, v53
v_mfma_f32_32x32x16_bf16 v[32:47], v[148:151], a[236:239], v[32:47]
ds_read_b128 a[248:251], v1 offset:63488
v_rcp_f32 v54, v54
v_rcp_f32 v55, v55
v_rcp_f32 v56, v56
v_rcp_f32 v57, v57
v_rcp_f32 v58, v58
v_rcp_f32 v59, v59
v_rcp_f32 v60, v60
v_rcp_f32 v61, v61
v_rcp_f32 v62, v62
v_rcp_f32_e64 v63, v63
v_pk_mul_f32 v[16:17], v[48:49], v[16:17]
v_pk_mul_f32 v[18:19], v[50:51], v[18:19]
v_pk_mul_f32 v[20:21], v[52:53], v[20:21]
v_pk_mul_f32 v[22:23], v[54:55], v[22:23]
v_pk_mul_f32 v[24:25], v[56:57], v[24:25]
v_pk_mul_f32 v[26:27], v[58:59], v[26:27]
v_pk_mul_f32 v[28:29], v[60:61], v[28:29]
v_pk_mul_f32 v[30:31], v[62:63], v[30:31]
v_pk_mul_f32 v[116:117], v[16:17], v[16:17]
v_pk_fma_f32 v[48:49], v[32:33], v[32:33], s[60:61] neg_lo:[1,0,0] neg_hi:[1,0,0]
v_pk_fma_f32 v[116:117], v[18:19], v[18:19], v[116:117]
v_pk_fma_f32 v[50:51], v[34:35], v[34:35], s[60:61] neg_lo:[1,0,0] neg_hi:[1,0,0]
v_pk_fma_f32 v[116:117], v[20:21], v[20:21], v[116:117]
v_pk_fma_f32 v[52:53], v[36:37], v[36:37], s[60:61] neg_lo:[1,0,0] neg_hi:[1,0,0]
v_pk_fma_f32 v[116:117], v[22:23], v[22:23], v[116:117]
v_pk_fma_f32 v[54:55], v[38:39], v[38:39], s[60:61] neg_lo:[1,0,0] neg_hi:[1,0,0]
v_pk_fma_f32 v[116:117], v[24:25], v[24:25], v[116:117]
v_pk_fma_f32 v[56:57], v[40:41], v[40:41], s[60:61] neg_lo:[1,0,0] neg_hi:[1,0,0]
v_pk_fma_f32 v[116:117], v[26:27], v[26:27], v[116:117]
v_pk_fma_f32 v[58:59], v[42:43], v[42:43], s[60:61] neg_lo:[1,0,0] neg_hi:[1,0,0]
v_pk_fma_f32 v[116:117], v[28:29], v[28:29], v[116:117]
v_pk_fma_f32 v[60:61], v[44:45], v[44:45], s[60:61] neg_lo:[1,0,0] neg_hi:[1,0,0]
v_pk_fma_f32 v[116:117], v[30:31], v[30:31], v[116:117]
v_pk_fma_f32 v[62:63], v[46:47], v[46:47], s[60:61] neg_lo:[1,0,0] neg_hi:[1,0,0]
v_pk_mul_f32 v[48:49], v[48:49], v[32:33]
v_pk_mul_f32 v[50:51], v[50:51], v[34:35]
v_pk_mul_f32 v[52:53], v[52:53], v[36:37]
v_pk_mul_f32 v[54:55], v[54:55], v[38:39]
v_pk_mul_f32 v[56:57], v[56:57], v[40:41]
v_pk_mul_f32 v[58:59], v[58:59], v[42:43]
v_pk_mul_f32 v[60:61], v[60:61], v[44:45]
v_pk_mul_f32 v[62:63], v[62:63], v[46:47]
s_waitcnt lgkmcnt(0)
v_mfma_f32_32x32x16_bf16 v[16:31], v[128:131], a[240:243], 0
ds_read_b128 a[252:255], v1 offset:64000
v_exp_f32 v48, v48
v_exp_f32 v49, v49
v_exp_f32 v50, v50
v_mfma_f32_32x32x16_bf16 v[16:31], v[132:135], a[244:247], v[16:31]
ds_read_b128 v[224:227], v7 offset:0
v_exp_f32 v51, v51
v_exp_f32 v52, v52
v_exp_f32 v53, v53
v_mfma_f32_32x32x16_bf16 v[16:31], v[136:139], a[248:251], v[16:31]
ds_read_b128 v[228:231], v7 offset:512
v_exp_f32 v54, v54
v_exp_f32 v55, v55
v_exp_f32 v56, v56
v_exp_f32 v57, v57
v_exp_f32 v58, v58
v_exp_f32 v59, v59
v_exp_f32 v60, v60
v_exp_f32 v61, v61
v_exp_f32 v62, v62
v_exp_f32_e64 v63, v63
v_pk_add_f32 v[48:49], v[48:49], 1.0 op_sel_hi:[1,0]
v_pk_add_f32 v[50:51], v[50:51], 1.0 op_sel_hi:[1,0]
v_pk_add_f32 v[52:53], v[52:53], 1.0 op_sel_hi:[1,0]
v_pk_add_f32 v[54:55], v[54:55], 1.0 op_sel_hi:[1,0]
v_pk_add_f32 v[56:57], v[56:57], 1.0 op_sel_hi:[1,0]
v_pk_add_f32 v[58:59], v[58:59], 1.0 op_sel_hi:[1,0]
v_pk_add_f32 v[60:61], v[60:61], 1.0 op_sel_hi:[1,0]
v_pk_add_f32 v[62:63], v[62:63], 1.0 op_sel_hi:[1,0]
s_waitcnt lgkmcnt(0)
v_mfma_f32_32x32x16_bf16 v[16:31], v[140:143], a[252:255], v[16:31]
ds_read_b128 v[232:235], v7 offset:2048
v_rcp_f32 v48, v48
v_rcp_f32 v49, v49
v_rcp_f32 v50, v50
v_mfma_f32_32x32x16_bf16 v[16:31], v[144:147], v[224:227], v[16:31]
ds_read_b128 v[236:239], v7 offset:2560
v_rcp_f32 v51, v51
v_rcp_f32 v52, v52
v_rcp_f32 v53, v53
v_mfma_f32_32x32x16_bf16 v[16:31], v[148:151], v[228:231], v[16:31]
ds_read_b128 v[240:243], v7 offset:4096
v_rcp_f32 v54, v54
v_rcp_f32 v55, v55
v_rcp_f32 v56, v56
v_rcp_f32 v57, v57
v_rcp_f32 v58, v58
v_rcp_f32 v59, v59
v_rcp_f32 v60, v60
v_rcp_f32 v61, v61
v_rcp_f32 v62, v62
v_rcp_f32_e64 v63, v63
v_pk_mul_f32 v[32:33], v[48:49], v[32:33]
v_pk_mul_f32 v[34:35], v[50:51], v[34:35]
v_pk_mul_f32 v[36:37], v[52:53], v[36:37]
v_pk_mul_f32 v[38:39], v[54:55], v[38:39]
v_pk_mul_f32 v[40:41], v[56:57], v[40:41]
v_pk_mul_f32 v[42:43], v[58:59], v[42:43]
v_pk_mul_f32 v[44:45], v[60:61], v[44:45]
v_pk_mul_f32 v[46:47], v[62:63], v[46:47]
v_pk_mul_f32 v[118:119], v[32:33], v[32:33]
v_pk_fma_f32 v[48:49], v[16:17], v[16:17], s[60:61] neg_lo:[1,0,0] neg_hi:[1,0,0]
v_pk_fma_f32 v[118:119], v[34:35], v[34:35], v[118:119]
v_pk_fma_f32 v[50:51], v[18:19], v[18:19], s[60:61] neg_lo:[1,0,0] neg_hi:[1,0,0]
v_pk_fma_f32 v[118:119], v[36:37], v[36:37], v[118:119]
v_pk_fma_f32 v[52:53], v[20:21], v[20:21], s[60:61] neg_lo:[1,0,0] neg_hi:[1,0,0]
v_pk_fma_f32 v[118:119], v[38:39], v[38:39], v[118:119]
v_pk_fma_f32 v[54:55], v[22:23], v[22:23], s[60:61] neg_lo:[1,0,0] neg_hi:[1,0,0]
v_pk_fma_f32 v[118:119], v[40:41], v[40:41], v[118:119]
v_pk_fma_f32 v[56:57], v[24:25], v[24:25], s[60:61] neg_lo:[1,0,0] neg_hi:[1,0,0]
v_pk_fma_f32 v[118:119], v[42:43], v[42:43], v[118:119]
v_pk_fma_f32 v[58:59], v[26:27], v[26:27], s[60:61] neg_lo:[1,0,0] neg_hi:[1,0,0]
v_pk_fma_f32 v[118:119], v[44:45], v[44:45], v[118:119]
v_pk_fma_f32 v[60:61], v[28:29], v[28:29], s[60:61] neg_lo:[1,0,0] neg_hi:[1,0,0]
v_pk_fma_f32 v[118:119], v[46:47], v[46:47], v[118:119]
v_pk_fma_f32 v[62:63], v[30:31], v[30:31], s[60:61] neg_lo:[1,0,0] neg_hi:[1,0,0]
v_pk_mul_f32 v[48:49], v[48:49], v[16:17]
v_pk_mul_f32 v[50:51], v[50:51], v[18:19]
v_pk_mul_f32 v[52:53], v[52:53], v[20:21]
v_pk_mul_f32 v[54:55], v[54:55], v[22:23]
v_pk_mul_f32 v[56:57], v[56:57], v[24:25]
v_pk_mul_f32 v[58:59], v[58:59], v[26:27]
v_pk_mul_f32 v[60:61], v[60:61], v[28:29]
v_pk_mul_f32 v[62:63], v[62:63], v[30:31]
s_waitcnt lgkmcnt(0)
v_mfma_f32_32x32x16_bf16 v[32:47], v[128:131], v[232:235], 0
ds_read_b128 v[244:247], v7 offset:4608
v_exp_f32 v48, v48
v_exp_f32 v49, v49
v_exp_f32 v50, v50
v_mfma_f32_32x32x16_bf16 v[32:47], v[132:135], v[236:239], v[32:47]
ds_read_b128 v[248:251], v7 offset:6144
v_exp_f32 v51, v51
v_exp_f32 v52, v52
v_exp_f32 v53, v53
v_mfma_f32_32x32x16_bf16 v[32:47], v[136:139], v[240:243], v[32:47]
ds_read_b128 v[252:255], v7 offset:6656
v_exp_f32 v54, v54
v_exp_f32 v55, v55
v_exp_f32 v56, v56
v_exp_f32 v57, v57
v_exp_f32 v58, v58
v_exp_f32 v59, v59
v_exp_f32 v60, v60
v_exp_f32 v61, v61
v_exp_f32 v62, v62
v_exp_f32_e64 v63, v63
v_pk_add_f32 v[48:49], v[48:49], 1.0 op_sel_hi:[1,0]
v_pk_add_f32 v[50:51], v[50:51], 1.0 op_sel_hi:[1,0]
v_pk_add_f32 v[52:53], v[52:53], 1.0 op_sel_hi:[1,0]
v_pk_add_f32 v[54:55], v[54:55], 1.0 op_sel_hi:[1,0]
v_pk_add_f32 v[56:57], v[56:57], 1.0 op_sel_hi:[1,0]
v_pk_add_f32 v[58:59], v[58:59], 1.0 op_sel_hi:[1,0]
v_pk_add_f32 v[60:61], v[60:61], 1.0 op_sel_hi:[1,0]
v_pk_add_f32 v[62:63], v[62:63], 1.0 op_sel_hi:[1,0]
s_waitcnt lgkmcnt(0)
v_mfma_f32_32x32x16_bf16 v[32:47], v[140:143], v[244:247], v[32:47]
s_waitcnt vmcnt(1)
buffer_atomic_add v127, v124, s[44:47], 0 offen sc1
v_rcp_f32 v48, v48
v_rcp_f32 v49, v49
v_rcp_f32 v50, v50
v_mfma_f32_32x32x16_bf16 v[32:47], v[144:147], v[248:251], v[32:47]
v_rcp_f32 v51, v51
v_rcp_f32 v52, v52
v_rcp_f32 v53, v53
v_mfma_f32_32x32x16_bf16 v[32:47], v[148:151], v[252:255], v[32:47]
v_rcp_f32 v54, v54
v_rcp_f32 v55, v55
v_rcp_f32 v56, v56
v_rcp_f32 v57, v57
v_rcp_f32 v58, v58
v_rcp_f32 v59, v59
v_rcp_f32 v60, v60
v_rcp_f32 v61, v61
v_rcp_f32 v62, v62
v_rcp_f32 v63, v63
v_pk_mul_f32 v[16:17], v[48:49], v[16:17]
v_pk_mul_f32 v[18:19], v[50:51], v[18:19]
v_pk_mul_f32 v[20:21], v[52:53], v[20:21]
v_pk_mul_f32 v[22:23], v[54:55], v[22:23]
v_pk_mul_f32 v[24:25], v[56:57], v[24:25]
v_pk_mul_f32 v[26:27], v[58:59], v[26:27]
v_pk_mul_f32 v[28:29], v[60:61], v[28:29]
v_pk_mul_f32 v[30:31], v[62:63], v[30:31]
v_pk_mul_f32 v[120:121], v[16:17], v[16:17]
v_pk_fma_f32 v[48:49], v[32:33], v[32:33], s[60:61] neg_lo:[1,0,0] neg_hi:[1,0,0]
v_pk_fma_f32 v[120:121], v[18:19], v[18:19], v[120:121]
v_pk_fma_f32 v[50:51], v[34:35], v[34:35], s[60:61] neg_lo:[1,0,0] neg_hi:[1,0,0]
v_pk_fma_f32 v[120:121], v[20:21], v[20:21], v[120:121]
v_pk_fma_f32 v[52:53], v[36:37], v[36:37], s[60:61] neg_lo:[1,0,0] neg_hi:[1,0,0]
v_pk_fma_f32 v[120:121], v[22:23], v[22:23], v[120:121]
v_pk_fma_f32 v[54:55], v[38:39], v[38:39], s[60:61] neg_lo:[1,0,0] neg_hi:[1,0,0]
v_pk_fma_f32 v[120:121], v[24:25], v[24:25], v[120:121]
v_pk_fma_f32 v[56:57], v[40:41], v[40:41], s[60:61] neg_lo:[1,0,0] neg_hi:[1,0,0]
v_pk_fma_f32 v[120:121], v[26:27], v[26:27], v[120:121]
v_pk_fma_f32 v[58:59], v[42:43], v[42:43], s[60:61] neg_lo:[1,0,0] neg_hi:[1,0,0]
v_pk_fma_f32 v[120:121], v[28:29], v[28:29], v[120:121]
v_pk_fma_f32 v[60:61], v[44:45], v[44:45], s[60:61] neg_lo:[1,0,0] neg_hi:[1,0,0]
v_pk_fma_f32 v[120:121], v[30:31], v[30:31], v[120:121]
v_pk_fma_f32 v[62:63], v[46:47], v[46:47], s[60:61] neg_lo:[1,0,0] neg_hi:[1,0,0]
v_pk_mul_f32 v[48:49], v[48:49], v[32:33]
v_pk_mul_f32 v[50:51], v[50:51], v[34:35]
v_pk_mul_f32 v[52:53], v[52:53], v[36:37]
v_pk_mul_f32 v[54:55], v[54:55], v[38:39]
v_pk_mul_f32 v[56:57], v[56:57], v[40:41]
v_pk_mul_f32 v[58:59], v[58:59], v[42:43]
v_pk_mul_f32 v[60:61], v[60:61], v[44:45]
v_pk_mul_f32 v[62:63], v[62:63], v[46:47]
v_mfma_f32_32x32x16_bf16 v[16:31], v[64:67], a[0:3], 0
ds_read_b128 v[128:131], v5 offset:0
v_exp_f32 v48, v48
v_exp_f32 v49, v49
v_exp_f32 v50, v50
v_mfma_f32_32x32x16_bf16 v[16:31], v[68:71], a[4:7], v[16:31]
ds_read_b128 v[132:135], v6 offset:0
v_exp_f32 v51, v51
v_exp_f32 v52, v52
v_exp_f32 v53, v53
v_mfma_f32_32x32x16_bf16 v[16:31], v[72:75], a[8:11], v[16:31]
ds_read_b128 v[136:139], v5 offset:528
v_exp_f32 v54, v54
v_exp_f32 v55, v55
v_exp_f32 v56, v56
v_exp_f32 v57, v57
v_exp_f32 v58, v58
v_exp_f32 v59, v59
v_exp_f32 v60, v60
v_exp_f32 v61, v61
v_exp_f32 v62, v62
v_exp_f32 v63, v63
v_pk_add_f32 v[48:49], v[48:49], 1.0 op_sel_hi:[1,0]
v_pk_add_f32 v[50:51], v[50:51], 1.0 op_sel_hi:[1,0]
v_pk_add_f32 v[52:53], v[52:53], 1.0 op_sel_hi:[1,0]
v_pk_add_f32 v[54:55], v[54:55], 1.0 op_sel_hi:[1,0]
v_pk_add_f32 v[56:57], v[56:57], 1.0 op_sel_hi:[1,0]
v_pk_add_f32 v[58:59], v[58:59], 1.0 op_sel_hi:[1,0]
v_pk_add_f32 v[60:61], v[60:61], 1.0 op_sel_hi:[1,0]
v_pk_add_f32 v[62:63], v[62:63], 1.0 op_sel_hi:[1,0]
v_mfma_f32_32x32x16_bf16 v[16:31], v[76:79], a[12:15], v[16:31]
ds_read_b128 v[140:143], v6 offset:528
v_rcp_f32 v48, v48
v_rcp_f32 v49, v49
v_rcp_f32 v50, v50
v_mfma_f32_32x32x16_bf16 v[16:31], v[80:83], a[16:19], v[16:31]
ds_read_b128 v[144:147], v5 offset:1056
v_rcp_f32 v51, v51
v_rcp_f32 v52, v52
v_rcp_f32 v53, v53
v_mfma_f32_32x32x16_bf16 v[16:31], v[84:87], a[20:23], v[16:31]
ds_read_b128 v[148:151], v6 offset:1056
v_rcp_f32 v54, v54
v_rcp_f32 v55, v55
v_rcp_f32 v56, v56
v_rcp_f32 v57, v57
v_rcp_f32 v58, v58
v_rcp_f32 v59, v59
v_rcp_f32 v60, v60
v_rcp_f32 v61, v61
v_rcp_f32 v62, v62
v_rcp_f32 v63, v63
v_pk_mul_f32 v[32:33], v[48:49], v[32:33]
v_pk_mul_f32 v[34:35], v[50:51], v[34:35]
v_pk_mul_f32 v[36:37], v[52:53], v[36:37]
v_pk_mul_f32 v[38:39], v[54:55], v[38:39]
v_pk_mul_f32 v[40:41], v[56:57], v[40:41]
v_pk_mul_f32 v[42:43], v[58:59], v[42:43]
v_pk_mul_f32 v[44:45], v[60:61], v[44:45]
v_pk_mul_f32 v[46:47], v[62:63], v[46:47]
v_pk_mul_f32 v[122:123], v[32:33], v[32:33]
v_pk_fma_f32 v[48:49], v[16:17], v[16:17], s[60:61] neg_lo:[1,0,0] neg_hi:[1,0,0]
v_pk_fma_f32 v[122:123], v[34:35], v[34:35], v[122:123]
v_pk_fma_f32 v[50:51], v[18:19], v[18:19], s[60:61] neg_lo:[1,0,0] neg_hi:[1,0,0]
v_pk_fma_f32 v[122:123], v[36:37], v[36:37], v[122:123]
v_pk_fma_f32 v[52:53], v[20:21], v[20:21], s[60:61] neg_lo:[1,0,0] neg_hi:[1,0,0]
v_pk_fma_f32 v[122:123], v[38:39], v[38:39], v[122:123]
v_pk_fma_f32 v[54:55], v[22:23], v[22:23], s[60:61] neg_lo:[1,0,0] neg_hi:[1,0,0]
v_pk_fma_f32 v[122:123], v[40:41], v[40:41], v[122:123]
v_pk_fma_f32 v[56:57], v[24:25], v[24:25], s[60:61] neg_lo:[1,0,0] neg_hi:[1,0,0]
v_pk_fma_f32 v[122:123], v[42:43], v[42:43], v[122:123]
v_pk_fma_f32 v[58:59], v[26:27], v[26:27], s[60:61] neg_lo:[1,0,0] neg_hi:[1,0,0]
v_pk_fma_f32 v[122:123], v[44:45], v[44:45], v[122:123]
v_pk_fma_f32 v[60:61], v[28:29], v[28:29], s[60:61] neg_lo:[1,0,0] neg_hi:[1,0,0]
v_pk_fma_f32 v[122:123], v[46:47], v[46:47], v[122:123]
v_pk_fma_f32 v[62:63], v[30:31], v[30:31], s[60:61] neg_lo:[1,0,0] neg_hi:[1,0,0]
v_pk_mul_f32 v[48:49], v[48:49], v[16:17]
v_pk_mul_f32 v[50:51], v[50:51], v[18:19]
v_pk_mul_f32 v[52:53], v[52:53], v[20:21]
v_pk_mul_f32 v[54:55], v[54:55], v[22:23]
v_pk_mul_f32 v[56:57], v[56:57], v[24:25]
v_pk_mul_f32 v[58:59], v[58:59], v[26:27]
v_pk_mul_f32 v[60:61], v[60:61], v[28:29]
v_pk_mul_f32 v[62:63], v[62:63], v[30:31]
L_b1_1:
v_mfma_f32_32x32x16_bf16 v[32:47], v[64:67], a[24:27], 0
v_exp_f32 v48, v48
v_exp_f32 v49, v49
v_exp_f32 v50, v50
v_mfma_f32_32x32x16_bf16 v[32:47], v[68:71], a[28:31], v[32:47]
v_exp_f32 v51, v51
v_exp_f32 v52, v52
v_exp_f32 v53, v53
v_mfma_f32_32x32x16_bf16 v[32:47], v[72:75], a[32:35], v[32:47]
v_exp_f32 v54, v54
v_exp_f32 v55, v55
v_exp_f32 v56, v56
s_waitcnt lgkmcnt(0)
v_mfma_f32_32x32x16_bf16 v[152:167], v[128:131], v[200:203], 0
v_exp_f32 v57, v57
v_exp_f32 v58, v58
v_exp_f32 v59, v59
v_mfma_f32_32x32x16_bf16 v[152:167], v[132:135], v[204:207], v[152:167]
v_exp_f32 v60, v60
v_exp_f32 v61, v61
v_exp_f32 v62, v62
v_exp_f32_e64 v63, v63
v_pk_add_f32 v[48:49], v[48:49], 1.0 op_sel_hi:[1,0]
v_pk_add_f32 v[50:51], v[50:51], 1.0 op_sel_hi:[1,0]
v_pk_add_f32 v[52:53], v[52:53], 1.0 op_sel_hi:[1,0]
v_pk_add_f32 v[54:55], v[54:55], 1.0 op_sel_hi:[1,0]
v_pk_add_f32 v[56:57], v[56:57], 1.0 op_sel_hi:[1,0]
v_pk_add_f32 v[58:59], v[58:59], 1.0 op_sel_hi:[1,0]
v_pk_add_f32 v[60:61], v[60:61], 1.0 op_sel_hi:[1,0]
v_pk_add_f32 v[62:63], v[62:63], 1.0 op_sel_hi:[1,0]
v_mfma_f32_32x32x16_bf16 v[32:47], v[76:79], a[36:39], v[32:47]
v_rcp_f32 v48, v48
v_rcp_f32 v49, v49
v_rcp_f32 v50, v50
v_mfma_f32_32x32x16_bf16 v[32:47], v[80:83], a[40:43], v[32:47]
v_rcp_f32 v51, v51
v_rcp_f32 v52, v52
v_rcp_f32 v53, v53
v_mfma_f32_32x32x16_bf16 v[32:47], v[84:87], a[44:47], v[32:47]
v_rcp_f32 v54, v54
v_rcp_f32 v55, v55
v_rcp_f32 v56, v56
v_mfma_f32_32x32x16_bf16 v[168:183], v[136:139], v[208:211], 0
v_rcp_f32 v57, v57
v_rcp_f32 v58, v58
v_rcp_f32 v59, v59
v_mfma_f32_32x32x16_bf16 v[168:183], v[140:143], v[212:215], v[168:183]
v_rcp_f32 v60, v60
v_rcp_f32 v61, v61
v_rcp_f32 v62, v62
v_rcp_f32 v63, v63
v_pk_mul_f32 v[16:17], v[48:49], v[16:17]
v_pk_mul_f32 v[18:19], v[50:51], v[18:19]
v_pk_mul_f32 v[20:21], v[52:53], v[20:21]
v_pk_mul_f32 v[22:23], v[54:55], v[22:23]
v_pk_mul_f32 v[24:25], v[56:57], v[24:25]
v_pk_mul_f32 v[26:27], v[58:59], v[26:27]
v_pk_mul_f32 v[28:29], v[60:61], v[28:29]
v_pk_mul_f32 v[30:31], v[62:63], v[30:31]
v_pk_fma_f32 v[100:101], v[16:17], v[16:17], v[100:101]
v_pk_fma_f32 v[48:49], v[32:33], v[32:33], s[60:61] neg_lo:[1,0,0] neg_hi:[1,0,0]
v_pk_fma_f32 v[100:101], v[18:19], v[18:19], v[100:101]
v_pk_fma_f32 v[50:51], v[34:35], v[34:35], s[60:61] neg_lo:[1,0,0] neg_hi:[1,0,0]
v_pk_fma_f32 v[100:101], v[20:21], v[20:21], v[100:101]
v_pk_fma_f32 v[52:53], v[36:37], v[36:37], s[60:61] neg_lo:[1,0,0] neg_hi:[1,0,0]
v_pk_fma_f32 v[100:101], v[22:23], v[22:23], v[100:101]
v_pk_fma_f32 v[54:55], v[38:39], v[38:39], s[60:61] neg_lo:[1,0,0] neg_hi:[1,0,0]
v_pk_fma_f32 v[100:101], v[24:25], v[24:25], v[100:101]
v_pk_fma_f32 v[56:57], v[40:41], v[40:41], s[60:61] neg_lo:[1,0,0] neg_hi:[1,0,0]
v_pk_fma_f32 v[100:101], v[26:27], v[26:27], v[100:101]
v_pk_fma_f32 v[58:59], v[42:43], v[42:43], s[60:61] neg_lo:[1,0,0] neg_hi:[1,0,0]
v_pk_fma_f32 v[100:101], v[28:29], v[28:29], v[100:101]
v_pk_fma_f32 v[60:61], v[44:45], v[44:45], s[60:61] neg_lo:[1,0,0] neg_hi:[1,0,0]
v_pk_fma_f32 v[100:101], v[30:31], v[30:31], v[100:101]
v_pk_fma_f32 v[62:63], v[46:47], v[46:47], s[60:61] neg_lo:[1,0,0] neg_hi:[1,0,0]
v_pk_mul_f32 v[48:49], v[48:49], v[32:33]
v_pk_mul_f32 v[50:51], v[50:51], v[34:35]
v_pk_mul_f32 v[52:53], v[52:53], v[36:37]
v_pk_mul_f32 v[54:55], v[54:55], v[38:39]
v_pk_mul_f32 v[56:57], v[56:57], v[40:41]
v_pk_mul_f32 v[58:59], v[58:59], v[42:43]
v_pk_mul_f32 v[60:61], v[60:61], v[44:45]
v_pk_mul_f32 v[62:63], v[62:63], v[46:47]
v_mfma_f32_32x32x16_bf16 v[16:31], v[64:67], a[48:51], 0
v_exp_f32 v48, v48
v_exp_f32 v49, v49
v_exp_f32 v50, v50
v_mfma_f32_32x32x16_bf16 v[16:31], v[68:71], a[52:55], v[16:31]
v_exp_f32 v51, v51
v_exp_f32 v52, v52
v_exp_f32 v53, v53
v_mfma_f32_32x32x16_bf16 v[16:31], v[72:75], a[56:59], v[16:31]
v_exp_f32 v54, v54
v_exp_f32 v55, v55
v_exp_f32 v56, v56
v_mfma_f32_32x32x16_bf16 v[184:199], v[144:147], v[216:219], 0
v_exp_f32 v57, v57
v_exp_f32 v58, v58
v_exp_f32 v59, v59
v_mfma_f32_32x32x16_bf16 v[184:199], v[148:151], v[220:223], v[184:199]
v_exp_f32 v60, v60
v_exp_f32 v61, v61
v_exp_f32 v62, v62
v_exp_f32 v63, v63
v_pk_add_f32 v[48:49], v[48:49], 1.0 op_sel_hi:[1,0]
v_pk_add_f32 v[50:51], v[50:51], 1.0 op_sel_hi:[1,0]
v_pk_add_f32 v[52:53], v[52:53], 1.0 op_sel_hi:[1,0]
v_pk_add_f32 v[54:55], v[54:55], 1.0 op_sel_hi:[1,0]
v_pk_add_f32 v[56:57], v[56:57], 1.0 op_sel_hi:[1,0]
v_pk_add_f32 v[58:59], v[58:59], 1.0 op_sel_hi:[1,0]
v_pk_add_f32 v[60:61], v[60:61], 1.0 op_sel_hi:[1,0]
v_pk_add_f32 v[62:63], v[62:63], 1.0 op_sel_hi:[1,0]
v_mfma_f32_32x32x16_bf16 v[16:31], v[76:79], a[60:63], v[16:31]
s_mov_b32 s64, 18874368
v_rcp_f32 v48, v48
v_rcp_f32 v49, v49
v_rcp_f32 v50, v50
v_mfma_f32_32x32x16_bf16 v[16:31], v[80:83], a[64:67], v[16:31]
buffer_load_dwordx4 v[200:203], v2, s[24:27], s64 offen offset:0
v_rcp_f32 v51, v51
v_rcp_f32 v52, v52
v_rcp_f32 v53, v53
v_mfma_f32_32x32x16_bf16 v[16:31], v[84:87], a[68:71], v[16:31]
buffer_load_dwordx4 v[204:207], v2, s[24:27], s64 offen offset:16
v_rcp_f32 v54, v54
v_rcp_f32 v55, v55
v_rcp_f32 v56, v56
v_rcp_f32 v57, v57
v_rcp_f32 v58, v58
v_rcp_f32 v59, v59
v_rcp_f32 v60, v60
v_rcp_f32 v61, v61
v_rcp_f32 v62, v62
v_rcp_f32 v63, v63
v_pk_mul_f32 v[32:33], v[48:49], v[32:33]
v_pk_mul_f32 v[34:35], v[50:51], v[34:35]
v_pk_mul_f32 v[36:37], v[52:53], v[36:37]
v_pk_mul_f32 v[38:39], v[54:55], v[38:39]
v_pk_mul_f32 v[40:41], v[56:57], v[40:41]
v_pk_mul_f32 v[42:43], v[58:59], v[42:43]
v_pk_mul_f32 v[44:45], v[60:61], v[44:45]
v_pk_mul_f32 v[46:47], v[62:63], v[46:47]
v_pk_fma_f32 v[102:103], v[32:33], v[32:33], v[102:103]
v_pk_fma_f32 v[48:49], v[16:17], v[16:17], s[60:61] neg_lo:[1,0,0] neg_hi:[1,0,0]
v_pk_fma_f32 v[102:103], v[34:35], v[34:35], v[102:103]
v_pk_fma_f32 v[50:51], v[18:19], v[18:19], s[60:61] neg_lo:[1,0,0] neg_hi:[1,0,0]
v_pk_fma_f32 v[102:103], v[36:37], v[36:37], v[102:103]
v_pk_fma_f32 v[52:53], v[20:21], v[20:21], s[60:61] neg_lo:[1,0,0] neg_hi:[1,0,0]
v_pk_fma_f32 v[102:103], v[38:39], v[38:39], v[102:103]
v_pk_fma_f32 v[54:55], v[22:23], v[22:23], s[60:61] neg_lo:[1,0,0] neg_hi:[1,0,0]
v_pk_fma_f32 v[102:103], v[40:41], v[40:41], v[102:103]
v_pk_fma_f32 v[56:57], v[24:25], v[24:25], s[60:61] neg_lo:[1,0,0] neg_hi:[1,0,0]
v_pk_fma_f32 v[102:103], v[42:43], v[42:43], v[102:103]
v_pk_fma_f32 v[58:59], v[26:27], v[26:27], s[60:61] neg_lo:[1,0,0] neg_hi:[1,0,0]
v_pk_fma_f32 v[102:103], v[44:45], v[44:45], v[102:103]
v_pk_fma_f32 v[60:61], v[28:29], v[28:29], s[60:61] neg_lo:[1,0,0] neg_hi:[1,0,0]
v_pk_fma_f32 v[102:103], v[46:47], v[46:47], v[102:103]
v_pk_fma_f32 v[62:63], v[30:31], v[30:31], s[60:61] neg_lo:[1,0,0] neg_hi:[1,0,0]
v_pk_mul_f32 v[48:49], v[48:49], v[16:17]
v_pk_mul_f32 v[50:51], v[50:51], v[18:19]
v_pk_mul_f32 v[52:53], v[52:53], v[20:21]
v_pk_mul_f32 v[54:55], v[54:55], v[22:23]
v_pk_mul_f32 v[56:57], v[56:57], v[24:25]
v_pk_mul_f32 v[58:59], v[58:59], v[26:27]
v_pk_mul_f32 v[60:61], v[60:61], v[28:29]
v_pk_mul_f32 v[62:63], v[62:63], v[30:31]
v_pk_mul_f32 v[10:11], v[152:153], v[152:153]
v_pk_add_f32 v[8:9], v[152:153], v[154:155]
v_pk_fma_f32 v[10:11], v[154:155], v[154:155], v[10:11]
v_pk_add_f32 v[8:9], v[8:9], v[156:157]
v_pk_fma_f32 v[10:11], v[156:157], v[156:157], v[10:11]
v_pk_add_f32 v[8:9], v[8:9], v[158:159]
v_pk_fma_f32 v[10:11], v[158:159], v[158:159], v[10:11]
v_pk_add_f32 v[8:9], v[8:9], v[160:161]
v_pk_fma_f32 v[10:11], v[160:161], v[160:161], v[10:11]
v_pk_add_f32 v[8:9], v[8:9], v[162:163]
v_pk_fma_f32 v[10:11], v[162:163], v[162:163], v[10:11]
v_pk_add_f32 v[8:9], v[8:9], v[164:165]
v_pk_fma_f32 v[10:11], v[164:165], v[164:165], v[10:11]
v_pk_add_f32 v[8:9], v[8:9], v[166:167]
v_pk_fma_f32 v[10:11], v[166:167], v[166:167], v[10:11]
v_pk_add_f32 v[8:9], v[8:9], v[168:169]
v_pk_fma_f32 v[10:11], v[168:169], v[168:169], v[10:11]
v_pk_add_f32 v[8:9], v[8:9], v[170:171]
v_pk_fma_f32 v[10:11], v[170:171], v[170:171], v[10:11]
v_pk_add_f32 v[8:9], v[8:9], v[172:173]
v_pk_fma_f32 v[10:11], v[172:173], v[172:173], v[10:11]
v_pk_add_f32 v[8:9], v[8:9], v[174:175]
v_pk_fma_f32 v[10:11], v[174:175], v[174:175], v[10:11]
v_pk_add_f32 v[8:9], v[8:9], v[176:177]
v_pk_fma_f32 v[10:11], v[176:177], v[176:177], v[10:11]
v_pk_add_f32 v[8:9], v[8:9], v[178:179]
v_pk_fma_f32 v[10:11], v[178:179], v[178:179], v[10:11]
v_pk_add_f32 v[8:9], v[8:9], v[180:181]
v_pk_fma_f32 v[10:11], v[180:181], v[180:181], v[10:11]
v_pk_add_f32 v[8:9], v[8:9], v[182:183]
v_pk_fma_f32 v[10:11], v[182:183], v[182:183], v[10:11]
v_pk_add_f32 v[8:9], v[8:9], v[184:185]
v_pk_fma_f32 v[10:11], v[184:185], v[184:185], v[10:11]
v_pk_add_f32 v[8:9], v[8:9], v[186:187]
v_pk_fma_f32 v[10:11], v[186:187], v[186:187], v[10:11]
v_pk_add_f32 v[8:9], v[8:9], v[188:189]
v_pk_fma_f32 v[10:11], v[188:189], v[188:189], v[10:11]
v_pk_add_f32 v[8:9], v[8:9], v[190:191]
v_pk_fma_f32 v[10:11], v[190:191], v[190:191], v[10:11]
v_pk_add_f32 v[8:9], v[8:9], v[192:193]
v_pk_fma_f32 v[10:11], v[192:193], v[192:193], v[10:11]
v_pk_add_f32 v[8:9], v[8:9], v[194:195]
v_pk_fma_f32 v[10:11], v[194:195], v[194:195], v[10:11]
v_pk_add_f32 v[8:9], v[8:9], v[196:197]
v_pk_fma_f32 v[10:11], v[196:197], v[196:197], v[10:11]
v_pk_add_f32 v[8:9], v[8:9], v[198:199]
v_pk_fma_f32 v[10:11], v[198:199], v[198:199], v[10:11]
v_mfma_f32_32x32x16_bf16 v[32:47], v[64:67], a[72:75], 0
buffer_load_dwordx4 v[208:211], v2, s[24:27], s64 offen offset:64
v_exp_f32 v48, v48
v_exp_f32 v49, v49
v_add_f32 v8, v8, v9
v_exp_f32 v50, v50
v_mfma_f32_32x32x16_bf16 v[32:47], v[68:71], a[76:79], v[32:47]
buffer_load_dwordx4 v[212:215], v2, s[24:27], s64 offen offset:80
v_add_f32 v10, v10, v11
v_exp_f32 v51, v51
s_nop 0
v_permlane32_swap_b32 v8, v10
v_mfma_f32_32x32x16_bf16 v[32:47], v[72:75], a[80:83], v[32:47]
v_exp_f32 v52, v52
v_add_f32 v8, v8, v10
v_exp_f32 v53, v53
v_mov_b32 v10, v8
v_exp_f32 v54, v54
s_nop 0
v_permlane32_swap_b32 v8, v10
v_exp_f32 v55, v55
v_mul_f32 v13, 0x3c2aaaab, v8
v_exp_f32 v56, v56
v_exp_f32 v57, v57
v_mul_f32 v10, 0x3c2aaaab, v10
v_exp_f32 v58, v58
v_fma_f32 v10, -v13, v13, v10
v_exp_f32 v59, v59
v_max_f32 v10, 0, v10
v_exp_f32 v60, v60
v_add_f32 v10, 0x3727c5ac, v10
v_exp_f32 v61, v61
v_rsq_f32 v12, v10
v_exp_f32 v62, v62
v_mul_f32 v12, 0x3eeff558, v12
v_exp_f32 v63, v63
v_mul_f32_e64 v13, v13, v12
v_pk_add_f32 v[48:49], v[48:49], 1.0 op_sel_hi:[1,0]
v_pk_add_f32 v[50:51], v[50:51], 1.0 op_sel_hi:[1,0]
v_pk_add_f32 v[52:53], v[52:53], 1.0 op_sel_hi:[1,0]
v_pk_add_f32 v[54:55], v[54:55], 1.0 op_sel_hi:[1,0]
v_pk_add_f32 v[56:57], v[56:57], 1.0 op_sel_hi:[1,0]
v_pk_add_f32 v[58:59], v[58:59], 1.0 op_sel_hi:[1,0]
v_pk_add_f32 v[60:61], v[60:61], 1.0 op_sel_hi:[1,0]
v_pk_add_f32 v[62:63], v[62:63], 1.0 op_sel_hi:[1,0]
v_mfma_f32_32x32x16_bf16 v[32:47], v[76:79], a[84:87], v[32:47]
buffer_load_dwordx4 v[216:219], v2, s[24:27], s64 offen offset:128
v_rcp_f32 v48, v48
v_rcp_f32 v49, v49
v_rcp_f32 v50, v50
v_mfma_f32_32x32x16_bf16 v[32:47], v[80:83], a[88:91], v[32:47]
buffer_load_dwordx4 v[220:223], v2, s[24:27], s64 offen offset:144
v_rcp_f32 v51, v51
v_rcp_f32 v52, v52
v_rcp_f32 v53, v53
v_mfma_f32_32x32x16_bf16 v[32:47], v[84:87], a[92:95], v[32:47]
v_rcp_f32 v54, v54
v_rcp_f32 v55, v55
v_rcp_f32 v56, v56
v_rcp_f32 v57, v57
v_rcp_f32 v58, v58
v_rcp_f32 v59, v59
v_rcp_f32 v60, v60
v_rcp_f32 v61, v61
v_rcp_f32 v62, v62
v_rcp_f32 v63, v63
v_pk_mul_f32 v[16:17], v[48:49], v[16:17]
v_pk_mul_f32 v[18:19], v[50:51], v[18:19]
v_pk_mul_f32 v[20:21], v[52:53], v[20:21]
v_pk_mul_f32 v[22:23], v[54:55], v[22:23]
v_pk_mul_f32 v[24:25], v[56:57], v[24:25]
v_pk_mul_f32 v[26:27], v[58:59], v[26:27]
v_pk_mul_f32 v[28:29], v[60:61], v[28:29]
v_pk_mul_f32 v[30:31], v[62:63], v[30:31]
v_pk_fma_f32 v[104:105], v[16:17], v[16:17], v[104:105]
v_pk_fma_f32 v[48:49], v[32:33], v[32:33], s[60:61] neg_lo:[1,0,0] neg_hi:[1,0,0]
v_pk_fma_f32 v[104:105], v[18:19], v[18:19], v[104:105]
v_pk_fma_f32 v[50:51], v[34:35], v[34:35], s[60:61] neg_lo:[1,0,0] neg_hi:[1,0,0]
v_pk_fma_f32 v[104:105], v[20:21], v[20:21], v[104:105]
v_pk_fma_f32 v[52:53], v[36:37], v[36:37], s[60:61] neg_lo:[1,0,0] neg_hi:[1,0,0]
v_pk_fma_f32 v[104:105], v[22:23], v[22:23], v[104:105]
v_pk_fma_f32 v[54:55], v[38:39], v[38:39], s[60:61] neg_lo:[1,0,0] neg_hi:[1,0,0]
v_pk_fma_f32 v[104:105], v[24:25], v[24:25], v[104:105]
v_pk_fma_f32 v[56:57], v[40:41], v[40:41], s[60:61] neg_lo:[1,0,0] neg_hi:[1,0,0]
v_pk_fma_f32 v[104:105], v[26:27], v[26:27], v[104:105]
v_pk_fma_f32 v[58:59], v[42:43], v[42:43], s[60:61] neg_lo:[1,0,0] neg_hi:[1,0,0]
v_pk_fma_f32 v[104:105], v[28:29], v[28:29], v[104:105]
v_pk_fma_f32 v[60:61], v[44:45], v[44:45], s[60:61] neg_lo:[1,0,0] neg_hi:[1,0,0]
v_pk_fma_f32 v[104:105], v[30:31], v[30:31], v[104:105]
v_pk_fma_f32 v[62:63], v[46:47], v[46:47], s[60:61] neg_lo:[1,0,0] neg_hi:[1,0,0]
v_pk_mul_f32 v[48:49], v[48:49], v[32:33]
v_pk_mul_f32 v[50:51], v[50:51], v[34:35]
v_pk_mul_f32 v[52:53], v[52:53], v[36:37]
v_pk_mul_f32 v[54:55], v[54:55], v[38:39]
v_pk_mul_f32 v[56:57], v[56:57], v[40:41]
v_pk_mul_f32 v[58:59], v[58:59], v[42:43]
v_pk_mul_f32 v[60:61], v[60:61], v[44:45]
v_pk_mul_f32 v[62:63], v[62:63], v[46:47]
v_pk_fma_f32 v[152:153], v[152:153], v[12:13], v[12:13] op_sel:[0,0,1] op_sel_hi:[1,0,1] neg_lo:[0,0,1] neg_hi:[0,0,1]
v_pk_fma_f32 v[154:155], v[154:155], v[12:13], v[12:13] op_sel:[0,0,1] op_sel_hi:[1,0,1] neg_lo:[0,0,1] neg_hi:[0,0,1]
v_pk_fma_f32 v[156:157], v[156:157], v[12:13], v[12:13] op_sel:[0,0,1] op_sel_hi:[1,0,1] neg_lo:[0,0,1] neg_hi:[0,0,1]
v_pk_fma_f32 v[158:159], v[158:159], v[12:13], v[12:13] op_sel:[0,0,1] op_sel_hi:[1,0,1] neg_lo:[0,0,1] neg_hi:[0,0,1]
v_pk_fma_f32 v[160:161], v[160:161], v[12:13], v[12:13] op_sel:[0,0,1] op_sel_hi:[1,0,1] neg_lo:[0,0,1] neg_hi:[0,0,1]
v_pk_fma_f32 v[162:163], v[162:163], v[12:13], v[12:13] op_sel:[0,0,1] op_sel_hi:[1,0,1] neg_lo:[0,0,1] neg_hi:[0,0,1]
v_pk_fma_f32 v[164:165], v[164:165], v[12:13], v[12:13] op_sel:[0,0,1] op_sel_hi:[1,0,1] neg_lo:[0,0,1] neg_hi:[0,0,1]
v_pk_fma_f32 v[166:167], v[166:167], v[12:13], v[12:13] op_sel:[0,0,1] op_sel_hi:[1,0,1] neg_lo:[0,0,1] neg_hi:[0,0,1]
v_pk_fma_f32 v[168:169], v[168:169], v[12:13], v[12:13] op_sel:[0,0,1] op_sel_hi:[1,0,1] neg_lo:[0,0,1] neg_hi:[0,0,1]
v_pk_fma_f32 v[170:171], v[170:171], v[12:13], v[12:13] op_sel:[0,0,1] op_sel_hi:[1,0,1] neg_lo:[0,0,1] neg_hi:[0,0,1]
v_pk_fma_f32 v[172:173], v[172:173], v[12:13], v[12:13] op_sel:[0,0,1] op_sel_hi:[1,0,1] neg_lo:[0,0,1] neg_hi:[0,0,1]
v_pk_fma_f32 v[174:175], v[174:175], v[12:13], v[12:13] op_sel:[0,0,1] op_sel_hi:[1,0,1] neg_lo:[0,0,1] neg_hi:[0,0,1]
v_pk_fma_f32 v[176:177], v[176:177], v[12:13], v[12:13] op_sel:[0,0,1] op_sel_hi:[1,0,1] neg_lo:[0,0,1] neg_hi:[0,0,1]
v_pk_fma_f32 v[178:179], v[178:179], v[12:13], v[12:13] op_sel:[0,0,1] op_sel_hi:[1,0,1] neg_lo:[0,0,1] neg_hi:[0,0,1]
v_pk_fma_f32 v[180:181], v[180:181], v[12:13], v[12:13] op_sel:[0,0,1] op_sel_hi:[1,0,1] neg_lo:[0,0,1] neg_hi:[0,0,1]
v_pk_fma_f32 v[182:183], v[182:183], v[12:13], v[12:13] op_sel:[0,0,1] op_sel_hi:[1,0,1] neg_lo:[0,0,1] neg_hi:[0,0,1]
v_pk_fma_f32 v[184:185], v[184:185], v[12:13], v[12:13] op_sel:[0,0,1] op_sel_hi:[1,0,1] neg_lo:[0,0,1] neg_hi:[0,0,1]
v_pk_fma_f32 v[186:187], v[186:187], v[12:13], v[12:13] op_sel:[0,0,1] op_sel_hi:[1,0,1] neg_lo:[0,0,1] neg_hi:[0,0,1]
v_pk_fma_f32 v[188:189], v[188:189], v[12:13], v[12:13] op_sel:[0,0,1] op_sel_hi:[1,0,1] neg_lo:[0,0,1] neg_hi:[0,0,1]
v_pk_fma_f32 v[190:191], v[190:191], v[12:13], v[12:13] op_sel:[0,0,1] op_sel_hi:[1,0,1] neg_lo:[0,0,1] neg_hi:[0,0,1]
v_pk_fma_f32 v[192:193], v[192:193], v[12:13], v[12:13] op_sel:[0,0,1] op_sel_hi:[1,0,1] neg_lo:[0,0,1] neg_hi:[0,0,1]
v_pk_fma_f32 v[194:195], v[194:195], v[12:13], v[12:13] op_sel:[0,0,1] op_sel_hi:[1,0,1] neg_lo:[0,0,1] neg_hi:[0,0,1]
v_pk_fma_f32 v[196:197], v[196:197], v[12:13], v[12:13] op_sel:[0,0,1] op_sel_hi:[1,0,1] neg_lo:[0,0,1] neg_hi:[0,0,1]
v_pk_fma_f32 v[198:199], v[198:199], v[12:13], v[12:13] op_sel:[0,0,1] op_sel_hi:[1,0,1] neg_lo:[0,0,1] neg_hi:[0,0,1]
v_mfma_f32_32x32x16_bf16 v[16:31], v[64:67], a[96:99], 0
v_exp_f32 v48, v48
v_exp_f32 v49, v49
v_cvt_pk_bf16_f32 v128, v152, v153
v_exp_f32 v50, v50
v_mfma_f32_32x32x16_bf16 v[16:31], v[68:71], a[100:103], v[16:31]
v_cvt_pk_bf16_f32 v129, v154, v155
v_exp_f32 v51, v51
v_cvt_pk_bf16_f32 v130, v156, v157
v_exp_f32 v52, v52
v_mfma_f32_32x32x16_bf16 v[16:31], v[72:75], a[104:107], v[16:31]
v_exp_f32 v53, v53
v_cvt_pk_bf16_f32 v131, v158, v159
v_exp_f32 v54, v54
v_cvt_pk_bf16_f32 v132, v160, v161
v_exp_f32 v55, v55
v_cvt_pk_bf16_f32 v133, v162, v163
v_exp_f32 v56, v56
v_exp_f32 v57, v57
v_cvt_pk_bf16_f32 v134, v164, v165
v_exp_f32 v58, v58
v_cvt_pk_bf16_f32 v135, v166, v167
v_exp_f32 v59, v59
v_cvt_pk_bf16_f32 v136, v168, v169
v_exp_f32 v60, v60
v_exp_f32 v61, v61
v_cvt_pk_bf16_f32 v137, v170, v171
v_exp_f32 v62, v62
v_cvt_pk_bf16_f32 v138, v172, v173
v_exp_f32 v63, v63
v_cvt_pk_bf16_f32 v139, v174, v175
v_pk_add_f32 v[48:49], v[48:49], 1.0 op_sel_hi:[1,0]
v_pk_add_f32 v[50:51], v[50:51], 1.0 op_sel_hi:[1,0]
v_pk_add_f32 v[52:53], v[52:53], 1.0 op_sel_hi:[1,0]
v_pk_add_f32 v[54:55], v[54:55], 1.0 op_sel_hi:[1,0]
v_pk_add_f32 v[56:57], v[56:57], 1.0 op_sel_hi:[1,0]
v_pk_add_f32 v[58:59], v[58:59], 1.0 op_sel_hi:[1,0]
v_pk_add_f32 v[60:61], v[60:61], 1.0 op_sel_hi:[1,0]
v_pk_add_f32 v[62:63], v[62:63], 1.0 op_sel_hi:[1,0]
v_mfma_f32_32x32x16_bf16 v[16:31], v[76:79], a[108:111], v[16:31]
v_rcp_f32 v48, v48
v_rcp_f32 v49, v49
v_cvt_pk_bf16_f32 v140, v176, v177
v_rcp_f32 v50, v50
v_mfma_f32_32x32x16_bf16 v[16:31], v[80:83], a[112:115], v[16:31]
v_cvt_pk_bf16_f32 v141, v178, v179
v_rcp_f32 v51, v51
v_cvt_pk_bf16_f32 v142, v180, v181
v_rcp_f32 v52, v52
v_mfma_f32_32x32x16_bf16 v[16:31], v[84:87], a[116:119], v[16:31]
v_rcp_f32 v53, v53
v_cvt_pk_bf16_f32 v143, v182, v183
v_rcp_f32 v54, v54
v_cvt_pk_bf16_f32 v144, v184, v185
v_rcp_f32 v55, v55
v_cvt_pk_bf16_f32 v145, v186, v187
v_rcp_f32 v56, v56
v_rcp_f32 v57, v57
v_cvt_pk_bf16_f32 v146, v188, v189
v_rcp_f32 v58, v58
v_cvt_pk_bf16_f32 v147, v190, v191
v_rcp_f32 v59, v59
v_cvt_pk_bf16_f32 v148, v192, v193
v_rcp_f32 v60, v60
v_rcp_f32 v61, v61
v_cvt_pk_bf16_f32 v149, v194, v195
v_rcp_f32 v62, v62
v_cvt_pk_bf16_f32 v150, v196, v197
v_rcp_f32 v63, v63
v_cvt_pk_bf16_f32 v151, v198, v199
v_pk_mul_f32 v[32:33], v[48:49], v[32:33]
v_pk_mul_f32 v[34:35], v[50:51], v[34:35]
v_pk_mul_f32 v[36:37], v[52:53], v[36:37]
v_pk_mul_f32 v[38:39], v[54:55], v[38:39]
v_pk_mul_f32 v[40:41], v[56:57], v[40:41]
v_pk_mul_f32 v[42:43], v[58:59], v[42:43]
v_pk_mul_f32 v[44:45], v[60:61], v[44:45]
v_pk_mul_f32 v[46:47], v[62:63], v[46:47]
v_pk_fma_f32 v[106:107], v[32:33], v[32:33], v[106:107]
v_pk_fma_f32 v[48:49], v[16:17], v[16:17], s[60:61] neg_lo:[1,0,0] neg_hi:[1,0,0]
v_pk_fma_f32 v[106:107], v[34:35], v[34:35], v[106:107]
v_pk_fma_f32 v[50:51], v[18:19], v[18:19], s[60:61] neg_lo:[1,0,0] neg_hi:[1,0,0]
v_pk_fma_f32 v[106:107], v[36:37], v[36:37], v[106:107]
v_pk_fma_f32 v[52:53], v[20:21], v[20:21], s[60:61] neg_lo:[1,0,0] neg_hi:[1,0,0]
v_pk_fma_f32 v[106:107], v[38:39], v[38:39], v[106:107]
v_pk_fma_f32 v[54:55], v[22:23], v[22:23], s[60:61] neg_lo:[1,0,0] neg_hi:[1,0,0]
v_pk_fma_f32 v[106:107], v[40:41], v[40:41], v[106:107]
v_pk_fma_f32 v[56:57], v[24:25], v[24:25], s[60:61] neg_lo:[1,0,0] neg_hi:[1,0,0]
v_pk_fma_f32 v[106:107], v[42:43], v[42:43], v[106:107]
v_pk_fma_f32 v[58:59], v[26:27], v[26:27], s[60:61] neg_lo:[1,0,0] neg_hi:[1,0,0]
v_pk_fma_f32 v[106:107], v[44:45], v[44:45], v[106:107]
v_pk_fma_f32 v[60:61], v[28:29], v[28:29], s[60:61] neg_lo:[1,0,0] neg_hi:[1,0,0]
v_pk_fma_f32 v[106:107], v[46:47], v[46:47], v[106:107]
v_pk_fma_f32 v[62:63], v[30:31], v[30:31], s[60:61] neg_lo:[1,0,0] neg_hi:[1,0,0]
v_pk_mul_f32 v[48:49], v[48:49], v[16:17]
v_pk_mul_f32 v[50:51], v[50:51], v[18:19]
v_pk_mul_f32 v[52:53], v[52:53], v[20:21]
v_pk_mul_f32 v[54:55], v[54:55], v[22:23]
v_pk_mul_f32 v[56:57], v[56:57], v[24:25]
v_pk_mul_f32 v[58:59], v[58:59], v[26:27]
v_pk_mul_f32 v[60:61], v[60:61], v[28:29]
v_pk_mul_f32 v[62:63], v[62:63], v[30:31]
v_mfma_f32_32x32x16_bf16 v[32:47], v[64:67], a[120:123], 0
v_exp_f32 v48, v48
v_exp_f32 v49, v49
v_exp_f32 v50, v50
v_mfma_f32_32x32x16_bf16 v[32:47], v[68:71], a[124:127], v[32:47]
v_exp_f32 v51, v51
v_exp_f32 v52, v52
v_exp_f32 v53, v53
v_mfma_f32_32x32x16_bf16 v[32:47], v[72:75], a[128:131], v[32:47]
v_exp_f32 v54, v54
v_exp_f32 v55, v55
v_exp_f32 v56, v56
v_exp_f32 v57, v57
v_exp_f32 v58, v58
v_exp_f32 v59, v59
v_exp_f32 v60, v60
v_exp_f32 v61, v61
v_exp_f32 v62, v62
v_exp_f32 v63, v63
v_pk_add_f32 v[48:49], v[48:49], 1.0 op_sel_hi:[1,0]
v_pk_add_f32 v[50:51], v[50:51], 1.0 op_sel_hi:[1,0]
v_pk_add_f32 v[52:53], v[52:53], 1.0 op_sel_hi:[1,0]
v_pk_add_f32 v[54:55], v[54:55], 1.0 op_sel_hi:[1,0]
v_pk_add_f32 v[56:57], v[56:57], 1.0 op_sel_hi:[1,0]
v_pk_add_f32 v[58:59], v[58:59], 1.0 op_sel_hi:[1,0]
v_pk_add_f32 v[60:61], v[60:61], 1.0 op_sel_hi:[1,0]
v_pk_add_f32 v[62:63], v[62:63], 1.0 op_sel_hi:[1,0]
v_mfma_f32_32x32x16_bf16 v[32:47], v[76:79], a[132:135], v[32:47]
v_rcp_f32 v48, v48
v_rcp_f32 v49, v49
v_rcp_f32 v50, v50
v_mfma_f32_32x32x16_bf16 v[32:47], v[80:83], a[136:139], v[32:47]
v_rcp_f32 v51, v51
v_rcp_f32 v52, v52
v_rcp_f32 v53, v53
v_mfma_f32_32x32x16_bf16 v[32:47], v[84:87], a[140:143], v[32:47]
v_rcp_f32 v54, v54
v_rcp_f32 v55, v55
v_rcp_f32 v56, v56
v_rcp_f32 v57, v57
v_rcp_f32 v58, v58
v_rcp_f32 v59, v59
v_rcp_f32 v60, v60
v_rcp_f32 v61, v61
v_rcp_f32 v62, v62
v_rcp_f32 v63, v63
v_pk_mul_f32 v[16:17], v[48:49], v[16:17]
v_pk_mul_f32 v[18:19], v[50:51], v[18:19]
v_pk_mul_f32 v[20:21], v[52:53], v[20:21]
v_pk_mul_f32 v[22:23], v[54:55], v[22:23]
v_pk_mul_f32 v[24:25], v[56:57], v[24:25]
v_pk_mul_f32 v[26:27], v[58:59], v[26:27]
v_pk_mul_f32 v[28:29], v[60:61], v[28:29]
v_pk_mul_f32 v[30:31], v[62:63], v[30:31]
v_pk_fma_f32 v[108:109], v[16:17], v[16:17], v[108:109]
v_pk_fma_f32 v[48:49], v[32:33], v[32:33], s[60:61] neg_lo:[1,0,0] neg_hi:[1,0,0]
v_pk_fma_f32 v[108:109], v[18:19], v[18:19], v[108:109]
v_pk_fma_f32 v[50:51], v[34:35], v[34:35], s[60:61] neg_lo:[1,0,0] neg_hi:[1,0,0]
v_pk_fma_f32 v[108:109], v[20:21], v[20:21], v[108:109]
v_pk_fma_f32 v[52:53], v[36:37], v[36:37], s[60:61] neg_lo:[1,0,0] neg_hi:[1,0,0]
v_pk_fma_f32 v[108:109], v[22:23], v[22:23], v[108:109]
v_pk_fma_f32 v[54:55], v[38:39], v[38:39], s[60:61] neg_lo:[1,0,0] neg_hi:[1,0,0]
v_pk_fma_f32 v[108:109], v[24:25], v[24:25], v[108:109]
v_pk_fma_f32 v[56:57], v[40:41], v[40:41], s[60:61] neg_lo:[1,0,0] neg_hi:[1,0,0]
v_pk_fma_f32 v[108:109], v[26:27], v[26:27], v[108:109]
v_pk_fma_f32 v[58:59], v[42:43], v[42:43], s[60:61] neg_lo:[1,0,0] neg_hi:[1,0,0]
v_pk_fma_f32 v[108:109], v[28:29], v[28:29], v[108:109]
v_pk_fma_f32 v[60:61], v[44:45], v[44:45], s[60:61] neg_lo:[1,0,0] neg_hi:[1,0,0]
v_pk_fma_f32 v[108:109], v[30:31], v[30:31], v[108:109]
v_pk_fma_f32 v[62:63], v[46:47], v[46:47], s[60:61] neg_lo:[1,0,0] neg_hi:[1,0,0]
v_pk_mul_f32 v[48:49], v[48:49], v[32:33]
v_pk_mul_f32 v[50:51], v[50:51], v[34:35]
v_pk_mul_f32 v[52:53], v[52:53], v[36:37]
v_pk_mul_f32 v[54:55], v[54:55], v[38:39]
v_pk_mul_f32 v[56:57], v[56:57], v[40:41]
v_pk_mul_f32 v[58:59], v[58:59], v[42:43]
v_pk_mul_f32 v[60:61], v[60:61], v[44:45]
v_pk_mul_f32 v[62:63], v[62:63], v[46:47]
v_mfma_f32_32x32x16_bf16 v[16:31], v[64:67], a[144:147], 0
v_exp_f32 v48, v48
v_exp_f32 v49, v49
v_exp_f32 v50, v50
v_mfma_f32_32x32x16_bf16 v[16:31], v[68:71], a[148:151], v[16:31]
v_exp_f32 v51, v51
v_exp_f32 v52, v52
v_exp_f32 v53, v53
v_mfma_f32_32x32x16_bf16 v[16:31], v[72:75], a[152:155], v[16:31]
v_exp_f32 v54, v54
v_exp_f32 v55, v55
v_exp_f32 v56, v56
v_exp_f32 v57, v57
v_exp_f32 v58, v58
v_exp_f32 v59, v59
v_exp_f32 v60, v60
v_exp_f32 v61, v61
v_exp_f32 v62, v62
v_exp_f32 v63, v63
v_pk_add_f32 v[48:49], v[48:49], 1.0 op_sel_hi:[1,0]
v_pk_add_f32 v[50:51], v[50:51], 1.0 op_sel_hi:[1,0]
v_pk_add_f32 v[52:53], v[52:53], 1.0 op_sel_hi:[1,0]
v_pk_add_f32 v[54:55], v[54:55], 1.0 op_sel_hi:[1,0]
v_pk_add_f32 v[56:57], v[56:57], 1.0 op_sel_hi:[1,0]
v_pk_add_f32 v[58:59], v[58:59], 1.0 op_sel_hi:[1,0]
v_pk_add_f32 v[60:61], v[60:61], 1.0 op_sel_hi:[1,0]
v_pk_add_f32 v[62:63], v[62:63], 1.0 op_sel_hi:[1,0]
v_mfma_f32_32x32x16_bf16 v[16:31], v[76:79], a[156:159], v[16:31]
v_rcp_f32 v48, v48
v_rcp_f32 v49, v49
v_rcp_f32 v50, v50
v_mfma_f32_32x32x16_bf16 v[16:31], v[80:83], a[160:163], v[16:31]
v_rcp_f32 v51, v51
v_rcp_f32 v52, v52
v_rcp_f32 v53, v53
v_mfma_f32_32x32x16_bf16 v[16:31], v[84:87], a[164:167], v[16:31]
v_rcp_f32 v54, v54
v_rcp_f32 v55, v55
v_rcp_f32 v56, v56
v_rcp_f32 v57, v57
v_rcp_f32 v58, v58
v_rcp_f32 v59, v59
v_rcp_f32 v60, v60
v_rcp_f32 v61, v61
v_rcp_f32 v62, v62
v_rcp_f32 v63, v63
v_pk_mul_f32 v[32:33], v[48:49], v[32:33]
v_pk_mul_f32 v[34:35], v[50:51], v[34:35]
v_pk_mul_f32 v[36:37], v[52:53], v[36:37]
v_pk_mul_f32 v[38:39], v[54:55], v[38:39]
v_pk_mul_f32 v[40:41], v[56:57], v[40:41]
v_pk_mul_f32 v[42:43], v[58:59], v[42:43]
v_pk_mul_f32 v[44:45], v[60:61], v[44:45]
v_pk_mul_f32 v[46:47], v[62:63], v[46:47]
v_pk_fma_f32 v[110:111], v[32:33], v[32:33], v[110:111]
v_pk_fma_f32 v[48:49], v[16:17], v[16:17], s[60:61] neg_lo:[1,0,0] neg_hi:[1,0,0]
v_pk_fma_f32 v[110:111], v[34:35], v[34:35], v[110:111]
v_pk_fma_f32 v[50:51], v[18:19], v[18:19], s[60:61] neg_lo:[1,0,0] neg_hi:[1,0,0]
v_pk_fma_f32 v[110:111], v[36:37], v[36:37], v[110:111]
v_pk_fma_f32 v[52:53], v[20:21], v[20:21], s[60:61] neg_lo:[1,0,0] neg_hi:[1,0,0]
v_pk_fma_f32 v[110:111], v[38:39], v[38:39], v[110:111]
v_pk_fma_f32 v[54:55], v[22:23], v[22:23], s[60:61] neg_lo:[1,0,0] neg_hi:[1,0,0]
v_pk_fma_f32 v[110:111], v[40:41], v[40:41], v[110:111]
v_pk_fma_f32 v[56:57], v[24:25], v[24:25], s[60:61] neg_lo:[1,0,0] neg_hi:[1,0,0]
v_pk_fma_f32 v[110:111], v[42:43], v[42:43], v[110:111]
v_pk_fma_f32 v[58:59], v[26:27], v[26:27], s[60:61] neg_lo:[1,0,0] neg_hi:[1,0,0]
v_pk_fma_f32 v[110:111], v[44:45], v[44:45], v[110:111]
v_pk_fma_f32 v[60:61], v[28:29], v[28:29], s[60:61] neg_lo:[1,0,0] neg_hi:[1,0,0]
v_pk_fma_f32 v[110:111], v[46:47], v[46:47], v[110:111]
v_pk_fma_f32 v[62:63], v[30:31], v[30:31], s[60:61] neg_lo:[1,0,0] neg_hi:[1,0,0]
v_pk_mul_f32 v[48:49], v[48:49], v[16:17]
v_pk_mul_f32 v[50:51], v[50:51], v[18:19]
v_pk_mul_f32 v[52:53], v[52:53], v[20:21]
v_pk_mul_f32 v[54:55], v[54:55], v[22:23]
v_pk_mul_f32 v[56:57], v[56:57], v[24:25]
v_pk_mul_f32 v[58:59], v[58:59], v[26:27]
v_pk_mul_f32 v[60:61], v[60:61], v[28:29]
v_pk_mul_f32 v[62:63], v[62:63], v[30:31]
v_mfma_f32_32x32x16_bf16 v[32:47], v[64:67], a[168:171], 0
v_exp_f32 v48, v48
v_exp_f32 v49, v49
v_exp_f32 v50, v50
v_mfma_f32_32x32x16_bf16 v[32:47], v[68:71], a[172:175], v[32:47]
s_add_u32 s74, s87, L_b1_2-L_pc
v_exp_f32 v51, v51
v_exp_f32 v52, v52
v_exp_f32 v53, v53
v_mfma_f32_32x32x16_bf16 v[32:47], v[72:75], a[176:179], v[32:47]
v_lshl_add_u32 v14, v0, 3, s74
v_exp_f32 v54, v54
v_exp_f32 v55, v55
v_min_u32 v14, L_pf1-L_pc-4, v14
v_exp_f32 v56, v56
v_exp_f32 v57, v57
v_exp_f32 v58, v58
v_mov_b32 v15, s89
v_exp_f32 v59, v59
v_exp_f32 v60, v60
v_exp_f32 v61, v61
v_add_co_u32 v14, vcc, s88, v14
v_exp_f32 v62, v62
v_exp_f32 v63, v63
v_addc_co_u32_e64 v15, vcc, 0, v15, vcc
v_pk_add_f32 v[48:49], v[48:49], 1.0 op_sel_hi:[1,0]
v_pk_add_f32 v[50:51], v[50:51], 1.0 op_sel_hi:[1,0]
v_pk_add_f32 v[52:53], v[52:53], 1.0 op_sel_hi:[1,0]
v_pk_add_f32 v[54:55], v[54:55], 1.0 op_sel_hi:[1,0]
v_pk_add_f32 v[56:57], v[56:57], 1.0 op_sel_hi:[1,0]
v_pk_add_f32 v[58:59], v[58:59], 1.0 op_sel_hi:[1,0]
v_pk_add_f32 v[60:61], v[60:61], 1.0 op_sel_hi:[1,0]
v_pk_add_f32 v[62:63], v[62:63], 1.0 op_sel_hi:[1,0]
v_mfma_f32_32x32x16_bf16 v[32:47], v[76:79], a[180:183], v[32:47]
s_waitcnt vmcnt(6)
global_load_dword v126, v[14:15], off
v_rcp_f32 v48, v48
v_rcp_f32 v49, v49
v_rcp_f32 v50, v50
v_mfma_f32_32x32x16_bf16 v[32:47], v[80:83], a[184:187], v[32:47]
v_rcp_f32 v51, v51
v_rcp_f32 v52, v52
v_rcp_f32 v53, v53
v_mfma_f32_32x32x16_bf16 v[32:47], v[84:87], a[188:191], v[32:47]
v_rcp_f32 v54, v54
v_rcp_f32 v55, v55
v_rcp_f32 v56, v56
v_rcp_f32 v57, v57
v_rcp_f32 v58, v58
v_rcp_f32 v59, v59
v_rcp_f32 v60, v60
v_rcp_f32 v61, v61
v_rcp_f32 v62, v62
v_rcp_f32_e64 v63, v63
v_pk_mul_f32 v[16:17], v[48:49], v[16:17]
v_pk_mul_f32 v[18:19], v[50:51], v[18:19]
v_pk_mul_f32 v[20:21], v[52:53], v[20:21]
v_pk_mul_f32 v[22:23], v[54:55], v[22:23]
v_pk_mul_f32 v[24:25], v[56:57], v[24:25]
v_pk_mul_f32 v[26:27], v[58:59], v[26:27]
v_pk_mul_f32 v[28:29], v[60:61], v[28:29]
v_pk_mul_f32 v[30:31], v[62:63], v[30:31]
v_pk_fma_f32 v[112:113], v[16:17], v[16:17], v[112:113]
v_pk_fma_f32 v[48:49], v[32:33], v[32:33], s[60:61] neg_lo:[1,0,0] neg_hi:[1,0,0]
v_pk_fma_f32 v[112:113], v[18:19], v[18:19], v[112:113]
v_pk_fma_f32 v[50:51], v[34:35], v[34:35], s[60:61] neg_lo:[1,0,0] neg_hi:[1,0,0]
v_pk_fma_f32 v[112:113], v[20:21], v[20:21], v[112:113]
v_pk_fma_f32 v[52:53], v[36:37], v[36:37], s[60:61] neg_lo:[1,0,0] neg_hi:[1,0,0]
v_pk_fma_f32 v[112:113], v[22:23], v[22:23], v[112:113]
v_pk_fma_f32 v[54:55], v[38:39], v[38:39], s[60:61] neg_lo:[1,0,0] neg_hi:[1,0,0]
v_pk_fma_f32 v[112:113], v[24:25], v[24:25], v[112:113]
v_pk_fma_f32 v[56:57], v[40:41], v[40:41], s[60:61] neg_lo:[1,0,0] neg_hi:[1,0,0]
v_pk_fma_f32 v[112:113], v[26:27], v[26:27], v[112:113]
v_pk_fma_f32 v[58:59], v[42:43], v[42:43], s[60:61] neg_lo:[1,0,0] neg_hi:[1,0,0]
v_pk_fma_f32 v[112:113], v[28:29], v[28:29], v[112:113]
v_pk_fma_f32 v[60:61], v[44:45], v[44:45], s[60:61] neg_lo:[1,0,0] neg_hi:[1,0,0]
v_pk_fma_f32 v[112:113], v[30:31], v[30:31], v[112:113]
v_pk_fma_f32 v[62:63], v[46:47], v[46:47], s[60:61] neg_lo:[1,0,0] neg_hi:[1,0,0]
v_pk_mul_f32 v[48:49], v[48:49], v[32:33]
v_pk_mul_f32 v[50:51], v[50:51], v[34:35]
v_pk_mul_f32 v[52:53], v[52:53], v[36:37]
v_pk_mul_f32 v[54:55], v[54:55], v[38:39]
v_pk_mul_f32 v[56:57], v[56:57], v[40:41]
v_pk_mul_f32 v[58:59], v[58:59], v[42:43]
v_pk_mul_f32 v[60:61], v[60:61], v[44:45]
v_pk_mul_f32 v[62:63], v[62:63], v[46:47]
v_mfma_f32_32x32x16_bf16 v[16:31], v[64:67], a[192:195], 0
v_exp_f32 v48, v48
v_exp_f32 v49, v49
v_exp_f32 v50, v50
v_mfma_f32_32x32x16_bf16 v[16:31], v[68:71], a[196:199], v[16:31]
v_exp_f32 v51, v51
v_exp_f32 v52, v52
v_exp_f32 v53, v53
v_mfma_f32_32x32x16_bf16 v[16:31], v[72:75], a[200:203], v[16:31]
v_exp_f32 v54, v54
v_exp_f32 v55, v55
v_exp_f32 v56, v56
v_exp_f32 v57, v57
v_exp_f32 v58, v58
v_exp_f32 v59, v59
v_exp_f32 v60, v60
v_exp_f32 v61, v61
v_exp_f32 v62, v62
v_exp_f32 v63, v63
v_pk_add_f32 v[48:49], v[48:49], 1.0 op_sel_hi:[1,0]
v_pk_add_f32 v[50:51], v[50:51], 1.0 op_sel_hi:[1,0]
v_pk_add_f32 v[52:53], v[52:53], 1.0 op_sel_hi:[1,0]
v_pk_add_f32 v[54:55], v[54:55], 1.0 op_sel_hi:[1,0]
v_pk_add_f32 v[56:57], v[56:57], 1.0 op_sel_hi:[1,0]
v_pk_add_f32 v[58:59], v[58:59], 1.0 op_sel_hi:[1,0]
v_pk_add_f32 v[60:61], v[60:61], 1.0 op_sel_hi:[1,0]
v_pk_add_f32 v[62:63], v[62:63], 1.0 op_sel_hi:[1,0]
v_mfma_f32_32x32x16_bf16 v[16:31], v[76:79], a[204:207], v[16:31]
v_rcp_f32 v48, v48
v_rcp_f32 v49, v49
v_rcp_f32 v50, v50
v_mfma_f32_32x32x16_bf16 v[16:31], v[80:83], a[208:211], v[16:31]
v_rcp_f32 v51, v51
v_rcp_f32 v52, v52
v_rcp_f32 v53, v53
v_mfma_f32_32x32x16_bf16 v[16:31], v[84:87], a[212:215], v[16:31]
v_rcp_f32 v54, v54
v_rcp_f32 v55, v55
v_rcp_f32 v56, v56
v_rcp_f32 v57, v57
v_rcp_f32 v58, v58
v_rcp_f32 v59, v59
v_rcp_f32 v60, v60
v_rcp_f32 v61, v61
v_rcp_f32 v62, v62
v_rcp_f32 v63, v63
v_pk_mul_f32 v[32:33], v[48:49], v[32:33]
v_pk_mul_f32 v[34:35], v[50:51], v[34:35]
v_pk_mul_f32 v[36:37], v[52:53], v[36:37]
v_pk_mul_f32 v[38:39], v[54:55], v[38:39]
v_pk_mul_f32 v[40:41], v[56:57], v[40:41]
v_pk_mul_f32 v[42:43], v[58:59], v[42:43]
v_pk_mul_f32 v[44:45], v[60:61], v[44:45]
v_pk_mul_f32 v[46:47], v[62:63], v[46:47]
v_pk_fma_f32 v[114:115], v[32:33], v[32:33], v[114:115]
v_pk_fma_f32 v[48:49], v[16:17], v[16:17], s[60:61] neg_lo:[1,0,0] neg_hi:[1,0,0]
v_pk_fma_f32 v[114:115], v[34:35], v[34:35], v[114:115]
v_pk_fma_f32 v[50:51], v[18:19], v[18:19], s[60:61] neg_lo:[1,0,0] neg_hi:[1,0,0]
v_pk_fma_f32 v[114:115], v[36:37], v[36:37], v[114:115]
v_pk_fma_f32 v[52:53], v[20:21], v[20:21], s[60:61] neg_lo:[1,0,0] neg_hi:[1,0,0]
v_pk_fma_f32 v[114:115], v[38:39], v[38:39], v[114:115]
v_pk_fma_f32 v[54:55], v[22:23], v[22:23], s[60:61] neg_lo:[1,0,0] neg_hi:[1,0,0]
v_pk_fma_f32 v[114:115], v[40:41], v[40:41], v[114:115]
v_pk_fma_f32 v[56:57], v[24:25], v[24:25], s[60:61] neg_lo:[1,0,0] neg_hi:[1,0,0]
v_pk_fma_f32 v[114:115], v[42:43], v[42:43], v[114:115]
v_pk_fma_f32 v[58:59], v[26:27], v[26:27], s[60:61] neg_lo:[1,0,0] neg_hi:[1,0,0]
v_pk_fma_f32 v[114:115], v[44:45], v[44:45], v[114:115]
v_pk_fma_f32 v[60:61], v[28:29], v[28:29], s[60:61] neg_lo:[1,0,0] neg_hi:[1,0,0]
v_pk_fma_f32 v[114:115], v[46:47], v[46:47], v[114:115]
v_pk_fma_f32 v[62:63], v[30:31], v[30:31], s[60:61] neg_lo:[1,0,0] neg_hi:[1,0,0]
v_pk_mul_f32 v[48:49], v[48:49], v[16:17]
v_pk_mul_f32 v[50:51], v[50:51], v[18:19]
v_pk_mul_f32 v[52:53], v[52:53], v[20:21]
v_pk_mul_f32 v[54:55], v[54:55], v[22:23]
v_pk_mul_f32 v[56:57], v[56:57], v[24:25]
v_pk_mul_f32 v[58:59], v[58:59], v[26:27]
v_pk_mul_f32 v[60:61], v[60:61], v[28:29]
v_pk_mul_f32 v[62:63], v[62:63], v[30:31]
v_mfma_f32_32x32x16_bf16 v[32:47], v[64:67], a[216:219], 0
v_exp_f32 v48, v48
v_exp_f32 v49, v49
s_min_u32 s67, s2, 71
v_exp_f32 v50, v50
v_mfma_f32_32x32x16_bf16 v[32:47], v[68:71], a[220:223], v[32:47]
v_exp_f32 v51, v51
s_lshl_b32 s67, s67, 10
v_exp_f32 v52, v52
v_mfma_f32_32x32x16_bf16 v[32:47], v[72:75], a[224:227], v[32:47]
v_exp_f32 v53, v53
v_add_u32 v14, s67, v0
v_exp_f32 v54, v54
v_exp_f32 v55, v55
s_cmp_lt_u32 s2, 72
v_exp_f32 v56, v56
s_cselect_b32 s68, 0, 1073741824
v_exp_f32 v57, v57
v_exp_f32 v58, v58
s_cmp_eq_u32 s66, 0
v_exp_f32 v59, v59
v_exp_f32 v60, v60
s_cselect_b32 s68, s68, 1073741824
v_exp_f32 v61, v61
v_exp_f32 v62, v62
v_add_u32 v15, s68, v14
v_exp_f32 v63, v63
s_mov_b32 s69, 1835008
v_pk_add_f32 v[48:49], v[48:49], 1.0 op_sel_hi:[1,0]
v_pk_add_f32 v[50:51], v[50:51], 1.0 op_sel_hi:[1,0]
v_pk_add_f32 v[52:53], v[52:53], 1.0 op_sel_hi:[1,0]
v_pk_add_f32 v[54:55], v[54:55], 1.0 op_sel_hi:[1,0]
v_pk_add_f32 v[56:57], v[56:57], 1.0 op_sel_hi:[1,0]
v_pk_add_f32 v[58:59], v[58:59], 1.0 op_sel_hi:[1,0]
v_pk_add_f32 v[60:61], v[60:61], 1.0 op_sel_hi:[1,0]
v_pk_add_f32 v[62:63], v[62:63], 1.0 op_sel_hi:[1,0]
v_mfma_f32_32x32x16_bf16 v[32:47], v[76:79], a[228:231], v[32:47]
ds_read_b128 v[8:11], v14
v_rcp_f32 v48, v48
v_rcp_f32 v49, v49
v_rcp_f32 v50, v50
v_mfma_f32_32x32x16_bf16 v[32:47], v[80:83], a[232:235], v[32:47]
v_rcp_f32 v51, v51
v_rcp_f32 v52, v52
v_rcp_f32 v53, v53
v_mfma_f32_32x32x16_bf16 v[32:47], v[84:87], a[236:239], v[32:47]
v_rcp_f32 v54, v54
v_rcp_f32 v55, v55
v_rcp_f32 v56, v56
v_rcp_f32 v57, v57
v_rcp_f32 v58, v58
v_rcp_f32 v59, v59
v_rcp_f32 v60, v60
v_rcp_f32 v61, v61
v_rcp_f32 v62, v62
v_rcp_f32 v63, v63
v_pk_mul_f32 v[16:17], v[48:49], v[16:17]
v_pk_mul_f32 v[18:19], v[50:51], v[18:19]
v_pk_mul_f32 v[20:21], v[52:53], v[20:21]
v_pk_mul_f32 v[22:23], v[54:55], v[22:23]
v_pk_mul_f32 v[24:25], v[56:57], v[24:25]
v_pk_mul_f32 v[26:27], v[58:59], v[26:27]
v_pk_mul_f32 v[28:29], v[60:61], v[28:29]
v_pk_mul_f32 v[30:31], v[62:63], v[30:31]
v_pk_fma_f32 v[116:117], v[16:17], v[16:17], v[116:117]
v_pk_fma_f32 v[48:49], v[32:33], v[32:33], s[60:61] neg_lo:[1,0,0] neg_hi:[1,0,0]
v_pk_fma_f32 v[116:117], v[18:19], v[18:19], v[116:117]
v_pk_fma_f32 v[50:51], v[34:35], v[34:35], s[60:61] neg_lo:[1,0,0] neg_hi:[1,0,0]
v_pk_fma_f32 v[116:117], v[20:21], v[20:21], v[116:117]
v_pk_fma_f32 v[52:53], v[36:37], v[36:37], s[60:61] neg_lo:[1,0,0] neg_hi:[1,0,0]
v_pk_fma_f32 v[116:117], v[22:23], v[22:23], v[116:117]
v_pk_fma_f32 v[54:55], v[38:39], v[38:39], s[60:61] neg_lo:[1,0,0] neg_hi:[1,0,0]
v_pk_fma_f32 v[116:117], v[24:25], v[24:25], v[116:117]
v_pk_fma_f32 v[56:57], v[40:41], v[40:41], s[60:61] neg_lo:[1,0,0] neg_hi:[1,0,0]
v_pk_fma_f32 v[116:117], v[26:27], v[26:27], v[116:117]
v_pk_fma_f32 v[58:59], v[42:43], v[42:43], s[60:61] neg_lo:[1,0,0] neg_hi:[1,0,0]
v_pk_fma_f32 v[116:117], v[28:29], v[28:29], v[116:117]
v_pk_fma_f32 v[60:61], v[44:45], v[44:45], s[60:61] neg_lo:[1,0,0] neg_hi:[1,0,0]
v_pk_fma_f32 v[116:117], v[30:31], v[30:31], v[116:117]
v_pk_fma_f32 v[62:63], v[46:47], v[46:47], s[60:61] neg_lo:[1,0,0] neg_hi:[1,0,0]
v_pk_mul_f32 v[48:49], v[48:49], v[32:33]
v_pk_mul_f32 v[50:51], v[50:51], v[34:35]
v_pk_mul_f32 v[52:53], v[52:53], v[36:37]
v_pk_mul_f32 v[54:55], v[54:55], v[38:39]
v_pk_mul_f32 v[56:57], v[56:57], v[40:41]
v_pk_mul_f32 v[58:59], v[58:59], v[42:43]
v_pk_mul_f32 v[60:61], v[60:61], v[44:45]
v_pk_mul_f32 v[62:63], v[62:63], v[46:47]
v_mfma_f32_32x32x16_bf16 v[16:31], v[64:67], a[240:243], 0
v_exp_f32 v48, v48
v_exp_f32 v49, v49
v_exp_f32 v50, v50
v_mfma_f32_32x32x16_bf16 v[16:31], v[68:71], a[244:247], v[16:31]
v_exp_f32 v51, v51
v_exp_f32 v52, v52
v_exp_f32 v53, v53
v_mfma_f32_32x32x16_bf16 v[16:31], v[72:75], a[248:251], v[16:31]
v_exp_f32 v54, v54
v_exp_f32 v55, v55
v_exp_f32 v56, v56
v_exp_f32 v57, v57
v_exp_f32 v58, v58
v_exp_f32 v59, v59
v_exp_f32 v60, v60
v_exp_f32 v61, v61
v_exp_f32 v62, v62
v_exp_f32 v63, v63
v_pk_add_f32 v[48:49], v[48:49], 1.0 op_sel_hi:[1,0]
v_pk_add_f32 v[50:51], v[50:51], 1.0 op_sel_hi:[1,0]
v_pk_add_f32 v[52:53], v[52:53], 1.0 op_sel_hi:[1,0]
v_pk_add_f32 v[54:55], v[54:55], 1.0 op_sel_hi:[1,0]
v_pk_add_f32 v[56:57], v[56:57], 1.0 op_sel_hi:[1,0]
v_pk_add_f32 v[58:59], v[58:59], 1.0 op_sel_hi:[1,0]
v_pk_add_f32 v[60:61], v[60:61], 1.0 op_sel_hi:[1,0]
v_pk_add_f32 v[62:63], v[62:63], 1.0 op_sel_hi:[1,0]
v_mfma_f32_32x32x16_bf16 v[16:31], v[76:79], a[252:255], v[16:31]
s_waitcnt lgkmcnt(0)
buffer_store_dwordx4 v[8:11], v15, s[40:43], s69 offen sc1
v_rcp_f32 v48, v48
v_rcp_f32 v49, v49
v_rcp_f32 v50, v50
v_mfma_f32_32x32x16_bf16 v[16:31], v[80:83], v[224:227], v[16:31]
v_rcp_f32 v51, v51
v_rcp_f32 v52, v52
v_rcp_f32 v53, v53
v_mfma_f32_32x32x16_bf16 v[16:31], v[84:87], v[228:231], v[16:31]
v_rcp_f32 v54, v54
v_rcp_f32 v55, v55
v_rcp_f32 v56, v56
v_rcp_f32 v57, v57
v_rcp_f32 v58, v58
v_rcp_f32 v59, v59
v_rcp_f32 v60, v60
v_rcp_f32 v61, v61
v_rcp_f32 v62, v62
v_rcp_f32_e64 v63, v63
v_pk_mul_f32 v[32:33], v[48:49], v[32:33]
v_pk_mul_f32 v[34:35], v[50:51], v[34:35]
v_pk_mul_f32 v[36:37], v[52:53], v[36:37]
v_pk_mul_f32 v[38:39], v[54:55], v[38:39]
v_pk_mul_f32 v[40:41], v[56:57], v[40:41]
v_pk_mul_f32 v[42:43], v[58:59], v[42:43]
v_pk_mul_f32 v[44:45], v[60:61], v[44:45]
v_pk_mul_f32 v[46:47], v[62:63], v[46:47]
v_pk_fma_f32 v[118:119], v[32:33], v[32:33], v[118:119]
v_pk_fma_f32 v[48:49], v[16:17], v[16:17], s[60:61] neg_lo:[1,0,0] neg_hi:[1,0,0]
v_pk_fma_f32 v[118:119], v[34:35], v[34:35], v[118:119]
v_pk_fma_f32 v[50:51], v[18:19], v[18:19], s[60:61] neg_lo:[1,0,0] neg_hi:[1,0,0]
v_pk_fma_f32 v[118:119], v[36:37], v[36:37], v[118:119]
v_pk_fma_f32 v[52:53], v[20:21], v[20:21], s[60:61] neg_lo:[1,0,0] neg_hi:[1,0,0]
v_pk_fma_f32 v[118:119], v[38:39], v[38:39], v[118:119]
v_pk_fma_f32 v[54:55], v[22:23], v[22:23], s[60:61] neg_lo:[1,0,0] neg_hi:[1,0,0]
v_pk_fma_f32 v[118:119], v[40:41], v[40:41], v[118:119]
v_pk_fma_f32 v[56:57], v[24:25], v[24:25], s[60:61] neg_lo:[1,0,0] neg_hi:[1,0,0]
v_pk_fma_f32 v[118:119], v[42:43], v[42:43], v[118:119]
v_pk_fma_f32 v[58:59], v[26:27], v[26:27], s[60:61] neg_lo:[1,0,0] neg_hi:[1,0,0]
v_pk_fma_f32 v[118:119], v[44:45], v[44:45], v[118:119]
v_pk_fma_f32 v[60:61], v[28:29], v[28:29], s[60:61] neg_lo:[1,0,0] neg_hi:[1,0,0]
v_pk_fma_f32 v[118:119], v[46:47], v[46:47], v[118:119]
v_pk_fma_f32 v[62:63], v[30:31], v[30:31], s[60:61] neg_lo:[1,0,0] neg_hi:[1,0,0]
v_pk_mul_f32 v[48:49], v[48:49], v[16:17]
v_pk_mul_f32 v[50:51], v[50:51], v[18:19]
v_pk_mul_f32 v[52:53], v[52:53], v[20:21]
v_pk_mul_f32 v[54:55], v[54:55], v[22:23]
v_pk_mul_f32 v[56:57], v[56:57], v[24:25]
v_pk_mul_f32 v[58:59], v[58:59], v[26:27]
v_pk_mul_f32 v[60:61], v[60:61], v[28:29]
v_pk_mul_f32 v[62:63], v[62:63], v[30:31]
v_mfma_f32_32x32x16_bf16 v[32:47], v[64:67], v[232:235], 0
v_exp_f32 v48, v48
v_exp_f32 v49, v49
v_exp_f32 v50, v50
v_mfma_f32_32x32x16_bf16 v[32:47], v[68:71], v[236:239], v[32:47]
v_exp_f32 v51, v51
v_exp_f32 v52, v52
v_exp_f32 v53, v53
v_mfma_f32_32x32x16_bf16 v[32:47], v[72:75], v[240:243], v[32:47]
v_exp_f32 v54, v54
v_exp_f32 v55, v55
v_exp_f32 v56, v56
v_exp_f32 v57, v57
v_exp_f32 v58, v58
v_exp_f32 v59, v59
v_exp_f32 v60, v60
v_exp_f32 v61, v61
v_exp_f32 v62, v62
v_exp_f32 v63, v63
v_pk_add_f32 v[48:49], v[48:49], 1.0 op_sel_hi:[1,0]
v_pk_add_f32 v[50:51], v[50:51], 1.0 op_sel_hi:[1,0]
v_pk_add_f32 v[52:53], v[52:53], 1.0 op_sel_hi:[1,0]
v_pk_add_f32 v[54:55], v[54:55], 1.0 op_sel_hi:[1,0]
v_pk_add_f32 v[56:57], v[56:57], 1.0 op_sel_hi:[1,0]
v_pk_add_f32 v[58:59], v[58:59], 1.0 op_sel_hi:[1,0]
v_pk_add_f32 v[60:61], v[60:61], 1.0 op_sel_hi:[1,0]
v_pk_add_f32 v[62:63], v[62:63], 1.0 op_sel_hi:[1,0]
v_mfma_f32_32x32x16_bf16 v[32:47], v[76:79], v[244:247], v[32:47]
v_rcp_f32 v48, v48
v_rcp_f32 v49, v49
v_rcp_f32 v50, v50
v_mfma_f32_32x32x16_bf16 v[32:47], v[80:83], v[248:251], v[32:47]
v_rcp_f32 v51, v51
v_rcp_f32 v52, v52
v_rcp_f32 v53, v53
v_mfma_f32_32x32x16_bf16 v[32:47], v[84:87], v[252:255], v[32:47]
v_rcp_f32 v54, v54
v_rcp_f32 v55, v55
v_rcp_f32 v56, v56
v_rcp_f32 v57, v57
v_rcp_f32 v58, v58
v_rcp_f32 v59, v59
v_rcp_f32 v60, v60
v_rcp_f32 v61, v61
v_rcp_f32 v62, v62
v_rcp_f32 v63, v63
v_pk_mul_f32 v[16:17], v[48:49], v[16:17]
v_pk_mul_f32 v[18:19], v[50:51], v[18:19]
v_pk_mul_f32 v[20:21], v[52:53], v[20:21]
v_pk_mul_f32 v[22:23], v[54:55], v[22:23]
v_pk_mul_f32 v[24:25], v[56:57], v[24:25]
v_pk_mul_f32 v[26:27], v[58:59], v[26:27]
v_pk_mul_f32 v[28:29], v[60:61], v[28:29]
v_pk_mul_f32 v[30:31], v[62:63], v[30:31]
v_pk_fma_f32 v[120:121], v[16:17], v[16:17], v[120:121]
v_pk_fma_f32 v[48:49], v[32:33], v[32:33], s[60:61] neg_lo:[1,0,0] neg_hi:[1,0,0]
v_pk_fma_f32 v[120:121], v[18:19], v[18:19], v[120:121]
v_pk_fma_f32 v[50:51], v[34:35], v[34:35], s[60:61] neg_lo:[1,0,0] neg_hi:[1,0,0]
v_pk_fma_f32 v[120:121], v[20:21], v[20:21], v[120:121]
v_pk_fma_f32 v[52:53], v[36:37], v[36:37], s[60:61] neg_lo:[1,0,0] neg_hi:[1,0,0]
v_pk_fma_f32 v[120:121], v[22:23], v[22:23], v[120:121]
v_pk_fma_f32 v[54:55], v[38:39], v[38:39], s[60:61] neg_lo:[1,0,0] neg_hi:[1,0,0]
v_pk_fma_f32 v[120:121], v[24:25], v[24:25], v[120:121]
v_pk_fma_f32 v[56:57], v[40:41], v[40:41], s[60:61] neg_lo:[1,0,0] neg_hi:[1,0,0]
v_pk_fma_f32 v[120:121], v[26:27], v[26:27], v[120:121]
v_pk_fma_f32 v[58:59], v[42:43], v[42:43], s[60:61] neg_lo:[1,0,0] neg_hi:[1,0,0]
v_pk_fma_f32 v[120:121], v[28:29], v[28:29], v[120:121]
v_pk_fma_f32 v[60:61], v[44:45], v[44:45], s[60:61] neg_lo:[1,0,0] neg_hi:[1,0,0]
v_pk_fma_f32 v[120:121], v[30:31], v[30:31], v[120:121]
v_pk_fma_f32 v[62:63], v[46:47], v[46:47], s[60:61] neg_lo:[1,0,0] neg_hi:[1,0,0]
v_pk_mul_f32 v[48:49], v[48:49], v[32:33]
v_pk_mul_f32 v[50:51], v[50:51], v[34:35]
v_pk_mul_f32 v[52:53], v[52:53], v[36:37]
v_pk_mul_f32 v[54:55], v[54:55], v[38:39]
v_pk_mul_f32 v[56:57], v[56:57], v[40:41]
v_pk_mul_f32 v[58:59], v[58:59], v[42:43]
v_pk_mul_f32 v[60:61], v[60:61], v[44:45]
v_pk_mul_f32 v[62:63], v[62:63], v[46:47]
v_mfma_f32_32x32x16_bf16 v[16:31], v[128:131], a[0:3], 0
ds_read_b128 v[64:67], v5 offset:0
v_exp_f32 v48, v48
v_exp_f32 v49, v49
v_exp_f32 v50, v50
v_mfma_f32_32x32x16_bf16 v[16:31], v[132:135], a[4:7], v[16:31]
ds_read_b128 v[68:71], v6 offset:0
v_exp_f32 v51, v51
v_exp_f32 v52, v52
v_exp_f32 v53, v53
v_mfma_f32_32x32x16_bf16 v[16:31], v[136:139], a[8:11], v[16:31]
ds_read_b128 v[72:75], v5 offset:528
v_exp_f32 v54, v54
v_exp_f32 v55, v55
v_exp_f32 v56, v56
v_exp_f32 v57, v57
v_exp_f32 v58, v58
v_exp_f32 v59, v59
v_exp_f32 v60, v60
v_exp_f32 v61, v61
v_exp_f32 v62, v62
v_exp_f32 v63, v63
v_pk_add_f32 v[48:49], v[48:49], 1.0 op_sel_hi:[1,0]
v_pk_add_f32 v[50:51], v[50:51], 1.0 op_sel_hi:[1,0]
v_pk_add_f32 v[52:53], v[52:53], 1.0 op_sel_hi:[1,0]
v_pk_add_f32 v[54:55], v[54:55], 1.0 op_sel_hi:[1,0]
v_pk_add_f32 v[56:57], v[56:57], 1.0 op_sel_hi:[1,0]
v_pk_add_f32 v[58:59], v[58:59], 1.0 op_sel_hi:[1,0]
v_pk_add_f32 v[60:61], v[60:61], 1.0 op_sel_hi:[1,0]
v_pk_add_f32 v[62:63], v[62:63], 1.0 op_sel_hi:[1,0]
v_mfma_f32_32x32x16_bf16 v[16:31], v[140:143], a[12:15], v[16:31]
ds_read_b128 v[76:79], v6 offset:528
v_rcp_f32 v48, v48
v_rcp_f32 v49, v49
v_rcp_f32 v50, v50
v_mfma_f32_32x32x16_bf16 v[16:31], v[144:147], a[16:19], v[16:31]
ds_read_b128 v[80:83], v5 offset:1056
v_rcp_f32 v51, v51
v_rcp_f32 v52, v52
v_rcp_f32 v53, v53
v_mfma_f32_32x32x16_bf16 v[16:31], v[148:151], a[20:23], v[16:31]
ds_read_b128 v[84:87], v6 offset:1056
v_rcp_f32 v54, v54
v_rcp_f32 v55, v55
v_rcp_f32 v56, v56
v_rcp_f32 v57, v57
v_rcp_f32 v58, v58
v_rcp_f32 v59, v59
v_rcp_f32 v60, v60
v_rcp_f32 v61, v61
v_rcp_f32 v62, v62
v_rcp_f32 v63, v63
v_pk_mul_f32 v[32:33], v[48:49], v[32:33]
v_pk_mul_f32 v[34:35], v[50:51], v[34:35]
v_pk_mul_f32 v[36:37], v[52:53], v[36:37]
v_pk_mul_f32 v[38:39], v[54:55], v[38:39]
v_pk_mul_f32 v[40:41], v[56:57], v[40:41]
v_pk_mul_f32 v[42:43], v[58:59], v[42:43]
v_pk_mul_f32 v[44:45], v[60:61], v[44:45]
v_pk_mul_f32 v[46:47], v[62:63], v[46:47]
v_pk_fma_f32 v[122:123], v[32:33], v[32:33], v[122:123]
v_pk_fma_f32 v[48:49], v[16:17], v[16:17], s[60:61] neg_lo:[1,0,0] neg_hi:[1,0,0]
v_pk_fma_f32 v[122:123], v[34:35], v[34:35], v[122:123]
v_pk_fma_f32 v[50:51], v[18:19], v[18:19], s[60:61] neg_lo:[1,0,0] neg_hi:[1,0,0]
v_pk_fma_f32 v[122:123], v[36:37], v[36:37], v[122:123]
v_pk_fma_f32 v[52:53], v[20:21], v[20:21], s[60:61] neg_lo:[1,0,0] neg_hi:[1,0,0]
v_pk_fma_f32 v[122:123], v[38:39], v[38:39], v[122:123]
v_pk_fma_f32 v[54:55], v[22:23], v[22:23], s[60:61] neg_lo:[1,0,0] neg_hi:[1,0,0]
v_pk_fma_f32 v[122:123], v[40:41], v[40:41], v[122:123]
v_pk_fma_f32 v[56:57], v[24:25], v[24:25], s[60:61] neg_lo:[1,0,0] neg_hi:[1,0,0]
v_pk_fma_f32 v[122:123], v[42:43], v[42:43], v[122:123]
v_pk_fma_f32 v[58:59], v[26:27], v[26:27], s[60:61] neg_lo:[1,0,0] neg_hi:[1,0,0]
v_pk_fma_f32 v[122:123], v[44:45], v[44:45], v[122:123]
v_pk_fma_f32 v[60:61], v[28:29], v[28:29], s[60:61] neg_lo:[1,0,0] neg_hi:[1,0,0]
v_pk_fma_f32 v[122:123], v[46:47], v[46:47], v[122:123]
v_pk_fma_f32 v[62:63], v[30:31], v[30:31], s[60:61] neg_lo:[1,0,0] neg_hi:[1,0,0]
v_pk_mul_f32 v[48:49], v[48:49], v[16:17]
v_pk_mul_f32 v[50:51], v[50:51], v[18:19]
v_pk_mul_f32 v[52:53], v[52:53], v[20:21]
v_pk_mul_f32 v[54:55], v[54:55], v[22:23]
v_pk_mul_f32 v[56:57], v[56:57], v[24:25]
v_pk_mul_f32 v[58:59], v[58:59], v[26:27]
v_pk_mul_f32 v[60:61], v[60:61], v[28:29]
v_pk_mul_f32 v[62:63], v[62:63], v[30:31]
L_b1_2:
v_mfma_f32_32x32x16_bf16 v[32:47], v[128:131], a[24:27], 0
v_exp_f32 v48, v48
v_exp_f32 v49, v49
v_exp_f32 v50, v50
v_mfma_f32_32x32x16_bf16 v[32:47], v[132:135], a[28:31], v[32:47]
v_exp_f32 v51, v51
v_exp_f32 v52, v52
v_exp_f32 v53, v53
v_mfma_f32_32x32x16_bf16 v[32:47], v[136:139], a[32:35], v[32:47]
v_exp_f32 v54, v54
v_exp_f32 v55, v55
v_exp_f32 v56, v56
s_waitcnt vmcnt(2) lgkmcnt(0)
v_mfma_f32_32x32x16_bf16 v[152:167], v[64:67], v[200:203], 0
v_exp_f32 v57, v57
v_exp_f32 v58, v58
v_exp_f32 v59, v59
v_mfma_f32_32x32x16_bf16 v[152:167], v[68:71], v[204:207], v[152:167]
v_exp_f32 v60, v60
v_exp_f32 v61, v61
v_exp_f32 v62, v62
v_exp_f32_e64 v63, v63
v_pk_add_f32 v[48:49], v[48:49], 1.0 op_sel_hi:[1,0]
v_pk_add_f32 v[50:51], v[50:51], 1.0 op_sel_hi:[1,0]
v_pk_add_f32 v[52:53], v[52:53], 1.0 op_sel_hi:[1,0]
v_pk_add_f32 v[54:55], v[54:55], 1.0 op_sel_hi:[1,0]
v_pk_add_f32 v[56:57], v[56:57], 1.0 op_sel_hi:[1,0]
v_pk_add_f32 v[58:59], v[58:59], 1.0 op_sel_hi:[1,0]
v_pk_add_f32 v[60:61], v[60:61], 1.0 op_sel_hi:[1,0]
v_pk_add_f32 v[62:63], v[62:63], 1.0 op_sel_hi:[1,0]
v_mfma_f32_32x32x16_bf16 v[32:47], v[140:143], a[36:39], v[32:47]
v_rcp_f32 v48, v48
v_rcp_f32 v49, v49
v_rcp_f32 v50, v50
v_mfma_f32_32x32x16_bf16 v[32:47], v[144:147], a[40:43], v[32:47]
v_rcp_f32 v51, v51
v_rcp_f32 v52, v52
v_rcp_f32 v53, v53
v_mfma_f32_32x32x16_bf16 v[32:47], v[148:151], a[44:47], v[32:47]
v_rcp_f32 v54, v54
v_rcp_f32 v55, v55
v_rcp_f32 v56, v56
v_mfma_f32_32x32x16_bf16 v[168:183], v[72:75], v[208:211], 0
v_rcp_f32 v57, v57
v_rcp_f32 v58, v58
v_rcp_f32 v59, v59
v_mfma_f32_32x32x16_bf16 v[168:183], v[76:79], v[212:215], v[168:183]
v_rcp_f32 v60, v60
v_rcp_f32 v61, v61
v_rcp_f32 v62, v62
v_rcp_f32 v63, v63
v_pk_mul_f32 v[16:17], v[48:49], v[16:17]
v_pk_mul_f32 v[18:19], v[50:51], v[18:19]
v_pk_mul_f32 v[20:21], v[52:53], v[20:21]
v_pk_mul_f32 v[22:23], v[54:55], v[22:23]
v_pk_mul_f32 v[24:25], v[56:57], v[24:25]
v_pk_mul_f32 v[26:27], v[58:59], v[26:27]
v_pk_mul_f32 v[28:29], v[60:61], v[28:29]
v_pk_mul_f32 v[30:31], v[62:63], v[30:31]
v_pk_fma_f32 v[100:101], v[16:17], v[16:17], v[100:101]
v_pk_fma_f32 v[48:49], v[32:33], v[32:33], s[60:61] neg_lo:[1,0,0] neg_hi:[1,0,0]
v_pk_fma_f32 v[100:101], v[18:19], v[18:19], v[100:101]
v_pk_fma_f32 v[50:51], v[34:35], v[34:35], s[60:61] neg_lo:[1,0,0] neg_hi:[1,0,0]
v_pk_fma_f32 v[100:101], v[20:21], v[20:21], v[100:101]
v_pk_fma_f32 v[52:53], v[36:37], v[36:37], s[60:61] neg_lo:[1,0,0] neg_hi:[1,0,0]
v_pk_fma_f32 v[100:101], v[22:23], v[22:23], v[100:101]
v_pk_fma_f32 v[54:55], v[38:39], v[38:39], s[60:61] neg_lo:[1,0,0] neg_hi:[1,0,0]
v_pk_fma_f32 v[100:101], v[24:25], v[24:25], v[100:101]
v_pk_fma_f32 v[56:57], v[40:41], v[40:41], s[60:61] neg_lo:[1,0,0] neg_hi:[1,0,0]
v_pk_fma_f32 v[100:101], v[26:27], v[26:27], v[100:101]
v_pk_fma_f32 v[58:59], v[42:43], v[42:43], s[60:61] neg_lo:[1,0,0] neg_hi:[1,0,0]
v_pk_fma_f32 v[100:101], v[28:29], v[28:29], v[100:101]
v_pk_fma_f32 v[60:61], v[44:45], v[44:45], s[60:61] neg_lo:[1,0,0] neg_hi:[1,0,0]
v_pk_fma_f32 v[100:101], v[30:31], v[30:31], v[100:101]
v_pk_fma_f32 v[62:63], v[46:47], v[46:47], s[60:61] neg_lo:[1,0,0] neg_hi:[1,0,0]
v_pk_mul_f32 v[48:49], v[48:49], v[32:33]
v_pk_mul_f32 v[50:51], v[50:51], v[34:35]
v_pk_mul_f32 v[52:53], v[52:53], v[36:37]
v_pk_mul_f32 v[54:55], v[54:55], v[38:39]
v_pk_mul_f32 v[56:57], v[56:57], v[40:41]
v_pk_mul_f32 v[58:59], v[58:59], v[42:43]
v_pk_mul_f32 v[60:61], v[60:61], v[44:45]
v_pk_mul_f32 v[62:63], v[62:63], v[46:47]
v_add_u32_e64 v3, s21, v3
v_cvt_pk_bf16_f32 v248, v16, v17
v_cvt_pk_bf16_f32 v249, v18, v19
v_cvt_pk_bf16_f32 v250, v20, v21
v_cvt_pk_bf16_f32 v251, v22, v23
v_cvt_pk_bf16_f32 v252, v24, v25
v_cvt_pk_bf16_f32 v253, v26, v27
v_cvt_pk_bf16_f32 v254, v28, v29
v_cvt_pk_bf16_f32 v255, v30, v31
v_mfma_f32_32x32x16_bf16 v[16:31], v[128:131], a[48:51], 0
ds_write_b64 v3, v[248:249] offset:0
v_exp_f32 v48, v48
v_exp_f32 v49, v49
v_exp_f32 v50, v50
v_mfma_f32_32x32x16_bf16 v[16:31], v[132:135], a[52:55], v[16:31]
ds_write_b64 v3, v[250:251] offset:128
v_exp_f32 v51, v51
v_exp_f32 v52, v52
v_exp_f32 v53, v53
v_mfma_f32_32x32x16_bf16 v[16:31], v[136:139], a[56:59], v[16:31]
ds_write_b64 v3, v[252:253] offset:1024
v_exp_f32 v54, v54
v_exp_f32 v55, v55
v_exp_f32 v56, v56
v_mfma_f32_32x32x16_bf16 v[184:199], v[80:83], v[216:219], 0
v_exp_f32 v57, v57
v_exp_f32 v58, v58
v_exp_f32 v59, v59
v_mfma_f32_32x32x16_bf16 v[184:199], v[84:87], v[220:223], v[184:199]
v_exp_f32 v60, v60
v_exp_f32 v61, v61
v_exp_f32 v62, v62
v_exp_f32 v63, v63
v_pk_add_f32 v[48:49], v[48:49], 1.0 op_sel_hi:[1,0]
v_pk_add_f32 v[50:51], v[50:51], 1.0 op_sel_hi:[1,0]
v_pk_add_f32 v[52:53], v[52:53], 1.0 op_sel_hi:[1,0]
v_pk_add_f32 v[54:55], v[54:55], 1.0 op_sel_hi:[1,0]
v_pk_add_f32 v[56:57], v[56:57], 1.0 op_sel_hi:[1,0]
v_pk_add_f32 v[58:59], v[58:59], 1.0 op_sel_hi:[1,0]
v_pk_add_f32 v[60:61], v[60:61], 1.0 op_sel_hi:[1,0]
v_pk_add_f32 v[62:63], v[62:63], 1.0 op_sel_hi:[1,0]
v_mfma_f32_32x32x16_bf16 v[16:31], v[140:143], a[60:63], v[16:31]
ds_write_b64 v3, v[254:255] offset:1152
s_mov_b32 s64, 25165824
v_rcp_f32 v48, v48
v_rcp_f32 v49, v49
v_rcp_f32 v50, v50
v_mfma_f32_32x32x16_bf16 v[16:31], v[144:147], a[64:67], v[16:31]
buffer_load_dwordx4 v[200:203], v2, s[24:27], s64 offen offset:0
v_rcp_f32 v51, v51
v_rcp_f32 v52, v52
v_rcp_f32 v53, v53
v_mfma_f32_32x32x16_bf16 v[16:31], v[148:151], a[68:71], v[16:31]
buffer_load_dwordx4 v[204:207], v2, s[24:27], s64 offen offset:16
v_rcp_f32 v54, v54
v_rcp_f32 v55, v55
v_rcp_f32 v56, v56
v_rcp_f32 v57, v57
v_rcp_f32 v58, v58
v_rcp_f32 v59, v59
v_rcp_f32 v60, v60
v_rcp_f32 v61, v61
v_rcp_f32 v62, v62
v_rcp_f32 v63, v63
v_pk_mul_f32 v[32:33], v[48:49], v[32:33]
v_pk_mul_f32 v[34:35], v[50:51], v[34:35]
v_pk_mul_f32 v[36:37], v[52:53], v[36:37]
v_pk_mul_f32 v[38:39], v[54:55], v[38:39]
v_pk_mul_f32 v[40:41], v[56:57], v[40:41]
v_pk_mul_f32 v[42:43], v[58:59], v[42:43]
v_pk_mul_f32 v[44:45], v[60:61], v[44:45]
v_pk_mul_f32 v[46:47], v[62:63], v[46:47]
v_pk_fma_f32 v[102:103], v[32:33], v[32:33], v[102:103]
v_pk_fma_f32 v[48:49], v[16:17], v[16:17], s[60:61] neg_lo:[1,0,0] neg_hi:[1,0,0]
v_pk_fma_f32 v[102:103], v[34:35], v[34:35], v[102:103]
v_pk_fma_f32 v[50:51], v[18:19], v[18:19], s[60:61] neg_lo:[1,0,0] neg_hi:[1,0,0]
v_pk_fma_f32 v[102:103], v[36:37], v[36:37], v[102:103]
v_pk_fma_f32 v[52:53], v[20:21], v[20:21], s[60:61] neg_lo:[1,0,0] neg_hi:[1,0,0]
v_pk_fma_f32 v[102:103], v[38:39], v[38:39], v[102:103]
v_pk_fma_f32 v[54:55], v[22:23], v[22:23], s[60:61] neg_lo:[1,0,0] neg_hi:[1,0,0]
v_pk_fma_f32 v[102:103], v[40:41], v[40:41], v[102:103]
v_pk_fma_f32 v[56:57], v[24:25], v[24:25], s[60:61] neg_lo:[1,0,0] neg_hi:[1,0,0]
v_pk_fma_f32 v[102:103], v[42:43], v[42:43], v[102:103]
v_pk_fma_f32 v[58:59], v[26:27], v[26:27], s[60:61] neg_lo:[1,0,0] neg_hi:[1,0,0]
v_pk_fma_f32 v[102:103], v[44:45], v[44:45], v[102:103]
v_pk_fma_f32 v[60:61], v[28:29], v[28:29], s[60:61] neg_lo:[1,0,0] neg_hi:[1,0,0]
v_pk_fma_f32 v[102:103], v[46:47], v[46:47], v[102:103]
v_pk_fma_f32 v[62:63], v[30:31], v[30:31], s[60:61] neg_lo:[1,0,0] neg_hi:[1,0,0]
v_pk_mul_f32 v[48:49], v[48:49], v[16:17]
v_pk_mul_f32 v[50:51], v[50:51], v[18:19]
v_pk_mul_f32 v[52:53], v[52:53], v[20:21]
v_pk_mul_f32 v[54:55], v[54:55], v[22:23]
v_pk_mul_f32 v[56:57], v[56:57], v[24:25]
v_pk_mul_f32 v[58:59], v[58:59], v[26:27]
v_pk_mul_f32 v[60:61], v[60:61], v[28:29]
v_pk_mul_f32 v[62:63], v[62:63], v[30:31]
v_pk_mul_f32 v[10:11], v[152:153], v[152:153]
v_pk_add_f32 v[8:9], v[152:153], v[154:155]
v_pk_fma_f32 v[10:11], v[154:155], v[154:155], v[10:11]
v_pk_add_f32 v[8:9], v[8:9], v[156:157]
v_pk_fma_f32 v[10:11], v[156:157], v[156:157], v[10:11]
v_pk_add_f32 v[8:9], v[8:9], v[158:159]
v_pk_fma_f32 v[10:11], v[158:159], v[158:159], v[10:11]
v_pk_add_f32 v[8:9], v[8:9], v[160:161]
v_pk_fma_f32 v[10:11], v[160:161], v[160:161], v[10:11]
v_pk_add_f32 v[8:9], v[8:9], v[162:163]
v_pk_fma_f32 v[10:11], v[162:163], v[162:163], v[10:11]
v_pk_add_f32 v[8:9], v[8:9], v[164:165]
v_pk_fma_f32 v[10:11], v[164:165], v[164:165], v[10:11]
v_pk_add_f32 v[8:9], v[8:9], v[166:167]
v_pk_fma_f32 v[10:11], v[166:167], v[166:167], v[10:11]
v_pk_add_f32 v[8:9], v[8:9], v[168:169]
v_pk_fma_f32 v[10:11], v[168:169], v[168:169], v[10:11]
v_pk_add_f32 v[8:9], v[8:9], v[170:171]
v_pk_fma_f32 v[10:11], v[170:171], v[170:171], v[10:11]
v_pk_add_f32 v[8:9], v[8:9], v[172:173]
v_pk_fma_f32 v[10:11], v[172:173], v[172:173], v[10:11]
v_pk_add_f32 v[8:9], v[8:9], v[174:175]
v_pk_fma_f32 v[10:11], v[174:175], v[174:175], v[10:11]
v_pk_add_f32 v[8:9], v[8:9], v[176:177]
v_pk_fma_f32 v[10:11], v[176:177], v[176:177], v[10:11]
v_pk_add_f32 v[8:9], v[8:9], v[178:179]
v_pk_fma_f32 v[10:11], v[178:179], v[178:179], v[10:11]
v_pk_add_f32 v[8:9], v[8:9], v[180:181]
v_pk_fma_f32 v[10:11], v[180:181], v[180:181], v[10:11]
v_pk_add_f32 v[8:9], v[8:9], v[182:183]
v_pk_fma_f32 v[10:11], v[182:183], v[182:183], v[10:11]
v_pk_add_f32 v[8:9], v[8:9], v[184:185]
v_pk_fma_f32 v[10:11], v[184:185], v[184:185], v[10:11]
v_pk_add_f32 v[8:9], v[8:9], v[186:187]
v_pk_fma_f32 v[10:11], v[186:187], v[186:187], v[10:11]
v_pk_add_f32 v[8:9], v[8:9], v[188:189]
v_pk_fma_f32 v[10:11], v[188:189], v[188:189], v[10:11]
v_pk_add_f32 v[8:9], v[8:9], v[190:191]
v_pk_fma_f32 v[10:11], v[190:191], v[190:191], v[10:11]
v_pk_add_f32 v[8:9], v[8:9], v[192:193]
v_pk_fma_f32 v[10:11], v[192:193], v[192:193], v[10:11]
v_pk_add_f32 v[8:9], v[8:9], v[194:195]
v_pk_fma_f32 v[10:11], v[194:195], v[194:195], v[10:11]
v_pk_add_f32 v[8:9], v[8:9], v[196:197]
v_pk_fma_f32 v[10:11], v[196:197], v[196:197], v[10:11]
v_pk_add_f32 v[8:9], v[8:9], v[198:199]
v_pk_fma_f32 v[10:11], v[198:199], v[198:199], v[10:11]
v_cvt_pk_bf16_f32 v248, v32, v33
v_cvt_pk_bf16_f32 v249, v34, v35
v_cvt_pk_bf16_f32 v250, v36, v37
v_cvt_pk_bf16_f32 v251, v38, v39
v_cvt_pk_bf16_f32 v252, v40, v41
v_cvt_pk_bf16_f32 v253, v42, v43
v_cvt_pk_bf16_f32 v254, v44, v45
v_cvt_pk_bf16_f32 v255, v46, v47
v_mfma_f32_32x32x16_bf16 v[32:47], v[128:131], a[72:75], 0
ds_write_b64 v3, v[248:249] offset:2048
v_exp_f32 v48, v48
v_exp_f32 v49, v49
v_add_f32 v8, v8, v9
v_exp_f32 v50, v50
v_mfma_f32_32x32x16_bf16 v[32:47], v[132:135], a[76:79], v[32:47]
ds_write_b64 v3, v[250:251] offset:2176
buffer_load_dwordx4 v[208:211], v2, s[24:27], s64 offen offset:64
v_add_f32 v10, v10, v11
v_exp_f32 v51, v51
s_nop 0
v_permlane32_swap_b32 v8, v10
v_mfma_f32_32x32x16_bf16 v[32:47], v[136:139], a[80:83], v[32:47]
ds_write_b64 v3, v[252:253] offset:3072
buffer_load_dwordx4 v[212:215], v2, s[24:27], s64 offen offset:80
v_exp_f32 v52, v52
v_add_f32 v8, v8, v10
v_exp_f32 v53, v53
v_mov_b32 v10, v8
v_exp_f32 v54, v54
s_nop 0
v_permlane32_swap_b32 v8, v10
v_exp_f32 v55, v55
v_mul_f32 v13, 0x3c2aaaab, v8
v_exp_f32 v56, v56
v_exp_f32 v57, v57
v_mul_f32 v10, 0x3c2aaaab, v10
v_exp_f32 v58, v58
v_fma_f32 v10, -v13, v13, v10
v_exp_f32 v59, v59
v_max_f32 v10, 0, v10
v_exp_f32 v60, v60
v_add_f32 v10, 0x3727c5ac, v10
v_exp_f32 v61, v61
v_rsq_f32 v12, v10
v_exp_f32 v62, v62
v_mul_f32 v12, 0x3eeff558, v12
v_exp_f32 v63, v63
v_mul_f32_e64 v13, v13, v12
v_pk_add_f32 v[48:49], v[48:49], 1.0 op_sel_hi:[1,0]
v_pk_add_f32 v[50:51], v[50:51], 1.0 op_sel_hi:[1,0]
v_pk_add_f32 v[52:53], v[52:53], 1.0 op_sel_hi:[1,0]
v_pk_add_f32 v[54:55], v[54:55], 1.0 op_sel_hi:[1,0]
v_pk_add_f32 v[56:57], v[56:57], 1.0 op_sel_hi:[1,0]
v_pk_add_f32 v[58:59], v[58:59], 1.0 op_sel_hi:[1,0]
v_pk_add_f32 v[60:61], v[60:61], 1.0 op_sel_hi:[1,0]
v_pk_add_f32 v[62:63], v[62:63], 1.0 op_sel_hi:[1,0]
v_mfma_f32_32x32x16_bf16 v[32:47], v[140:143], a[84:87], v[32:47]
ds_write_b64 v3, v[254:255] offset:3200
v_rcp_f32 v48, v48
v_rcp_f32 v49, v49
v_rcp_f32 v50, v50
v_mfma_f32_32x32x16_bf16 v[32:47], v[144:147], a[88:91], v[32:47]
buffer_load_dwordx4 v[216:219], v2, s[24:27], s64 offen offset:128
v_rcp_f32 v51, v51
v_rcp_f32 v52, v52
v_rcp_f32 v53, v53
v_mfma_f32_32x32x16_bf16 v[32:47], v[148:151], a[92:95], v[32:47]
buffer_load_dwordx4 v[220:223], v2, s[24:27], s64 offen offset:144
v_rcp_f32 v54, v54
v_rcp_f32 v55, v55
v_rcp_f32 v56, v56
v_rcp_f32 v57, v57
v_rcp_f32 v58, v58
v_rcp_f32 v59, v59
v_rcp_f32 v60, v60
v_rcp_f32 v61, v61
v_rcp_f32 v62, v62
v_rcp_f32 v63, v63
v_pk_mul_f32 v[16:17], v[48:49], v[16:17]
v_pk_mul_f32 v[18:19], v[50:51], v[18:19]
v_pk_mul_f32 v[20:21], v[52:53], v[20:21]
v_pk_mul_f32 v[22:23], v[54:55], v[22:23]
v_pk_mul_f32 v[24:25], v[56:57], v[24:25]
v_pk_mul_f32 v[26:27], v[58:59], v[26:27]
v_pk_mul_f32 v[28:29], v[60:61], v[28:29]
v_pk_mul_f32 v[30:31], v[62:63], v[30:31]
v_pk_fma_f32 v[104:105], v[16:17], v[16:17], v[104:105]
v_pk_fma_f32 v[48:49], v[32:33], v[32:33], s[60:61] neg_lo:[1,0,0] neg_hi:[1,0,0]
v_pk_fma_f32 v[104:105], v[18:19], v[18:19], v[104:105]
v_pk_fma_f32 v[50:51], v[34:35], v[34:35], s[60:61] neg_lo:[1,0,0] neg_hi:[1,0,0]
v_pk_fma_f32 v[104:105], v[20:21], v[20:21], v[104:105]
v_pk_fma_f32 v[52:53], v[36:37], v[36:37], s[60:61] neg_lo:[1,0,0] neg_hi:[1,0,0]
v_pk_fma_f32 v[104:105], v[22:23], v[22:23], v[104:105]
v_pk_fma_f32 v[54:55], v[38:39], v[38:39], s[60:61] neg_lo:[1,0,0] neg_hi:[1,0,0]
v_pk_fma_f32 v[104:105], v[24:25], v[24:25], v[104:105]
v_pk_fma_f32 v[56:57], v[40:41], v[40:41], s[60:61] neg_lo:[1,0,0] neg_hi:[1,0,0]
v_pk_fma_f32 v[104:105], v[26:27], v[26:27], v[104:105]
v_pk_fma_f32 v[58:59], v[42:43], v[42:43], s[60:61] neg_lo:[1,0,0] neg_hi:[1,0,0]
v_pk_fma_f32 v[104:105], v[28:29], v[28:29], v[104:105]
v_pk_fma_f32 v[60:61], v[44:45], v[44:45], s[60:61] neg_lo:[1,0,0] neg_hi:[1,0,0]
v_pk_fma_f32 v[104:105], v[30:31], v[30:31], v[104:105]
v_pk_fma_f32 v[62:63], v[46:47], v[46:47], s[60:61] neg_lo:[1,0,0] neg_hi:[1,0,0]
v_pk_mul_f32 v[48:49], v[48:49], v[32:33]
v_pk_mul_f32 v[50:51], v[50:51], v[34:35]
v_pk_mul_f32 v[52:53], v[52:53], v[36:37]
v_pk_mul_f32 v[54:55], v[54:55], v[38:39]
v_pk_mul_f32 v[56:57], v[56:57], v[40:41]
v_pk_mul_f32 v[58:59], v[58:59], v[42:43]
v_pk_mul_f32 v[60:61], v[60:61], v[44:45]
v_pk_mul_f32 v[62:63], v[62:63], v[46:47]
v_pk_fma_f32 v[152:153], v[152:153], v[12:13], v[12:13] op_sel:[0,0,1] op_sel_hi:[1,0,1] neg_lo:[0,0,1] neg_hi:[0,0,1]
v_pk_fma_f32 v[154:155], v[154:155], v[12:13], v[12:13] op_sel:[0,0,1] op_sel_hi:[1,0,1] neg_lo:[0,0,1] neg_hi:[0,0,1]
v_pk_fma_f32 v[156:157], v[156:157], v[12:13], v[12:13] op_sel:[0,0,1] op_sel_hi:[1,0,1] neg_lo:[0,0,1] neg_hi:[0,0,1]
v_pk_fma_f32 v[158:159], v[158:159], v[12:13], v[12:13] op_sel:[0,0,1] op_sel_hi:[1,0,1] neg_lo:[0,0,1] neg_hi:[0,0,1]
v_pk_fma_f32 v[160:161], v[160:161], v[12:13], v[12:13] op_sel:[0,0,1] op_sel_hi:[1,0,1] neg_lo:[0,0,1] neg_hi:[0,0,1]
v_pk_fma_f32 v[162:163], v[162:163], v[12:13], v[12:13] op_sel:[0,0,1] op_sel_hi:[1,0,1] neg_lo:[0,0,1] neg_hi:[0,0,1]
v_pk_fma_f32 v[164:165], v[164:165], v[12:13], v[12:13] op_sel:[0,0,1] op_sel_hi:[1,0,1] neg_lo:[0,0,1] neg_hi:[0,0,1]
v_pk_fma_f32 v[166:167], v[166:167], v[12:13], v[12:13] op_sel:[0,0,1] op_sel_hi:[1,0,1] neg_lo:[0,0,1] neg_hi:[0,0,1]
v_pk_fma_f32 v[168:169], v[168:169], v[12:13], v[12:13] op_sel:[0,0,1] op_sel_hi:[1,0,1] neg_lo:[0,0,1] neg_hi:[0,0,1]
v_pk_fma_f32 v[170:171], v[170:171], v[12:13], v[12:13] op_sel:[0,0,1] op_sel_hi:[1,0,1] neg_lo:[0,0,1] neg_hi:[0,0,1]
v_pk_fma_f32 v[172:173], v[172:173], v[12:13], v[12:13] op_sel:[0,0,1] op_sel_hi:[1,0,1] neg_lo:[0,0,1] neg_hi:[0,0,1]
v_pk_fma_f32 v[174:175], v[174:175], v[12:13], v[12:13] op_sel:[0,0,1] op_sel_hi:[1,0,1] neg_lo:[0,0,1] neg_hi:[0,0,1]
v_pk_fma_f32 v[176:177], v[176:177], v[12:13], v[12:13] op_sel:[0,0,1] op_sel_hi:[1,0,1] neg_lo:[0,0,1] neg_hi:[0,0,1]
v_pk_fma_f32 v[178:179], v[178:179], v[12:13], v[12:13] op_sel:[0,0,1] op_sel_hi:[1,0,1] neg_lo:[0,0,1] neg_hi:[0,0,1]
v_pk_fma_f32 v[180:181], v[180:181], v[12:13], v[12:13] op_sel:[0,0,1] op_sel_hi:[1,0,1] neg_lo:[0,0,1] neg_hi:[0,0,1]
v_pk_fma_f32 v[182:183], v[182:183], v[12:13], v[12:13] op_sel:[0,0,1] op_sel_hi:[1,0,1] neg_lo:[0,0,1] neg_hi:[0,0,1]
v_pk_fma_f32 v[184:185], v[184:185], v[12:13], v[12:13] op_sel:[0,0,1] op_sel_hi:[1,0,1] neg_lo:[0,0,1] neg_hi:[0,0,1]
v_pk_fma_f32 v[186:187], v[186:187], v[12:13], v[12:13] op_sel:[0,0,1] op_sel_hi:[1,0,1] neg_lo:[0,0,1] neg_hi:[0,0,1]
v_pk_fma_f32 v[188:189], v[188:189], v[12:13], v[12:13] op_sel:[0,0,1] op_sel_hi:[1,0,1] neg_lo:[0,0,1] neg_hi:[0,0,1]
v_pk_fma_f32 v[190:191], v[190:191], v[12:13], v[12:13] op_sel:[0,0,1] op_sel_hi:[1,0,1] neg_lo:[0,0,1] neg_hi:[0,0,1]
v_pk_fma_f32 v[192:193], v[192:193], v[12:13], v[12:13] op_sel:[0,0,1] op_sel_hi:[1,0,1] neg_lo:[0,0,1] neg_hi:[0,0,1]
v_pk_fma_f32 v[194:195], v[194:195], v[12:13], v[12:13] op_sel:[0,0,1] op_sel_hi:[1,0,1] neg_lo:[0,0,1] neg_hi:[0,0,1]
v_pk_fma_f32 v[196:197], v[196:197], v[12:13], v[12:13] op_sel:[0,0,1] op_sel_hi:[1,0,1] neg_lo:[0,0,1] neg_hi:[0,0,1]
v_pk_fma_f32 v[198:199], v[198:199], v[12:13], v[12:13] op_sel:[0,0,1] op_sel_hi:[1,0,1] neg_lo:[0,0,1] neg_hi:[0,0,1]
v_cvt_pk_bf16_f32 v248, v16, v17
v_cvt_pk_bf16_f32 v249, v18, v19
v_cvt_pk_bf16_f32 v250, v20, v21
v_cvt_pk_bf16_f32 v251, v22, v23
v_cvt_pk_bf16_f32 v252, v24, v25
v_cvt_pk_bf16_f32 v253, v26, v27
v_cvt_pk_bf16_f32 v254, v28, v29
v_cvt_pk_bf16_f32 v255, v30, v31
v_mfma_f32_32x32x16_bf16 v[16:31], v[128:131], a[96:99], 0
ds_write_b64 v3, v[248:249] offset:4096
v_exp_f32 v48, v48
v_exp_f32 v49, v49
v_cvt_pk_bf16_f32 v64, v152, v153
v_exp_f32_e64 v50, v50
v_mfma_f32_32x32x16_bf16 v[16:31], v[132:135], a[100:103], v[16:31]
ds_write_b64 v3, v[250:251] offset:4224
v_cvt_pk_bf16_f32 v65, v154, v155
v_exp_f32 v51, v51
v_cvt_pk_bf16_f32 v66, v156, v157
v_exp_f32 v52, v52
v_mfma_f32_32x32x16_bf16 v[16:31], v[136:139], a[104:107], v[16:31]
ds_write_b64 v3, v[252:253] offset:5120
v_exp_f32 v53, v53
v_cvt_pk_bf16_f32 v67, v158, v159
v_exp_f32 v54, v54
v_cvt_pk_bf16_f32 v68, v160, v161
v_exp_f32 v55, v55
v_cvt_pk_bf16_f32 v69, v162, v163
v_exp_f32 v56, v56
v_exp_f32 v57, v57
v_cvt_pk_bf16_f32 v70, v164, v165
v_exp_f32 v58, v58
v_cvt_pk_bf16_f32 v71, v166, v167
v_exp_f32 v59, v59
v_cvt_pk_bf16_f32 v72, v168, v169
v_exp_f32 v60, v60
v_exp_f32 v61, v61
v_cvt_pk_bf16_f32 v73, v170, v171
v_exp_f32 v62, v62
v_cvt_pk_bf16_f32 v74, v172, v173
v_exp_f32_e64 v63, v63
v_cvt_pk_bf16_f32 v75, v174, v175
v_pk_add_f32 v[48:49], v[48:49], 1.0 op_sel_hi:[1,0]
v_pk_add_f32 v[50:51], v[50:51], 1.0 op_sel_hi:[1,0]
v_pk_add_f32 v[52:53], v[52:53], 1.0 op_sel_hi:[1,0]
v_pk_add_f32 v[54:55], v[54:55], 1.0 op_sel_hi:[1,0]
v_pk_add_f32 v[56:57], v[56:57], 1.0 op_sel_hi:[1,0]
v_pk_add_f32 v[58:59], v[58:59], 1.0 op_sel_hi:[1,0]
v_pk_add_f32 v[60:61], v[60:61], 1.0 op_sel_hi:[1,0]
v_pk_add_f32 v[62:63], v[62:63], 1.0 op_sel_hi:[1,0]
v_mfma_f32_32x32x16_bf16 v[16:31], v[140:143], a[108:111], v[16:31]
ds_write_b64 v3, v[254:255] offset:5248
v_rcp_f32 v48, v48
v_rcp_f32 v49, v49
v_cvt_pk_bf16_f32 v76, v176, v177
v_rcp_f32 v50, v50
v_mfma_f32_32x32x16_bf16 v[16:31], v[144:147], a[112:115], v[16:31]
v_cvt_pk_bf16_f32 v77, v178, v179
v_rcp_f32 v51, v51
v_cvt_pk_bf16_f32 v78, v180, v181
v_rcp_f32 v52, v52
v_mfma_f32_32x32x16_bf16 v[16:31], v[148:151], a[116:119], v[16:31]
v_rcp_f32 v53, v53
v_cvt_pk_bf16_f32 v79, v182, v183
v_rcp_f32 v54, v54
v_cvt_pk_bf16_f32 v80, v184, v185
v_rcp_f32 v55, v55
v_cvt_pk_bf16_f32 v81, v186, v187
v_rcp_f32 v56, v56
v_rcp_f32 v57, v57
v_cvt_pk_bf16_f32 v82, v188, v189
v_rcp_f32 v58, v58
v_cvt_pk_bf16_f32 v83, v190, v191
v_rcp_f32 v59, v59
v_cvt_pk_bf16_f32 v84, v192, v193
v_rcp_f32 v60, v60
v_rcp_f32 v61, v61
v_cvt_pk_bf16_f32 v85, v194, v195
v_rcp_f32 v62, v62
v_cvt_pk_bf16_f32 v86, v196, v197
v_rcp_f32 v63, v63
v_cvt_pk_bf16_f32 v87, v198, v199
v_pk_mul_f32 v[32:33], v[48:49], v[32:33]
v_pk_mul_f32 v[34:35], v[50:51], v[34:35]
v_pk_mul_f32 v[36:37], v[52:53], v[36:37]
v_pk_mul_f32 v[38:39], v[54:55], v[38:39]
v_pk_mul_f32 v[40:41], v[56:57], v[40:41]
v_pk_mul_f32 v[42:43], v[58:59], v[42:43]
v_pk_mul_f32 v[44:45], v[60:61], v[44:45]
v_pk_mul_f32 v[46:47], v[62:63], v[46:47]
v_pk_fma_f32 v[106:107], v[32:33], v[32:33], v[106:107]
v_pk_fma_f32 v[48:49], v[16:17], v[16:17], s[60:61] neg_lo:[1,0,0] neg_hi:[1,0,0]
v_pk_fma_f32 v[106:107], v[34:35], v[34:35], v[106:107]
v_pk_fma_f32 v[50:51], v[18:19], v[18:19], s[60:61] neg_lo:[1,0,0] neg_hi:[1,0,0]
v_pk_fma_f32 v[106:107], v[36:37], v[36:37], v[106:107]
v_pk_fma_f32 v[52:53], v[20:21], v[20:21], s[60:61] neg_lo:[1,0,0] neg_hi:[1,0,0]
v_pk_fma_f32 v[106:107], v[38:39], v[38:39], v[106:107]
v_pk_fma_f32 v[54:55], v[22:23], v[22:23], s[60:61] neg_lo:[1,0,0] neg_hi:[1,0,0]
v_pk_fma_f32 v[106:107], v[40:41], v[40:41], v[106:107]
v_pk_fma_f32 v[56:57], v[24:25], v[24:25], s[60:61] neg_lo:[1,0,0] neg_hi:[1,0,0]
v_pk_fma_f32 v[106:107], v[42:43], v[42:43], v[106:107]
v_pk_fma_f32 v[58:59], v[26:27], v[26:27], s[60:61] neg_lo:[1,0,0] neg_hi:[1,0,0]
v_pk_fma_f32 v[106:107], v[44:45], v[44:45], v[106:107]
v_pk_fma_f32 v[60:61], v[28:29], v[28:29], s[60:61] neg_lo:[1,0,0] neg_hi:[1,0,0]
v_pk_fma_f32 v[106:107], v[46:47], v[46:47], v[106:107]
v_pk_fma_f32 v[62:63], v[30:31], v[30:31], s[60:61] neg_lo:[1,0,0] neg_hi:[1,0,0]
v_pk_mul_f32 v[48:49], v[48:49], v[16:17]
v_pk_mul_f32 v[50:51], v[50:51], v[18:19]
v_pk_mul_f32 v[52:53], v[52:53], v[20:21]
v_pk_mul_f32 v[54:55], v[54:55], v[22:23]
v_pk_mul_f32 v[56:57], v[56:57], v[24:25]
v_pk_mul_f32 v[58:59], v[58:59], v[26:27]
v_pk_mul_f32 v[60:61], v[60:61], v[28:29]
v_pk_mul_f32 v[62:63], v[62:63], v[30:31]
v_cvt_pk_bf16_f32 v248, v32, v33
v_cvt_pk_bf16_f32 v249, v34, v35
v_cvt_pk_bf16_f32 v250, v36, v37
v_cvt_pk_bf16_f32 v251, v38, v39
v_cvt_pk_bf16_f32 v252, v40, v41
v_cvt_pk_bf16_f32 v253, v42, v43
v_cvt_pk_bf16_f32 v254, v44, v45
v_cvt_pk_bf16_f32 v255, v46, v47
v_mfma_f32_32x32x16_bf16 v[32:47], v[128:131], a[120:123], 0
ds_write_b64 v3, v[248:249] offset:6144
v_exp_f32 v48, v48
v_exp_f32 v49, v49
v_exp_f32 v50, v50
v_mfma_f32_32x32x16_bf16 v[32:47], v[132:135], a[124:127], v[32:47]
ds_write_b64 v3, v[250:251] offset:6272
v_exp_f32 v51, v51
v_exp_f32 v52, v52
v_exp_f32 v53, v53
v_mfma_f32_32x32x16_bf16 v[32:47], v[136:139], a[128:131], v[32:47]
ds_write_b64 v3, v[252:253] offset:7168
v_exp_f32 v54, v54
v_exp_f32 v55, v55
v_exp_f32 v56, v56
v_exp_f32 v57, v57
v_exp_f32 v58, v58
v_exp_f32 v59, v59
v_exp_f32 v60, v60
v_exp_f32 v61, v61
v_exp_f32 v62, v62
v_exp_f32 v63, v63
v_pk_add_f32 v[48:49], v[48:49], 1.0 op_sel_hi:[1,0]
v_pk_add_f32 v[50:51], v[50:51], 1.0 op_sel_hi:[1,0]
v_pk_add_f32 v[52:53], v[52:53], 1.0 op_sel_hi:[1,0]
v_pk_add_f32 v[54:55], v[54:55], 1.0 op_sel_hi:[1,0]
v_pk_add_f32 v[56:57], v[56:57], 1.0 op_sel_hi:[1,0]
v_pk_add_f32 v[58:59], v[58:59], 1.0 op_sel_hi:[1,0]
v_pk_add_f32 v[60:61], v[60:61], 1.0 op_sel_hi:[1,0]
v_pk_add_f32 v[62:63], v[62:63], 1.0 op_sel_hi:[1,0]
v_mfma_f32_32x32x16_bf16 v[32:47], v[140:143], a[132:135], v[32:47]
ds_write_b64 v3, v[254:255] offset:7296
v_rcp_f32 v48, v48
v_rcp_f32 v49, v49
v_rcp_f32 v50, v50
v_mfma_f32_32x32x16_bf16 v[32:47], v[144:147], a[136:139], v[32:47]
v_rcp_f32 v51, v51
v_rcp_f32 v52, v52
v_rcp_f32 v53, v53
v_mfma_f32_32x32x16_bf16 v[32:47], v[148:151], a[140:143], v[32:47]
v_rcp_f32 v54, v54
v_rcp_f32 v55, v55
v_rcp_f32 v56, v56
v_rcp_f32 v57, v57
v_rcp_f32 v58, v58
v_rcp_f32 v59, v59
v_rcp_f32 v60, v60
v_rcp_f32 v61, v61
v_rcp_f32 v62, v62
v_rcp_f32 v63, v63
v_pk_mul_f32 v[16:17], v[48:49], v[16:17]
v_pk_mul_f32 v[18:19], v[50:51], v[18:19]
v_pk_mul_f32 v[20:21], v[52:53], v[20:21]
v_pk_mul_f32 v[22:23], v[54:55], v[22:23]
v_pk_mul_f32 v[24:25], v[56:57], v[24:25]
v_pk_mul_f32 v[26:27], v[58:59], v[26:27]
v_pk_mul_f32 v[28:29], v[60:61], v[28:29]
v_pk_mul_f32 v[30:31], v[62:63], v[30:31]
v_pk_fma_f32 v[108:109], v[16:17], v[16:17], v[108:109]
v_pk_fma_f32 v[48:49], v[32:33], v[32:33], s[60:61] neg_lo:[1,0,0] neg_hi:[1,0,0]
v_pk_fma_f32 v[108:109], v[18:19], v[18:19], v[108:109]
v_pk_fma_f32 v[50:51], v[34:35], v[34:35], s[60:61] neg_lo:[1,0,0] neg_hi:[1,0,0]
v_pk_fma_f32 v[108:109], v[20:21], v[20:21], v[108:109]
v_pk_fma_f32 v[52:53], v[36:37], v[36:37], s[60:61] neg_lo:[1,0,0] neg_hi:[1,0,0]
v_pk_fma_f32 v[108:109], v[22:23], v[22:23], v[108:109]
v_pk_fma_f32 v[54:55], v[38:39], v[38:39], s[60:61] neg_lo:[1,0,0] neg_hi:[1,0,0]
v_pk_fma_f32 v[108:109], v[24:25], v[24:25], v[108:109]
v_pk_fma_f32 v[56:57], v[40:41], v[40:41], s[60:61] neg_lo:[1,0,0] neg_hi:[1,0,0]
v_pk_fma_f32 v[108:109], v[26:27], v[26:27], v[108:109]
v_pk_fma_f32 v[58:59], v[42:43], v[42:43], s[60:61] neg_lo:[1,0,0] neg_hi:[1,0,0]
v_pk_fma_f32 v[108:109], v[28:29], v[28:29], v[108:109]
v_pk_fma_f32 v[60:61], v[44:45], v[44:45], s[60:61] neg_lo:[1,0,0] neg_hi:[1,0,0]
v_pk_fma_f32 v[108:109], v[30:31], v[30:31], v[108:109]
v_pk_fma_f32 v[62:63], v[46:47], v[46:47], s[60:61] neg_lo:[1,0,0] neg_hi:[1,0,0]
v_pk_mul_f32 v[48:49], v[48:49], v[32:33]
v_pk_mul_f32 v[50:51], v[50:51], v[34:35]
v_pk_mul_f32 v[52:53], v[52:53], v[36:37]
v_pk_mul_f32 v[54:55], v[54:55], v[38:39]
v_pk_mul_f32 v[56:57], v[56:57], v[40:41]
v_pk_mul_f32 v[58:59], v[58:59], v[42:43]
v_pk_mul_f32 v[60:61], v[60:61], v[44:45]
v_pk_mul_f32 v[62:63], v[62:63], v[46:47]
v_cvt_pk_bf16_f32 v248, v16, v17
v_cvt_pk_bf16_f32 v249, v18, v19
v_cvt_pk_bf16_f32 v250, v20, v21
v_cvt_pk_bf16_f32 v251, v22, v23
v_cvt_pk_bf16_f32 v252, v24, v25
v_cvt_pk_bf16_f32 v253, v26, v27
v_cvt_pk_bf16_f32 v254, v28, v29
v_cvt_pk_bf16_f32 v255, v30, v31
v_mfma_f32_32x32x16_bf16 v[16:31], v[128:131], a[144:147], 0
ds_write_b64 v3, v[248:249] offset:8192
v_exp_f32 v48, v48
v_exp_f32 v49, v49
v_exp_f32 v50, v50
v_mfma_f32_32x32x16_bf16 v[16:31], v[132:135], a[148:151], v[16:31]
ds_write_b64 v3, v[250:251] offset:8320
v_exp_f32 v51, v51
v_exp_f32 v52, v52
v_exp_f32 v53, v53
v_mfma_f32_32x32x16_bf16 v[16:31], v[136:139], a[152:155], v[16:31]
ds_write_b64 v3, v[252:253] offset:9216
v_exp_f32 v54, v54
v_exp_f32 v55, v55
v_exp_f32 v56, v56
v_exp_f32 v57, v57
v_exp_f32 v58, v58
v_exp_f32 v59, v59
v_exp_f32 v60, v60
v_exp_f32 v61, v61
v_exp_f32 v62, v62
v_exp_f32 v63, v63
v_pk_add_f32 v[48:49], v[48:49], 1.0 op_sel_hi:[1,0]
v_pk_add_f32 v[50:51], v[50:51], 1.0 op_sel_hi:[1,0]
v_pk_add_f32 v[52:53], v[52:53], 1.0 op_sel_hi:[1,0]
v_pk_add_f32 v[54:55], v[54:55], 1.0 op_sel_hi:[1,0]
v_pk_add_f32 v[56:57], v[56:57], 1.0 op_sel_hi:[1,0]
v_pk_add_f32 v[58:59], v[58:59], 1.0 op_sel_hi:[1,0]
v_pk_add_f32 v[60:61], v[60:61], 1.0 op_sel_hi:[1,0]
v_pk_add_f32 v[62:63], v[62:63], 1.0 op_sel_hi:[1,0]
v_mfma_f32_32x32x16_bf16 v[16:31], v[140:143], a[156:159], v[16:31]
ds_write_b64 v3, v[254:255] offset:9344
v_rcp_f32 v48, v48
v_rcp_f32 v49, v49
v_rcp_f32 v50, v50
v_mfma_f32_32x32x16_bf16 v[16:31], v[144:147], a[160:163], v[16:31]
v_rcp_f32 v51, v51
v_rcp_f32 v52, v52
v_rcp_f32 v53, v53
v_mfma_f32_32x32x16_bf16 v[16:31], v[148:151], a[164:167], v[16:31]
v_rcp_f32 v54, v54
v_rcp_f32 v55, v55
v_rcp_f32 v56, v56
v_rcp_f32 v57, v57
v_rcp_f32 v58, v58
v_rcp_f32 v59, v59
v_rcp_f32 v60, v60
v_rcp_f32 v61, v61
v_rcp_f32 v62, v62
v_rcp_f32 v63, v63
v_pk_mul_f32 v[32:33], v[48:49], v[32:33]
v_pk_mul_f32 v[34:35], v[50:51], v[34:35]
v_pk_mul_f32 v[36:37], v[52:53], v[36:37]
v_pk_mul_f32 v[38:39], v[54:55], v[38:39]
v_pk_mul_f32 v[40:41], v[56:57], v[40:41]
v_pk_mul_f32 v[42:43], v[58:59], v[42:43]
v_pk_mul_f32 v[44:45], v[60:61], v[44:45]
v_pk_mul_f32 v[46:47], v[62:63], v[46:47]
v_pk_fma_f32 v[110:111], v[32:33], v[32:33], v[110:111]
v_pk_fma_f32 v[48:49], v[16:17], v[16:17], s[60:61] neg_lo:[1,0,0] neg_hi:[1,0,0]
v_pk_fma_f32 v[110:111], v[34:35], v[34:35], v[110:111]
v_pk_fma_f32 v[50:51], v[18:19], v[18:19], s[60:61] neg_lo:[1,0,0] neg_hi:[1,0,0]
v_pk_fma_f32 v[110:111], v[36:37], v[36:37], v[110:111]
v_pk_fma_f32 v[52:53], v[20:21], v[20:21], s[60:61] neg_lo:[1,0,0] neg_hi:[1,0,0]
v_pk_fma_f32 v[110:111], v[38:39], v[38:39], v[110:111]
v_pk_fma_f32 v[54:55], v[22:23], v[22:23], s[60:61] neg_lo:[1,0,0] neg_hi:[1,0,0]
v_pk_fma_f32 v[110:111], v[40:41], v[40:41], v[110:111]
v_pk_fma_f32 v[56:57], v[24:25], v[24:25], s[60:61] neg_lo:[1,0,0] neg_hi:[1,0,0]
v_pk_fma_f32 v[110:111], v[42:43], v[42:43], v[110:111]
v_pk_fma_f32 v[58:59], v[26:27], v[26:27], s[60:61] neg_lo:[1,0,0] neg_hi:[1,0,0]
v_pk_fma_f32 v[110:111], v[44:45], v[44:45], v[110:111]
v_pk_fma_f32 v[60:61], v[28:29], v[28:29], s[60:61] neg_lo:[1,0,0] neg_hi:[1,0,0]
v_pk_fma_f32 v[110:111], v[46:47], v[46:47], v[110:111]
v_pk_fma_f32 v[62:63], v[30:31], v[30:31], s[60:61] neg_lo:[1,0,0] neg_hi:[1,0,0]
v_pk_mul_f32 v[48:49], v[48:49], v[16:17]
v_pk_mul_f32 v[50:51], v[50:51], v[18:19]
v_pk_mul_f32 v[52:53], v[52:53], v[20:21]
v_pk_mul_f32 v[54:55], v[54:55], v[22:23]
v_pk_mul_f32 v[56:57], v[56:57], v[24:25]
v_pk_mul_f32 v[58:59], v[58:59], v[26:27]
v_pk_mul_f32 v[60:61], v[60:61], v[28:29]
v_pk_mul_f32 v[62:63], v[62:63], v[30:31]
v_cvt_pk_bf16_f32 v248, v32, v33
v_cvt_pk_bf16_f32 v249, v34, v35
v_cvt_pk_bf16_f32 v250, v36, v37
v_cvt_pk_bf16_f32 v251, v38, v39
v_cvt_pk_bf16_f32 v252, v40, v41
v_cvt_pk_bf16_f32 v253, v42, v43
v_cvt_pk_bf16_f32 v254, v44, v45
v_cvt_pk_bf16_f32 v255, v46, v47
v_mfma_f32_32x32x16_bf16 v[32:47], v[128:131], a[168:171], 0
ds_write_b64 v3, v[248:249] offset:10240
v_exp_f32 v48, v48
v_exp_f32 v49, v49
v_exp_f32_e64 v50, v50
v_mfma_f32_32x32x16_bf16 v[32:47], v[132:135], a[172:175], v[32:47]
ds_write_b64 v3, v[250:251] offset:10368
s_add_u32 s74, s87, L_b1_3-L_pc
v_exp_f32 v51, v51
v_exp_f32 v52, v52
v_exp_f32_e64 v53, v53
v_mfma_f32_32x32x16_bf16 v[32:47], v[136:139], a[176:179], v[32:47]
ds_write_b64 v3, v[252:253] offset:11264
v_lshl_add_u32 v14, v0, 3, s74
v_exp_f32 v54, v54
v_exp_f32 v55, v55
v_min_u32 v14, L_pf1-L_pc-4, v14
v_exp_f32 v56, v56
v_exp_f32 v57, v57
v_exp_f32 v58, v58
v_mov_b32 v15, s89
v_exp_f32 v59, v59
v_exp_f32 v60, v60
v_exp_f32 v61, v61
v_add_co_u32 v14, vcc, s88, v14
v_exp_f32 v62, v62
v_exp_f32 v63, v63
v_addc_co_u32_e64 v15, vcc, 0, v15, vcc
v_pk_add_f32 v[48:49], v[48:49], 1.0 op_sel_hi:[1,0]
v_pk_add_f32 v[50:51], v[50:51], 1.0 op_sel_hi:[1,0]
v_pk_add_f32 v[52:53], v[52:53], 1.0 op_sel_hi:[1,0]
v_pk_add_f32 v[54:55], v[54:55], 1.0 op_sel_hi:[1,0]
v_pk_add_f32 v[56:57], v[56:57], 1.0 op_sel_hi:[1,0]
v_pk_add_f32 v[58:59], v[58:59], 1.0 op_sel_hi:[1,0]
v_pk_add_f32 v[60:61], v[60:61], 1.0 op_sel_hi:[1,0]
v_pk_add_f32 v[62:63], v[62:63], 1.0 op_sel_hi:[1,0]
v_mfma_f32_32x32x16_bf16 v[32:47], v[140:143], a[180:183], v[32:47]
ds_write_b64 v3, v[254:255] offset:11392
v_rcp_f32 v48, v48
v_rcp_f32 v49, v49
v_rcp_f32 v50, v50
v_mfma_f32_32x32x16_bf16 v[32:47], v[144:147], a[184:187], v[32:47]
s_waitcnt vmcnt(6)
global_load_dword v126, v[14:15], off
v_rcp_f32 v51, v51
v_rcp_f32 v52, v52
v_rcp_f32 v53, v53
v_mfma_f32_32x32x16_bf16 v[32:47], v[148:151], a[188:191], v[32:47]
v_rcp_f32 v54, v54
v_rcp_f32 v55, v55
v_rcp_f32 v56, v56
v_rcp_f32 v57, v57
v_rcp_f32 v58, v58
v_rcp_f32 v59, v59
v_rcp_f32 v60, v60
v_rcp_f32 v61, v61
v_rcp_f32 v62, v62
v_rcp_f32_e64 v63, v63
v_pk_mul_f32 v[16:17], v[48:49], v[16:17]
v_pk_mul_f32 v[18:19], v[50:51], v[18:19]
v_pk_mul_f32 v[20:21], v[52:53], v[20:21]
v_pk_mul_f32 v[22:23], v[54:55], v[22:23]
v_pk_mul_f32 v[24:25], v[56:57], v[24:25]
v_pk_mul_f32 v[26:27], v[58:59], v[26:27]
v_pk_mul_f32 v[28:29], v[60:61], v[28:29]
v_pk_mul_f32 v[30:31], v[62:63], v[30:31]
v_pk_fma_f32 v[112:113], v[16:17], v[16:17], v[112:113]
v_pk_fma_f32 v[48:49], v[32:33], v[32:33], s[60:61] neg_lo:[1,0,0] neg_hi:[1,0,0]
v_pk_fma_f32 v[112:113], v[18:19], v[18:19], v[112:113]
v_pk_fma_f32 v[50:51], v[34:35], v[34:35], s[60:61] neg_lo:[1,0,0] neg_hi:[1,0,0]
v_pk_fma_f32 v[112:113], v[20:21], v[20:21], v[112:113]
v_pk_fma_f32 v[52:53], v[36:37], v[36:37], s[60:61] neg_lo:[1,0,0] neg_hi:[1,0,0]
v_pk_fma_f32 v[112:113], v[22:23], v[22:23], v[112:113]
v_pk_fma_f32 v[54:55], v[38:39], v[38:39], s[60:61] neg_lo:[1,0,0] neg_hi:[1,0,0]
v_pk_fma_f32 v[112:113], v[24:25], v[24:25], v[112:113]
v_pk_fma_f32 v[56:57], v[40:41], v[40:41], s[60:61] neg_lo:[1,0,0] neg_hi:[1,0,0]
v_pk_fma_f32 v[112:113], v[26:27], v[26:27], v[112:113]
v_pk_fma_f32 v[58:59], v[42:43], v[42:43], s[60:61] neg_lo:[1,0,0] neg_hi:[1,0,0]
v_pk_fma_f32 v[112:113], v[28:29], v[28:29], v[112:113]
v_pk_fma_f32 v[60:61], v[44:45], v[44:45], s[60:61] neg_lo:[1,0,0] neg_hi:[1,0,0]
v_pk_fma_f32 v[112:113], v[30:31], v[30:31], v[112:113]
v_pk_fma_f32 v[62:63], v[46:47], v[46:47], s[60:61] neg_lo:[1,0,0] neg_hi:[1,0,0]
v_pk_mul_f32 v[48:49], v[48:49], v[32:33]
v_pk_mul_f32 v[50:51], v[50:51], v[34:35]
v_pk_mul_f32 v[52:53], v[52:53], v[36:37]
v_pk_mul_f32 v[54:55], v[54:55], v[38:39]
v_pk_mul_f32 v[56:57], v[56:57], v[40:41]
v_pk_mul_f32 v[58:59], v[58:59], v[42:43]
v_pk_mul_f32 v[60:61], v[60:61], v[44:45]
v_pk_mul_f32 v[62:63], v[62:63], v[46:47]
v_cvt_pk_bf16_f32 v248, v16, v17
v_cvt_pk_bf16_f32 v249, v18, v19
v_cvt_pk_bf16_f32 v250, v20, v21
v_cvt_pk_bf16_f32 v251, v22, v23
v_cvt_pk_bf16_f32 v252, v24, v25
v_cvt_pk_bf16_f32 v253, v26, v27
v_cvt_pk_bf16_f32 v254, v28, v29
v_cvt_pk_bf16_f32 v255, v30, v31
v_mfma_f32_32x32x16_bf16 v[16:31], v[128:131], a[192:195], 0
ds_write_b64 v3, v[248:249] offset:12288
v_exp_f32 v48, v48
v_exp_f32 v49, v49
v_exp_f32 v50, v50
v_mfma_f32_32x32x16_bf16 v[16:31], v[132:135], a[196:199], v[16:31]
ds_write_b64 v3, v[250:251] offset:12416
v_exp_f32 v51, v51
v_exp_f32 v52, v52
v_exp_f32 v53, v53
v_mfma_f32_32x32x16_bf16 v[16:31], v[136:139], a[200:203], v[16:31]
ds_write_b64 v3, v[252:253] offset:13312
v_exp_f32 v54, v54
v_exp_f32 v55, v55
v_exp_f32 v56, v56
v_exp_f32 v57, v57
v_exp_f32 v58, v58
v_exp_f32 v59, v59
v_exp_f32 v60, v60
v_exp_f32 v61, v61
v_exp_f32 v62, v62
v_exp_f32 v63, v63
v_pk_add_f32 v[48:49], v[48:49], 1.0 op_sel_hi:[1,0]
v_pk_add_f32 v[50:51], v[50:51], 1.0 op_sel_hi:[1,0]
v_pk_add_f32 v[52:53], v[52:53], 1.0 op_sel_hi:[1,0]
v_pk_add_f32 v[54:55], v[54:55], 1.0 op_sel_hi:[1,0]
v_pk_add_f32 v[56:57], v[56:57], 1.0 op_sel_hi:[1,0]
v_pk_add_f32 v[58:59], v[58:59], 1.0 op_sel_hi:[1,0]
v_pk_add_f32 v[60:61], v[60:61], 1.0 op_sel_hi:[1,0]
v_pk_add_f32 v[62:63], v[62:63], 1.0 op_sel_hi:[1,0]
v_mfma_f32_32x32x16_bf16 v[16:31], v[140:143], a[204:207], v[16:31]
ds_write_b64 v3, v[254:255] offset:13440
v_rcp_f32 v48, v48
v_rcp_f32 v49, v49
v_rcp_f32 v50, v50
v_mfma_f32_32x32x16_bf16 v[16:31], v[144:147], a[208:211], v[16:31]
v_rcp_f32 v51, v51
v_rcp_f32 v52, v52
v_rcp_f32 v53, v53
v_mfma_f32_32x32x16_bf16 v[16:31], v[148:151], a[212:215], v[16:31]
v_rcp_f32 v54, v54
v_rcp_f32 v55, v55
v_rcp_f32 v56, v56
v_rcp_f32 v57, v57
v_rcp_f32 v58, v58
v_rcp_f32 v59, v59
v_rcp_f32 v60, v60
v_rcp_f32 v61, v61
v_rcp_f32 v62, v62
v_rcp_f32 v63, v63
v_pk_mul_f32 v[32:33], v[48:49], v[32:33]
v_pk_mul_f32 v[34:35], v[50:51], v[34:35]
v_pk_mul_f32 v[36:37], v[52:53], v[36:37]
v_pk_mul_f32 v[38:39], v[54:55], v[38:39]
v_pk_mul_f32 v[40:41], v[56:57], v[40:41]
v_pk_mul_f32 v[42:43], v[58:59], v[42:43]
v_pk_mul_f32 v[44:45], v[60:61], v[44:45]
v_pk_mul_f32 v[46:47], v[62:63], v[46:47]
v_pk_fma_f32 v[114:115], v[32:33], v[32:33], v[114:115]
v_pk_fma_f32 v[48:49], v[16:17], v[16:17], s[60:61] neg_lo:[1,0,0] neg_hi:[1,0,0]
v_pk_fma_f32 v[114:115], v[34:35], v[34:35], v[114:115]
v_pk_fma_f32 v[50:51], v[18:19], v[18:19], s[60:61] neg_lo:[1,0,0] neg_hi:[1,0,0]
v_pk_fma_f32 v[114:115], v[36:37], v[36:37], v[114:115]
v_pk_fma_f32 v[52:53], v[20:21], v[20:21], s[60:61] neg_lo:[1,0,0] neg_hi:[1,0,0]
v_pk_fma_f32 v[114:115], v[38:39], v[38:39], v[114:115]
v_pk_fma_f32 v[54:55], v[22:23], v[22:23], s[60:61] neg_lo:[1,0,0] neg_hi:[1,0,0]
v_pk_fma_f32 v[114:115], v[40:41], v[40:41], v[114:115]
v_pk_fma_f32 v[56:57], v[24:25], v[24:25], s[60:61] neg_lo:[1,0,0] neg_hi:[1,0,0]
v_pk_fma_f32 v[114:115], v[42:43], v[42:43], v[114:115]
v_pk_fma_f32 v[58:59], v[26:27], v[26:27], s[60:61] neg_lo:[1,0,0] neg_hi:[1,0,0]
v_pk_fma_f32 v[114:115], v[44:45], v[44:45], v[114:115]
v_pk_fma_f32 v[60:61], v[28:29], v[28:29], s[60:61] neg_lo:[1,0,0] neg_hi:[1,0,0]
v_pk_fma_f32 v[114:115], v[46:47], v[46:47], v[114:115]
v_pk_fma_f32 v[62:63], v[30:31], v[30:31], s[60:61] neg_lo:[1,0,0] neg_hi:[1,0,0]
v_pk_mul_f32 v[48:49], v[48:49], v[16:17]
v_pk_mul_f32 v[50:51], v[50:51], v[18:19]
v_pk_mul_f32 v[52:53], v[52:53], v[20:21]
v_pk_mul_f32 v[54:55], v[54:55], v[22:23]
v_pk_mul_f32 v[56:57], v[56:57], v[24:25]
v_pk_mul_f32 v[58:59], v[58:59], v[26:27]
v_pk_mul_f32 v[60:61], v[60:61], v[28:29]
v_pk_mul_f32 v[62:63], v[62:63], v[30:31]
v_cvt_pk_bf16_f32 v248, v32, v33
v_cvt_pk_bf16_f32 v249, v34, v35
v_cvt_pk_bf16_f32 v250, v36, v37
v_cvt_pk_bf16_f32 v251, v38, v39
v_cvt_pk_bf16_f32 v252, v40, v41
v_cvt_pk_bf16_f32 v253, v42, v43
v_cvt_pk_bf16_f32 v254, v44, v45
v_cvt_pk_bf16_f32 v255, v46, v47
v_mfma_f32_32x32x16_bf16 v[32:47], v[128:131], a[216:219], 0
ds_write_b64 v3, v[248:249] offset:14336
v_exp_f32 v48, v48
v_exp_f32 v49, v49
v_exp_f32 v50, v50
v_mfma_f32_32x32x16_bf16 v[32:47], v[132:135], a[220:223], v[32:47]
ds_write_b64 v3, v[250:251] offset:14464
v_exp_f32 v51, v51
v_exp_f32 v52, v52
v_exp_f32 v53, v53
v_mfma_f32_32x32x16_bf16 v[32:47], v[136:139], a[224:227], v[32:47]
ds_write_b64 v3, v[252:253] offset:15360
v_exp_f32 v54, v54
v_exp_f32 v55, v55
v_exp_f32 v56, v56
v_exp_f32 v57, v57
v_exp_f32 v58, v58
v_exp_f32 v59, v59
v_exp_f32 v60, v60
v_exp_f32 v61, v61
v_exp_f32 v62, v62
v_exp_f32 v63, v63
v_pk_add_f32 v[48:49], v[48:49], 1.0 op_sel_hi:[1,0]
v_pk_add_f32 v[50:51], v[50:51], 1.0 op_sel_hi:[1,0]
v_pk_add_f32 v[52:53], v[52:53], 1.0 op_sel_hi:[1,0]
v_pk_add_f32 v[54:55], v[54:55], 1.0 op_sel_hi:[1,0]
v_pk_add_f32 v[56:57], v[56:57], 1.0 op_sel_hi:[1,0]
v_pk_add_f32 v[58:59], v[58:59], 1.0 op_sel_hi:[1,0]
v_pk_add_f32 v[60:61], v[60:61], 1.0 op_sel_hi:[1,0]
v_pk_add_f32 v[62:63], v[62:63], 1.0 op_sel_hi:[1,0]
v_mfma_f32_32x32x16_bf16 v[32:47], v[140:143], a[228:231], v[32:47]
ds_write_b64 v3, v[254:255] offset:15488
v_rcp_f32 v48, v48
v_rcp_f32 v49, v49
v_rcp_f32 v50, v50
v_mfma_f32_32x32x16_bf16 v[32:47], v[144:147], a[232:235], v[32:47]
v_rcp_f32 v51, v51
v_rcp_f32 v52, v52
v_rcp_f32 v53, v53
v_mfma_f32_32x32x16_bf16 v[32:47], v[148:151], a[236:239], v[32:47]
v_rcp_f32 v54, v54
v_rcp_f32 v55, v55
v_rcp_f32 v56, v56
v_rcp_f32 v57, v57
v_rcp_f32 v58, v58
v_rcp_f32 v59, v59
v_rcp_f32 v60, v60
v_rcp_f32 v61, v61
v_rcp_f32 v62, v62
v_rcp_f32 v63, v63
v_pk_mul_f32 v[16:17], v[48:49], v[16:17]
v_pk_mul_f32 v[18:19], v[50:51], v[18:19]
v_pk_mul_f32 v[20:21], v[52:53], v[20:21]
v_pk_mul_f32 v[22:23], v[54:55], v[22:23]
v_pk_mul_f32 v[24:25], v[56:57], v[24:25]
v_pk_mul_f32 v[26:27], v[58:59], v[26:27]
v_pk_mul_f32 v[28:29], v[60:61], v[28:29]
v_pk_mul_f32 v[30:31], v[62:63], v[30:31]
v_pk_fma_f32 v[116:117], v[16:17], v[16:17], v[116:117]
v_pk_fma_f32 v[48:49], v[32:33], v[32:33], s[60:61] neg_lo:[1,0,0] neg_hi:[1,0,0]
v_pk_fma_f32 v[116:117], v[18:19], v[18:19], v[116:117]
v_pk_fma_f32 v[50:51], v[34:35], v[34:35], s[60:61] neg_lo:[1,0,0] neg_hi:[1,0,0]
v_pk_fma_f32 v[116:117], v[20:21], v[20:21], v[116:117]
v_pk_fma_f32 v[52:53], v[36:37], v[36:37], s[60:61] neg_lo:[1,0,0] neg_hi:[1,0,0]
v_pk_fma_f32 v[116:117], v[22:23], v[22:23], v[116:117]
v_pk_fma_f32 v[54:55], v[38:39], v[38:39], s[60:61] neg_lo:[1,0,0] neg_hi:[1,0,0]
v_pk_fma_f32 v[116:117], v[24:25], v[24:25], v[116:117]
v_pk_fma_f32 v[56:57], v[40:41], v[40:41], s[60:61] neg_lo:[1,0,0] neg_hi:[1,0,0]
v_pk_fma_f32 v[116:117], v[26:27], v[26:27], v[116:117]
v_pk_fma_f32 v[58:59], v[42:43], v[42:43], s[60:61] neg_lo:[1,0,0] neg_hi:[1,0,0]
v_pk_fma_f32 v[116:117], v[28:29], v[28:29], v[116:117]
v_pk_fma_f32 v[60:61], v[44:45], v[44:45], s[60:61] neg_lo:[1,0,0] neg_hi:[1,0,0]
v_pk_fma_f32 v[116:117], v[30:31], v[30:31], v[116:117]
v_pk_fma_f32 v[62:63], v[46:47], v[46:47], s[60:61] neg_lo:[1,0,0] neg_hi:[1,0,0]
v_pk_mul_f32 v[48:49], v[48:49], v[32:33]
v_pk_mul_f32 v[50:51], v[50:51], v[34:35]
v_pk_mul_f32 v[52:53], v[52:53], v[36:37]
v_pk_mul_f32 v[54:55], v[54:55], v[38:39]
v_pk_mul_f32 v[56:57], v[56:57], v[40:41]
v_pk_mul_f32 v[58:59], v[58:59], v[42:43]
v_pk_mul_f32 v[60:61], v[60:61], v[44:45]
v_pk_mul_f32 v[62:63], v[62:63], v[46:47]
v_cvt_pk_bf16_f32 v248, v16, v17
v_cvt_pk_bf16_f32 v249, v18, v19
v_cvt_pk_bf16_f32 v250, v20, v21
v_cvt_pk_bf16_f32 v251, v22, v23
v_cvt_pk_bf16_f32 v252, v24, v25
v_cvt_pk_bf16_f32 v253, v26, v27
v_cvt_pk_bf16_f32 v254, v28, v29
v_cvt_pk_bf16_f32 v255, v30, v31
v_mfma_f32_32x32x16_bf16 v[16:31], v[128:131], a[240:243], 0
ds_write_b64 v3, v[248:249] offset:16384
v_exp_f32 v48, v48
v_exp_f32 v49, v49
v_exp_f32 v50, v50
v_mfma_f32_32x32x16_bf16 v[16:31], v[132:135], a[244:247], v[16:31]
ds_write_b64 v3, v[250:251] offset:16512
v_exp_f32 v51, v51
v_exp_f32 v52, v52
v_exp_f32 v53, v53
v_mfma_f32_32x32x16_bf16 v[16:31], v[136:139], a[248:251], v[16:31]
ds_write_b64 v3, v[252:253] offset:17408
v_exp_f32 v54, v54
v_exp_f32 v55, v55
v_exp_f32 v56, v56
v_exp_f32 v57, v57
v_exp_f32 v58, v58
v_exp_f32 v59, v59
v_exp_f32 v60, v60
v_exp_f32 v61, v61
v_exp_f32 v62, v62
v_exp_f32 v63, v63
v_pk_add_f32 v[48:49], v[48:49], 1.0 op_sel_hi:[1,0]
v_pk_add_f32 v[50:51], v[50:51], 1.0 op_sel_hi:[1,0]
v_pk_add_f32 v[52:53], v[52:53], 1.0 op_sel_hi:[1,0]
v_pk_add_f32 v[54:55], v[54:55], 1.0 op_sel_hi:[1,0]
v_pk_add_f32 v[56:57], v[56:57], 1.0 op_sel_hi:[1,0]
v_pk_add_f32 v[58:59], v[58:59], 1.0 op_sel_hi:[1,0]
v_pk_add_f32 v[60:61], v[60:61], 1.0 op_sel_hi:[1,0]
v_pk_add_f32 v[62:63], v[62:63], 1.0 op_sel_hi:[1,0]
v_mfma_f32_32x32x16_bf16 v[16:31], v[140:143], a[252:255], v[16:31]
ds_write_b64 v3, v[254:255] offset:17536
v_rcp_f32 v48, v48
v_rcp_f32 v49, v49
v_rcp_f32 v50, v50
v_mfma_f32_32x32x16_bf16 v[16:31], v[144:147], v[224:227], v[16:31]
v_rcp_f32 v51, v51
v_rcp_f32 v52, v52
v_rcp_f32 v53, v53
v_mfma_f32_32x32x16_bf16 v[16:31], v[148:151], v[228:231], v[16:31]
v_rcp_f32 v54, v54
v_rcp_f32 v55, v55
v_rcp_f32 v56, v56
v_rcp_f32 v57, v57
v_rcp_f32 v58, v58
v_rcp_f32 v59, v59
v_rcp_f32 v60, v60
v_rcp_f32 v61, v61
v_rcp_f32 v62, v62
v_rcp_f32 v63, v63
v_pk_mul_f32 v[32:33], v[48:49], v[32:33]
v_pk_mul_f32 v[34:35], v[50:51], v[34:35]
v_pk_mul_f32 v[36:37], v[52:53], v[36:37]
v_pk_mul_f32 v[38:39], v[54:55], v[38:39]
v_pk_mul_f32 v[40:41], v[56:57], v[40:41]
v_pk_mul_f32 v[42:43], v[58:59], v[42:43]
v_pk_mul_f32 v[44:45], v[60:61], v[44:45]
v_pk_mul_f32 v[46:47], v[62:63], v[46:47]
v_pk_fma_f32 v[118:119], v[32:33], v[32:33], v[118:119]
v_pk_fma_f32 v[48:49], v[16:17], v[16:17], s[60:61] neg_lo:[1,0,0] neg_hi:[1,0,0]
v_pk_fma_f32 v[118:119], v[34:35], v[34:35], v[118:119]
v_pk_fma_f32 v[50:51], v[18:19], v[18:19], s[60:61] neg_lo:[1,0,0] neg_hi:[1,0,0]
v_pk_fma_f32 v[118:119], v[36:37], v[36:37], v[118:119]
v_pk_fma_f32 v[52:53], v[20:21], v[20:21], s[60:61] neg_lo:[1,0,0] neg_hi:[1,0,0]
v_pk_fma_f32 v[118:119], v[38:39], v[38:39], v[118:119]
v_pk_fma_f32 v[54:55], v[22:23], v[22:23], s[60:61] neg_lo:[1,0,0] neg_hi:[1,0,0]
v_pk_fma_f32 v[118:119], v[40:41], v[40:41], v[118:119]
v_pk_fma_f32 v[56:57], v[24:25], v[24:25], s[60:61] neg_lo:[1,0,0] neg_hi:[1,0,0]
v_pk_fma_f32 v[118:119], v[42:43], v[42:43], v[118:119]
v_pk_fma_f32 v[58:59], v[26:27], v[26:27], s[60:61] neg_lo:[1,0,0] neg_hi:[1,0,0]
v_pk_fma_f32 v[118:119], v[44:45], v[44:45], v[118:119]
v_pk_fma_f32 v[60:61], v[28:29], v[28:29], s[60:61] neg_lo:[1,0,0] neg_hi:[1,0,0]
v_pk_fma_f32 v[118:119], v[46:47], v[46:47], v[118:119]
v_pk_fma_f32 v[62:63], v[30:31], v[30:31], s[60:61] neg_lo:[1,0,0] neg_hi:[1,0,0]
v_pk_mul_f32 v[48:49], v[48:49], v[16:17]
v_pk_mul_f32 v[50:51], v[50:51], v[18:19]
v_pk_mul_f32 v[52:53], v[52:53], v[20:21]
v_pk_mul_f32 v[54:55], v[54:55], v[22:23]
v_pk_mul_f32 v[56:57], v[56:57], v[24:25]
v_pk_mul_f32 v[58:59], v[58:59], v[26:27]
v_pk_mul_f32 v[60:61], v[60:61], v[28:29]
v_pk_mul_f32 v[62:63], v[62:63], v[30:31]
v_subrev_u32_e64 v3, s21, v3
v_cvt_pk_bf16_f32 v248, v32, v33
v_cvt_pk_bf16_f32 v249, v34, v35
v_cvt_pk_bf16_f32 v250, v36, v37
v_cvt_pk_bf16_f32 v251, v38, v39
v_cvt_pk_bf16_f32 v252, v40, v41
v_cvt_pk_bf16_f32 v253, v42, v43
v_cvt_pk_bf16_f32 v254, v44, v45
v_cvt_pk_bf16_f32 v255, v46, v47
v_mfma_f32_32x32x16_bf16 v[32:47], v[128:131], v[232:235], 0
ds_write_b64 v3, v[248:249] offset:0
v_exp_f32 v48, v48
v_exp_f32 v49, v49
v_exp_f32_e64 v50, v50
v_mfma_f32_32x32x16_bf16 v[32:47], v[132:135], v[236:239], v[32:47]
ds_read_b128 v[92:95], v7 offset:6144
ds_write_b64 v3, v[250:251] offset:128
v_exp_f32 v51, v51
v_exp_f32 v52, v52
v_exp_f32_e64 v53, v53
v_mfma_f32_32x32x16_bf16 v[32:47], v[136:139], v[240:243], v[32:47]
ds_read_b128 v[96:99], v7 offset:6656
ds_write_b64 v3, v[252:253] offset:1024
v_exp_f32 v54, v54
v_exp_f32 v55, v55
v_exp_f32 v56, v56
v_exp_f32 v57, v57
v_exp_f32 v58, v58
v_exp_f32 v59, v59
v_exp_f32 v60, v60
v_exp_f32 v61, v61
v_exp_f32 v62, v62
v_exp_f32 v63, v63
v_pk_add_f32 v[48:49], v[48:49], 1.0 op_sel_hi:[1,0]
v_pk_add_f32 v[50:51], v[50:51], 1.0 op_sel_hi:[1,0]
v_pk_add_f32 v[52:53], v[52:53], 1.0 op_sel_hi:[1,0]
v_pk_add_f32 v[54:55], v[54:55], 1.0 op_sel_hi:[1,0]
v_pk_add_f32 v[56:57], v[56:57], 1.0 op_sel_hi:[1,0]
v_pk_add_f32 v[58:59], v[58:59], 1.0 op_sel_hi:[1,0]
v_pk_add_f32 v[60:61], v[60:61], 1.0 op_sel_hi:[1,0]
v_pk_add_f32 v[62:63], v[62:63], 1.0 op_sel_hi:[1,0]
v_mfma_f32_32x32x16_bf16 v[32:47], v[140:143], v[244:247], v[32:47]
ds_write_b64 v3, v[254:255] offset:1152
v_rcp_f32 v48, v48
v_rcp_f32 v49, v49
v_rcp_f32 v50, v50
s_waitcnt lgkmcnt(1)
v_mfma_f32_32x32x16_bf16 v[32:47], v[144:147], v[92:95], v[32:47]
ds_read_b64_tr_b16 v[232:233], v4 offset:0
ds_read_b64_tr_b16 v[234:235], v4 offset:512
v_rcp_f32 v51, v51
v_rcp_f32 v52, v52
v_rcp_f32_e64 v53, v53
v_mfma_f32_32x32x16_bf16 v[32:47], v[148:151], v[96:99], v[32:47]
ds_read_b64_tr_b16 v[236:237], v4 offset:1024
ds_read_b64_tr_b16 v[238:239], v4 offset:1536
v_rcp_f32 v54, v54
v_rcp_f32 v55, v55
v_rcp_f32 v56, v56
v_rcp_f32 v57, v57
v_rcp_f32 v58, v58
v_rcp_f32 v59, v59
v_rcp_f32 v60, v60
v_rcp_f32 v61, v61
v_rcp_f32 v62, v62
v_rcp_f32 v63, v63
v_pk_mul_f32 v[16:17], v[48:49], v[16:17]
v_pk_mul_f32 v[18:19], v[50:51], v[18:19]
v_pk_mul_f32 v[20:21], v[52:53], v[20:21]
v_pk_mul_f32 v[22:23], v[54:55], v[22:23]
v_pk_mul_f32 v[24:25], v[56:57], v[24:25]
v_pk_mul_f32 v[26:27], v[58:59], v[26:27]
v_pk_mul_f32 v[28:29], v[60:61], v[28:29]
v_pk_mul_f32 v[30:31], v[62:63], v[30:31]
v_pk_fma_f32 v[120:121], v[16:17], v[16:17], v[120:121]
v_pk_fma_f32 v[48:49], v[32:33], v[32:33], s[60:61] neg_lo:[1,0,0] neg_hi:[1,0,0]
v_pk_fma_f32 v[120:121], v[18:19], v[18:19], v[120:121]
v_pk_fma_f32 v[50:51], v[34:35], v[34:35], s[60:61] neg_lo:[1,0,0] neg_hi:[1,0,0]
v_pk_fma_f32 v[120:121], v[20:21], v[20:21], v[120:121]
v_pk_fma_f32 v[52:53], v[36:37], v[36:37], s[60:61] neg_lo:[1,0,0] neg_hi:[1,0,0]
v_pk_fma_f32 v[120:121], v[22:23], v[22:23], v[120:121]
v_pk_fma_f32 v[54:55], v[38:39], v[38:39], s[60:61] neg_lo:[1,0,0] neg_hi:[1,0,0]
v_pk_fma_f32 v[120:121], v[24:25], v[24:25], v[120:121]
v_pk_fma_f32 v[56:57], v[40:41], v[40:41], s[60:61] neg_lo:[1,0,0] neg_hi:[1,0,0]
v_pk_fma_f32 v[120:121], v[26:27], v[26:27], v[120:121]
v_pk_fma_f32 v[58:59], v[42:43], v[42:43], s[60:61] neg_lo:[1,0,0] neg_hi:[1,0,0]
v_pk_fma_f32 v[120:121], v[28:29], v[28:29], v[120:121]
v_pk_fma_f32 v[60:61], v[44:45], v[44:45], s[60:61] neg_lo:[1,0,0] neg_hi:[1,0,0]
v_pk_fma_f32 v[120:121], v[30:31], v[30:31], v[120:121]
v_pk_fma_f32 v[62:63], v[46:47], v[46:47], s[60:61] neg_lo:[1,0,0] neg_hi:[1,0,0]
v_pk_mul_f32 v[48:49], v[48:49], v[32:33]
v_pk_mul_f32 v[50:51], v[50:51], v[34:35]
v_pk_mul_f32 v[52:53], v[52:53], v[36:37]
v_pk_mul_f32 v[54:55], v[54:55], v[38:39]
v_pk_mul_f32 v[56:57], v[56:57], v[40:41]
v_pk_mul_f32 v[58:59], v[58:59], v[42:43]
v_pk_mul_f32 v[60:61], v[60:61], v[44:45]
v_pk_mul_f32 v[62:63], v[62:63], v[46:47]
v_cvt_pk_bf16_f32 v248, v16, v17
v_cvt_pk_bf16_f32 v249, v18, v19
v_cvt_pk_bf16_f32 v250, v20, v21
v_cvt_pk_bf16_f32 v251, v22, v23
v_cvt_pk_bf16_f32 v252, v24, v25
v_cvt_pk_bf16_f32 v253, v26, v27
v_cvt_pk_bf16_f32 v254, v28, v29
v_cvt_pk_bf16_f32 v255, v30, v31
v_mfma_f32_32x32x16_bf16 v[16:31], v[64:67], a[0:3], 0
ds_write_b64 v3, v[248:249] offset:0
v_exp_f32 v48, v48
v_exp_f32 v49, v49
v_exp_f32_e64 v50, v50
v_mfma_f32_32x32x16_bf16 v[16:31], v[68:71], a[4:7], v[16:31]
ds_write_b64 v3, v[250:251] offset:128
ds_read_b128 v[128:131], v5 offset:0
v_exp_f32 v51, v51
v_exp_f32 v52, v52
v_exp_f32_e64 v53, v53
v_mfma_f32_32x32x16_bf16 v[16:31], v[72:75], a[8:11], v[16:31]
ds_write_b64 v3, v[252:253] offset:1024
s_add_u32 s81, s80, 0
s_waitcnt lgkmcnt(3)
buffer_store_dwordx4 v[232:235], v0, s[40:43], s81 offen offset:0 sc1
ds_read_b128 v[132:135], v6 offset:0
ds_read_b128 v[136:139], v5 offset:528
v_exp_f32 v54, v54
v_exp_f32 v55, v55
v_exp_f32 v56, v56
v_exp_f32 v57, v57
v_exp_f32 v58, v58
v_exp_f32 v59, v59
v_exp_f32 v60, v60
v_exp_f32 v61, v61
v_exp_f32 v62, v62
v_exp_f32 v63, v63
v_pk_add_f32 v[48:49], v[48:49], 1.0 op_sel_hi:[1,0]
v_pk_add_f32 v[50:51], v[50:51], 1.0 op_sel_hi:[1,0]
v_pk_add_f32 v[52:53], v[52:53], 1.0 op_sel_hi:[1,0]
v_pk_add_f32 v[54:55], v[54:55], 1.0 op_sel_hi:[1,0]
v_pk_add_f32 v[56:57], v[56:57], 1.0 op_sel_hi:[1,0]
v_pk_add_f32 v[58:59], v[58:59], 1.0 op_sel_hi:[1,0]
v_pk_add_f32 v[60:61], v[60:61], 1.0 op_sel_hi:[1,0]
v_pk_add_f32 v[62:63], v[62:63], 1.0 op_sel_hi:[1,0]
v_mfma_f32_32x32x16_bf16 v[16:31], v[76:79], a[12:15], v[16:31]
ds_write_b64 v3, v[254:255] offset:1152
buffer_store_dwordx4 v[236:239], v0, s[40:43], s81 offen offset:1024 sc1
v_rcp_f32 v48, v48
v_rcp_f32 v49, v49
v_rcp_f32_e64 v50, v50
v_mfma_f32_32x32x16_bf16 v[16:31], v[80:83], a[16:19], v[16:31]
ds_read_b64_tr_b16 v[240:241], v4 offset:0
ds_read_b64_tr_b16 v[242:243], v4 offset:512
v_rcp_f32 v51, v51
v_rcp_f32 v52, v52
v_mfma_f32_32x32x16_bf16 v[16:31], v[84:87], a[20:23], v[16:31]
ds_read_b64_tr_b16 v[244:245], v4 offset:1024
ds_read_b64_tr_b16 v[246:247], v4 offset:1536
ds_read_b128 v[140:143], v6 offset:528
ds_read_b128 v[144:147], v5 offset:1056
ds_read_b128 v[148:151], v6 offset:1056
v_rcp_f32 v53, v53
v_rcp_f32 v54, v54
v_rcp_f32 v55, v55
v_rcp_f32 v56, v56
v_rcp_f32 v57, v57
v_rcp_f32 v58, v58
v_rcp_f32 v59, v59
v_rcp_f32 v60, v60
v_rcp_f32 v61, v61
v_rcp_f32 v62, v62
v_rcp_f32_e64 v63, v63
v_pk_mul_f32 v[32:33], v[48:49], v[32:33]
v_pk_mul_f32 v[34:35], v[50:51], v[34:35]
v_pk_mul_f32 v[36:37], v[52:53], v[36:37]
v_pk_mul_f32 v[38:39], v[54:55], v[38:39]
v_pk_mul_f32 v[40:41], v[56:57], v[40:41]
v_pk_mul_f32 v[42:43], v[58:59], v[42:43]
v_pk_mul_f32 v[44:45], v[60:61], v[44:45]
v_pk_mul_f32 v[46:47], v[62:63], v[46:47]
v_pk_fma_f32 v[122:123], v[32:33], v[32:33], v[122:123]
v_pk_fma_f32 v[48:49], v[16:17], v[16:17], s[60:61] neg_lo:[1,0,0] neg_hi:[1,0,0]
v_pk_fma_f32 v[122:123], v[34:35], v[34:35], v[122:123]
v_pk_fma_f32 v[50:51], v[18:19], v[18:19], s[60:61] neg_lo:[1,0,0] neg_hi:[1,0,0]
v_pk_fma_f32 v[122:123], v[36:37], v[36:37], v[122:123]
v_pk_fma_f32 v[52:53], v[20:21], v[20:21], s[60:61] neg_lo:[1,0,0] neg_hi:[1,0,0]
v_pk_fma_f32 v[122:123], v[38:39], v[38:39], v[122:123]
v_pk_fma_f32 v[54:55], v[22:23], v[22:23], s[60:61] neg_lo:[1,0,0] neg_hi:[1,0,0]
v_pk_fma_f32 v[122:123], v[40:41], v[40:41], v[122:123]
v_pk_fma_f32 v[56:57], v[24:25], v[24:25], s[60:61] neg_lo:[1,0,0] neg_hi:[1,0,0]
v_pk_fma_f32 v[122:123], v[42:43], v[42:43], v[122:123]
v_pk_fma_f32 v[58:59], v[26:27], v[26:27], s[60:61] neg_lo:[1,0,0] neg_hi:[1,0,0]
v_pk_fma_f32 v[122:123], v[44:45], v[44:45], v[122:123]
v_pk_fma_f32 v[60:61], v[28:29], v[28:29], s[60:61] neg_lo:[1,0,0] neg_hi:[1,0,0]
v_pk_fma_f32 v[122:123], v[46:47], v[46:47], v[122:123]
v_pk_fma_f32 v[62:63], v[30:31], v[30:31], s[60:61] neg_lo:[1,0,0] neg_hi:[1,0,0]
v_pk_mul_f32 v[48:49], v[48:49], v[16:17]
v_pk_mul_f32 v[50:51], v[50:51], v[18:19]
v_pk_mul_f32 v[52:53], v[52:53], v[20:21]
v_pk_mul_f32 v[54:55], v[54:55], v[22:23]
v_pk_mul_f32 v[56:57], v[56:57], v[24:25]
v_pk_mul_f32 v[58:59], v[58:59], v[26:27]
v_pk_mul_f32 v[60:61], v[60:61], v[28:29]
v_pk_mul_f32 v[62:63], v[62:63], v[30:31]
L_b1_3:
v_cvt_pk_bf16_f32 v248, v32, v33
v_cvt_pk_bf16_f32 v249, v34, v35
v_cvt_pk_bf16_f32 v250, v36, v37
v_cvt_pk_bf16_f32 v251, v38, v39
v_cvt_pk_bf16_f32 v252, v40, v41
v_cvt_pk_bf16_f32 v253, v42, v43
v_cvt_pk_bf16_f32 v254, v44, v45
v_cvt_pk_bf16_f32 v255, v46, v47
v_mfma_f32_32x32x16_bf16 v[32:47], v[64:67], a[24:27], 0
ds_write_b64 v3, v[248:249] offset:0
v_exp_f32 v48, v48
v_exp_f32 v49, v49
v_exp_f32 v50, v50
v_mfma_f32_32x32x16_bf16 v[32:47], v[68:71], a[28:31], v[32:47]
ds_write_b64 v3, v[250:251] offset:128
v_exp_f32 v51, v51
v_exp_f32 v52, v52
v_exp_f32 v53, v53
v_mfma_f32_32x32x16_bf16 v[32:47], v[72:75], a[32:35], v[32:47]
ds_write_b64 v3, v[252:253] offset:1024
s_add_u32 s81, s80, 2048
s_waitcnt lgkmcnt(2)
buffer_store_dwordx4 v[240:243], v0, s[40:43], s81 offen offset:0 sc1
v_exp_f32 v54, v54
v_exp_f32 v55, v55
s_waitcnt vmcnt(4)
v_mfma_f32_32x32x16_bf16 v[152:167], v[128:131], v[200:203], 0
v_exp_f32 v56, v56
v_exp_f32 v57, v57
v_exp_f32 v58, v58
v_mfma_f32_32x32x16_bf16 v[152:167], v[132:135], v[204:207], v[152:167]
v_exp_f32 v59, v59
v_exp_f32 v60, v60
v_exp_f32 v61, v61
v_exp_f32 v62, v62
v_exp_f32 v63, v63
v_pk_add_f32 v[48:49], v[48:49], 1.0 op_sel_hi:[1,0]
v_pk_add_f32 v[50:51], v[50:51], 1.0 op_sel_hi:[1,0]
v_pk_add_f32 v[52:53], v[52:53], 1.0 op_sel_hi:[1,0]
v_pk_add_f32 v[54:55], v[54:55], 1.0 op_sel_hi:[1,0]
v_pk_add_f32 v[56:57], v[56:57], 1.0 op_sel_hi:[1,0]
v_pk_add_f32 v[58:59], v[58:59], 1.0 op_sel_hi:[1,0]
v_pk_add_f32 v[60:61], v[60:61], 1.0 op_sel_hi:[1,0]
v_pk_add_f32 v[62:63], v[62:63], 1.0 op_sel_hi:[1,0]
v_mfma_f32_32x32x16_bf16 v[32:47], v[76:79], a[36:39], v[32:47]
ds_write_b64 v3, v[254:255] offset:1152
buffer_store_dwordx4 v[244:247], v0, s[40:43], s81 offen offset:1024 sc1
v_rcp_f32 v48, v48
v_rcp_f32 v49, v49
v_rcp_f32_e64 v50, v50
v_mfma_f32_32x32x16_bf16 v[32:47], v[80:83], a[40:43], v[32:47]
ds_read_b64_tr_b16 v[232:233], v4 offset:0
ds_read_b64_tr_b16 v[234:235], v4 offset:512
v_rcp_f32 v51, v51
v_rcp_f32 v52, v52
v_mfma_f32_32x32x16_bf16 v[32:47], v[84:87], a[44:47], v[32:47]
ds_read_b64_tr_b16 v[236:237], v4 offset:1024
ds_read_b64_tr_b16 v[238:239], v4 offset:1536
v_rcp_f32 v53, v53
v_rcp_f32 v54, v54
v_rcp_f32 v55, v55
v_mfma_f32_32x32x16_bf16 v[168:183], v[136:139], v[208:211], 0
v_rcp_f32 v56, v56
v_rcp_f32 v57, v57
v_rcp_f32 v58, v58
v_mfma_f32_32x32x16_bf16 v[168:183], v[140:143], v[212:215], v[168:183]
v_rcp_f32 v59, v59
v_rcp_f32 v60, v60
v_rcp_f32 v61, v61
v_rcp_f32 v62, v62
v_rcp_f32_e64 v63, v63
v_pk_mul_f32 v[16:17], v[48:49], v[16:17]
v_pk_mul_f32 v[18:19], v[50:51], v[18:19]
v_pk_mul_f32 v[20:21], v[52:53], v[20:21]
v_pk_mul_f32 v[22:23], v[54:55], v[22:23]
v_pk_mul_f32 v[24:25], v[56:57], v[24:25]
v_pk_mul_f32 v[26:27], v[58:59], v[26:27]
v_pk_mul_f32 v[28:29], v[60:61], v[28:29]
v_pk_mul_f32 v[30:31], v[62:63], v[30:31]
v_pk_fma_f32 v[100:101], v[16:17], v[16:17], v[100:101]
v_pk_fma_f32 v[48:49], v[32:33], v[32:33], s[60:61] neg_lo:[1,0,0] neg_hi:[1,0,0]
v_pk_fma_f32 v[100:101], v[18:19], v[18:19], v[100:101]
v_pk_fma_f32 v[50:51], v[34:35], v[34:35], s[60:61] neg_lo:[1,0,0] neg_hi:[1,0,0]
v_pk_fma_f32 v[100:101], v[20:21], v[20:21], v[100:101]
v_pk_fma_f32 v[52:53], v[36:37], v[36:37], s[60:61] neg_lo:[1,0,0] neg_hi:[1,0,0]
v_pk_fma_f32 v[100:101], v[22:23], v[22:23], v[100:101]
v_pk_fma_f32 v[54:55], v[38:39], v[38:39], s[60:61] neg_lo:[1,0,0] neg_hi:[1,0,0]
v_pk_fma_f32 v[100:101], v[24:25], v[24:25], v[100:101]
v_pk_fma_f32 v[56:57], v[40:41], v[40:41], s[60:61] neg_lo:[1,0,0] neg_hi:[1,0,0]
v_pk_fma_f32 v[100:101], v[26:27], v[26:27], v[100:101]
v_pk_fma_f32 v[58:59], v[42:43], v[42:43], s[60:61] neg_lo:[1,0,0] neg_hi:[1,0,0]
v_pk_fma_f32 v[100:101], v[28:29], v[28:29], v[100:101]
v_pk_fma_f32 v[60:61], v[44:45], v[44:45], s[60:61] neg_lo:[1,0,0] neg_hi:[1,0,0]
v_pk_fma_f32 v[100:101], v[30:31], v[30:31], v[100:101]
v_pk_fma_f32 v[62:63], v[46:47], v[46:47], s[60:61] neg_lo:[1,0,0] neg_hi:[1,0,0]
v_pk_mul_f32 v[48:49], v[48:49], v[32:33]
v_pk_mul_f32 v[50:51], v[50:51], v[34:35]
v_pk_mul_f32 v[52:53], v[52:53], v[36:37]
v_pk_mul_f32 v[54:55], v[54:55], v[38:39]
v_pk_mul_f32 v[56:57], v[56:57], v[40:41]
v_pk_mul_f32 v[58:59], v[58:59], v[42:43]
v_pk_mul_f32 v[60:61], v[60:61], v[44:45]
v_pk_mul_f32 v[62:63], v[62:63], v[46:47]
v_cvt_pk_bf16_f32 v248, v16, v17
v_cvt_pk_bf16_f32 v249, v18, v19
v_cvt_pk_bf16_f32 v250, v20, v21
v_cvt_pk_bf16_f32 v251, v22, v23
v_cvt_pk_bf16_f32 v252, v24, v25
v_cvt_pk_bf16_f32 v253, v26, v27
v_cvt_pk_bf16_f32 v254, v28, v29
v_cvt_pk_bf16_f32 v255, v30, v31
v_mfma_f32_32x32x16_bf16 v[16:31], v[64:67], a[48:51], 0
ds_write_b64 v3, v[248:249] offset:0
v_exp_f32 v48, v48
v_exp_f32 v49, v49
v_exp_f32 v50, v50
v_mfma_f32_32x32x16_bf16 v[16:31], v[68:71], a[52:55], v[16:31]
ds_write_b64 v3, v[250:251] offset:128
v_exp_f32 v51, v51
v_exp_f32 v52, v52
v_exp_f32 v53, v53
v_mfma_f32_32x32x16_bf16 v[16:31], v[72:75], a[56:59], v[16:31]
ds_write_b64 v3, v[252:253] offset:1024
s_add_u32 s81, s80, 4096
s_waitcnt lgkmcnt(2)
buffer_store_dwordx4 v[232:235], v0, s[40:43], s81 offen offset:0 sc1
v_exp_f32 v54, v54
v_exp_f32 v55, v55
v_mfma_f32_32x32x16_bf16 v[184:199], v[144:147], v[216:219], 0
v_exp_f32 v56, v56
v_exp_f32 v57, v57
v_exp_f32 v58, v58
v_mfma_f32_32x32x16_bf16 v[184:199], v[148:151], v[220:223], v[184:199]
v_exp_f32 v59, v59
v_exp_f32 v60, v60
v_exp_f32 v61, v61
v_exp_f32 v62, v62
v_exp_f32_e64 v63, v63
v_pk_add_f32 v[48:49], v[48:49], 1.0 op_sel_hi:[1,0]
v_pk_add_f32 v[50:51], v[50:51], 1.0 op_sel_hi:[1,0]
v_pk_add_f32 v[52:53], v[52:53], 1.0 op_sel_hi:[1,0]
v_pk_add_f32 v[54:55], v[54:55], 1.0 op_sel_hi:[1,0]
v_pk_add_f32 v[56:57], v[56:57], 1.0 op_sel_hi:[1,0]
v_pk_add_f32 v[58:59], v[58:59], 1.0 op_sel_hi:[1,0]
v_pk_add_f32 v[60:61], v[60:61], 1.0 op_sel_hi:[1,0]
v_pk_add_f32 v[62:63], v[62:63], 1.0 op_sel_hi:[1,0]
v_mfma_f32_32x32x16_bf16 v[16:31], v[76:79], a[60:63], v[16:31]
ds_write_b64 v3, v[254:255] offset:1152
buffer_store_dwordx4 v[236:239], v0, s[40:43], s81 offen offset:1024 sc1
v_rcp_f32 v48, v48
v_rcp_f32 v49, v49
v_rcp_f32_e64 v50, v50
v_mfma_f32_32x32x16_bf16 v[16:31], v[80:83], a[64:67], v[16:31]
ds_read_b64_tr_b16 v[240:241], v4 offset:0
ds_read_b64_tr_b16 v[242:243], v4 offset:512
v_rcp_f32 v51, v51
v_rcp_f32 v52, v52
v_mfma_f32_32x32x16_bf16 v[16:31], v[84:87], a[68:71], v[16:31]
ds_read_b64_tr_b16 v[244:245], v4 offset:1024
ds_read_b64_tr_b16 v[246:247], v4 offset:1536
s_mov_b32 s64, 31457280
buffer_load_dwordx4 v[200:203], v2, s[24:27], s64 offen offset:0
buffer_load_dwordx4 v[204:207], v2, s[24:27], s64 offen offset:16
v_rcp_f32 v53, v53
v_rcp_f32 v54, v54
v_rcp_f32 v55, v55
v_rcp_f32 v56, v56
v_rcp_f32 v57, v57
v_rcp_f32 v58, v58
v_rcp_f32 v59, v59
v_rcp_f32 v60, v60
v_rcp_f32 v61, v61
v_rcp_f32 v62, v62
v_rcp_f32_e64 v63, v63
v_pk_mul_f32 v[32:33], v[48:49], v[32:33]
v_pk_mul_f32 v[34:35], v[50:51], v[34:35]
v_pk_mul_f32 v[36:37], v[52:53], v[36:37]
v_pk_mul_f32 v[38:39], v[54:55], v[38:39]
v_pk_mul_f32 v[40:41], v[56:57], v[40:41]
v_pk_mul_f32 v[42:43], v[58:59], v[42:43]
v_pk_mul_f32 v[44:45], v[60:61], v[44:45]
v_pk_mul_f32 v[46:47], v[62:63], v[46:47]
v_pk_fma_f32 v[102:103], v[32:33], v[32:33], v[102:103]
v_pk_fma_f32 v[48:49], v[16:17], v[16:17], s[60:61] neg_lo:[1,0,0] neg_hi:[1,0,0]
v_pk_fma_f32 v[102:103], v[34:35], v[34:35], v[102:103]
v_pk_fma_f32 v[50:51], v[18:19], v[18:19], s[60:61] neg_lo:[1,0,0] neg_hi:[1,0,0]
v_pk_fma_f32 v[102:103], v[36:37], v[36:37], v[102:103]
v_pk_fma_f32 v[52:53], v[20:21], v[20:21], s[60:61] neg_lo:[1,0,0] neg_hi:[1,0,0]
v_pk_fma_f32 v[102:103], v[38:39], v[38:39], v[102:103]
v_pk_fma_f32 v[54:55], v[22:23], v[22:23], s[60:61] neg_lo:[1,0,0] neg_hi:[1,0,0]
v_pk_fma_f32 v[102:103], v[40:41], v[40:41], v[102:103]
v_pk_fma_f32 v[56:57], v[24:25], v[24:25], s[60:61] neg_lo:[1,0,0] neg_hi:[1,0,0]
v_pk_fma_f32 v[102:103], v[42:43], v[42:43], v[102:103]
v_pk_fma_f32 v[58:59], v[26:27], v[26:27], s[60:61] neg_lo:[1,0,0] neg_hi:[1,0,0]
v_pk_fma_f32 v[102:103], v[44:45], v[44:45], v[102:103]
v_pk_fma_f32 v[60:61], v[28:29], v[28:29], s[60:61] neg_lo:[1,0,0] neg_hi:[1,0,0]
v_pk_fma_f32 v[102:103], v[46:47], v[46:47], v[102:103]
v_pk_fma_f32 v[62:63], v[30:31], v[30:31], s[60:61] neg_lo:[1,0,0] neg_hi:[1,0,0]
v_pk_mul_f32 v[48:49], v[48:49], v[16:17]
v_pk_mul_f32 v[50:51], v[50:51], v[18:19]
v_pk_mul_f32 v[52:53], v[52:53], v[20:21]
v_pk_mul_f32 v[54:55], v[54:55], v[22:23]
v_pk_mul_f32 v[56:57], v[56:57], v[24:25]
v_pk_mul_f32 v[58:59], v[58:59], v[26:27]
v_pk_mul_f32 v[60:61], v[60:61], v[28:29]
v_pk_mul_f32 v[62:63], v[62:63], v[30:31]
v_pk_mul_f32 v[10:11], v[152:153], v[152:153]
v_pk_add_f32 v[8:9], v[152:153], v[154:155]
v_pk_fma_f32 v[10:11], v[154:155], v[154:155], v[10:11]
v_pk_add_f32 v[8:9], v[8:9], v[156:157]
v_pk_fma_f32 v[10:11], v[156:157], v[156:157], v[10:11]
v_pk_add_f32 v[8:9], v[8:9], v[158:159]
v_pk_fma_f32 v[10:11], v[158:159], v[158:159], v[10:11]
v_pk_add_f32 v[8:9], v[8:9], v[160:161]
v_pk_fma_f32 v[10:11], v[160:161], v[160:161], v[10:11]
v_pk_add_f32 v[8:9], v[8:9], v[162:163]
v_pk_fma_f32 v[10:11], v[162:163], v[162:163], v[10:11]
v_pk_add_f32 v[8:9], v[8:9], v[164:165]
v_pk_fma_f32 v[10:11], v[164:165], v[164:165], v[10:11]
v_pk_add_f32 v[8:9], v[8:9], v[166:167]
v_pk_fma_f32 v[10:11], v[166:167], v[166:167], v[10:11]
v_pk_add_f32 v[8:9], v[8:9], v[168:169]
v_pk_fma_f32 v[10:11], v[168:169], v[168:169], v[10:11]
v_pk_add_f32 v[8:9], v[8:9], v[170:171]
v_pk_fma_f32 v[10:11], v[170:171], v[170:171], v[10:11]
v_pk_add_f32 v[8:9], v[8:9], v[172:173]
v_pk_fma_f32 v[10:11], v[172:173], v[172:173], v[10:11]
v_pk_add_f32 v[8:9], v[8:9], v[174:175]
v_pk_fma_f32 v[10:11], v[174:175], v[174:175], v[10:11]
v_pk_add_f32 v[8:9], v[8:9], v[176:177]
v_pk_fma_f32 v[10:11], v[176:177], v[176:177], v[10:11]
v_pk_add_f32 v[8:9], v[8:9], v[178:179]
v_pk_fma_f32 v[10:11], v[178:179], v[178:179], v[10:11]
v_pk_add_f32 v[8:9], v[8:9], v[180:181]
v_pk_fma_f32 v[10:11], v[180:181], v[180:181], v[10:11]
v_pk_add_f32 v[8:9], v[8:9], v[182:183]
v_pk_fma_f32 v[10:11], v[182:183], v[182:183], v[10:11]
v_pk_add_f32 v[8:9], v[8:9], v[184:185]
v_pk_fma_f32 v[10:11], v[184:185], v[184:185], v[10:11]
v_pk_add_f32 v[8:9], v[8:9], v[186:187]
v_pk_fma_f32 v[10:11], v[186:187], v[186:187], v[10:11]
v_pk_add_f32 v[8:9], v[8:9], v[188:189]
v_pk_fma_f32 v[10:11], v[188:189], v[188:189], v[10:11]
v_pk_add_f32 v[8:9], v[8:9], v[190:191]
v_pk_fma_f32 v[10:11], v[190:191], v[190:191], v[10:11]
v_pk_add_f32 v[8:9], v[8:9], v[192:193]
v_pk_fma_f32 v[10:11], v[192:193], v[192:193], v[10:11]
v_pk_add_f32 v[8:9], v[8:9], v[194:195]
v_pk_fma_f32 v[10:11], v[194:195], v[194:195], v[10:11]
v_pk_add_f32 v[8:9], v[8:9], v[196:197]
v_pk_fma_f32 v[10:11], v[196:197], v[196:197], v[10:11]
v_pk_add_f32 v[8:9], v[8:9], v[198:199]
v_pk_fma_f32 v[10:11], v[198:199], v[198:199], v[10:11]
v_cvt_pk_bf16_f32 v248, v32, v33
v_cvt_pk_bf16_f32 v249, v34, v35
v_cvt_pk_bf16_f32 v250, v36, v37
v_cvt_pk_bf16_f32 v251, v38, v39
v_cvt_pk_bf16_f32 v252, v40, v41
v_cvt_pk_bf16_f32 v253, v42, v43
v_cvt_pk_bf16_f32 v254, v44, v45
v_cvt_pk_bf16_f32 v255, v46, v47
v_mfma_f32_32x32x16_bf16 v[32:47], v[64:67], a[72:75], 0
ds_write_b64 v3, v[248:249] offset:0
v_exp_f32 v48, v48
v_exp_f32 v49, v49
v_add_f32 v8, v8, v9
v_exp_f32 v50, v50
v_mfma_f32_32x32x16_bf16 v[32:47], v[68:71], a[76:79], v[32:47]
ds_write_b64 v3, v[250:251] offset:128
v_add_f32 v10, v10, v11
v_exp_f32_e64 v51, v51
s_nop 0
v_permlane32_swap_b32 v8, v10
v_mfma_f32_32x32x16_bf16 v[32:47], v[72:75], a[80:83], v[32:47]
ds_write_b64 v3, v[252:253] offset:1024
s_add_u32 s81, s80, 6144
s_waitcnt lgkmcnt(2)
buffer_store_dwordx4 v[240:243], v0, s[40:43], s81 offen offset:0
buffer_load_dwordx4 v[208:211], v2, s[24:27], s64 offen offset:64
buffer_load_dwordx4 v[212:215], v2, s[24:27], s64 offen offset:80
v_exp_f32 v52, v52
v_add_f32 v8, v8, v10
v_exp_f32 v53, v53
v_mov_b32 v10, v8
v_exp_f32 v54, v54
s_nop 0
v_permlane32_swap_b32 v8, v10
v_exp_f32 v55, v55
v_mul_f32 v13, 0x3c2aaaab, v8
v_exp_f32 v56, v56
v_exp_f32 v57, v57
v_mul_f32 v10, 0x3c2aaaab, v10
v_exp_f32 v58, v58
v_fma_f32 v10, -v13, v13, v10
v_exp_f32 v59, v59
v_max_f32 v10, 0, v10
v_exp_f32 v60, v60
v_add_f32 v10, 0x3727c5ac, v10
v_exp_f32 v61, v61
v_rsq_f32 v12, v10
v_exp_f32 v62, v62
v_mul_f32 v12, 0x3eeff558, v12
v_exp_f32 v63, v63
v_mul_f32_e64 v13, v13, v12
v_pk_add_f32 v[48:49], v[48:49], 1.0 op_sel_hi:[1,0]
v_pk_add_f32 v[50:51], v[50:51], 1.0 op_sel_hi:[1,0]
v_pk_add_f32 v[52:53], v[52:53], 1.0 op_sel_hi:[1,0]
v_pk_add_f32 v[54:55], v[54:55], 1.0 op_sel_hi:[1,0]
v_pk_add_f32 v[56:57], v[56:57], 1.0 op_sel_hi:[1,0]
v_pk_add_f32 v[58:59], v[58:59], 1.0 op_sel_hi:[1,0]
v_pk_add_f32 v[60:61], v[60:61], 1.0 op_sel_hi:[1,0]
v_pk_add_f32 v[62:63], v[62:63], 1.0 op_sel_hi:[1,0]
v_mfma_f32_32x32x16_bf16 v[32:47], v[76:79], a[84:87], v[32:47]
ds_write_b64 v3, v[254:255] offset:1152
buffer_store_dwordx4 v[244:247], v0, s[40:43], s81 offen offset:1024
v_rcp_f32 v48, v48
v_rcp_f32 v49, v49
v_rcp_f32_e64 v50, v50
v_mfma_f32_32x32x16_bf16 v[32:47], v[80:83], a[88:91], v[32:47]
ds_read_b64_tr_b16 v[232:233], v4 offset:0
ds_read_b64_tr_b16 v[234:235], v4 offset:512
v_rcp_f32 v51, v51
v_rcp_f32 v52, v52
v_mfma_f32_32x32x16_bf16 v[32:47], v[84:87], a[92:95], v[32:47]
ds_read_b64_tr_b16 v[236:237], v4 offset:1024
ds_read_b64_tr_b16 v[238:239], v4 offset:1536
buffer_load_dwordx4 v[216:219], v2, s[24:27], s64 offen offset:128
buffer_load_dwordx4 v[220:223], v2, s[24:27], s64 offen offset:144
v_rcp_f32 v53, v53
v_rcp_f32 v54, v54
v_rcp_f32 v55, v55
v_rcp_f32 v56, v56
v_rcp_f32 v57, v57
v_rcp_f32 v58, v58
v_rcp_f32 v59, v59
v_rcp_f32 v60, v60
v_rcp_f32 v61, v61
v_rcp_f32 v62, v62
v_rcp_f32_e64 v63, v63
v_pk_mul_f32 v[16:17], v[48:49], v[16:17]
v_pk_mul_f32 v[18:19], v[50:51], v[18:19]
v_pk_mul_f32 v[20:21], v[52:53], v[20:21]
v_pk_mul_f32 v[22:23], v[54:55], v[22:23]
v_pk_mul_f32 v[24:25], v[56:57], v[24:25]
v_pk_mul_f32 v[26:27], v[58:59], v[26:27]
v_pk_mul_f32 v[28:29], v[60:61], v[28:29]
v_pk_mul_f32 v[30:31], v[62:63], v[30:31]
v_pk_fma_f32 v[104:105], v[16:17], v[16:17], v[104:105]
v_pk_fma_f32 v[48:49], v[32:33], v[32:33], s[60:61] neg_lo:[1,0,0] neg_hi:[1,0,0]
v_pk_fma_f32 v[104:105], v[18:19], v[18:19], v[104:105]
v_pk_fma_f32 v[50:51], v[34:35], v[34:35], s[60:61] neg_lo:[1,0,0] neg_hi:[1,0,0]
v_pk_fma_f32 v[104:105], v[20:21], v[20:21], v[104:105]
v_pk_fma_f32 v[52:53], v[36:37], v[36:37], s[60:61] neg_lo:[1,0,0] neg_hi:[1,0,0]
v_pk_fma_f32 v[104:105], v[22:23], v[22:23], v[104:105]
v_pk_fma_f32 v[54:55], v[38:39], v[38:39], s[60:61] neg_lo:[1,0,0] neg_hi:[1,0,0]
v_pk_fma_f32 v[104:105], v[24:25], v[24:25], v[104:105]
v_pk_fma_f32 v[56:57], v[40:41], v[40:41], s[60:61] neg_lo:[1,0,0] neg_hi:[1,0,0]
v_pk_fma_f32 v[104:105], v[26:27], v[26:27], v[104:105]
v_pk_fma_f32 v[58:59], v[42:43], v[42:43], s[60:61] neg_lo:[1,0,0] neg_hi:[1,0,0]
v_pk_fma_f32 v[104:105], v[28:29], v[28:29], v[104:105]
v_pk_fma_f32 v[60:61], v[44:45], v[44:45], s[60:61] neg_lo:[1,0,0] neg_hi:[1,0,0]
v_pk_fma_f32 v[104:105], v[30:31], v[30:31], v[104:105]
v_pk_fma_f32 v[62:63], v[46:47], v[46:47], s[60:61] neg_lo:[1,0,0] neg_hi:[1,0,0]
v_pk_mul_f32 v[48:49], v[48:49], v[32:33]
v_pk_mul_f32 v[50:51], v[50:51], v[34:35]
v_pk_mul_f32 v[52:53], v[52:53], v[36:37]
v_pk_mul_f32 v[54:55], v[54:55], v[38:39]
v_pk_mul_f32 v[56:57], v[56:57], v[40:41]
v_pk_mul_f32 v[58:59], v[58:59], v[42:43]
v_pk_mul_f32 v[60:61], v[60:61], v[44:45]
v_pk_mul_f32 v[62:63], v[62:63], v[46:47]
v_pk_fma_f32 v[152:153], v[152:153], v[12:13], v[12:13] op_sel:[0,0,1] op_sel_hi:[1,0,1] neg_lo:[0,0,1] neg_hi:[0,0,1]
v_pk_fma_f32 v[154:155], v[154:155], v[12:13], v[12:13] op_sel:[0,0,1] op_sel_hi:[1,0,1] neg_lo:[0,0,1] neg_hi:[0,0,1]
v_pk_fma_f32 v[156:157], v[156:157], v[12:13], v[12:13] op_sel:[0,0,1] op_sel_hi:[1,0,1] neg_lo:[0,0,1] neg_hi:[0,0,1]
v_pk_fma_f32 v[158:159], v[158:159], v[12:13], v[12:13] op_sel:[0,0,1] op_sel_hi:[1,0,1] neg_lo:[0,0,1] neg_hi:[0,0,1]
v_pk_fma_f32 v[160:161], v[160:161], v[12:13], v[12:13] op_sel:[0,0,1] op_sel_hi:[1,0,1] neg_lo:[0,0,1] neg_hi:[0,0,1]
v_pk_fma_f32 v[162:163], v[162:163], v[12:13], v[12:13] op_sel:[0,0,1] op_sel_hi:[1,0,1] neg_lo:[0,0,1] neg_hi:[0,0,1]
v_pk_fma_f32 v[164:165], v[164:165], v[12:13], v[12:13] op_sel:[0,0,1] op_sel_hi:[1,0,1] neg_lo:[0,0,1] neg_hi:[0,0,1]
v_pk_fma_f32 v[166:167], v[166:167], v[12:13], v[12:13] op_sel:[0,0,1] op_sel_hi:[1,0,1] neg_lo:[0,0,1] neg_hi:[0,0,1]
v_pk_fma_f32 v[168:169], v[168:169], v[12:13], v[12:13] op_sel:[0,0,1] op_sel_hi:[1,0,1] neg_lo:[0,0,1] neg_hi:[0,0,1]
v_pk_fma_f32 v[170:171], v[170:171], v[12:13], v[12:13] op_sel:[0,0,1] op_sel_hi:[1,0,1] neg_lo:[0,0,1] neg_hi:[0,0,1]
v_pk_fma_f32 v[172:173], v[172:173], v[12:13], v[12:13] op_sel:[0,0,1] op_sel_hi:[1,0,1] neg_lo:[0,0,1] neg_hi:[0,0,1]
v_pk_fma_f32 v[174:175], v[174:175], v[12:13], v[12:13] op_sel:[0,0,1] op_sel_hi:[1,0,1] neg_lo:[0,0,1] neg_hi:[0,0,1]
v_pk_fma_f32 v[176:177], v[176:177], v[12:13], v[12:13] op_sel:[0,0,1] op_sel_hi:[1,0,1] neg_lo:[0,0,1] neg_hi:[0,0,1]
v_pk_fma_f32 v[178:179], v[178:179], v[12:13], v[12:13] op_sel:[0,0,1] op_sel_hi:[1,0,1] neg_lo:[0,0,1] neg_hi:[0,0,1]
v_pk_fma_f32 v[180:181], v[180:181], v[12:13], v[12:13] op_sel:[0,0,1] op_sel_hi:[1,0,1] neg_lo:[0,0,1] neg_hi:[0,0,1]
v_pk_fma_f32 v[182:183], v[182:183], v[12:13], v[12:13] op_sel:[0,0,1] op_sel_hi:[1,0,1] neg_lo:[0,0,1] neg_hi:[0,0,1]
v_pk_fma_f32 v[184:185], v[184:185], v[12:13], v[12:13] op_sel:[0,0,1] op_sel_hi:[1,0,1] neg_lo:[0,0,1] neg_hi:[0,0,1]
v_pk_fma_f32 v[186:187], v[186:187], v[12:13], v[12:13] op_sel:[0,0,1] op_sel_hi:[1,0,1] neg_lo:[0,0,1] neg_hi:[0,0,1]
v_pk_fma_f32 v[188:189], v[188:189], v[12:13], v[12:13] op_sel:[0,0,1] op_sel_hi:[1,0,1] neg_lo:[0,0,1] neg_hi:[0,0,1]
v_pk_fma_f32 v[190:191], v[190:191], v[12:13], v[12:13] op_sel:[0,0,1] op_sel_hi:[1,0,1] neg_lo:[0,0,1] neg_hi:[0,0,1]
v_pk_fma_f32 v[192:193], v[192:193], v[12:13], v[12:13] op_sel:[0,0,1] op_sel_hi:[1,0,1] neg_lo:[0,0,1] neg_hi:[0,0,1]
v_pk_fma_f32 v[194:195], v[194:195], v[12:13], v[12:13] op_sel:[0,0,1] op_sel_hi:[1,0,1] neg_lo:[0,0,1] neg_hi:[0,0,1]
v_pk_fma_f32 v[196:197], v[196:197], v[12:13], v[12:13] op_sel:[0,0,1] op_sel_hi:[1,0,1] neg_lo:[0,0,1] neg_hi:[0,0,1]
v_pk_fma_f32 v[198:199], v[198:199], v[12:13], v[12:13] op_sel:[0,0,1] op_sel_hi:[1,0,1] neg_lo:[0,0,1] neg_hi:[0,0,1]
v_cvt_pk_bf16_f32 v248, v16, v17
v_cvt_pk_bf16_f32 v249, v18, v19
v_cvt_pk_bf16_f32 v250, v20, v21
v_cvt_pk_bf16_f32 v251, v22, v23
v_cvt_pk_bf16_f32 v252, v24, v25
v_cvt_pk_bf16_f32 v253, v26, v27
v_cvt_pk_bf16_f32 v254, v28, v29
v_cvt_pk_bf16_f32 v255, v30, v31
v_mfma_f32_32x32x16_bf16 v[16:31], v[64:67], a[96:99], 0
ds_write_b64 v3, v[248:249] offset:0
v_exp_f32 v48, v48
v_exp_f32 v49, v49
v_cvt_pk_bf16_f32 v128, v152, v153
v_exp_f32_e64 v50, v50
v_mfma_f32_32x32x16_bf16 v[16:31], v[68:71], a[100:103], v[16:31]
ds_write_b64 v3, v[250:251] offset:128
v_cvt_pk_bf16_f32 v129, v154, v155
v_exp_f32 v51, v51
v_cvt_pk_bf16_f32 v130, v156, v157
v_exp_f32 v52, v52
v_mfma_f32_32x32x16_bf16 v[16:31], v[72:75], a[104:107], v[16:31]
ds_write_b64 v3, v[252:253] offset:1024
s_add_u32 s81, s80, 8192
s_waitcnt lgkmcnt(2)
buffer_store_dwordx4 v[232:235], v0, s[40:43], s81 offen offset:0
v_exp_f32 v53, v53
v_cvt_pk_bf16_f32 v131, v158, v159
v_exp_f32 v54, v54
v_cvt_pk_bf16_f32 v132, v160, v161
v_exp_f32 v55, v55
v_cvt_pk_bf16_f32 v133, v162, v163
v_exp_f32 v56, v56
v_exp_f32 v57, v57
v_cvt_pk_bf16_f32 v134, v164, v165
v_exp_f32 v58, v58
v_cvt_pk_bf16_f32 v135, v166, v167
v_exp_f32 v59, v59
v_cvt_pk_bf16_f32 v136, v168, v169
v_exp_f32 v60, v60
v_exp_f32 v61, v61
v_cvt_pk_bf16_f32 v137, v170, v171
v_exp_f32 v62, v62
v_cvt_pk_bf16_f32 v138, v172, v173
v_exp_f32 v63, v63
v_cvt_pk_bf16_f32 v139, v174, v175
v_pk_add_f32 v[48:49], v[48:49], 1.0 op_sel_hi:[1,0]
v_pk_add_f32 v[50:51], v[50:51], 1.0 op_sel_hi:[1,0]
v_pk_add_f32 v[52:53], v[52:53], 1.0 op_sel_hi:[1,0]
v_pk_add_f32 v[54:55], v[54:55], 1.0 op_sel_hi:[1,0]
v_pk_add_f32 v[56:57], v[56:57], 1.0 op_sel_hi:[1,0]
v_pk_add_f32 v[58:59], v[58:59], 1.0 op_sel_hi:[1,0]
v_pk_add_f32 v[60:61], v[60:61], 1.0 op_sel_hi:[1,0]
v_pk_add_f32 v[62:63], v[62:63], 1.0 op_sel_hi:[1,0]
v_mfma_f32_32x32x16_bf16 v[16:31], v[76:79], a[108:111], v[16:31]
ds_write_b64 v3, v[254:255] offset:1152
buffer_store_dwordx4 v[236:239], v0, s[40:43], s81 offen offset:1024
v_rcp_f32 v48, v48
v_rcp_f32 v49, v49
v_cvt_pk_bf16_f32 v140, v176, v177
v_mfma_f32_32x32x16_bf16 v[16:31], v[80:83], a[112:115], v[16:31]
ds_read_b64_tr_b16 v[240:241], v4 offset:0
ds_read_b64_tr_b16 v[242:243], v4 offset:512
v_rcp_f32 v50, v50
v_cvt_pk_bf16_f32 v141, v178, v179
v_rcp_f32 v51, v51
v_mfma_f32_32x32x16_bf16 v[16:31], v[84:87], a[116:119], v[16:31]
ds_read_b64_tr_b16 v[244:245], v4 offset:1024
ds_read_b64_tr_b16 v[246:247], v4 offset:1536
v_cvt_pk_bf16_f32 v142, v180, v181
v_rcp_f32 v52, v52
v_rcp_f32 v53, v53
v_cvt_pk_bf16_f32 v143, v182, v183
v_rcp_f32 v54, v54
v_cvt_pk_bf16_f32 v144, v184, v185
v_rcp_f32 v55, v55
v_cvt_pk_bf16_f32 v145, v186, v187
v_rcp_f32 v56, v56
v_rcp_f32 v57, v57
v_cvt_pk_bf16_f32 v146, v188, v189
v_rcp_f32 v58, v58
v_cvt_pk_bf16_f32 v147, v190, v191
v_rcp_f32 v59, v59
v_cvt_pk_bf16_f32 v148, v192, v193
v_rcp_f32 v60, v60
v_rcp_f32 v61, v61
v_cvt_pk_bf16_f32 v149, v194, v195
v_rcp_f32 v62, v62
v_cvt_pk_bf16_f32 v150, v196, v197
v_rcp_f32 v63, v63
v_cvt_pk_bf16_f32 v151, v198, v199
v_pk_mul_f32 v[32:33], v[48:49], v[32:33]
v_pk_mul_f32 v[34:35], v[50:51], v[34:35]
v_pk_mul_f32 v[36:37], v[52:53], v[36:37]
v_pk_mul_f32 v[38:39], v[54:55], v[38:39]
v_pk_mul_f32 v[40:41], v[56:57], v[40:41]
v_pk_mul_f32 v[42:43], v[58:59], v[42:43]
v_pk_mul_f32 v[44:45], v[60:61], v[44:45]
v_pk_mul_f32 v[46:47], v[62:63], v[46:47]
v_pk_fma_f32 v[106:107], v[32:33], v[32:33], v[106:107]
v_pk_fma_f32 v[48:49], v[16:17], v[16:17], s[60:61] neg_lo:[1,0,0] neg_hi:[1,0,0]
v_pk_fma_f32 v[106:107], v[34:35], v[34:35], v[106:107]
v_pk_fma_f32 v[50:51], v[18:19], v[18:19], s[60:61] neg_lo:[1,0,0] neg_hi:[1,0,0]
v_pk_fma_f32 v[106:107], v[36:37], v[36:37], v[106:107]
v_pk_fma_f32 v[52:53], v[20:21], v[20:21], s[60:61] neg_lo:[1,0,0] neg_hi:[1,0,0]
v_pk_fma_f32 v[106:107], v[38:39], v[38:39], v[106:107]
v_pk_fma_f32 v[54:55], v[22:23], v[22:23], s[60:61] neg_lo:[1,0,0] neg_hi:[1,0,0]
v_pk_fma_f32 v[106:107], v[40:41], v[40:41], v[106:107]
v_pk_fma_f32 v[56:57], v[24:25], v[24:25], s[60:61] neg_lo:[1,0,0] neg_hi:[1,0,0]
v_pk_fma_f32 v[106:107], v[42:43], v[42:43], v[106:107]
v_pk_fma_f32 v[58:59], v[26:27], v[26:27], s[60:61] neg_lo:[1,0,0] neg_hi:[1,0,0]
v_pk_fma_f32 v[106:107], v[44:45], v[44:45], v[106:107]
v_pk_fma_f32 v[60:61], v[28:29], v[28:29], s[60:61] neg_lo:[1,0,0] neg_hi:[1,0,0]
v_pk_fma_f32 v[106:107], v[46:47], v[46:47], v[106:107]
v_pk_fma_f32 v[62:63], v[30:31], v[30:31], s[60:61] neg_lo:[1,0,0] neg_hi:[1,0,0]
v_pk_mul_f32 v[48:49], v[48:49], v[16:17]
v_pk_mul_f32 v[50:51], v[50:51], v[18:19]
v_pk_mul_f32 v[52:53], v[52:53], v[20:21]
v_pk_mul_f32 v[54:55], v[54:55], v[22:23]
v_pk_mul_f32 v[56:57], v[56:57], v[24:25]
v_pk_mul_f32 v[58:59], v[58:59], v[26:27]
v_pk_mul_f32 v[60:61], v[60:61], v[28:29]
v_pk_mul_f32 v[62:63], v[62:63], v[30:31]
v_cvt_pk_bf16_f32 v248, v32, v33
v_cvt_pk_bf16_f32 v249, v34, v35
v_cvt_pk_bf16_f32 v250, v36, v37
v_cvt_pk_bf16_f32 v251, v38, v39
v_cvt_pk_bf16_f32 v252, v40, v41
v_cvt_pk_bf16_f32 v253, v42, v43
v_cvt_pk_bf16_f32 v254, v44, v45
v_cvt_pk_bf16_f32 v255, v46, v47
v_mfma_f32_32x32x16_bf16 v[32:47], v[64:67], a[120:123], 0
ds_write_b64 v3, v[248:249] offset:0
v_exp_f32 v48, v48
v_exp_f32 v49, v49
v_exp_f32 v50, v50
v_mfma_f32_32x32x16_bf16 v[32:47], v[68:71], a[124:127], v[32:47]
ds_write_b64 v3, v[250:251] offset:128
v_exp_f32 v51, v51
v_exp_f32 v52, v52
v_exp_f32 v53, v53
v_mfma_f32_32x32x16_bf16 v[32:47], v[72:75], a[128:131], v[32:47]
ds_write_b64 v3, v[252:253] offset:1024
s_add_u32 s81, s80, 10240
s_waitcnt lgkmcnt(2)
buffer_store_dwordx4 v[240:243], v0, s[40:43], s81 offen offset:0
v_exp_f32 v54, v54
v_exp_f32 v55, v55
v_exp_f32 v56, v56
v_exp_f32 v57, v57
v_exp_f32 v58, v58
v_exp_f32 v59, v59
v_exp_f32 v60, v60
v_exp_f32 v61, v61
v_exp_f32 v62, v62
v_exp_f32_e64 v63, v63
v_pk_add_f32 v[48:49], v[48:49], 1.0 op_sel_hi:[1,0]
v_pk_add_f32 v[50:51], v[50:51], 1.0 op_sel_hi:[1,0]
v_pk_add_f32 v[52:53], v[52:53], 1.0 op_sel_hi:[1,0]
v_pk_add_f32 v[54:55], v[54:55], 1.0 op_sel_hi:[1,0]
v_pk_add_f32 v[56:57], v[56:57], 1.0 op_sel_hi:[1,0]
v_pk_add_f32 v[58:59], v[58:59], 1.0 op_sel_hi:[1,0]
v_pk_add_f32 v[60:61], v[60:61], 1.0 op_sel_hi:[1,0]
v_pk_add_f32 v[62:63], v[62:63], 1.0 op_sel_hi:[1,0]
v_mfma_f32_32x32x16_bf16 v[32:47], v[76:79], a[132:135], v[32:47]
ds_write_b64 v3, v[254:255] offset:1152
buffer_store_dwordx4 v[244:247], v0, s[40:43], s81 offen offset:1024
v_rcp_f32 v48, v48
v_rcp_f32 v49, v49
v_rcp_f32_e64 v50, v50
v_mfma_f32_32x32x16_bf16 v[32:47], v[80:83], a[136:139], v[32:47]
ds_read_b64_tr_b16 v[232:233], v4 offset:0
ds_read_b64_tr_b16 v[234:235], v4 offset:512
v_rcp_f32 v51, v51
v_rcp_f32 v52, v52
v_mfma_f32_32x32x16_bf16 v[32:47], v[84:87], a[140:143], v[32:47]
ds_read_b64_tr_b16 v[236:237], v4 offset:1024
ds_read_b64_tr_b16 v[238:239], v4 offset:1536
v_rcp_f32 v53, v53
v_rcp_f32 v54, v54
v_rcp_f32 v55, v55
v_rcp_f32 v56, v56
v_rcp_f32 v57, v57
v_rcp_f32 v58, v58
v_rcp_f32 v59, v59
v_rcp_f32 v60, v60
v_rcp_f32 v61, v61
v_rcp_f32 v62, v62
v_rcp_f32_e64 v63, v63
v_pk_mul_f32 v[16:17], v[48:49], v[16:17]
v_pk_mul_f32 v[18:19], v[50:51], v[18:19]
v_pk_mul_f32 v[20:21], v[52:53], v[20:21]
v_pk_mul_f32 v[22:23], v[54:55], v[22:23]
v_pk_mul_f32 v[24:25], v[56:57], v[24:25]
v_pk_mul_f32 v[26:27], v[58:59], v[26:27]
v_pk_mul_f32 v[28:29], v[60:61], v[28:29]
v_pk_mul_f32 v[30:31], v[62:63], v[30:31]
v_pk_fma_f32 v[108:109], v[16:17], v[16:17], v[108:109]
v_pk_fma_f32 v[48:49], v[32:33], v[32:33], s[60:61] neg_lo:[1,0,0] neg_hi:[1,0,0]
v_pk_fma_f32 v[108:109], v[18:19], v[18:19], v[108:109]
v_pk_fma_f32 v[50:51], v[34:35], v[34:35], s[60:61] neg_lo:[1,0,0] neg_hi:[1,0,0]
v_pk_fma_f32 v[108:109], v[20:21], v[20:21], v[108:109]
v_pk_fma_f32 v[52:53], v[36:37], v[36:37], s[60:61] neg_lo:[1,0,0] neg_hi:[1,0,0]
v_pk_fma_f32 v[108:109], v[22:23], v[22:23], v[108:109]
v_pk_fma_f32 v[54:55], v[38:39], v[38:39], s[60:61] neg_lo:[1,0,0] neg_hi:[1,0,0]
v_pk_fma_f32 v[108:109], v[24:25], v[24:25], v[108:109]
v_pk_fma_f32 v[56:57], v[40:41], v[40:41], s[60:61] neg_lo:[1,0,0] neg_hi:[1,0,0]
v_pk_fma_f32 v[108:109], v[26:27], v[26:27], v[108:109]
v_pk_fma_f32 v[58:59], v[42:43], v[42:43], s[60:61] neg_lo:[1,0,0] neg_hi:[1,0,0]
v_pk_fma_f32 v[108:109], v[28:29], v[28:29], v[108:109]
v_pk_fma_f32 v[60:61], v[44:45], v[44:45], s[60:61] neg_lo:[1,0,0] neg_hi:[1,0,0]
v_pk_fma_f32 v[108:109], v[30:31], v[30:31], v[108:109]
v_pk_fma_f32 v[62:63], v[46:47], v[46:47], s[60:61] neg_lo:[1,0,0] neg_hi:[1,0,0]
v_pk_mul_f32 v[48:49], v[48:49], v[32:33]
v_pk_mul_f32 v[50:51], v[50:51], v[34:35]
v_pk_mul_f32 v[52:53], v[52:53], v[36:37]
v_pk_mul_f32 v[54:55], v[54:55], v[38:39]
v_pk_mul_f32 v[56:57], v[56:57], v[40:41]
v_pk_mul_f32 v[58:59], v[58:59], v[42:43]
v_pk_mul_f32 v[60:61], v[60:61], v[44:45]
v_pk_mul_f32 v[62:63], v[62:63], v[46:47]
v_cvt_pk_bf16_f32 v248, v16, v17
v_cvt_pk_bf16_f32 v249, v18, v19
v_cvt_pk_bf16_f32 v250, v20, v21
v_cvt_pk_bf16_f32 v251, v22, v23
v_cvt_pk_bf16_f32 v252, v24, v25
v_cvt_pk_bf16_f32 v253, v26, v27
v_cvt_pk_bf16_f32 v254, v28, v29
v_cvt_pk_bf16_f32 v255, v30, v31
v_mfma_f32_32x32x16_bf16 v[16:31], v[64:67], a[144:147], 0
ds_write_b64 v3, v[248:249] offset:0
v_exp_f32 v48, v48
v_exp_f32 v49, v49
v_exp_f32 v50, v50
v_mfma_f32_32x32x16_bf16 v[16:31], v[68:71], a[148:151], v[16:31]
ds_write_b64 v3, v[250:251] offset:128
v_exp_f32 v51, v51
v_exp_f32 v52, v52
v_exp_f32 v53, v53
v_mfma_f32_32x32x16_bf16 v[16:31], v[72:75], a[152:155], v[16:31]
ds_write_b64 v3, v[252:253] offset:1024
s_add_u32 s81, s80, 12288
s_waitcnt lgkmcnt(2)
buffer_store_dwordx4 v[232:235], v0, s[40:43], s81 offen offset:0
v_exp_f32 v54, v54
v_exp_f32 v55, v55
v_exp_f32 v56, v56
v_exp_f32 v57, v57
v_exp_f32 v58, v58
v_exp_f32 v59, v59
v_exp_f32 v60, v60
v_exp_f32 v61, v61
v_exp_f32 v62, v62
v_exp_f32_e64 v63, v63
v_pk_add_f32 v[48:49], v[48:49], 1.0 op_sel_hi:[1,0]
v_pk_add_f32 v[50:51], v[50:51], 1.0 op_sel_hi:[1,0]
v_pk_add_f32 v[52:53], v[52:53], 1.0 op_sel_hi:[1,0]
v_pk_add_f32 v[54:55], v[54:55], 1.0 op_sel_hi:[1,0]
v_pk_add_f32 v[56:57], v[56:57], 1.0 op_sel_hi:[1,0]
v_pk_add_f32 v[58:59], v[58:59], 1.0 op_sel_hi:[1,0]
v_pk_add_f32 v[60:61], v[60:61], 1.0 op_sel_hi:[1,0]
v_pk_add_f32 v[62:63], v[62:63], 1.0 op_sel_hi:[1,0]
v_mfma_f32_32x32x16_bf16 v[16:31], v[76:79], a[156:159], v[16:31]
ds_write_b64 v3, v[254:255] offset:1152
buffer_store_dwordx4 v[236:239], v0, s[40:43], s81 offen offset:1024
v_rcp_f32 v48, v48
v_rcp_f32 v49, v49
v_rcp_f32_e64 v50, v50
v_mfma_f32_32x32x16_bf16 v[16:31], v[80:83], a[160:163], v[16:31]
ds_read_b64_tr_b16 v[240:241], v4 offset:0
ds_read_b64_tr_b16 v[242:243], v4 offset:512
v_rcp_f32 v51, v51
v_rcp_f32 v52, v52
v_mfma_f32_32x32x16_bf16 v[16:31], v[84:87], a[164:167], v[16:31]
ds_read_b64_tr_b16 v[244:245], v4 offset:1024
ds_read_b64_tr_b16 v[246:247], v4 offset:1536
v_rcp_f32 v53, v53
v_rcp_f32 v54, v54
v_rcp_f32 v55, v55
v_rcp_f32 v56, v56
v_rcp_f32 v57, v57
v_rcp_f32 v58, v58
v_rcp_f32 v59, v59
v_rcp_f32 v60, v60
v_rcp_f32 v61, v61
v_rcp_f32 v62, v62
v_rcp_f32_e64 v63, v63
v_pk_mul_f32 v[32:33], v[48:49], v[32:33]
v_pk_mul_f32 v[34:35], v[50:51], v[34:35]
v_pk_mul_f32 v[36:37], v[52:53], v[36:37]
v_pk_mul_f32 v[38:39], v[54:55], v[38:39]
v_pk_mul_f32 v[40:41], v[56:57], v[40:41]
v_pk_mul_f32 v[42:43], v[58:59], v[42:43]
v_pk_mul_f32 v[44:45], v[60:61], v[44:45]
v_pk_mul_f32 v[46:47], v[62:63], v[46:47]
v_pk_fma_f32 v[110:111], v[32:33], v[32:33], v[110:111]
v_pk_fma_f32 v[48:49], v[16:17], v[16:17], s[60:61] neg_lo:[1,0,0] neg_hi:[1,0,0]
v_pk_fma_f32 v[110:111], v[34:35], v[34:35], v[110:111]
v_pk_fma_f32 v[50:51], v[18:19], v[18:19], s[60:61] neg_lo:[1,0,0] neg_hi:[1,0,0]
v_pk_fma_f32 v[110:111], v[36:37], v[36:37], v[110:111]
v_pk_fma_f32 v[52:53], v[20:21], v[20:21], s[60:61] neg_lo:[1,0,0] neg_hi:[1,0,0]
v_pk_fma_f32 v[110:111], v[38:39], v[38:39], v[110:111]
v_pk_fma_f32 v[54:55], v[22:23], v[22:23], s[60:61] neg_lo:[1,0,0] neg_hi:[1,0,0]
v_pk_fma_f32 v[110:111], v[40:41], v[40:41], v[110:111]
v_pk_fma_f32 v[56:57], v[24:25], v[24:25], s[60:61] neg_lo:[1,0,0] neg_hi:[1,0,0]
v_pk_fma_f32 v[110:111], v[42:43], v[42:43], v[110:111]
v_pk_fma_f32 v[58:59], v[26:27], v[26:27], s[60:61] neg_lo:[1,0,0] neg_hi:[1,0,0]
v_pk_fma_f32 v[110:111], v[44:45], v[44:45], v[110:111]
v_pk_fma_f32 v[60:61], v[28:29], v[28:29], s[60:61] neg_lo:[1,0,0] neg_hi:[1,0,0]
v_pk_fma_f32 v[110:111], v[46:47], v[46:47], v[110:111]
v_pk_fma_f32 v[62:63], v[30:31], v[30:31], s[60:61] neg_lo:[1,0,0] neg_hi:[1,0,0]
v_pk_mul_f32 v[48:49], v[48:49], v[16:17]
v_pk_mul_f32 v[50:51], v[50:51], v[18:19]
v_pk_mul_f32 v[52:53], v[52:53], v[20:21]
v_pk_mul_f32 v[54:55], v[54:55], v[22:23]
v_pk_mul_f32 v[56:57], v[56:57], v[24:25]
v_pk_mul_f32 v[58:59], v[58:59], v[26:27]
v_pk_mul_f32 v[60:61], v[60:61], v[28:29]
v_pk_mul_f32 v[62:63], v[62:63], v[30:31]
v_cvt_pk_bf16_f32 v248, v32, v33
v_cvt_pk_bf16_f32 v249, v34, v35
v_cvt_pk_bf16_f32 v250, v36, v37
v_cvt_pk_bf16_f32 v251, v38, v39
v_cvt_pk_bf16_f32 v252, v40, v41
v_cvt_pk_bf16_f32 v253, v42, v43
v_cvt_pk_bf16_f32 v254, v44, v45
v_cvt_pk_bf16_f32 v255, v46, v47
v_mfma_f32_32x32x16_bf16 v[32:47], v[64:67], a[168:171], 0
ds_write_b64 v3, v[248:249] offset:0
v_exp_f32 v48, v48
v_exp_f32 v49, v49
v_exp_f32_e64 v50, v50
v_mfma_f32_32x32x16_bf16 v[32:47], v[68:71], a[172:175], v[32:47]
ds_write_b64 v3, v[250:251] offset:128
s_add_u32 s74, s87, L_b1_4-L_pc
v_exp_f32 v51, v51
v_exp_f32 v52, v52
v_exp_f32_e64 v53, v53
v_mfma_f32_32x32x16_bf16 v[32:47], v[72:75], a[176:179], v[32:47]
ds_write_b64 v3, v[252:253] offset:1024
s_add_u32 s81, s80, 14336
s_waitcnt lgkmcnt(2)
buffer_store_dwordx4 v[240:243], v0, s[40:43], s81 offen offset:0
v_lshl_add_u32 v14, v0, 3, s74
v_exp_f32 v54, v54
v_exp_f32 v55, v55
v_min_u32 v14, L_pf1-L_pc-4, v14
v_exp_f32 v56, v56
v_exp_f32 v57, v57
v_exp_f32 v58, v58
v_mov_b32 v15, s89
v_exp_f32 v59, v59
v_exp_f32 v60, v60
v_exp_f32 v61, v61
v_add_co_u32 v14, vcc, s88, v14
v_exp_f32 v62, v62
v_exp_f32 v63, v63
v_addc_co_u32 v15, vcc, 0, v15, vcc
v_pk_add_f32 v[48:49], v[48:49], 1.0 op_sel_hi:[1,0]
v_pk_add_f32 v[50:51], v[50:51], 1.0 op_sel_hi:[1,0]
v_pk_add_f32 v[52:53], v[52:53], 1.0 op_sel_hi:[1,0]
v_pk_add_f32 v[54:55], v[54:55], 1.0 op_sel_hi:[1,0]
v_pk_add_f32 v[56:57], v[56:57], 1.0 op_sel_hi:[1,0]
v_pk_add_f32 v[58:59], v[58:59], 1.0 op_sel_hi:[1,0]
v_pk_add_f32 v[60:61], v[60:61], 1.0 op_sel_hi:[1,0]
v_pk_add_f32 v[62:63], v[62:63], 1.0 op_sel_hi:[1,0]
v_mfma_f32_32x32x16_bf16 v[32:47], v[76:79], a[180:183], v[32:47]
ds_write_b64 v3, v[254:255] offset:1152
buffer_store_dwordx4 v[244:247], v0, s[40:43], s81 offen offset:1024
v_rcp_f32 v48, v48
v_rcp_f32 v49, v49
v_rcp_f32_e64 v50, v50
v_mfma_f32_32x32x16_bf16 v[32:47], v[80:83], a[184:187], v[32:47]
ds_read_b64_tr_b16 v[232:233], v4 offset:0
ds_read_b64_tr_b16 v[234:235], v4 offset:512
v_rcp_f32 v51, v51
v_rcp_f32 v52, v52
v_mfma_f32_32x32x16_bf16 v[32:47], v[84:87], a[188:191], v[32:47]
ds_read_b64_tr_b16 v[236:237], v4 offset:1024
ds_read_b64_tr_b16 v[238:239], v4 offset:1536
s_waitcnt vmcnt(18)
global_load_dword v126, v[14:15], off
v_rcp_f32 v53, v53
v_rcp_f32 v54, v54
v_rcp_f32 v55, v55
v_rcp_f32 v56, v56
v_rcp_f32 v57, v57
v_rcp_f32 v58, v58
v_rcp_f32 v59, v59
v_rcp_f32 v60, v60
v_rcp_f32 v61, v61
v_rcp_f32 v62, v62
v_rcp_f32 v63, v63
v_pk_mul_f32 v[16:17], v[48:49], v[16:17]
v_pk_mul_f32 v[18:19], v[50:51], v[18:19]
v_pk_mul_f32 v[20:21], v[52:53], v[20:21]
v_pk_mul_f32 v[22:23], v[54:55], v[22:23]
v_pk_mul_f32 v[24:25], v[56:57], v[24:25]
v_pk_mul_f32 v[26:27], v[58:59], v[26:27]
v_pk_mul_f32 v[28:29], v[60:61], v[28:29]
v_pk_mul_f32 v[30:31], v[62:63], v[30:31]
v_pk_fma_f32 v[112:113], v[16:17], v[16:17], v[112:113]
v_pk_fma_f32 v[48:49], v[32:33], v[32:33], s[60:61] neg_lo:[1,0,0] neg_hi:[1,0,0]
v_pk_fma_f32 v[112:113], v[18:19], v[18:19], v[112:113]
v_pk_fma_f32 v[50:51], v[34:35], v[34:35], s[60:61] neg_lo:[1,0,0] neg_hi:[1,0,0]
v_pk_fma_f32 v[112:113], v[20:21], v[20:21], v[112:113]
v_pk_fma_f32 v[52:53], v[36:37], v[36:37], s[60:61] neg_lo:[1,0,0] neg_hi:[1,0,0]
v_pk_fma_f32 v[112:113], v[22:23], v[22:23], v[112:113]
v_pk_fma_f32 v[54:55], v[38:39], v[38:39], s[60:61] neg_lo:[1,0,0] neg_hi:[1,0,0]
v_pk_fma_f32 v[112:113], v[24:25], v[24:25], v[112:113]
v_pk_fma_f32 v[56:57], v[40:41], v[40:41], s[60:61] neg_lo:[1,0,0] neg_hi:[1,0,0]
v_pk_fma_f32 v[112:113], v[26:27], v[26:27], v[112:113]
v_pk_fma_f32 v[58:59], v[42:43], v[42:43], s[60:61] neg_lo:[1,0,0] neg_hi:[1,0,0]
v_pk_fma_f32 v[112:113], v[28:29], v[28:29], v[112:113]
v_pk_fma_f32 v[60:61], v[44:45], v[44:45], s[60:61] neg_lo:[1,0,0] neg_hi:[1,0,0]
v_pk_fma_f32 v[112:113], v[30:31], v[30:31], v[112:113]
v_pk_fma_f32 v[62:63], v[46:47], v[46:47], s[60:61] neg_lo:[1,0,0] neg_hi:[1,0,0]
v_pk_mul_f32 v[48:49], v[48:49], v[32:33]
v_pk_mul_f32 v[50:51], v[50:51], v[34:35]
v_pk_mul_f32 v[52:53], v[52:53], v[36:37]
v_pk_mul_f32 v[54:55], v[54:55], v[38:39]
v_pk_mul_f32 v[56:57], v[56:57], v[40:41]
v_pk_mul_f32 v[58:59], v[58:59], v[42:43]
v_pk_mul_f32 v[60:61], v[60:61], v[44:45]
v_pk_mul_f32 v[62:63], v[62:63], v[46:47]
v_cvt_pk_bf16_f32 v248, v16, v17
v_cvt_pk_bf16_f32 v249, v18, v19
v_cvt_pk_bf16_f32 v250, v20, v21
v_cvt_pk_bf16_f32 v251, v22, v23
v_cvt_pk_bf16_f32 v252, v24, v25
v_cvt_pk_bf16_f32 v253, v26, v27
v_cvt_pk_bf16_f32 v254, v28, v29
v_cvt_pk_bf16_f32 v255, v30, v31
v_mfma_f32_32x32x16_bf16 v[16:31], v[64:67], a[192:195], 0
ds_write_b64 v3, v[248:249] offset:0
v_exp_f32 v48, v48
v_exp_f32 v49, v49
v_exp_f32 v50, v50
v_mfma_f32_32x32x16_bf16 v[16:31], v[68:71], a[196:199], v[16:31]
ds_write_b64 v3, v[250:251] offset:128
v_exp_f32 v51, v51
v_exp_f32 v52, v52
v_exp_f32 v53, v53
v_mfma_f32_32x32x16_bf16 v[16:31], v[72:75], a[200:203], v[16:31]
ds_write_b64 v3, v[252:253] offset:1024
s_add_u32 s81, s80, 16384
s_waitcnt lgkmcnt(2)
buffer_store_dwordx4 v[232:235], v0, s[40:43], s81 offen offset:0
v_exp_f32 v54, v54
v_exp_f32 v55, v55
v_exp_f32 v56, v56
v_exp_f32 v57, v57
v_exp_f32 v58, v58
v_exp_f32 v59, v59
v_exp_f32 v60, v60
v_exp_f32 v61, v61
v_exp_f32 v62, v62
v_exp_f32_e64 v63, v63
v_pk_add_f32 v[48:49], v[48:49], 1.0 op_sel_hi:[1,0]
v_pk_add_f32 v[50:51], v[50:51], 1.0 op_sel_hi:[1,0]
v_pk_add_f32 v[52:53], v[52:53], 1.0 op_sel_hi:[1,0]
v_pk_add_f32 v[54:55], v[54:55], 1.0 op_sel_hi:[1,0]
v_pk_add_f32 v[56:57], v[56:57], 1.0 op_sel_hi:[1,0]
v_pk_add_f32 v[58:59], v[58:59], 1.0 op_sel_hi:[1,0]
v_pk_add_f32 v[60:61], v[60:61], 1.0 op_sel_hi:[1,0]
v_pk_add_f32 v[62:63], v[62:63], 1.0 op_sel_hi:[1,0]
v_mfma_f32_32x32x16_bf16 v[16:31], v[76:79], a[204:207], v[16:31]
ds_write_b64 v3, v[254:255] offset:1152
buffer_store_dwordx4 v[236:239], v0, s[40:43], s81 offen offset:1024
v_rcp_f32 v48, v48
v_rcp_f32 v49, v49
v_rcp_f32_e64 v50, v50
v_mfma_f32_32x32x16_bf16 v[16:31], v[80:83], a[208:211], v[16:31]
ds_read_b64_tr_b16 v[240:241], v4 offset:0
ds_read_b64_tr_b16 v[242:243], v4 offset:512
v_rcp_f32 v51, v51
v_rcp_f32 v52, v52
v_mfma_f32_32x32x16_bf16 v[16:31], v[84:87], a[212:215], v[16:31]
ds_read_b64_tr_b16 v[244:245], v4 offset:1024
ds_read_b64_tr_b16 v[246:247], v4 offset:1536
v_rcp_f32 v53, v53
v_rcp_f32 v54, v54
v_rcp_f32 v55, v55
v_rcp_f32 v56, v56
v_rcp_f32 v57, v57
v_rcp_f32 v58, v58
v_rcp_f32 v59, v59
v_rcp_f32 v60, v60
v_rcp_f32 v61, v61
v_rcp_f32 v62, v62
v_rcp_f32_e64 v63, v63
v_pk_mul_f32 v[32:33], v[48:49], v[32:33]
v_pk_mul_f32 v[34:35], v[50:51], v[34:35]
v_pk_mul_f32 v[36:37], v[52:53], v[36:37]
v_pk_mul_f32 v[38:39], v[54:55], v[38:39]
v_pk_mul_f32 v[40:41], v[56:57], v[40:41]
v_pk_mul_f32 v[42:43], v[58:59], v[42:43]
v_pk_mul_f32 v[44:45], v[60:61], v[44:45]
v_pk_mul_f32 v[46:47], v[62:63], v[46:47]
v_pk_fma_f32 v[114:115], v[32:33], v[32:33], v[114:115]
v_pk_fma_f32 v[48:49], v[16:17], v[16:17], s[60:61] neg_lo:[1,0,0] neg_hi:[1,0,0]
v_pk_fma_f32 v[114:115], v[34:35], v[34:35], v[114:115]
v_pk_fma_f32 v[50:51], v[18:19], v[18:19], s[60:61] neg_lo:[1,0,0] neg_hi:[1,0,0]
v_pk_fma_f32 v[114:115], v[36:37], v[36:37], v[114:115]
v_pk_fma_f32 v[52:53], v[20:21], v[20:21], s[60:61] neg_lo:[1,0,0] neg_hi:[1,0,0]
v_pk_fma_f32 v[114:115], v[38:39], v[38:39], v[114:115]
v_pk_fma_f32 v[54:55], v[22:23], v[22:23], s[60:61] neg_lo:[1,0,0] neg_hi:[1,0,0]
v_pk_fma_f32 v[114:115], v[40:41], v[40:41], v[114:115]
v_pk_fma_f32 v[56:57], v[24:25], v[24:25], s[60:61] neg_lo:[1,0,0] neg_hi:[1,0,0]
v_pk_fma_f32 v[114:115], v[42:43], v[42:43], v[114:115]
v_pk_fma_f32 v[58:59], v[26:27], v[26:27], s[60:61] neg_lo:[1,0,0] neg_hi:[1,0,0]
v_pk_fma_f32 v[114:115], v[44:45], v[44:45], v[114:115]
v_pk_fma_f32 v[60:61], v[28:29], v[28:29], s[60:61] neg_lo:[1,0,0] neg_hi:[1,0,0]
v_pk_fma_f32 v[114:115], v[46:47], v[46:47], v[114:115]
v_pk_fma_f32 v[62:63], v[30:31], v[30:31], s[60:61] neg_lo:[1,0,0] neg_hi:[1,0,0]
v_pk_mul_f32 v[48:49], v[48:49], v[16:17]
v_pk_mul_f32 v[50:51], v[50:51], v[18:19]
v_pk_mul_f32 v[52:53], v[52:53], v[20:21]
v_pk_mul_f32 v[54:55], v[54:55], v[22:23]
v_pk_mul_f32 v[56:57], v[56:57], v[24:25]
v_pk_mul_f32 v[58:59], v[58:59], v[26:27]
v_pk_mul_f32 v[60:61], v[60:61], v[28:29]
v_pk_mul_f32 v[62:63], v[62:63], v[30:31]
v_cvt_pk_bf16_f32 v248, v32, v33
v_cvt_pk_bf16_f32 v249, v34, v35
v_cvt_pk_bf16_f32 v250, v36, v37
v_cvt_pk_bf16_f32 v251, v38, v39
v_cvt_pk_bf16_f32 v252, v40, v41
v_cvt_pk_bf16_f32 v253, v42, v43
v_cvt_pk_bf16_f32 v254, v44, v45
v_cvt_pk_bf16_f32 v255, v46, v47
v_mfma_f32_32x32x16_bf16 v[32:47], v[64:67], a[216:219], 0
ds_write_b64 v3, v[248:249] offset:0
v_exp_f32 v48, v48
v_exp_f32 v49, v49
v_exp_f32 v50, v50
v_mfma_f32_32x32x16_bf16 v[32:47], v[68:71], a[220:223], v[32:47]
ds_write_b64 v3, v[250:251] offset:128
v_exp_f32 v51, v51
v_exp_f32 v52, v52
v_exp_f32 v53, v53
v_mfma_f32_32x32x16_bf16 v[32:47], v[72:75], a[224:227], v[32:47]
ds_write_b64 v3, v[252:253] offset:1024
s_add_u32 s81, s80, 18432
s_waitcnt lgkmcnt(2)
buffer_store_dwordx4 v[240:243], v0, s[40:43], s81 offen offset:0
v_exp_f32 v54, v54
v_exp_f32 v55, v55
v_exp_f32 v56, v56
v_exp_f32 v57, v57
v_exp_f32 v58, v58
v_exp_f32 v59, v59
v_exp_f32 v60, v60
v_exp_f32 v61, v61
v_exp_f32 v62, v62
v_exp_f32_e64 v63, v63
v_pk_add_f32 v[48:49], v[48:49], 1.0 op_sel_hi:[1,0]
v_pk_add_f32 v[50:51], v[50:51], 1.0 op_sel_hi:[1,0]
v_pk_add_f32 v[52:53], v[52:53], 1.0 op_sel_hi:[1,0]
v_pk_add_f32 v[54:55], v[54:55], 1.0 op_sel_hi:[1,0]
v_pk_add_f32 v[56:57], v[56:57], 1.0 op_sel_hi:[1,0]
v_pk_add_f32 v[58:59], v[58:59], 1.0 op_sel_hi:[1,0]
v_pk_add_f32 v[60:61], v[60:61], 1.0 op_sel_hi:[1,0]
v_pk_add_f32 v[62:63], v[62:63], 1.0 op_sel_hi:[1,0]
v_mfma_f32_32x32x16_bf16 v[32:47], v[76:79], a[228:231], v[32:47]
ds_write_b64 v3, v[254:255] offset:1152
buffer_store_dwordx4 v[244:247], v0, s[40:43], s81 offen offset:1024
v_rcp_f32 v48, v48
v_rcp_f32 v49, v49
v_rcp_f32_e64 v50, v50
v_mfma_f32_32x32x16_bf16 v[32:47], v[80:83], a[232:235], v[32:47]
ds_read_b64_tr_b16 v[232:233], v4 offset:0
ds_read_b64_tr_b16 v[234:235], v4 offset:512
v_rcp_f32 v51, v51
v_rcp_f32 v52, v52
v_mfma_f32_32x32x16_bf16 v[32:47], v[84:87], a[236:239], v[32:47]
ds_read_b64_tr_b16 v[236:237], v4 offset:1024
ds_read_b64_tr_b16 v[238:239], v4 offset:1536
v_rcp_f32 v53, v53
v_rcp_f32 v54, v54
v_rcp_f32 v55, v55
v_rcp_f32 v56, v56
v_rcp_f32 v57, v57
v_rcp_f32 v58, v58
v_rcp_f32 v59, v59
v_rcp_f32 v60, v60
v_rcp_f32 v61, v61
v_rcp_f32 v62, v62
v_rcp_f32_e64 v63, v63
v_pk_mul_f32 v[16:17], v[48:49], v[16:17]
v_pk_mul_f32 v[18:19], v[50:51], v[18:19]
v_pk_mul_f32 v[20:21], v[52:53], v[20:21]
v_pk_mul_f32 v[22:23], v[54:55], v[22:23]
v_pk_mul_f32 v[24:25], v[56:57], v[24:25]
v_pk_mul_f32 v[26:27], v[58:59], v[26:27]
v_pk_mul_f32 v[28:29], v[60:61], v[28:29]
v_pk_mul_f32 v[30:31], v[62:63], v[30:31]
v_pk_fma_f32 v[116:117], v[16:17], v[16:17], v[116:117]
v_pk_fma_f32 v[48:49], v[32:33], v[32:33], s[60:61] neg_lo:[1,0,0] neg_hi:[1,0,0]
v_pk_fma_f32 v[116:117], v[18:19], v[18:19], v[116:117]
v_pk_fma_f32 v[50:51], v[34:35], v[34:35], s[60:61] neg_lo:[1,0,0] neg_hi:[1,0,0]
v_pk_fma_f32 v[116:117], v[20:21], v[20:21], v[116:117]
v_pk_fma_f32 v[52:53], v[36:37], v[36:37], s[60:61] neg_lo:[1,0,0] neg_hi:[1,0,0]
v_pk_fma_f32 v[116:117], v[22:23], v[22:23], v[116:117]
v_pk_fma_f32 v[54:55], v[38:39], v[38:39], s[60:61] neg_lo:[1,0,0] neg_hi:[1,0,0]
v_pk_fma_f32 v[116:117], v[24:25], v[24:25], v[116:117]
v_pk_fma_f32 v[56:57], v[40:41], v[40:41], s[60:61] neg_lo:[1,0,0] neg_hi:[1,0,0]
v_pk_fma_f32 v[116:117], v[26:27], v[26:27], v[116:117]
v_pk_fma_f32 v[58:59], v[42:43], v[42:43], s[60:61] neg_lo:[1,0,0] neg_hi:[1,0,0]
v_pk_fma_f32 v[116:117], v[28:29], v[28:29], v[116:117]
v_pk_fma_f32 v[60:61], v[44:45], v[44:45], s[60:61] neg_lo:[1,0,0] neg_hi:[1,0,0]
v_pk_fma_f32 v[116:117], v[30:31], v[30:31], v[116:117]
v_pk_fma_f32 v[62:63], v[46:47], v[46:47], s[60:61] neg_lo:[1,0,0] neg_hi:[1,0,0]
v_pk_mul_f32 v[48:49], v[48:49], v[32:33]
v_pk_mul_f32 v[50:51], v[50:51], v[34:35]
v_pk_mul_f32 v[52:53], v[52:53], v[36:37]
v_pk_mul_f32 v[54:55], v[54:55], v[38:39]
v_pk_mul_f32 v[56:57], v[56:57], v[40:41]
v_pk_mul_f32 v[58:59], v[58:59], v[42:43]
v_pk_mul_f32 v[60:61], v[60:61], v[44:45]
v_pk_mul_f32 v[62:63], v[62:63], v[46:47]
v_cvt_pk_bf16_f32 v248, v16, v17
v_cvt_pk_bf16_f32 v249, v18, v19
v_cvt_pk_bf16_f32 v250, v20, v21
v_cvt_pk_bf16_f32 v251, v22, v23
v_cvt_pk_bf16_f32 v252, v24, v25
v_cvt_pk_bf16_f32 v253, v26, v27
v_cvt_pk_bf16_f32 v254, v28, v29
v_cvt_pk_bf16_f32 v255, v30, v31
v_mfma_f32_32x32x16_bf16 v[16:31], v[64:67], a[240:243], 0
ds_write_b64 v3, v[248:249] offset:0
v_exp_f32 v48, v48
v_exp_f32 v49, v49
v_exp_f32 v50, v50
v_mfma_f32_32x32x16_bf16 v[16:31], v[68:71], a[244:247], v[16:31]
ds_write_b64 v3, v[250:251] offset:128
v_exp_f32 v51, v51
v_exp_f32 v52, v52
v_exp_f32 v53, v53
v_mfma_f32_32x32x16_bf16 v[16:31], v[72:75], a[248:251], v[16:31]
ds_write_b64 v3, v[252:253] offset:1024
s_add_u32 s81, s80, 20480
s_waitcnt lgkmcnt(2)
buffer_store_dwordx4 v[232:235], v0, s[40:43], s81 offen offset:0
v_exp_f32 v54, v54
v_exp_f32 v55, v55
v_exp_f32 v56, v56
v_exp_f32 v57, v57
v_exp_f32 v58, v58
v_exp_f32 v59, v59
v_exp_f32 v60, v60
v_exp_f32 v61, v61
v_exp_f32 v62, v62
v_exp_f32_e64 v63, v63
v_pk_add_f32 v[48:49], v[48:49], 1.0 op_sel_hi:[1,0]
v_pk_add_f32 v[50:51], v[50:51], 1.0 op_sel_hi:[1,0]
v_pk_add_f32 v[52:53], v[52:53], 1.0 op_sel_hi:[1,0]
v_pk_add_f32 v[54:55], v[54:55], 1.0 op_sel_hi:[1,0]
v_pk_add_f32 v[56:57], v[56:57], 1.0 op_sel_hi:[1,0]
v_pk_add_f32 v[58:59], v[58:59], 1.0 op_sel_hi:[1,0]
v_pk_add_f32 v[60:61], v[60:61], 1.0 op_sel_hi:[1,0]
v_pk_add_f32 v[62:63], v[62:63], 1.0 op_sel_hi:[1,0]
v_mfma_f32_32x32x16_bf16 v[16:31], v[76:79], a[252:255], v[16:31]
ds_read_b128 v[88:91], v7 offset:2048
ds_write_b64 v3, v[254:255] offset:1152
buffer_store_dwordx4 v[236:239], v0, s[40:43], s81 offen offset:1024
v_rcp_f32 v48, v48
v_rcp_f32 v49, v49
v_mfma_f32_32x32x16_bf16 v[16:31], v[80:83], v[224:227], v[16:31]
ds_read_b128 v[92:95], v7 offset:2560
ds_read_b64_tr_b16 v[240:241], v4 offset:0
ds_read_b64_tr_b16 v[242:243], v4 offset:512
v_rcp_f32 v50, v50
v_rcp_f32 v51, v51
v_mfma_f32_32x32x16_bf16 v[16:31], v[84:87], v[228:231], v[16:31]
ds_read_b128 v[96:99], v7 offset:4096
ds_read_b64_tr_b16 v[244:245], v4 offset:1024
ds_read_b64_tr_b16 v[246:247], v4 offset:1536
v_rcp_f32 v52, v52
v_rcp_f32 v53, v53
v_rcp_f32 v54, v54
v_rcp_f32 v55, v55
v_rcp_f32 v56, v56
v_rcp_f32 v57, v57
v_rcp_f32 v58, v58
v_rcp_f32 v59, v59
v_rcp_f32 v60, v60
v_rcp_f32 v61, v61
v_rcp_f32 v62, v62
v_rcp_f32 v63, v63
v_pk_mul_f32 v[32:33], v[48:49], v[32:33]
v_pk_mul_f32 v[34:35], v[50:51], v[34:35]
v_pk_mul_f32 v[36:37], v[52:53], v[36:37]
v_pk_mul_f32 v[38:39], v[54:55], v[38:39]
v_pk_mul_f32 v[40:41], v[56:57], v[40:41]
v_pk_mul_f32 v[42:43], v[58:59], v[42:43]
v_pk_mul_f32 v[44:45], v[60:61], v[44:45]
v_pk_mul_f32 v[46:47], v[62:63], v[46:47]
v_pk_fma_f32 v[118:119], v[32:33], v[32:33], v[118:119]
v_pk_fma_f32 v[48:49], v[16:17], v[16:17], s[60:61] neg_lo:[1,0,0] neg_hi:[1,0,0]
v_pk_fma_f32 v[118:119], v[34:35], v[34:35], v[118:119]
v_pk_fma_f32 v[50:51], v[18:19], v[18:19], s[60:61] neg_lo:[1,0,0] neg_hi:[1,0,0]
v_pk_fma_f32 v[118:119], v[36:37], v[36:37], v[118:119]
v_pk_fma_f32 v[52:53], v[20:21], v[20:21], s[60:61] neg_lo:[1,0,0] neg_hi:[1,0,0]
v_pk_fma_f32 v[118:119], v[38:39], v[38:39], v[118:119]
v_pk_fma_f32 v[54:55], v[22:23], v[22:23], s[60:61] neg_lo:[1,0,0] neg_hi:[1,0,0]
v_pk_fma_f32 v[118:119], v[40:41], v[40:41], v[118:119]
v_pk_fma_f32 v[56:57], v[24:25], v[24:25], s[60:61] neg_lo:[1,0,0] neg_hi:[1,0,0]
v_pk_fma_f32 v[118:119], v[42:43], v[42:43], v[118:119]
v_pk_fma_f32 v[58:59], v[26:27], v[26:27], s[60:61] neg_lo:[1,0,0] neg_hi:[1,0,0]
v_pk_fma_f32 v[118:119], v[44:45], v[44:45], v[118:119]
v_pk_fma_f32 v[60:61], v[28:29], v[28:29], s[60:61] neg_lo:[1,0,0] neg_hi:[1,0,0]
v_pk_fma_f32 v[118:119], v[46:47], v[46:47], v[118:119]
v_pk_fma_f32 v[62:63], v[30:31], v[30:31], s[60:61] neg_lo:[1,0,0] neg_hi:[1,0,0]
v_pk_mul_f32 v[48:49], v[48:49], v[16:17]
v_pk_mul_f32 v[50:51], v[50:51], v[18:19]
v_pk_mul_f32 v[52:53], v[52:53], v[20:21]
v_pk_mul_f32 v[54:55], v[54:55], v[22:23]
v_pk_mul_f32 v[56:57], v[56:57], v[24:25]
v_pk_mul_f32 v[58:59], v[58:59], v[26:27]
v_pk_mul_f32 v[60:61], v[60:61], v[28:29]
v_pk_mul_f32 v[62:63], v[62:63], v[30:31]
v_cvt_pk_bf16_f32 v248, v32, v33
v_cvt_pk_bf16_f32 v249, v34, v35
v_cvt_pk_bf16_f32 v250, v36, v37
v_cvt_pk_bf16_f32 v251, v38, v39
v_cvt_pk_bf16_f32 v252, v40, v41
v_cvt_pk_bf16_f32 v253, v42, v43
v_cvt_pk_bf16_f32 v254, v44, v45
v_cvt_pk_bf16_f32 v255, v46, v47
s_waitcnt lgkmcnt(0)
v_mfma_f32_32x32x16_bf16 v[32:47], v[64:67], v[88:91], 0
ds_read_b128 v[88:91], v7 offset:4608
ds_write_b64 v3, v[248:249] offset:0
v_exp_f32 v48, v48
v_exp_f32 v49, v49
v_exp_f32 v50, v50
v_mfma_f32_32x32x16_bf16 v[32:47], v[68:71], v[92:95], v[32:47]
ds_read_b128 v[92:95], v7 offset:6144
ds_write_b64 v3, v[250:251] offset:128
v_exp_f32 v51, v51
v_exp_f32 v52, v52
v_mfma_f32_32x32x16_bf16 v[32:47], v[72:75], v[96:99], v[32:47]
ds_read_b128 v[96:99], v7 offset:6656
ds_write_b64 v3, v[252:253] offset:1024
s_add_u32 s81, s80, 22528
buffer_store_dwordx4 v[240:243], v0, s[40:43], s81 offen offset:0 sc1
v_exp_f32 v53, v53
v_exp_f32 v54, v54
v_exp_f32 v55, v55
v_exp_f32 v56, v56
v_exp_f32 v57, v57
v_exp_f32 v58, v58
v_exp_f32 v59, v59
v_exp_f32 v60, v60
v_exp_f32 v61, v61
v_exp_f32 v62, v62
v_exp_f32_e64 v63, v63
v_pk_add_f32 v[48:49], v[48:49], 1.0 op_sel_hi:[1,0]
v_pk_add_f32 v[50:51], v[50:51], 1.0 op_sel_hi:[1,0]
v_pk_add_f32 v[52:53], v[52:53], 1.0 op_sel_hi:[1,0]
v_pk_add_f32 v[54:55], v[54:55], 1.0 op_sel_hi:[1,0]
v_pk_add_f32 v[56:57], v[56:57], 1.0 op_sel_hi:[1,0]
v_pk_add_f32 v[58:59], v[58:59], 1.0 op_sel_hi:[1,0]
v_pk_add_f32 v[60:61], v[60:61], 1.0 op_sel_hi:[1,0]
v_pk_add_f32 v[62:63], v[62:63], 1.0 op_sel_hi:[1,0]
s_waitcnt lgkmcnt(0)
v_mfma_f32_32x32x16_bf16 v[32:47], v[76:79], v[88:91], v[32:47]
ds_write_b64 v3, v[254:255] offset:1152
buffer_store_dwordx4 v[244:247], v0, s[40:43], s81 offen offset:1024 sc1
v_rcp_f32 v48, v48
v_rcp_f32 v49, v49
v_rcp_f32 v50, v50
v_mfma_f32_32x32x16_bf16 v[32:47], v[80:83], v[92:95], v[32:47]
ds_read_b64_tr_b16 v[232:233], v4 offset:0
ds_read_b64_tr_b16 v[234:235], v4 offset:512
v_rcp_f32 v51, v51
v_rcp_f32 v52, v52
v_mfma_f32_32x32x16_bf16 v[32:47], v[84:87], v[96:99], v[32:47]
ds_read_b64_tr_b16 v[236:237], v4 offset:1024
ds_read_b64_tr_b16 v[238:239], v4 offset:1536
v_rcp_f32 v53, v53
v_rcp_f32 v54, v54
v_rcp_f32 v55, v55
v_rcp_f32 v56, v56
v_rcp_f32 v57, v57
v_rcp_f32 v58, v58
v_rcp_f32 v59, v59
v_rcp_f32 v60, v60
v_rcp_f32 v61, v61
v_rcp_f32 v62, v62
v_rcp_f32_e64 v63, v63
v_pk_mul_f32 v[16:17], v[48:49], v[16:17]
v_pk_mul_f32 v[18:19], v[50:51], v[18:19]
v_pk_mul_f32 v[20:21], v[52:53], v[20:21]
v_pk_mul_f32 v[22:23], v[54:55], v[22:23]
v_pk_mul_f32 v[24:25], v[56:57], v[24:25]
v_pk_mul_f32 v[26:27], v[58:59], v[26:27]
v_pk_mul_f32 v[28:29], v[60:61], v[28:29]
v_pk_mul_f32 v[30:31], v[62:63], v[30:31]
v_pk_fma_f32 v[120:121], v[16:17], v[16:17], v[120:121]
v_pk_fma_f32 v[48:49], v[32:33], v[32:33], s[60:61] neg_lo:[1,0,0] neg_hi:[1,0,0]
v_pk_fma_f32 v[120:121], v[18:19], v[18:19], v[120:121]
v_pk_fma_f32 v[50:51], v[34:35], v[34:35], s[60:61] neg_lo:[1,0,0] neg_hi:[1,0,0]
v_pk_fma_f32 v[120:121], v[20:21], v[20:21], v[120:121]
v_pk_fma_f32 v[52:53], v[36:37], v[36:37], s[60:61] neg_lo:[1,0,0] neg_hi:[1,0,0]
v_pk_fma_f32 v[120:121], v[22:23], v[22:23], v[120:121]
v_pk_fma_f32 v[54:55], v[38:39], v[38:39], s[60:61] neg_lo:[1,0,0] neg_hi:[1,0,0]
v_pk_fma_f32 v[120:121], v[24:25], v[24:25], v[120:121]
v_pk_fma_f32 v[56:57], v[40:41], v[40:41], s[60:61] neg_lo:[1,0,0] neg_hi:[1,0,0]
v_pk_fma_f32 v[120:121], v[26:27], v[26:27], v[120:121]
v_pk_fma_f32 v[58:59], v[42:43], v[42:43], s[60:61] neg_lo:[1,0,0] neg_hi:[1,0,0]
v_pk_fma_f32 v[120:121], v[28:29], v[28:29], v[120:121]
v_pk_fma_f32 v[60:61], v[44:45], v[44:45], s[60:61] neg_lo:[1,0,0] neg_hi:[1,0,0]
v_pk_fma_f32 v[120:121], v[30:31], v[30:31], v[120:121]
v_pk_fma_f32 v[62:63], v[46:47], v[46:47], s[60:61] neg_lo:[1,0,0] neg_hi:[1,0,0]
v_pk_mul_f32 v[48:49], v[48:49], v[32:33]
v_pk_mul_f32 v[50:51], v[50:51], v[34:35]
v_pk_mul_f32 v[52:53], v[52:53], v[36:37]
v_pk_mul_f32 v[54:55], v[54:55], v[38:39]
v_pk_mul_f32 v[56:57], v[56:57], v[40:41]
v_pk_mul_f32 v[58:59], v[58:59], v[42:43]
v_pk_mul_f32 v[60:61], v[60:61], v[44:45]
v_pk_mul_f32 v[62:63], v[62:63], v[46:47]
v_cvt_pk_bf16_f32 v248, v16, v17
v_cvt_pk_bf16_f32 v249, v18, v19
v_cvt_pk_bf16_f32 v250, v20, v21
v_cvt_pk_bf16_f32 v251, v22, v23
v_cvt_pk_bf16_f32 v252, v24, v25
v_cvt_pk_bf16_f32 v253, v26, v27
v_cvt_pk_bf16_f32 v254, v28, v29
v_cvt_pk_bf16_f32 v255, v30, v31
v_mfma_f32_32x32x16_bf16 v[16:31], v[128:131], a[0:3], 0
ds_write_b64 v3, v[248:249] offset:0
v_exp_f32 v48, v48
v_exp_f32 v49, v49
v_exp_f32_e64 v50, v50
v_mfma_f32_32x32x16_bf16 v[16:31], v[132:135], a[4:7], v[16:31]
ds_write_b64 v3, v[250:251] offset:128
ds_read_b128 v[64:67], v5 offset:0
v_exp_f32 v51, v51
v_exp_f32 v52, v52
v_exp_f32_e64 v53, v53
v_mfma_f32_32x32x16_bf16 v[16:31], v[136:139], a[8:11], v[16:31]
ds_write_b64 v3, v[252:253] offset:1024
s_add_u32 s81, s80, 24576
s_waitcnt lgkmcnt(3)
buffer_store_dwordx4 v[232:235], v0, s[40:43], s81 offen offset:0 sc1
ds_read_b128 v[68:71], v6 offset:0
ds_read_b128 v[72:75], v5 offset:528
v_exp_f32 v54, v54
v_exp_f32 v55, v55
v_exp_f32 v56, v56
v_exp_f32 v57, v57
v_exp_f32 v58, v58
v_exp_f32 v59, v59
v_exp_f32 v60, v60
v_exp_f32 v61, v61
v_exp_f32 v62, v62
v_exp_f32_e64 v63, v63
v_pk_add_f32 v[48:49], v[48:49], 1.0 op_sel_hi:[1,0]
v_pk_add_f32 v[50:51], v[50:51], 1.0 op_sel_hi:[1,0]
v_pk_add_f32 v[52:53], v[52:53], 1.0 op_sel_hi:[1,0]
v_pk_add_f32 v[54:55], v[54:55], 1.0 op_sel_hi:[1,0]
v_pk_add_f32 v[56:57], v[56:57], 1.0 op_sel_hi:[1,0]
v_pk_add_f32 v[58:59], v[58:59], 1.0 op_sel_hi:[1,0]
v_pk_add_f32 v[60:61], v[60:61], 1.0 op_sel_hi:[1,0]
v_pk_add_f32 v[62:63], v[62:63], 1.0 op_sel_hi:[1,0]
v_mfma_f32_32x32x16_bf16 v[16:31], v[140:143], a[12:15], v[16:31]
ds_write_b64 v3, v[254:255] offset:1152
buffer_store_dwordx4 v[236:239], v0, s[40:43], s81 offen offset:1024 sc1
v_rcp_f32 v48, v48
v_rcp_f32 v49, v49
v_rcp_f32_e64 v50, v50
v_mfma_f32_32x32x16_bf16 v[16:31], v[144:147], a[16:19], v[16:31]
ds_read_b64_tr_b16 v[240:241], v4 offset:0
ds_read_b64_tr_b16 v[242:243], v4 offset:512
v_rcp_f32 v51, v51
v_rcp_f32 v52, v52
v_mfma_f32_32x32x16_bf16 v[16:31], v[148:151], a[20:23], v[16:31]
ds_read_b64_tr_b16 v[244:245], v4 offset:1024
ds_read_b64_tr_b16 v[246:247], v4 offset:1536
ds_read_b128 v[76:79], v6 offset:528
ds_read_b128 v[80:83], v5 offset:1056
ds_read_b128 v[84:87], v6 offset:1056
v_rcp_f32 v53, v53
v_rcp_f32 v54, v54
v_rcp_f32 v55, v55
v_rcp_f32 v56, v56
v_rcp_f32 v57, v57
v_rcp_f32 v58, v58
v_rcp_f32 v59, v59
v_rcp_f32 v60, v60
v_rcp_f32 v61, v61
v_rcp_f32 v62, v62
v_rcp_f32_e64 v63, v63
v_pk_mul_f32 v[32:33], v[48:49], v[32:33]
v_pk_mul_f32 v[34:35], v[50:51], v[34:35]
v_pk_mul_f32 v[36:37], v[52:53], v[36:37]
v_pk_mul_f32 v[38:39], v[54:55], v[38:39]
v_pk_mul_f32 v[40:41], v[56:57], v[40:41]
v_pk_mul_f32 v[42:43], v[58:59], v[42:43]
v_pk_mul_f32 v[44:45], v[60:61], v[44:45]
v_pk_mul_f32 v[46:47], v[62:63], v[46:47]
v_pk_fma_f32 v[122:123], v[32:33], v[32:33], v[122:123]
v_pk_fma_f32 v[48:49], v[16:17], v[16:17], s[60:61] neg_lo:[1,0,0] neg_hi:[1,0,0]
v_pk_fma_f32 v[122:123], v[34:35], v[34:35], v[122:123]
v_pk_fma_f32 v[50:51], v[18:19], v[18:19], s[60:61] neg_lo:[1,0,0] neg_hi:[1,0,0]
v_pk_fma_f32 v[122:123], v[36:37], v[36:37], v[122:123]
v_pk_fma_f32 v[52:53], v[20:21], v[20:21], s[60:61] neg_lo:[1,0,0] neg_hi:[1,0,0]
v_pk_fma_f32 v[122:123], v[38:39], v[38:39], v[122:123]
v_pk_fma_f32 v[54:55], v[22:23], v[22:23], s[60:61] neg_lo:[1,0,0] neg_hi:[1,0,0]
v_pk_fma_f32 v[122:123], v[40:41], v[40:41], v[122:123]
v_pk_fma_f32 v[56:57], v[24:25], v[24:25], s[60:61] neg_lo:[1,0,0] neg_hi:[1,0,0]
v_pk_fma_f32 v[122:123], v[42:43], v[42:43], v[122:123]
v_pk_fma_f32 v[58:59], v[26:27], v[26:27], s[60:61] neg_lo:[1,0,0] neg_hi:[1,0,0]
v_pk_fma_f32 v[122:123], v[44:45], v[44:45], v[122:123]
v_pk_fma_f32 v[60:61], v[28:29], v[28:29], s[60:61] neg_lo:[1,0,0] neg_hi:[1,0,0]
v_pk_fma_f32 v[122:123], v[46:47], v[46:47], v[122:123]
v_pk_fma_f32 v[62:63], v[30:31], v[30:31], s[60:61] neg_lo:[1,0,0] neg_hi:[1,0,0]
v_pk_mul_f32 v[48:49], v[48:49], v[16:17]
v_pk_mul_f32 v[50:51], v[50:51], v[18:19]
v_pk_mul_f32 v[52:53], v[52:53], v[20:21]
v_pk_mul_f32 v[54:55], v[54:55], v[22:23]
v_pk_mul_f32 v[56:57], v[56:57], v[24:25]
v_pk_mul_f32 v[58:59], v[58:59], v[26:27]
v_pk_mul_f32 v[60:61], v[60:61], v[28:29]
v_pk_mul_f32 v[62:63], v[62:63], v[30:31]
L_b1_4:
v_cvt_pk_bf16_f32 v248, v32, v33
v_cvt_pk_bf16_f32 v249, v34, v35
v_cvt_pk_bf16_f32 v250, v36, v37
v_cvt_pk_bf16_f32 v251, v38, v39
v_cvt_pk_bf16_f32 v252, v40, v41
v_cvt_pk_bf16_f32 v253, v42, v43
v_cvt_pk_bf16_f32 v254, v44, v45
v_cvt_pk_bf16_f32 v255, v46, v47
v_mfma_f32_32x32x16_bf16 v[32:47], v[128:131], a[24:27], 0
ds_write_b64 v3, v[248:249] offset:0
v_exp_f32 v48, v48
v_exp_f32 v49, v49
v_exp_f32 v50, v50
v_mfma_f32_32x32x16_bf16 v[32:47], v[132:135], a[28:31], v[32:47]
ds_write_b64 v3, v[250:251] offset:128
v_exp_f32 v51, v51
v_exp_f32 v52, v52
v_exp_f32 v53, v53
v_mfma_f32_32x32x16_bf16 v[32:47], v[136:139], a[32:35], v[32:47]
ds_write_b64 v3, v[252:253] offset:1024
s_add_u32 s81, s80, 26624
s_waitcnt lgkmcnt(2)
buffer_store_dwordx4 v[240:243], v0, s[40:43], s81 offen offset:0 sc1
v_exp_f32 v54, v54
v_exp_f32 v55, v55
s_waitcnt vmcnt(14)
v_mfma_f32_32x32x16_bf16 v[152:167], v[64:67], v[200:203], 0
v_exp_f32 v56, v56
v_exp_f32 v57, v57
v_exp_f32 v58, v58
v_mfma_f32_32x32x16_bf16 v[152:167], v[68:71], v[204:207], v[152:167]
v_exp_f32 v59, v59
v_exp_f32 v60, v60
v_exp_f32 v61, v61
v_exp_f32 v62, v62
v_exp_f32 v63, v63
v_pk_add_f32 v[48:49], v[48:49], 1.0 op_sel_hi:[1,0]
v_pk_add_f32 v[50:51], v[50:51], 1.0 op_sel_hi:[1,0]
v_pk_add_f32 v[52:53], v[52:53], 1.0 op_sel_hi:[1,0]
v_pk_add_f32 v[54:55], v[54:55], 1.0 op_sel_hi:[1,0]
v_pk_add_f32 v[56:57], v[56:57], 1.0 op_sel_hi:[1,0]
v_pk_add_f32 v[58:59], v[58:59], 1.0 op_sel_hi:[1,0]
v_pk_add_f32 v[60:61], v[60:61], 1.0 op_sel_hi:[1,0]
v_pk_add_f32 v[62:63], v[62:63], 1.0 op_sel_hi:[1,0]
v_mfma_f32_32x32x16_bf16 v[32:47], v[140:143], a[36:39], v[32:47]
ds_write_b64 v3, v[254:255] offset:1152
buffer_store_dwordx4 v[244:247], v0, s[40:43], s81 offen offset:1024 sc1
v_rcp_f32 v48, v48
v_rcp_f32 v49, v49
v_rcp_f32_e64 v50, v50
v_mfma_f32_32x32x16_bf16 v[32:47], v[144:147], a[40:43], v[32:47]
ds_read_b64_tr_b16 v[232:233], v4 offset:0
ds_read_b64_tr_b16 v[234:235], v4 offset:512
v_rcp_f32 v51, v51
v_rcp_f32 v52, v52
v_mfma_f32_32x32x16_bf16 v[32:47], v[148:151], a[44:47], v[32:47]
ds_read_b64_tr_b16 v[236:237], v4 offset:1024
ds_read_b64_tr_b16 v[238:239], v4 offset:1536
v_rcp_f32 v53, v53
v_rcp_f32 v54, v54
v_rcp_f32 v55, v55
v_mfma_f32_32x32x16_bf16 v[168:183], v[72:75], v[208:211], 0
v_rcp_f32 v56, v56
v_rcp_f32 v57, v57
v_rcp_f32 v58, v58
v_mfma_f32_32x32x16_bf16 v[168:183], v[76:79], v[212:215], v[168:183]
v_rcp_f32 v59, v59
v_rcp_f32 v60, v60
v_rcp_f32 v61, v61
v_rcp_f32 v62, v62
v_rcp_f32_e64 v63, v63
v_pk_mul_f32 v[16:17], v[48:49], v[16:17]
v_pk_mul_f32 v[18:19], v[50:51], v[18:19]
v_pk_mul_f32 v[20:21], v[52:53], v[20:21]
v_pk_mul_f32 v[22:23], v[54:55], v[22:23]
v_pk_mul_f32 v[24:25], v[56:57], v[24:25]
v_pk_mul_f32 v[26:27], v[58:59], v[26:27]
v_pk_mul_f32 v[28:29], v[60:61], v[28:29]
v_pk_mul_f32 v[30:31], v[62:63], v[30:31]
v_pk_fma_f32 v[100:101], v[16:17], v[16:17], v[100:101]
v_pk_fma_f32 v[48:49], v[32:33], v[32:33], s[60:61] neg_lo:[1,0,0] neg_hi:[1,0,0]
v_pk_fma_f32 v[100:101], v[18:19], v[18:19], v[100:101]
v_pk_fma_f32 v[50:51], v[34:35], v[34:35], s[60:61] neg_lo:[1,0,0] neg_hi:[1,0,0]
v_pk_fma_f32 v[100:101], v[20:21], v[20:21], v[100:101]
v_pk_fma_f32 v[52:53], v[36:37], v[36:37], s[60:61] neg_lo:[1,0,0] neg_hi:[1,0,0]
v_pk_fma_f32 v[100:101], v[22:23], v[22:23], v[100:101]
v_pk_fma_f32 v[54:55], v[38:39], v[38:39], s[60:61] neg_lo:[1,0,0] neg_hi:[1,0,0]
v_pk_fma_f32 v[100:101], v[24:25], v[24:25], v[100:101]
v_pk_fma_f32 v[56:57], v[40:41], v[40:41], s[60:61] neg_lo:[1,0,0] neg_hi:[1,0,0]
v_pk_fma_f32 v[100:101], v[26:27], v[26:27], v[100:101]
v_pk_fma_f32 v[58:59], v[42:43], v[42:43], s[60:61] neg_lo:[1,0,0] neg_hi:[1,0,0]
v_pk_fma_f32 v[100:101], v[28:29], v[28:29], v[100:101]
v_pk_fma_f32 v[60:61], v[44:45], v[44:45], s[60:61] neg_lo:[1,0,0] neg_hi:[1,0,0]
v_pk_fma_f32 v[100:101], v[30:31], v[30:31], v[100:101]
v_pk_fma_f32 v[62:63], v[46:47], v[46:47], s[60:61] neg_lo:[1,0,0] neg_hi:[1,0,0]
v_pk_mul_f32 v[48:49], v[48:49], v[32:33]
v_pk_mul_f32 v[50:51], v[50:51], v[34:35]
v_pk_mul_f32 v[52:53], v[52:53], v[36:37]
v_pk_mul_f32 v[54:55], v[54:55], v[38:39]
v_pk_mul_f32 v[56:57], v[56:57], v[40:41]
v_pk_mul_f32 v[58:59], v[58:59], v[42:43]
v_pk_mul_f32 v[60:61], v[60:61], v[44:45]
v_pk_mul_f32 v[62:63], v[62:63], v[46:47]
v_cvt_pk_bf16_f32 v248, v16, v17
v_cvt_pk_bf16_f32 v249, v18, v19
v_cvt_pk_bf16_f32 v250, v20, v21
v_cvt_pk_bf16_f32 v251, v22, v23
v_cvt_pk_bf16_f32 v252, v24, v25
v_cvt_pk_bf16_f32 v253, v26, v27
v_cvt_pk_bf16_f32 v254, v28, v29
v_cvt_pk_bf16_f32 v255, v30, v31
v_mfma_f32_32x32x16_bf16 v[16:31], v[128:131], a[48:51], 0
ds_write_b64 v3, v[248:249] offset:0
v_exp_f32 v48, v48
v_exp_f32 v49, v49
v_exp_f32 v50, v50
v_mfma_f32_32x32x16_bf16 v[16:31], v[132:135], a[52:55], v[16:31]
ds_write_b64 v3, v[250:251] offset:128
v_exp_f32 v51, v51
v_exp_f32 v52, v52
v_exp_f32 v53, v53
v_mfma_f32_32x32x16_bf16 v[16:31], v[136:139], a[56:59], v[16:31]
ds_write_b64 v3, v[252:253] offset:1024
s_add_u32 s81, s80, 28672
s_waitcnt lgkmcnt(2)
buffer_store_dwordx4 v[232:235], v0, s[40:43], s81 offen offset:0 sc1
v_exp_f32 v54, v54
v_exp_f32 v55, v55
v_mfma_f32_32x32x16_bf16 v[184:199], v[80:83], v[216:219], 0
v_exp_f32 v56, v56
v_exp_f32 v57, v57
v_exp_f32 v58, v58
v_mfma_f32_32x32x16_bf16 v[184:199], v[84:87], v[220:223], v[184:199]
v_exp_f32 v59, v59
v_exp_f32 v60, v60
v_exp_f32 v61, v61
v_exp_f32 v62, v62
v_exp_f32_e64 v63, v63
v_pk_add_f32 v[48:49], v[48:49], 1.0 op_sel_hi:[1,0]
v_pk_add_f32 v[50:51], v[50:51], 1.0 op_sel_hi:[1,0]
v_pk_add_f32 v[52:53], v[52:53], 1.0 op_sel_hi:[1,0]
v_pk_add_f32 v[54:55], v[54:55], 1.0 op_sel_hi:[1,0]
v_pk_add_f32 v[56:57], v[56:57], 1.0 op_sel_hi:[1,0]
v_pk_add_f32 v[58:59], v[58:59], 1.0 op_sel_hi:[1,0]
v_pk_add_f32 v[60:61], v[60:61], 1.0 op_sel_hi:[1,0]
v_pk_add_f32 v[62:63], v[62:63], 1.0 op_sel_hi:[1,0]
v_mfma_f32_32x32x16_bf16 v[16:31], v[140:143], a[60:63], v[16:31]
ds_write_b64 v3, v[254:255] offset:1152
buffer_store_dwordx4 v[236:239], v0, s[40:43], s81 offen offset:1024 sc1
v_rcp_f32 v48, v48
v_rcp_f32 v49, v49
v_rcp_f32_e64 v50, v50
v_mfma_f32_32x32x16_bf16 v[16:31], v[144:147], a[64:67], v[16:31]
ds_read_b64_tr_b16 a[0:1], v4 offset:0
ds_read_b64_tr_b16 a[2:3], v4 offset:512
v_rcp_f32 v51, v51
v_rcp_f32 v52, v52
v_mfma_f32_32x32x16_bf16 v[16:31], v[148:151], a[68:71], v[16:31]
ds_read_b64_tr_b16 a[4:5], v4 offset:1024
ds_read_b64_tr_b16 a[6:7], v4 offset:1536
s_mov_b32 s64, 37748736
buffer_load_dwordx4 v[200:203], v2, s[24:27], s64 offen offset:0
buffer_load_dwordx4 v[204:207], v2, s[24:27], s64 offen offset:16
v_rcp_f32 v53, v53
v_rcp_f32 v54, v54
v_rcp_f32 v55, v55
v_rcp_f32 v56, v56
v_rcp_f32 v57, v57
v_rcp_f32 v58, v58
v_rcp_f32 v59, v59
v_rcp_f32 v60, v60
v_rcp_f32 v61, v61
v_rcp_f32 v62, v62
v_rcp_f32_e64 v63, v63
v_pk_mul_f32 v[32:33], v[48:49], v[32:33]
v_pk_mul_f32 v[34:35], v[50:51], v[34:35]
v_pk_mul_f32 v[36:37], v[52:53], v[36:37]
v_pk_mul_f32 v[38:39], v[54:55], v[38:39]
v_pk_mul_f32 v[40:41], v[56:57], v[40:41]
v_pk_mul_f32 v[42:43], v[58:59], v[42:43]
v_pk_mul_f32 v[44:45], v[60:61], v[44:45]
v_pk_mul_f32 v[46:47], v[62:63], v[46:47]
v_pk_fma_f32 v[102:103], v[32:33], v[32:33], v[102:103]
v_pk_fma_f32 v[48:49], v[16:17], v[16:17], s[60:61] neg_lo:[1,0,0] neg_hi:[1,0,0]
v_pk_fma_f32 v[102:103], v[34:35], v[34:35], v[102:103]
v_pk_fma_f32 v[50:51], v[18:19], v[18:19], s[60:61] neg_lo:[1,0,0] neg_hi:[1,0,0]
v_pk_fma_f32 v[102:103], v[36:37], v[36:37], v[102:103]
v_pk_fma_f32 v[52:53], v[20:21], v[20:21], s[60:61] neg_lo:[1,0,0] neg_hi:[1,0,0]
v_pk_fma_f32 v[102:103], v[38:39], v[38:39], v[102:103]
v_pk_fma_f32 v[54:55], v[22:23], v[22:23], s[60:61] neg_lo:[1,0,0] neg_hi:[1,0,0]
v_pk_fma_f32 v[102:103], v[40:41], v[40:41], v[102:103]
v_pk_fma_f32 v[56:57], v[24:25], v[24:25], s[60:61] neg_lo:[1,0,0] neg_hi:[1,0,0]
v_pk_fma_f32 v[102:103], v[42:43], v[42:43], v[102:103]
v_pk_fma_f32 v[58:59], v[26:27], v[26:27], s[60:61] neg_lo:[1,0,0] neg_hi:[1,0,0]
v_pk_fma_f32 v[102:103], v[44:45], v[44:45], v[102:103]
v_pk_fma_f32 v[60:61], v[28:29], v[28:29], s[60:61] neg_lo:[1,0,0] neg_hi:[1,0,0]
v_pk_fma_f32 v[102:103], v[46:47], v[46:47], v[102:103]
v_pk_fma_f32 v[62:63], v[30:31], v[30:31], s[60:61] neg_lo:[1,0,0] neg_hi:[1,0,0]
v_pk_mul_f32 v[48:49], v[48:49], v[16:17]
v_pk_mul_f32 v[50:51], v[50:51], v[18:19]
v_pk_mul_f32 v[52:53], v[52:53], v[20:21]
v_pk_mul_f32 v[54:55], v[54:55], v[22:23]
v_pk_mul_f32 v[56:57], v[56:57], v[24:25]
v_pk_mul_f32 v[58:59], v[58:59], v[26:27]
v_pk_mul_f32 v[60:61], v[60:61], v[28:29]
v_pk_mul_f32 v[62:63], v[62:63], v[30:31]
v_pk_mul_f32 v[10:11], v[152:153], v[152:153]
v_pk_add_f32 v[8:9], v[152:153], v[154:155]
v_pk_fma_f32 v[10:11], v[154:155], v[154:155], v[10:11]
v_pk_add_f32 v[8:9], v[8:9], v[156:157]
v_pk_fma_f32 v[10:11], v[156:157], v[156:157], v[10:11]
v_pk_add_f32 v[8:9], v[8:9], v[158:159]
v_pk_fma_f32 v[10:11], v[158:159], v[158:159], v[10:11]
v_pk_add_f32 v[8:9], v[8:9], v[160:161]
v_pk_fma_f32 v[10:11], v[160:161], v[160:161], v[10:11]
v_pk_add_f32 v[8:9], v[8:9], v[162:163]
v_pk_fma_f32 v[10:11], v[162:163], v[162:163], v[10:11]
v_pk_add_f32 v[8:9], v[8:9], v[164:165]
v_pk_fma_f32 v[10:11], v[164:165], v[164:165], v[10:11]
v_pk_add_f32 v[8:9], v[8:9], v[166:167]
v_pk_fma_f32 v[10:11], v[166:167], v[166:167], v[10:11]
v_pk_add_f32 v[8:9], v[8:9], v[168:169]
v_pk_fma_f32 v[10:11], v[168:169], v[168:169], v[10:11]
v_pk_add_f32 v[8:9], v[8:9], v[170:171]
v_pk_fma_f32 v[10:11], v[170:171], v[170:171], v[10:11]
v_pk_add_f32 v[8:9], v[8:9], v[172:173]
v_pk_fma_f32 v[10:11], v[172:173], v[172:173], v[10:11]
v_pk_add_f32 v[8:9], v[8:9], v[174:175]
v_pk_fma_f32 v[10:11], v[174:175], v[174:175], v[10:11]
v_pk_add_f32 v[8:9], v[8:9], v[176:177]
v_pk_fma_f32 v[10:11], v[176:177], v[176:177], v[10:11]
v_pk_add_f32 v[8:9], v[8:9], v[178:179]
v_pk_fma_f32 v[10:11], v[178:179], v[178:179], v[10:11]
v_pk_add_f32 v[8:9], v[8:9], v[180:181]
v_pk_fma_f32 v[10:11], v[180:181], v[180:181], v[10:11]
v_pk_add_f32 v[8:9], v[8:9], v[182:183]
v_pk_fma_f32 v[10:11], v[182:183], v[182:183], v[10:11]
v_pk_add_f32 v[8:9], v[8:9], v[184:185]
v_pk_fma_f32 v[10:11], v[184:185], v[184:185], v[10:11]
v_pk_add_f32 v[8:9], v[8:9], v[186:187]
v_pk_fma_f32 v[10:11], v[186:187], v[186:187], v[10:11]
v_pk_add_f32 v[8:9], v[8:9], v[188:189]
v_pk_fma_f32 v[10:11], v[188:189], v[188:189], v[10:11]
v_pk_add_f32 v[8:9], v[8:9], v[190:191]
v_pk_fma_f32 v[10:11], v[190:191], v[190:191], v[10:11]
v_pk_add_f32 v[8:9], v[8:9], v[192:193]
v_pk_fma_f32 v[10:11], v[192:193], v[192:193], v[10:11]
v_pk_add_f32 v[8:9], v[8:9], v[194:195]
v_pk_fma_f32 v[10:11], v[194:195], v[194:195], v[10:11]
v_pk_add_f32 v[8:9], v[8:9], v[196:197]
v_pk_fma_f32 v[10:11], v[196:197], v[196:197], v[10:11]
v_pk_add_f32 v[8:9], v[8:9], v[198:199]
v_pk_fma_f32 v[10:11], v[198:199], v[198:199], v[10:11]
v_cvt_pk_bf16_f32 v248, v32, v33
v_cvt_pk_bf16_f32 v249, v34, v35
v_cvt_pk_bf16_f32 v250, v36, v37
v_cvt_pk_bf16_f32 v251, v38, v39
v_cvt_pk_bf16_f32 v252, v40, v41
v_cvt_pk_bf16_f32 v253, v42, v43
v_cvt_pk_bf16_f32 v254, v44, v45
v_cvt_pk_bf16_f32 v255, v46, v47
v_mfma_f32_32x32x16_bf16 v[32:47], v[128:131], a[72:75], 0
ds_write_b64 v3, v[248:249] offset:0
v_exp_f32 v48, v48
v_exp_f32 v49, v49
v_add_f32 v8, v8, v9
v_exp_f32 v50, v50
v_mfma_f32_32x32x16_bf16 v[32:47], v[132:135], a[76:79], v[32:47]
ds_write_b64 v3, v[250:251] offset:128
buffer_load_dwordx4 v[208:211], v2, s[24:27], s64 offen offset:64
v_add_f32 v10, v10, v11
v_exp_f32 v51, v51
s_nop 0
v_permlane32_swap_b32 v8, v10
v_mfma_f32_32x32x16_bf16 v[32:47], v[136:139], a[80:83], v[32:47]
ds_write_b64 v3, v[252:253] offset:1024
buffer_load_dwordx4 v[212:215], v2, s[24:27], s64 offen offset:80
v_exp_f32 v52, v52
v_add_f32 v8, v8, v10
v_exp_f32 v53, v53
v_mov_b32 v10, v8
v_exp_f32 v54, v54
s_nop 0
v_permlane32_swap_b32 v8, v10
v_exp_f32 v55, v55
v_mul_f32 v13, 0x3c2aaaab, v8
v_exp_f32 v56, v56
v_exp_f32 v57, v57
v_mul_f32 v10, 0x3c2aaaab, v10
v_exp_f32 v58, v58
v_fma_f32 v10, -v13, v13, v10
v_exp_f32 v59, v59
v_max_f32 v10, 0, v10
v_exp_f32 v60, v60
v_add_f32 v10, 0x3727c5ac, v10
v_exp_f32 v61, v61
v_rsq_f32 v12, v10
v_exp_f32 v62, v62
v_mul_f32 v12, 0x3eeff558, v12
v_exp_f32 v63, v63
v_mul_f32_e64 v13, v13, v12
v_pk_add_f32 v[48:49], v[48:49], 1.0 op_sel_hi:[1,0]
v_pk_add_f32 v[50:51], v[50:51], 1.0 op_sel_hi:[1,0]
v_pk_add_f32 v[52:53], v[52:53], 1.0 op_sel_hi:[1,0]
v_pk_add_f32 v[54:55], v[54:55], 1.0 op_sel_hi:[1,0]
v_pk_add_f32 v[56:57], v[56:57], 1.0 op_sel_hi:[1,0]
v_pk_add_f32 v[58:59], v[58:59], 1.0 op_sel_hi:[1,0]
v_pk_add_f32 v[60:61], v[60:61], 1.0 op_sel_hi:[1,0]
v_pk_add_f32 v[62:63], v[62:63], 1.0 op_sel_hi:[1,0]
v_mfma_f32_32x32x16_bf16 v[32:47], v[140:143], a[84:87], v[32:47]
ds_write_b64 v3, v[254:255] offset:1152
v_rcp_f32 v48, v48
v_rcp_f32 v49, v49
v_rcp_f32_e64 v50, v50
v_mfma_f32_32x32x16_bf16 v[32:47], v[144:147], a[88:91], v[32:47]
ds_read_b64_tr_b16 a[8:9], v4 offset:0
ds_read_b64_tr_b16 a[10:11], v4 offset:512
v_rcp_f32 v51, v51
v_rcp_f32 v52, v52
v_rcp_f32_e64 v53, v53
v_mfma_f32_32x32x16_bf16 v[32:47], v[148:151], a[92:95], v[32:47]
ds_read_b64_tr_b16 a[12:13], v4 offset:1024
ds_read_b64_tr_b16 a[14:15], v4 offset:1536
buffer_load_dwordx4 v[216:219], v2, s[24:27], s64 offen offset:128
buffer_load_dwordx4 v[220:223], v2, s[24:27], s64 offen offset:144
v_rcp_f32 v54, v54
v_rcp_f32 v55, v55
v_rcp_f32 v56, v56
v_rcp_f32 v57, v57
v_rcp_f32 v58, v58
v_rcp_f32 v59, v59
v_rcp_f32 v60, v60
v_rcp_f32 v61, v61
v_rcp_f32 v62, v62
v_rcp_f32 v63, v63
v_pk_mul_f32 v[16:17], v[48:49], v[16:17]
v_pk_mul_f32 v[18:19], v[50:51], v[18:19]
v_pk_mul_f32 v[20:21], v[52:53], v[20:21]
v_pk_mul_f32 v[22:23], v[54:55], v[22:23]
v_pk_mul_f32 v[24:25], v[56:57], v[24:25]
v_pk_mul_f32 v[26:27], v[58:59], v[26:27]
v_pk_mul_f32 v[28:29], v[60:61], v[28:29]
v_pk_mul_f32 v[30:31], v[62:63], v[30:31]
v_pk_fma_f32 v[104:105], v[16:17], v[16:17], v[104:105]
v_pk_fma_f32 v[48:49], v[32:33], v[32:33], s[60:61] neg_lo:[1,0,0] neg_hi:[1,0,0]
v_pk_fma_f32 v[104:105], v[18:19], v[18:19], v[104:105]
v_pk_fma_f32 v[50:51], v[34:35], v[34:35], s[60:61] neg_lo:[1,0,0] neg_hi:[1,0,0]
v_pk_fma_f32 v[104:105], v[20:21], v[20:21], v[104:105]
v_pk_fma_f32 v[52:53], v[36:37], v[36:37], s[60:61] neg_lo:[1,0,0] neg_hi:[1,0,0]
v_pk_fma_f32 v[104:105], v[22:23], v[22:23], v[104:105]
v_pk_fma_f32 v[54:55], v[38:39], v[38:39], s[60:61] neg_lo:[1,0,0] neg_hi:[1,0,0]
v_pk_fma_f32 v[104:105], v[24:25], v[24:25], v[104:105]
v_pk_fma_f32 v[56:57], v[40:41], v[40:41], s[60:61] neg_lo:[1,0,0] neg_hi:[1,0,0]
v_pk_fma_f32 v[104:105], v[26:27], v[26:27], v[104:105]
v_pk_fma_f32 v[58:59], v[42:43], v[42:43], s[60:61] neg_lo:[1,0,0] neg_hi:[1,0,0]
v_pk_fma_f32 v[104:105], v[28:29], v[28:29], v[104:105]
v_pk_fma_f32 v[60:61], v[44:45], v[44:45], s[60:61] neg_lo:[1,0,0] neg_hi:[1,0,0]
v_pk_fma_f32 v[104:105], v[30:31], v[30:31], v[104:105]
v_pk_fma_f32 v[62:63], v[46:47], v[46:47], s[60:61] neg_lo:[1,0,0] neg_hi:[1,0,0]
v_pk_mul_f32 v[48:49], v[48:49], v[32:33]
v_pk_mul_f32 v[50:51], v[50:51], v[34:35]
v_pk_mul_f32 v[52:53], v[52:53], v[36:37]
v_pk_mul_f32 v[54:55], v[54:55], v[38:39]
v_pk_mul_f32 v[56:57], v[56:57], v[40:41]
v_pk_mul_f32 v[58:59], v[58:59], v[42:43]
v_pk_mul_f32 v[60:61], v[60:61], v[44:45]
v_pk_mul_f32 v[62:63], v[62:63], v[46:47]
v_pk_fma_f32 v[152:153], v[152:153], v[12:13], v[12:13] op_sel:[0,0,1] op_sel_hi:[1,0,1] neg_lo:[0,0,1] neg_hi:[0,0,1]
v_pk_fma_f32 v[154:155], v[154:155], v[12:13], v[12:13] op_sel:[0,0,1] op_sel_hi:[1,0,1] neg_lo:[0,0,1] neg_hi:[0,0,1]
v_pk_fma_f32 v[156:157], v[156:157], v[12:13], v[12:13] op_sel:[0,0,1] op_sel_hi:[1,0,1] neg_lo:[0,0,1] neg_hi:[0,0,1]
v_pk_fma_f32 v[158:159], v[158:159], v[12:13], v[12:13] op_sel:[0,0,1] op_sel_hi:[1,0,1] neg_lo:[0,0,1] neg_hi:[0,0,1]
v_pk_fma_f32 v[160:161], v[160:161], v[12:13], v[12:13] op_sel:[0,0,1] op_sel_hi:[1,0,1] neg_lo:[0,0,1] neg_hi:[0,0,1]
v_pk_fma_f32 v[162:163], v[162:163], v[12:13], v[12:13] op_sel:[0,0,1] op_sel_hi:[1,0,1] neg_lo:[0,0,1] neg_hi:[0,0,1]
v_pk_fma_f32 v[164:165], v[164:165], v[12:13], v[12:13] op_sel:[0,0,1] op_sel_hi:[1,0,1] neg_lo:[0,0,1] neg_hi:[0,0,1]
v_pk_fma_f32 v[166:167], v[166:167], v[12:13], v[12:13] op_sel:[0,0,1] op_sel_hi:[1,0,1] neg_lo:[0,0,1] neg_hi:[0,0,1]
v_pk_fma_f32 v[168:169], v[168:169], v[12:13], v[12:13] op_sel:[0,0,1] op_sel_hi:[1,0,1] neg_lo:[0,0,1] neg_hi:[0,0,1]
v_pk_fma_f32 v[170:171], v[170:171], v[12:13], v[12:13] op_sel:[0,0,1] op_sel_hi:[1,0,1] neg_lo:[0,0,1] neg_hi:[0,0,1]
v_pk_fma_f32 v[172:173], v[172:173], v[12:13], v[12:13] op_sel:[0,0,1] op_sel_hi:[1,0,1] neg_lo:[0,0,1] neg_hi:[0,0,1]
v_pk_fma_f32 v[174:175], v[174:175], v[12:13], v[12:13] op_sel:[0,0,1] op_sel_hi:[1,0,1] neg_lo:[0,0,1] neg_hi:[0,0,1]
v_pk_fma_f32 v[176:177], v[176:177], v[12:13], v[12:13] op_sel:[0,0,1] op_sel_hi:[1,0,1] neg_lo:[0,0,1] neg_hi:[0,0,1]
v_pk_fma_f32 v[178:179], v[178:179], v[12:13], v[12:13] op_sel:[0,0,1] op_sel_hi:[1,0,1] neg_lo:[0,0,1] neg_hi:[0,0,1]
v_pk_fma_f32 v[180:181], v[180:181], v[12:13], v[12:13] op_sel:[0,0,1] op_sel_hi:[1,0,1] neg_lo:[0,0,1] neg_hi:[0,0,1]
v_pk_fma_f32 v[182:183], v[182:183], v[12:13], v[12:13] op_sel:[0,0,1] op_sel_hi:[1,0,1] neg_lo:[0,0,1] neg_hi:[0,0,1]
v_pk_fma_f32 v[184:185], v[184:185], v[12:13], v[12:13] op_sel:[0,0,1] op_sel_hi:[1,0,1] neg_lo:[0,0,1] neg_hi:[0,0,1]
v_pk_fma_f32 v[186:187], v[186:187], v[12:13], v[12:13] op_sel:[0,0,1] op_sel_hi:[1,0,1] neg_lo:[0,0,1] neg_hi:[0,0,1]
v_pk_fma_f32 v[188:189], v[188:189], v[12:13], v[12:13] op_sel:[0,0,1] op_sel_hi:[1,0,1] neg_lo:[0,0,1] neg_hi:[0,0,1]
v_pk_fma_f32 v[190:191], v[190:191], v[12:13], v[12:13] op_sel:[0,0,1] op_sel_hi:[1,0,1] neg_lo:[0,0,1] neg_hi:[0,0,1]
v_pk_fma_f32 v[192:193], v[192:193], v[12:13], v[12:13] op_sel:[0,0,1] op_sel_hi:[1,0,1] neg_lo:[0,0,1] neg_hi:[0,0,1]
v_pk_fma_f32 v[194:195], v[194:195], v[12:13], v[12:13] op_sel:[0,0,1] op_sel_hi:[1,0,1] neg_lo:[0,0,1] neg_hi:[0,0,1]
v_pk_fma_f32 v[196:197], v[196:197], v[12:13], v[12:13] op_sel:[0,0,1] op_sel_hi:[1,0,1] neg_lo:[0,0,1] neg_hi:[0,0,1]
v_pk_fma_f32 v[198:199], v[198:199], v[12:13], v[12:13] op_sel:[0,0,1] op_sel_hi:[1,0,1] neg_lo:[0,0,1] neg_hi:[0,0,1]
v_cvt_pk_bf16_f32 v248, v16, v17
v_cvt_pk_bf16_f32 v249, v18, v19
v_cvt_pk_bf16_f32 v250, v20, v21
v_cvt_pk_bf16_f32 v251, v22, v23
v_cvt_pk_bf16_f32 v252, v24, v25
v_cvt_pk_bf16_f32 v253, v26, v27
v_cvt_pk_bf16_f32 v254, v28, v29
v_cvt_pk_bf16_f32 v255, v30, v31
v_mfma_f32_32x32x16_bf16 v[16:31], v[128:131], a[96:99], 0
ds_write_b64 v3, v[248:249] offset:0
v_exp_f32 v48, v48
v_exp_f32 v49, v49
v_cvt_pk_bf16_f32 v64, v152, v153
v_exp_f32_e64 v50, v50
v_mfma_f32_32x32x16_bf16 v[16:31], v[132:135], a[100:103], v[16:31]
ds_write_b64 v3, v[250:251] offset:128
v_cvt_pk_bf16_f32 v65, v154, v155
v_exp_f32 v51, v51
v_cvt_pk_bf16_f32 v66, v156, v157
v_exp_f32 v52, v52
v_mfma_f32_32x32x16_bf16 v[16:31], v[136:139], a[104:107], v[16:31]
ds_write_b64 v3, v[252:253] offset:1024
v_exp_f32 v53, v53
v_cvt_pk_bf16_f32 v67, v158, v159
v_exp_f32 v54, v54
v_cvt_pk_bf16_f32 v68, v160, v161
v_exp_f32 v55, v55
v_cvt_pk_bf16_f32 v69, v162, v163
v_exp_f32 v56, v56
v_exp_f32 v57, v57
v_cvt_pk_bf16_f32 v70, v164, v165
v_exp_f32 v58, v58
v_cvt_pk_bf16_f32 v71, v166, v167
v_exp_f32 v59, v59
v_cvt_pk_bf16_f32 v72, v168, v169
v_exp_f32 v60, v60
v_exp_f32 v61, v61
v_cvt_pk_bf16_f32 v73, v170, v171
v_exp_f32 v62, v62
v_cvt_pk_bf16_f32 v74, v172, v173
v_exp_f32_e64 v63, v63
v_cvt_pk_bf16_f32 v75, v174, v175
v_pk_add_f32 v[48:49], v[48:49], 1.0 op_sel_hi:[1,0]
v_pk_add_f32 v[50:51], v[50:51], 1.0 op_sel_hi:[1,0]
v_pk_add_f32 v[52:53], v[52:53], 1.0 op_sel_hi:[1,0]
v_pk_add_f32 v[54:55], v[54:55], 1.0 op_sel_hi:[1,0]
v_pk_add_f32 v[56:57], v[56:57], 1.0 op_sel_hi:[1,0]
v_pk_add_f32 v[58:59], v[58:59], 1.0 op_sel_hi:[1,0]
v_pk_add_f32 v[60:61], v[60:61], 1.0 op_sel_hi:[1,0]
v_pk_add_f32 v[62:63], v[62:63], 1.0 op_sel_hi:[1,0]
v_mfma_f32_32x32x16_bf16 v[16:31], v[140:143], a[108:111], v[16:31]
ds_write_b64 v3, v[254:255] offset:1152
v_rcp_f32 v48, v48
v_rcp_f32 v49, v49
v_cvt_pk_bf16_f32 v76, v176, v177
v_rcp_f32_e64 v50, v50
v_mfma_f32_32x32x16_bf16 v[16:31], v[144:147], a[112:115], v[16:31]
ds_read_b64_tr_b16 a[16:17], v4 offset:0
ds_read_b64_tr_b16 a[18:19], v4 offset:512
v_cvt_pk_bf16_f32 v77, v178, v179
v_rcp_f32_e64 v51, v51
v_cvt_pk_bf16_f32 v78, v180, v181
v_mfma_f32_32x32x16_bf16 v[16:31], v[148:151], a[116:119], v[16:31]
ds_read_b64_tr_b16 a[20:21], v4 offset:1024
ds_read_b64_tr_b16 a[22:23], v4 offset:1536
v_rcp_f32 v52, v52
v_rcp_f32 v53, v53
v_cvt_pk_bf16_f32 v79, v182, v183
v_rcp_f32 v54, v54
v_cvt_pk_bf16_f32 v80, v184, v185
v_rcp_f32 v55, v55
v_cvt_pk_bf16_f32 v81, v186, v187
v_rcp_f32 v56, v56
v_rcp_f32 v57, v57
v_cvt_pk_bf16_f32 v82, v188, v189
v_rcp_f32 v58, v58
v_cvt_pk_bf16_f32 v83, v190, v191
v_rcp_f32 v59, v59
v_cvt_pk_bf16_f32 v84, v192, v193
v_rcp_f32 v60, v60
v_rcp_f32 v61, v61
v_cvt_pk_bf16_f32 v85, v194, v195
v_rcp_f32 v62, v62
v_cvt_pk_bf16_f32 v86, v196, v197
v_rcp_f32 v63, v63
v_cvt_pk_bf16_f32 v87, v198, v199
v_pk_mul_f32 v[32:33], v[48:49], v[32:33]
v_pk_mul_f32 v[34:35], v[50:51], v[34:35]
v_pk_mul_f32 v[36:37], v[52:53], v[36:37]
v_pk_mul_f32 v[38:39], v[54:55], v[38:39]
v_pk_mul_f32 v[40:41], v[56:57], v[40:41]
v_pk_mul_f32 v[42:43], v[58:59], v[42:43]
v_pk_mul_f32 v[44:45], v[60:61], v[44:45]
v_pk_mul_f32 v[46:47], v[62:63], v[46:47]
v_pk_fma_f32 v[106:107], v[32:33], v[32:33], v[106:107]
v_pk_fma_f32 v[48:49], v[16:17], v[16:17], s[60:61] neg_lo:[1,0,0] neg_hi:[1,0,0]
v_pk_fma_f32 v[106:107], v[34:35], v[34:35], v[106:107]
v_pk_fma_f32 v[50:51], v[18:19], v[18:19], s[60:61] neg_lo:[1,0,0] neg_hi:[1,0,0]
v_pk_fma_f32 v[106:107], v[36:37], v[36:37], v[106:107]
v_pk_fma_f32 v[52:53], v[20:21], v[20:21], s[60:61] neg_lo:[1,0,0] neg_hi:[1,0,0]
v_pk_fma_f32 v[106:107], v[38:39], v[38:39], v[106:107]
v_pk_fma_f32 v[54:55], v[22:23], v[22:23], s[60:61] neg_lo:[1,0,0] neg_hi:[1,0,0]
v_pk_fma_f32 v[106:107], v[40:41], v[40:41], v[106:107]
v_pk_fma_f32 v[56:57], v[24:25], v[24:25], s[60:61] neg_lo:[1,0,0] neg_hi:[1,0,0]
v_pk_fma_f32 v[106:107], v[42:43], v[42:43], v[106:107]
v_pk_fma_f32 v[58:59], v[26:27], v[26:27], s[60:61] neg_lo:[1,0,0] neg_hi:[1,0,0]
v_pk_fma_f32 v[106:107], v[44:45], v[44:45], v[106:107]
v_pk_fma_f32 v[60:61], v[28:29], v[28:29], s[60:61] neg_lo:[1,0,0] neg_hi:[1,0,0]
v_pk_fma_f32 v[106:107], v[46:47], v[46:47], v[106:107]
v_pk_fma_f32 v[62:63], v[30:31], v[30:31], s[60:61] neg_lo:[1,0,0] neg_hi:[1,0,0]
v_pk_mul_f32 v[48:49], v[48:49], v[16:17]
v_pk_mul_f32 v[50:51], v[50:51], v[18:19]
v_pk_mul_f32 v[52:53], v[52:53], v[20:21]
v_pk_mul_f32 v[54:55], v[54:55], v[22:23]
v_pk_mul_f32 v[56:57], v[56:57], v[24:25]
v_pk_mul_f32 v[58:59], v[58:59], v[26:27]
v_pk_mul_f32 v[60:61], v[60:61], v[28:29]
v_pk_mul_f32 v[62:63], v[62:63], v[30:31]
v_cvt_pk_bf16_f32 v248, v32, v33
v_cvt_pk_bf16_f32 v249, v34, v35
v_cvt_pk_bf16_f32 v250, v36, v37
v_cvt_pk_bf16_f32 v251, v38, v39
v_cvt_pk_bf16_f32 v252, v40, v41
v_cvt_pk_bf16_f32 v253, v42, v43
v_cvt_pk_bf16_f32 v254, v44, v45
v_cvt_pk_bf16_f32 v255, v46, v47
v_mfma_f32_32x32x16_bf16 v[32:47], v[128:131], a[120:123], 0
ds_write_b64 v3, v[248:249] offset:0
v_exp_f32 v48, v48
v_exp_f32 v49, v49
v_exp_f32 v50, v50
v_mfma_f32_32x32x16_bf16 v[32:47], v[132:135], a[124:127], v[32:47]
ds_write_b64 v3, v[250:251] offset:128
v_exp_f32 v51, v51
v_exp_f32 v52, v52
v_exp_f32 v53, v53
v_mfma_f32_32x32x16_bf16 v[32:47], v[136:139], a[128:131], v[32:47]
ds_write_b64 v3, v[252:253] offset:1024
v_exp_f32 v54, v54
v_exp_f32 v55, v55
v_exp_f32 v56, v56
v_exp_f32 v57, v57
v_exp_f32 v58, v58
v_exp_f32 v59, v59
v_exp_f32 v60, v60
v_exp_f32 v61, v61
v_exp_f32 v62, v62
v_exp_f32 v63, v63
v_pk_add_f32 v[48:49], v[48:49], 1.0 op_sel_hi:[1,0]
v_pk_add_f32 v[50:51], v[50:51], 1.0 op_sel_hi:[1,0]
v_pk_add_f32 v[52:53], v[52:53], 1.0 op_sel_hi:[1,0]
v_pk_add_f32 v[54:55], v[54:55], 1.0 op_sel_hi:[1,0]
v_pk_add_f32 v[56:57], v[56:57], 1.0 op_sel_hi:[1,0]
v_pk_add_f32 v[58:59], v[58:59], 1.0 op_sel_hi:[1,0]
v_pk_add_f32 v[60:61], v[60:61], 1.0 op_sel_hi:[1,0]
v_pk_add_f32 v[62:63], v[62:63], 1.0 op_sel_hi:[1,0]
v_mfma_f32_32x32x16_bf16 v[32:47], v[140:143], a[132:135], v[32:47]
ds_write_b64 v3, v[254:255] offset:1152
v_rcp_f32 v48, v48
v_rcp_f32 v49, v49
v_rcp_f32_e64 v50, v50
v_mfma_f32_32x32x16_bf16 v[32:47], v[144:147], a[136:139], v[32:47]
ds_read_b64_tr_b16 a[24:25], v4 offset:0
ds_read_b64_tr_b16 a[26:27], v4 offset:512
v_rcp_f32 v51, v51
v_rcp_f32 v52, v52
v_rcp_f32_e64 v53, v53
v_mfma_f32_32x32x16_bf16 v[32:47], v[148:151], a[140:143], v[32:47]
ds_read_b64_tr_b16 a[28:29], v4 offset:1024
ds_read_b64_tr_b16 a[30:31], v4 offset:1536
v_rcp_f32 v54, v54
v_rcp_f32 v55, v55
v_rcp_f32 v56, v56
v_rcp_f32 v57, v57
v_rcp_f32 v58, v58
v_rcp_f32 v59, v59
v_rcp_f32 v60, v60
v_rcp_f32 v61, v61
v_rcp_f32 v62, v62
v_rcp_f32 v63, v63
v_pk_mul_f32 v[16:17], v[48:49], v[16:17]
v_pk_mul_f32 v[18:19], v[50:51], v[18:19]
v_pk_mul_f32 v[20:21], v[52:53], v[20:21]
v_pk_mul_f32 v[22:23], v[54:55], v[22:23]
v_pk_mul_f32 v[24:25], v[56:57], v[24:25]
v_pk_mul_f32 v[26:27], v[58:59], v[26:27]
v_pk_mul_f32 v[28:29], v[60:61], v[28:29]
v_pk_mul_f32 v[30:31], v[62:63], v[30:31]
v_pk_fma_f32 v[108:109], v[16:17], v[16:17], v[108:109]
v_pk_fma_f32 v[48:49], v[32:33], v[32:33], s[60:61] neg_lo:[1,0,0] neg_hi:[1,0,0]
v_pk_fma_f32 v[108:109], v[18:19], v[18:19], v[108:109]
v_pk_fma_f32 v[50:51], v[34:35], v[34:35], s[60:61] neg_lo:[1,0,0] neg_hi:[1,0,0]
v_pk_fma_f32 v[108:109], v[20:21], v[20:21], v[108:109]
v_pk_fma_f32 v[52:53], v[36:37], v[36:37], s[60:61] neg_lo:[1,0,0] neg_hi:[1,0,0]
v_pk_fma_f32 v[108:109], v[22:23], v[22:23], v[108:109]
v_pk_fma_f32 v[54:55], v[38:39], v[38:39], s[60:61] neg_lo:[1,0,0] neg_hi:[1,0,0]
v_pk_fma_f32 v[108:109], v[24:25], v[24:25], v[108:109]
v_pk_fma_f32 v[56:57], v[40:41], v[40:41], s[60:61] neg_lo:[1,0,0] neg_hi:[1,0,0]
v_pk_fma_f32 v[108:109], v[26:27], v[26:27], v[108:109]
v_pk_fma_f32 v[58:59], v[42:43], v[42:43], s[60:61] neg_lo:[1,0,0] neg_hi:[1,0,0]
v_pk_fma_f32 v[108:109], v[28:29], v[28:29], v[108:109]
v_pk_fma_f32 v[60:61], v[44:45], v[44:45], s[60:61] neg_lo:[1,0,0] neg_hi:[1,0,0]
v_pk_fma_f32 v[108:109], v[30:31], v[30:31], v[108:109]
v_pk_fma_f32 v[62:63], v[46:47], v[46:47], s[60:61] neg_lo:[1,0,0] neg_hi:[1,0,0]
v_pk_mul_f32 v[48:49], v[48:49], v[32:33]
v_pk_mul_f32 v[50:51], v[50:51], v[34:35]
v_pk_mul_f32 v[52:53], v[52:53], v[36:37]
v_pk_mul_f32 v[54:55], v[54:55], v[38:39]
v_pk_mul_f32 v[56:57], v[56:57], v[40:41]
v_pk_mul_f32 v[58:59], v[58:59], v[42:43]
v_pk_mul_f32 v[60:61], v[60:61], v[44:45]
v_pk_mul_f32 v[62:63], v[62:63], v[46:47]
v_cvt_pk_bf16_f32 v248, v16, v17
v_cvt_pk_bf16_f32 v249, v18, v19
v_cvt_pk_bf16_f32 v250, v20, v21
v_cvt_pk_bf16_f32 v251, v22, v23
v_cvt_pk_bf16_f32 v252, v24, v25
v_cvt_pk_bf16_f32 v253, v26, v27
v_cvt_pk_bf16_f32 v254, v28, v29
v_cvt_pk_bf16_f32 v255, v30, v31
v_mfma_f32_32x32x16_bf16 v[16:31], v[128:131], a[144:147], 0
ds_write_b64 v3, v[248:249] offset:0
v_exp_f32 v48, v48
v_exp_f32 v49, v49
v_exp_f32 v50, v50
v_mfma_f32_32x32x16_bf16 v[16:31], v[132:135], a[148:151], v[16:31]
ds_write_b64 v3, v[250:251] offset:128
v_exp_f32 v51, v51
v_exp_f32 v52, v52
v_exp_f32 v53, v53
v_mfma_f32_32x32x16_bf16 v[16:31], v[136:139], a[152:155], v[16:31]
ds_write_b64 v3, v[252:253] offset:1024
v_exp_f32 v54, v54
v_exp_f32 v55, v55
v_exp_f32 v56, v56
v_exp_f32 v57, v57
v_exp_f32 v58, v58
v_exp_f32 v59, v59
v_exp_f32 v60, v60
v_exp_f32 v61, v61
v_exp_f32 v62, v62
v_exp_f32 v63, v63
v_pk_add_f32 v[48:49], v[48:49], 1.0 op_sel_hi:[1,0]
v_pk_add_f32 v[50:51], v[50:51], 1.0 op_sel_hi:[1,0]
v_pk_add_f32 v[52:53], v[52:53], 1.0 op_sel_hi:[1,0]
v_pk_add_f32 v[54:55], v[54:55], 1.0 op_sel_hi:[1,0]
v_pk_add_f32 v[56:57], v[56:57], 1.0 op_sel_hi:[1,0]
v_pk_add_f32 v[58:59], v[58:59], 1.0 op_sel_hi:[1,0]
v_pk_add_f32 v[60:61], v[60:61], 1.0 op_sel_hi:[1,0]
v_pk_add_f32 v[62:63], v[62:63], 1.0 op_sel_hi:[1,0]
v_mfma_f32_32x32x16_bf16 v[16:31], v[140:143], a[156:159], v[16:31]
ds_write_b64 v3, v[254:255] offset:1152
v_rcp_f32 v48, v48
v_rcp_f32 v49, v49
v_rcp_f32_e64 v50, v50
v_mfma_f32_32x32x16_bf16 v[16:31], v[144:147], a[160:163], v[16:31]
ds_read_b64_tr_b16 a[32:33], v4 offset:0
ds_read_b64_tr_b16 a[34:35], v4 offset:512
v_rcp_f32 v51, v51
v_rcp_f32 v52, v52
v_rcp_f32_e64 v53, v53
v_mfma_f32_32x32x16_bf16 v[16:31], v[148:151], a[164:167], v[16:31]
ds_read_b64_tr_b16 a[36:37], v4 offset:1024
ds_read_b64_tr_b16 a[38:39], v4 offset:1536
v_rcp_f32 v54, v54
v_rcp_f32 v55, v55
v_rcp_f32 v56, v56
v_rcp_f32 v57, v57
v_rcp_f32 v58, v58
v_rcp_f32 v59, v59
v_rcp_f32 v60, v60
v_rcp_f32 v61, v61
v_rcp_f32 v62, v62
v_rcp_f32 v63, v63
v_pk_mul_f32 v[32:33], v[48:49], v[32:33]
v_pk_mul_f32 v[34:35], v[50:51], v[34:35]
v_pk_mul_f32 v[36:37], v[52:53], v[36:37]
v_pk_mul_f32 v[38:39], v[54:55], v[38:39]
v_pk_mul_f32 v[40:41], v[56:57], v[40:41]
v_pk_mul_f32 v[42:43], v[58:59], v[42:43]
v_pk_mul_f32 v[44:45], v[60:61], v[44:45]
v_pk_mul_f32 v[46:47], v[62:63], v[46:47]
v_pk_fma_f32 v[110:111], v[32:33], v[32:33], v[110:111]
v_pk_fma_f32 v[48:49], v[16:17], v[16:17], s[60:61] neg_lo:[1,0,0] neg_hi:[1,0,0]
v_pk_fma_f32 v[110:111], v[34:35], v[34:35], v[110:111]
v_pk_fma_f32 v[50:51], v[18:19], v[18:19], s[60:61] neg_lo:[1,0,0] neg_hi:[1,0,0]
v_pk_fma_f32 v[110:111], v[36:37], v[36:37], v[110:111]
v_pk_fma_f32 v[52:53], v[20:21], v[20:21], s[60:61] neg_lo:[1,0,0] neg_hi:[1,0,0]
v_pk_fma_f32 v[110:111], v[38:39], v[38:39], v[110:111]
v_pk_fma_f32 v[54:55], v[22:23], v[22:23], s[60:61] neg_lo:[1,0,0] neg_hi:[1,0,0]
v_pk_fma_f32 v[110:111], v[40:41], v[40:41], v[110:111]
v_pk_fma_f32 v[56:57], v[24:25], v[24:25], s[60:61] neg_lo:[1,0,0] neg_hi:[1,0,0]
v_pk_fma_f32 v[110:111], v[42:43], v[42:43], v[110:111]
v_pk_fma_f32 v[58:59], v[26:27], v[26:27], s[60:61] neg_lo:[1,0,0] neg_hi:[1,0,0]
v_pk_fma_f32 v[110:111], v[44:45], v[44:45], v[110:111]
v_pk_fma_f32 v[60:61], v[28:29], v[28:29], s[60:61] neg_lo:[1,0,0] neg_hi:[1,0,0]
v_pk_fma_f32 v[110:111], v[46:47], v[46:47], v[110:111]
v_pk_fma_f32 v[62:63], v[30:31], v[30:31], s[60:61] neg_lo:[1,0,0] neg_hi:[1,0,0]
v_pk_mul_f32 v[48:49], v[48:49], v[16:17]
v_pk_mul_f32 v[50:51], v[50:51], v[18:19]
v_pk_mul_f32 v[52:53], v[52:53], v[20:21]
v_pk_mul_f32 v[54:55], v[54:55], v[22:23]
v_pk_mul_f32 v[56:57], v[56:57], v[24:25]
v_pk_mul_f32 v[58:59], v[58:59], v[26:27]
v_pk_mul_f32 v[60:61], v[60:61], v[28:29]
v_pk_mul_f32 v[62:63], v[62:63], v[30:31]
v_cvt_pk_bf16_f32 v248, v32, v33
v_cvt_pk_bf16_f32 v249, v34, v35
v_cvt_pk_bf16_f32 v250, v36, v37
v_cvt_pk_bf16_f32 v251, v38, v39
v_cvt_pk_bf16_f32 v252, v40, v41
v_cvt_pk_bf16_f32 v253, v42, v43
v_cvt_pk_bf16_f32 v254, v44, v45
v_cvt_pk_bf16_f32 v255, v46, v47
v_mfma_f32_32x32x16_bf16 v[32:47], v[128:131], a[168:171], 0
ds_write_b64 v3, v[248:249] offset:0
v_exp_f32 v48, v48
v_exp_f32 v49, v49
v_exp_f32_e64 v50, v50
v_mfma_f32_32x32x16_bf16 v[32:47], v[132:135], a[172:175], v[32:47]
ds_write_b64 v3, v[250:251] offset:128
s_add_u32 s74, s87, L_b1_5-L_pc
v_exp_f32 v51, v51
v_exp_f32 v52, v52
v_exp_f32_e64 v53, v53
v_mfma_f32_32x32x16_bf16 v[32:47], v[136:139], a[176:179], v[32:47]
ds_write_b64 v3, v[252:253] offset:1024
v_lshl_add_u32 v14, v0, 3, s74
v_exp_f32 v54, v54
v_exp_f32 v55, v55
v_min_u32 v14, L_pf1-L_pc-4, v14
v_exp_f32 v56, v56
v_exp_f32 v57, v57
v_exp_f32 v58, v58
v_mov_b32 v15, s89
v_exp_f32 v59, v59
v_exp_f32 v60, v60
v_exp_f32 v61, v61
v_add_co_u32 v14, vcc, s88, v14
v_exp_f32 v62, v62
v_exp_f32 v63, v63
v_addc_co_u32_e64 v15, vcc, 0, v15, vcc
v_pk_add_f32 v[48:49], v[48:49], 1.0 op_sel_hi:[1,0]
v_pk_add_f32 v[50:51], v[50:51], 1.0 op_sel_hi:[1,0]
v_pk_add_f32 v[52:53], v[52:53], 1.0 op_sel_hi:[1,0]
v_pk_add_f32 v[54:55], v[54:55], 1.0 op_sel_hi:[1,0]
v_pk_add_f32 v[56:57], v[56:57], 1.0 op_sel_hi:[1,0]
v_pk_add_f32 v[58:59], v[58:59], 1.0 op_sel_hi:[1,0]
v_pk_add_f32 v[60:61], v[60:61], 1.0 op_sel_hi:[1,0]
v_pk_add_f32 v[62:63], v[62:63], 1.0 op_sel_hi:[1,0]
v_mfma_f32_32x32x16_bf16 v[32:47], v[140:143], a[180:183], v[32:47]
ds_write_b64 v3, v[254:255] offset:1152
v_rcp_f32 v48, v48
v_rcp_f32 v49, v49
v_rcp_f32_e64 v50, v50
v_mfma_f32_32x32x16_bf16 v[32:47], v[144:147], a[184:187], v[32:47]
ds_read_b64_tr_b16 a[40:41], v4 offset:0
ds_read_b64_tr_b16 a[42:43], v4 offset:512
v_rcp_f32 v51, v51
v_rcp_f32 v52, v52
v_rcp_f32_e64 v53, v53
v_mfma_f32_32x32x16_bf16 v[32:47], v[148:151], a[188:191], v[32:47]
ds_read_b64_tr_b16 a[44:45], v4 offset:1024
ds_read_b64_tr_b16 a[46:47], v4 offset:1536
s_waitcnt vmcnt(8)
global_load_dword v126, v[14:15], off
v_rcp_f32 v54, v54
v_rcp_f32 v55, v55
v_rcp_f32 v56, v56
v_rcp_f32 v57, v57
v_rcp_f32 v58, v58
v_rcp_f32 v59, v59
v_rcp_f32 v60, v60
v_rcp_f32 v61, v61
v_rcp_f32 v62, v62
v_rcp_f32_e64 v63, v63
v_pk_mul_f32 v[16:17], v[48:49], v[16:17]
v_pk_mul_f32 v[18:19], v[50:51], v[18:19]
v_pk_mul_f32 v[20:21], v[52:53], v[20:21]
v_pk_mul_f32 v[22:23], v[54:55], v[22:23]
v_pk_mul_f32 v[24:25], v[56:57], v[24:25]
v_pk_mul_f32 v[26:27], v[58:59], v[26:27]
v_pk_mul_f32 v[28:29], v[60:61], v[28:29]
v_pk_mul_f32 v[30:31], v[62:63], v[30:31]
v_pk_fma_f32 v[112:113], v[16:17], v[16:17], v[112:113]
v_pk_fma_f32 v[48:49], v[32:33], v[32:33], s[60:61] neg_lo:[1,0,0] neg_hi:[1,0,0]
v_pk_fma_f32 v[112:113], v[18:19], v[18:19], v[112:113]
v_pk_fma_f32 v[50:51], v[34:35], v[34:35], s[60:61] neg_lo:[1,0,0] neg_hi:[1,0,0]
v_pk_fma_f32 v[112:113], v[20:21], v[20:21], v[112:113]
v_pk_fma_f32 v[52:53], v[36:37], v[36:37], s[60:61] neg_lo:[1,0,0] neg_hi:[1,0,0]
v_pk_fma_f32 v[112:113], v[22:23], v[22:23], v[112:113]
v_pk_fma_f32 v[54:55], v[38:39], v[38:39], s[60:61] neg_lo:[1,0,0] neg_hi:[1,0,0]
v_pk_fma_f32 v[112:113], v[24:25], v[24:25], v[112:113]
v_pk_fma_f32 v[56:57], v[40:41], v[40:41], s[60:61] neg_lo:[1,0,0] neg_hi:[1,0,0]
v_pk_fma_f32 v[112:113], v[26:27], v[26:27], v[112:113]
v_pk_fma_f32 v[58:59], v[42:43], v[42:43], s[60:61] neg_lo:[1,0,0] neg_hi:[1,0,0]
v_pk_fma_f32 v[112:113], v[28:29], v[28:29], v[112:113]
v_pk_fma_f32 v[60:61], v[44:45], v[44:45], s[60:61] neg_lo:[1,0,0] neg_hi:[1,0,0]
v_pk_fma_f32 v[112:113], v[30:31], v[30:31], v[112:113]
v_pk_fma_f32 v[62:63], v[46:47], v[46:47], s[60:61] neg_lo:[1,0,0] neg_hi:[1,0,0]
v_pk_mul_f32 v[48:49], v[48:49], v[32:33]
v_pk_mul_f32 v[50:51], v[50:51], v[34:35]
v_pk_mul_f32 v[52:53], v[52:53], v[36:37]
v_pk_mul_f32 v[54:55], v[54:55], v[38:39]
v_pk_mul_f32 v[56:57], v[56:57], v[40:41]
v_pk_mul_f32 v[58:59], v[58:59], v[42:43]
v_pk_mul_f32 v[60:61], v[60:61], v[44:45]
v_pk_mul_f32 v[62:63], v[62:63], v[46:47]
v_cvt_pk_bf16_f32 v248, v16, v17
v_cvt_pk_bf16_f32 v249, v18, v19
v_cvt_pk_bf16_f32 v250, v20, v21
v_cvt_pk_bf16_f32 v251, v22, v23
v_cvt_pk_bf16_f32 v252, v24, v25
v_cvt_pk_bf16_f32 v253, v26, v27
v_cvt_pk_bf16_f32 v254, v28, v29
v_cvt_pk_bf16_f32 v255, v30, v31
v_mfma_f32_32x32x16_bf16 v[16:31], v[128:131], a[192:195], 0
ds_write_b64 v3, v[248:249] offset:0
v_exp_f32 v48, v48
v_exp_f32 v49, v49
v_exp_f32 v50, v50
v_mfma_f32_32x32x16_bf16 v[16:31], v[132:135], a[196:199], v[16:31]
ds_write_b64 v3, v[250:251] offset:128
v_exp_f32 v51, v51
v_exp_f32 v52, v52
v_exp_f32 v53, v53
v_mfma_f32_32x32x16_bf16 v[16:31], v[136:139], a[200:203], v[16:31]
ds_write_b64 v3, v[252:253] offset:1024
v_exp_f32 v54, v54
v_exp_f32 v55, v55
v_exp_f32 v56, v56
v_exp_f32 v57, v57
v_exp_f32 v58, v58
v_exp_f32 v59, v59
v_exp_f32 v60, v60
v_exp_f32 v61, v61
v_exp_f32 v62, v62
v_exp_f32 v63, v63
v_pk_add_f32 v[48:49], v[48:49], 1.0 op_sel_hi:[1,0]
v_pk_add_f32 v[50:51], v[50:51], 1.0 op_sel_hi:[1,0]
v_pk_add_f32 v[52:53], v[52:53], 1.0 op_sel_hi:[1,0]
v_pk_add_f32 v[54:55], v[54:55], 1.0 op_sel_hi:[1,0]
v_pk_add_f32 v[56:57], v[56:57], 1.0 op_sel_hi:[1,0]
v_pk_add_f32 v[58:59], v[58:59], 1.0 op_sel_hi:[1,0]
v_pk_add_f32 v[60:61], v[60:61], 1.0 op_sel_hi:[1,0]
v_pk_add_f32 v[62:63], v[62:63], 1.0 op_sel_hi:[1,0]
v_mfma_f32_32x32x16_bf16 v[16:31], v[140:143], a[204:207], v[16:31]
ds_write_b64 v3, v[254:255] offset:1152
v_rcp_f32 v48, v48
v_rcp_f32 v49, v49
v_rcp_f32_e64 v50, v50
v_mfma_f32_32x32x16_bf16 v[16:31], v[144:147], a[208:211], v[16:31]
ds_read_b64_tr_b16 a[48:49], v4 offset:0
ds_read_b64_tr_b16 a[50:51], v4 offset:512
v_rcp_f32 v51, v51
v_rcp_f32 v52, v52
v_rcp_f32_e64 v53, v53
v_mfma_f32_32x32x16_bf16 v[16:31], v[148:151], a[212:215], v[16:31]
ds_read_b64_tr_b16 a[52:53], v4 offset:1024
ds_read_b64_tr_b16 a[54:55], v4 offset:1536
v_rcp_f32 v54, v54
v_rcp_f32 v55, v55
v_rcp_f32 v56, v56
v_rcp_f32 v57, v57
v_rcp_f32 v58, v58
v_rcp_f32 v59, v59
v_rcp_f32 v60, v60
v_rcp_f32 v61, v61
v_rcp_f32 v62, v62
v_rcp_f32 v63, v63
v_pk_mul_f32 v[32:33], v[48:49], v[32:33]
v_pk_mul_f32 v[34:35], v[50:51], v[34:35]
v_pk_mul_f32 v[36:37], v[52:53], v[36:37]
v_pk_mul_f32 v[38:39], v[54:55], v[38:39]
v_pk_mul_f32 v[40:41], v[56:57], v[40:41]
v_pk_mul_f32 v[42:43], v[58:59], v[42:43]
v_pk_mul_f32 v[44:45], v[60:61], v[44:45]
v_pk_mul_f32 v[46:47], v[62:63], v[46:47]
v_pk_fma_f32 v[114:115], v[32:33], v[32:33], v[114:115]
v_pk_fma_f32 v[48:49], v[16:17], v[16:17], s[60:61] neg_lo:[1,0,0] neg_hi:[1,0,0]
v_pk_fma_f32 v[114:115], v[34:35], v[34:35], v[114:115]
v_pk_fma_f32 v[50:51], v[18:19], v[18:19], s[60:61] neg_lo:[1,0,0] neg_hi:[1,0,0]
v_pk_fma_f32 v[114:115], v[36:37], v[36:37], v[114:115]
v_pk_fma_f32 v[52:53], v[20:21], v[20:21], s[60:61] neg_lo:[1,0,0] neg_hi:[1,0,0]
v_pk_fma_f32 v[114:115], v[38:39], v[38:39], v[114:115]
v_pk_fma_f32 v[54:55], v[22:23], v[22:23], s[60:61] neg_lo:[1,0,0] neg_hi:[1,0,0]
v_pk_fma_f32 v[114:115], v[40:41], v[40:41], v[114:115]
v_pk_fma_f32 v[56:57], v[24:25], v[24:25], s[60:61] neg_lo:[1,0,0] neg_hi:[1,0,0]
v_pk_fma_f32 v[114:115], v[42:43], v[42:43], v[114:115]
v_pk_fma_f32 v[58:59], v[26:27], v[26:27], s[60:61] neg_lo:[1,0,0] neg_hi:[1,0,0]
v_pk_fma_f32 v[114:115], v[44:45], v[44:45], v[114:115]
v_pk_fma_f32 v[60:61], v[28:29], v[28:29], s[60:61] neg_lo:[1,0,0] neg_hi:[1,0,0]
v_pk_fma_f32 v[114:115], v[46:47], v[46:47], v[114:115]
v_pk_fma_f32 v[62:63], v[30:31], v[30:31], s[60:61] neg_lo:[1,0,0] neg_hi:[1,0,0]
v_pk_mul_f32 v[48:49], v[48:49], v[16:17]
v_pk_mul_f32 v[50:51], v[50:51], v[18:19]
v_pk_mul_f32 v[52:53], v[52:53], v[20:21]
v_pk_mul_f32 v[54:55], v[54:55], v[22:23]
v_pk_mul_f32 v[56:57], v[56:57], v[24:25]
v_pk_mul_f32 v[58:59], v[58:59], v[26:27]
v_pk_mul_f32 v[60:61], v[60:61], v[28:29]
v_pk_mul_f32 v[62:63], v[62:63], v[30:31]
v_cvt_pk_bf16_f32 v248, v32, v33
v_cvt_pk_bf16_f32 v249, v34, v35
v_cvt_pk_bf16_f32 v250, v36, v37
v_cvt_pk_bf16_f32 v251, v38, v39
v_cvt_pk_bf16_f32 v252, v40, v41
v_cvt_pk_bf16_f32 v253, v42, v43
v_cvt_pk_bf16_f32 v254, v44, v45
v_cvt_pk_bf16_f32 v255, v46, v47
v_mfma_f32_32x32x16_bf16 v[32:47], v[128:131], a[216:219], 0
ds_write_b64 v3, v[248:249] offset:0
v_exp_f32 v48, v48
v_exp_f32 v49, v49
v_exp_f32 v50, v50
v_mfma_f32_32x32x16_bf16 v[32:47], v[132:135], a[220:223], v[32:47]
ds_write_b64 v3, v[250:251] offset:128
v_exp_f32 v51, v51
v_exp_f32 v52, v52
v_exp_f32 v53, v53
v_mfma_f32_32x32x16_bf16 v[32:47], v[136:139], a[224:227], v[32:47]
ds_write_b64 v3, v[252:253] offset:1024
v_exp_f32 v54, v54
v_exp_f32 v55, v55
v_exp_f32 v56, v56
v_exp_f32 v57, v57
v_exp_f32 v58, v58
v_exp_f32 v59, v59
v_exp_f32 v60, v60
v_exp_f32 v61, v61
v_exp_f32 v62, v62
v_exp_f32 v63, v63
v_pk_add_f32 v[48:49], v[48:49], 1.0 op_sel_hi:[1,0]
v_pk_add_f32 v[50:51], v[50:51], 1.0 op_sel_hi:[1,0]
v_pk_add_f32 v[52:53], v[52:53], 1.0 op_sel_hi:[1,0]
v_pk_add_f32 v[54:55], v[54:55], 1.0 op_sel_hi:[1,0]
v_pk_add_f32 v[56:57], v[56:57], 1.0 op_sel_hi:[1,0]
v_pk_add_f32 v[58:59], v[58:59], 1.0 op_sel_hi:[1,0]
v_pk_add_f32 v[60:61], v[60:61], 1.0 op_sel_hi:[1,0]
v_pk_add_f32 v[62:63], v[62:63], 1.0 op_sel_hi:[1,0]
v_mfma_f32_32x32x16_bf16 v[32:47], v[140:143], a[228:231], v[32:47]
ds_write_b64 v3, v[254:255] offset:1152
v_rcp_f32 v48, v48
v_rcp_f32 v49, v49
v_rcp_f32_e64 v50, v50
v_mfma_f32_32x32x16_bf16 v[32:47], v[144:147], a[232:235], v[32:47]
ds_read_b64_tr_b16 a[56:57], v4 offset:0
ds_read_b64_tr_b16 a[58:59], v4 offset:512
v_rcp_f32 v51, v51
v_rcp_f32 v52, v52
v_rcp_f32_e64 v53, v53
v_mfma_f32_32x32x16_bf16 v[32:47], v[148:151], a[236:239], v[32:47]
ds_read_b64_tr_b16 a[60:61], v4 offset:1024
ds_read_b64_tr_b16 a[62:63], v4 offset:1536
v_rcp_f32 v54, v54
v_rcp_f32 v55, v55
v_rcp_f32 v56, v56
v_rcp_f32 v57, v57
v_rcp_f32 v58, v58
v_rcp_f32 v59, v59
v_rcp_f32 v60, v60
v_rcp_f32 v61, v61
v_rcp_f32 v62, v62
v_rcp_f32 v63, v63
v_pk_mul_f32 v[16:17], v[48:49], v[16:17]
v_pk_mul_f32 v[18:19], v[50:51], v[18:19]
v_pk_mul_f32 v[20:21], v[52:53], v[20:21]
v_pk_mul_f32 v[22:23], v[54:55], v[22:23]
v_pk_mul_f32 v[24:25], v[56:57], v[24:25]
v_pk_mul_f32 v[26:27], v[58:59], v[26:27]
v_pk_mul_f32 v[28:29], v[60:61], v[28:29]
v_pk_mul_f32 v[30:31], v[62:63], v[30:31]
v_pk_fma_f32 v[116:117], v[16:17], v[16:17], v[116:117]
v_pk_fma_f32 v[48:49], v[32:33], v[32:33], s[60:61] neg_lo:[1,0,0] neg_hi:[1,0,0]
v_pk_fma_f32 v[116:117], v[18:19], v[18:19], v[116:117]
v_pk_fma_f32 v[50:51], v[34:35], v[34:35], s[60:61] neg_lo:[1,0,0] neg_hi:[1,0,0]
v_pk_fma_f32 v[116:117], v[20:21], v[20:21], v[116:117]
v_pk_fma_f32 v[52:53], v[36:37], v[36:37], s[60:61] neg_lo:[1,0,0] neg_hi:[1,0,0]
v_pk_fma_f32 v[116:117], v[22:23], v[22:23], v[116:117]
v_pk_fma_f32 v[54:55], v[38:39], v[38:39], s[60:61] neg_lo:[1,0,0] neg_hi:[1,0,0]
v_pk_fma_f32 v[116:117], v[24:25], v[24:25], v[116:117]
v_pk_fma_f32 v[56:57], v[40:41], v[40:41], s[60:61] neg_lo:[1,0,0] neg_hi:[1,0,0]
v_pk_fma_f32 v[116:117], v[26:27], v[26:27], v[116:117]
v_pk_fma_f32 v[58:59], v[42:43], v[42:43], s[60:61] neg_lo:[1,0,0] neg_hi:[1,0,0]
v_pk_fma_f32 v[116:117], v[28:29], v[28:29], v[116:117]
v_pk_fma_f32 v[60:61], v[44:45], v[44:45], s[60:61] neg_lo:[1,0,0] neg_hi:[1,0,0]
v_pk_fma_f32 v[116:117], v[30:31], v[30:31], v[116:117]
v_pk_fma_f32 v[62:63], v[46:47], v[46:47], s[60:61] neg_lo:[1,0,0] neg_hi:[1,0,0]
v_pk_mul_f32 v[48:49], v[48:49], v[32:33]
v_pk_mul_f32 v[50:51], v[50:51], v[34:35]
v_pk_mul_f32 v[52:53], v[52:53], v[36:37]
v_pk_mul_f32 v[54:55], v[54:55], v[38:39]
v_pk_mul_f32 v[56:57], v[56:57], v[40:41]
v_pk_mul_f32 v[58:59], v[58:59], v[42:43]
v_pk_mul_f32 v[60:61], v[60:61], v[44:45]
v_pk_mul_f32 v[62:63], v[62:63], v[46:47]
v_cvt_pk_bf16_f32 v248, v16, v17
v_cvt_pk_bf16_f32 v249, v18, v19
v_cvt_pk_bf16_f32 v250, v20, v21
v_cvt_pk_bf16_f32 v251, v22, v23
v_cvt_pk_bf16_f32 v252, v24, v25
v_cvt_pk_bf16_f32 v253, v26, v27
v_cvt_pk_bf16_f32 v254, v28, v29
v_cvt_pk_bf16_f32 v255, v30, v31
v_mfma_f32_32x32x16_bf16 v[16:31], v[128:131], a[240:243], 0
ds_write_b64 v3, v[248:249] offset:0
v_exp_f32 v48, v48
v_exp_f32 v49, v49
v_exp_f32 v50, v50
v_mfma_f32_32x32x16_bf16 v[16:31], v[132:135], a[244:247], v[16:31]
ds_write_b64 v3, v[250:251] offset:128
v_exp_f32 v51, v51
v_exp_f32 v52, v52
v_exp_f32 v53, v53
v_mfma_f32_32x32x16_bf16 v[16:31], v[136:139], a[248:251], v[16:31]
ds_write_b64 v3, v[252:253] offset:1024
v_exp_f32 v54, v54
v_exp_f32 v55, v55
v_exp_f32 v56, v56
v_exp_f32 v57, v57
v_exp_f32 v58, v58
v_exp_f32 v59, v59
v_exp_f32 v60, v60
v_exp_f32 v61, v61
v_exp_f32 v62, v62
v_exp_f32 v63, v63
v_pk_add_f32 v[48:49], v[48:49], 1.0 op_sel_hi:[1,0]
v_pk_add_f32 v[50:51], v[50:51], 1.0 op_sel_hi:[1,0]
v_pk_add_f32 v[52:53], v[52:53], 1.0 op_sel_hi:[1,0]
v_pk_add_f32 v[54:55], v[54:55], 1.0 op_sel_hi:[1,0]
v_pk_add_f32 v[56:57], v[56:57], 1.0 op_sel_hi:[1,0]
v_pk_add_f32 v[58:59], v[58:59], 1.0 op_sel_hi:[1,0]
v_pk_add_f32 v[60:61], v[60:61], 1.0 op_sel_hi:[1,0]
v_pk_add_f32 v[62:63], v[62:63], 1.0 op_sel_hi:[1,0]
v_mfma_f32_32x32x16_bf16 v[16:31], v[140:143], a[252:255], v[16:31]
ds_read_b128 v[88:91], v7 offset:2048
ds_write_b64 v3, v[254:255] offset:1152
v_rcp_f32 v48, v48
v_rcp_f32 v49, v49
v_rcp_f32_e64 v50, v50
v_mfma_f32_32x32x16_bf16 v[16:31], v[144:147], v[224:227], v[16:31]
ds_read_b128 v[92:95], v7 offset:2560
ds_read_b64_tr_b16 a[64:65], v4 offset:0
ds_read_b64_tr_b16 a[66:67], v4 offset:512
v_rcp_f32 v51, v51
v_rcp_f32 v52, v52
v_mfma_f32_32x32x16_bf16 v[16:31], v[148:151], v[228:231], v[16:31]
ds_read_b128 v[96:99], v7 offset:4096
ds_read_b64_tr_b16 a[68:69], v4 offset:1024
ds_read_b64_tr_b16 a[70:71], v4 offset:1536
v_rcp_f32 v53, v53
v_rcp_f32 v54, v54
v_rcp_f32 v55, v55
v_rcp_f32 v56, v56
v_rcp_f32 v57, v57
v_rcp_f32 v58, v58
v_rcp_f32 v59, v59
v_rcp_f32 v60, v60
v_rcp_f32 v61, v61
v_rcp_f32 v62, v62
v_rcp_f32_e64 v63, v63
v_pk_mul_f32 v[32:33], v[48:49], v[32:33]
v_pk_mul_f32 v[34:35], v[50:51], v[34:35]
v_pk_mul_f32 v[36:37], v[52:53], v[36:37]
v_pk_mul_f32 v[38:39], v[54:55], v[38:39]
v_pk_mul_f32 v[40:41], v[56:57], v[40:41]
v_pk_mul_f32 v[42:43], v[58:59], v[42:43]
v_pk_mul_f32 v[44:45], v[60:61], v[44:45]
v_pk_mul_f32 v[46:47], v[62:63], v[46:47]
v_pk_fma_f32 v[118:119], v[32:33], v[32:33], v[118:119]
v_pk_fma_f32 v[48:49], v[16:17], v[16:17], s[60:61] neg_lo:[1,0,0] neg_hi:[1,0,0]
v_pk_fma_f32 v[118:119], v[34:35], v[34:35], v[118:119]
v_pk_fma_f32 v[50:51], v[18:19], v[18:19], s[60:61] neg_lo:[1,0,0] neg_hi:[1,0,0]
v_pk_fma_f32 v[118:119], v[36:37], v[36:37], v[118:119]
v_pk_fma_f32 v[52:53], v[20:21], v[20:21], s[60:61] neg_lo:[1,0,0] neg_hi:[1,0,0]
v_pk_fma_f32 v[118:119], v[38:39], v[38:39], v[118:119]
v_pk_fma_f32 v[54:55], v[22:23], v[22:23], s[60:61] neg_lo:[1,0,0] neg_hi:[1,0,0]
v_pk_fma_f32 v[118:119], v[40:41], v[40:41], v[118:119]
v_pk_fma_f32 v[56:57], v[24:25], v[24:25], s[60:61] neg_lo:[1,0,0] neg_hi:[1,0,0]
v_pk_fma_f32 v[118:119], v[42:43], v[42:43], v[118:119]
v_pk_fma_f32 v[58:59], v[26:27], v[26:27], s[60:61] neg_lo:[1,0,0] neg_hi:[1,0,0]
v_pk_fma_f32 v[118:119], v[44:45], v[44:45], v[118:119]
v_pk_fma_f32 v[60:61], v[28:29], v[28:29], s[60:61] neg_lo:[1,0,0] neg_hi:[1,0,0]
v_pk_fma_f32 v[118:119], v[46:47], v[46:47], v[118:119]
v_pk_fma_f32 v[62:63], v[30:31], v[30:31], s[60:61] neg_lo:[1,0,0] neg_hi:[1,0,0]
v_pk_mul_f32 v[48:49], v[48:49], v[16:17]
v_pk_mul_f32 v[50:51], v[50:51], v[18:19]
v_pk_mul_f32 v[52:53], v[52:53], v[20:21]
v_pk_mul_f32 v[54:55], v[54:55], v[22:23]
v_pk_mul_f32 v[56:57], v[56:57], v[24:25]
v_pk_mul_f32 v[58:59], v[58:59], v[26:27]
v_pk_mul_f32 v[60:61], v[60:61], v[28:29]
v_pk_mul_f32 v[62:63], v[62:63], v[30:31]
v_cvt_pk_bf16_f32 v248, v32, v33
v_cvt_pk_bf16_f32 v249, v34, v35
v_cvt_pk_bf16_f32 v250, v36, v37
v_cvt_pk_bf16_f32 v251, v38, v39
v_cvt_pk_bf16_f32 v252, v40, v41
v_cvt_pk_bf16_f32 v253, v42, v43
v_cvt_pk_bf16_f32 v254, v44, v45
v_cvt_pk_bf16_f32 v255, v46, v47
s_waitcnt lgkmcnt(0)
v_mfma_f32_32x32x16_bf16 v[32:47], v[128:131], v[88:91], 0
ds_read_b128 v[88:91], v7 offset:4608
ds_write_b64 v3, v[248:249] offset:0
v_exp_f32 v48, v48
v_exp_f32 v49, v49
v_exp_f32 v50, v50
v_mfma_f32_32x32x16_bf16 v[32:47], v[132:135], v[92:95], v[32:47]
ds_read_b128 v[92:95], v7 offset:6144
ds_write_b64 v3, v[250:251] offset:128
v_exp_f32 v51, v51
v_exp_f32 v52, v52
v_mfma_f32_32x32x16_bf16 v[32:47], v[136:139], v[96:99], v[32:47]
ds_read_b128 v[96:99], v7 offset:6656
ds_write_b64 v3, v[252:253] offset:1024
v_exp_f32 v53, v53
v_exp_f32 v54, v54
v_exp_f32 v55, v55
v_exp_f32 v56, v56
v_exp_f32 v57, v57
v_exp_f32 v58, v58
v_exp_f32 v59, v59
v_exp_f32 v60, v60
v_exp_f32 v61, v61
v_exp_f32 v62, v62
v_exp_f32_e64 v63, v63
v_pk_add_f32 v[48:49], v[48:49], 1.0 op_sel_hi:[1,0]
v_pk_add_f32 v[50:51], v[50:51], 1.0 op_sel_hi:[1,0]
v_pk_add_f32 v[52:53], v[52:53], 1.0 op_sel_hi:[1,0]
v_pk_add_f32 v[54:55], v[54:55], 1.0 op_sel_hi:[1,0]
v_pk_add_f32 v[56:57], v[56:57], 1.0 op_sel_hi:[1,0]
v_pk_add_f32 v[58:59], v[58:59], 1.0 op_sel_hi:[1,0]
v_pk_add_f32 v[60:61], v[60:61], 1.0 op_sel_hi:[1,0]
v_pk_add_f32 v[62:63], v[62:63], 1.0 op_sel_hi:[1,0]
s_waitcnt lgkmcnt(0)
v_mfma_f32_32x32x16_bf16 v[32:47], v[140:143], v[88:91], v[32:47]
ds_read_b128 v[88:91], v1 offset:0
ds_write_b64 v3, v[254:255] offset:1152
v_rcp_f32 v48, v48
v_rcp_f32 v49, v49
v_rcp_f32 v50, v50
v_mfma_f32_32x32x16_bf16 v[32:47], v[144:147], v[92:95], v[32:47]
ds_read_b128 v[92:95], v1 offset:512
ds_read_b64_tr_b16 a[72:73], v4 offset:0
ds_read_b64_tr_b16 a[74:75], v4 offset:512
v_rcp_f32 v51, v51
v_rcp_f32 v52, v52
v_mfma_f32_32x32x16_bf16 v[32:47], v[148:151], v[96:99], v[32:47]
ds_read_b128 v[96:99], v1 offset:2048
ds_read_b64_tr_b16 a[76:77], v4 offset:1024
ds_read_b64_tr_b16 a[78:79], v4 offset:1536
v_rcp_f32 v53, v53
v_rcp_f32 v54, v54
v_rcp_f32 v55, v55
v_rcp_f32 v56, v56
v_rcp_f32 v57, v57
v_rcp_f32 v58, v58
v_rcp_f32 v59, v59
v_rcp_f32 v60, v60
v_rcp_f32 v61, v61
v_rcp_f32 v62, v62
v_rcp_f32_e64 v63, v63
v_pk_mul_f32 v[16:17], v[48:49], v[16:17]
v_pk_mul_f32 v[18:19], v[50:51], v[18:19]
v_pk_mul_f32 v[20:21], v[52:53], v[20:21]
v_pk_mul_f32 v[22:23], v[54:55], v[22:23]
v_pk_mul_f32 v[24:25], v[56:57], v[24:25]
v_pk_mul_f32 v[26:27], v[58:59], v[26:27]
v_pk_mul_f32 v[28:29], v[60:61], v[28:29]
v_pk_mul_f32 v[30:31], v[62:63], v[30:31]
v_pk_fma_f32 v[120:121], v[16:17], v[16:17], v[120:121]
v_pk_fma_f32 v[48:49], v[32:33], v[32:33], s[60:61] neg_lo:[1,0,0] neg_hi:[1,0,0]
v_pk_fma_f32 v[120:121], v[18:19], v[18:19], v[120:121]
v_pk_fma_f32 v[50:51], v[34:35], v[34:35], s[60:61] neg_lo:[1,0,0] neg_hi:[1,0,0]
v_pk_fma_f32 v[120:121], v[20:21], v[20:21], v[120:121]
v_pk_fma_f32 v[52:53], v[36:37], v[36:37], s[60:61] neg_lo:[1,0,0] neg_hi:[1,0,0]
v_pk_fma_f32 v[120:121], v[22:23], v[22:23], v[120:121]
v_pk_fma_f32 v[54:55], v[38:39], v[38:39], s[60:61] neg_lo:[1,0,0] neg_hi:[1,0,0]
v_pk_fma_f32 v[120:121], v[24:25], v[24:25], v[120:121]
v_pk_fma_f32 v[56:57], v[40:41], v[40:41], s[60:61] neg_lo:[1,0,0] neg_hi:[1,0,0]
v_pk_fma_f32 v[120:121], v[26:27], v[26:27], v[120:121]
v_pk_fma_f32 v[58:59], v[42:43], v[42:43], s[60:61] neg_lo:[1,0,0] neg_hi:[1,0,0]
v_pk_fma_f32 v[120:121], v[28:29], v[28:29], v[120:121]
v_pk_fma_f32 v[60:61], v[44:45], v[44:45], s[60:61] neg_lo:[1,0,0] neg_hi:[1,0,0]
v_pk_fma_f32 v[120:121], v[30:31], v[30:31], v[120:121]
v_pk_fma_f32 v[62:63], v[46:47], v[46:47], s[60:61] neg_lo:[1,0,0] neg_hi:[1,0,0]
v_pk_mul_f32 v[48:49], v[48:49], v[32:33]
v_pk_mul_f32 v[50:51], v[50:51], v[34:35]
v_pk_mul_f32 v[52:53], v[52:53], v[36:37]
v_pk_mul_f32 v[54:55], v[54:55], v[38:39]
v_pk_mul_f32 v[56:57], v[56:57], v[40:41]
v_pk_mul_f32 v[58:59], v[58:59], v[42:43]
v_pk_mul_f32 v[60:61], v[60:61], v[44:45]
v_pk_mul_f32 v[62:63], v[62:63], v[46:47]
v_cvt_pk_bf16_f32 v248, v16, v17
v_cvt_pk_bf16_f32 v249, v18, v19
v_cvt_pk_bf16_f32 v250, v20, v21
v_cvt_pk_bf16_f32 v251, v22, v23
v_cvt_pk_bf16_f32 v252, v24, v25
v_cvt_pk_bf16_f32 v253, v26, v27
v_cvt_pk_bf16_f32 v254, v28, v29
v_cvt_pk_bf16_f32 v255, v30, v31
s_waitcnt lgkmcnt(0)
v_mfma_f32_32x32x16_bf16 v[16:31], v[64:67], v[88:91], 0
ds_read_b128 v[88:91], v1 offset:2560
ds_write_b64 v3, v[248:249] offset:0
v_exp_f32 v48, v48
v_exp_f32 v49, v49
v_exp_f32 v50, v50
v_mfma_f32_32x32x16_bf16 v[16:31], v[68:71], v[92:95], v[16:31]
ds_read_b128 v[92:95], v1 offset:4096
ds_write_b64 v3, v[250:251] offset:128
ds_read_b128 v[128:131], v5 offset:0
v_exp_f32 v51, v51
v_exp_f32 v52, v52
v_mfma_f32_32x32x16_bf16 v[16:31], v[72:75], v[96:99], v[16:31]
ds_read_b128 v[96:99], v1 offset:4608
ds_write_b64 v3, v[252:253] offset:1024
ds_read_b128 v[132:135], v6 offset:0
ds_read_b128 v[136:139], v5 offset:528
v_exp_f32 v53, v53
v_exp_f32 v54, v54
v_exp_f32 v55, v55
v_exp_f32 v56, v56
v_exp_f32 v57, v57
v_exp_f32 v58, v58
v_exp_f32 v59, v59
v_exp_f32 v60, v60
v_exp_f32 v61, v61
v_exp_f32 v62, v62
v_exp_f32_e64 v63, v63
v_pk_add_f32 v[48:49], v[48:49], 1.0 op_sel_hi:[1,0]
v_pk_add_f32 v[50:51], v[50:51], 1.0 op_sel_hi:[1,0]
v_pk_add_f32 v[52:53], v[52:53], 1.0 op_sel_hi:[1,0]
v_pk_add_f32 v[54:55], v[54:55], 1.0 op_sel_hi:[1,0]
v_pk_add_f32 v[56:57], v[56:57], 1.0 op_sel_hi:[1,0]
v_pk_add_f32 v[58:59], v[58:59], 1.0 op_sel_hi:[1,0]
v_pk_add_f32 v[60:61], v[60:61], 1.0 op_sel_hi:[1,0]
v_pk_add_f32 v[62:63], v[62:63], 1.0 op_sel_hi:[1,0]
s_waitcnt lgkmcnt(0)
v_mfma_f32_32x32x16_bf16 v[16:31], v[76:79], v[88:91], v[16:31]
ds_read_b128 v[88:91], v1 offset:6144
ds_write_b64 v3, v[254:255] offset:1152
v_rcp_f32 v48, v48
v_rcp_f32 v49, v49
v_rcp_f32 v50, v50
v_mfma_f32_32x32x16_bf16 v[16:31], v[80:83], v[92:95], v[16:31]
ds_read_b128 v[92:95], v1 offset:6656
ds_read_b64_tr_b16 a[80:81], v4 offset:0
ds_read_b64_tr_b16 a[82:83], v4 offset:512
ds_read_b128 v[140:143], v6 offset:528
v_rcp_f32_e64 v51, v51
v_mfma_f32_32x32x16_bf16 v[16:31], v[84:87], v[96:99], v[16:31]
ds_read_b128 v[96:99], v1 offset:8192
ds_read_b64_tr_b16 a[84:85], v4 offset:1024
ds_read_b64_tr_b16 a[86:87], v4 offset:1536
ds_read_b128 v[144:147], v5 offset:1056
ds_read_b128 v[148:151], v6 offset:1056
v_rcp_f32 v52, v52
v_rcp_f32 v53, v53
v_rcp_f32 v54, v54
v_rcp_f32 v55, v55
v_rcp_f32 v56, v56
v_rcp_f32 v57, v57
v_rcp_f32 v58, v58
v_rcp_f32 v59, v59
v_rcp_f32 v60, v60
v_rcp_f32 v61, v61
v_rcp_f32 v62, v62
v_rcp_f32 v63, v63
v_pk_mul_f32 v[32:33], v[48:49], v[32:33]
v_pk_mul_f32 v[34:35], v[50:51], v[34:35]
v_pk_mul_f32 v[36:37], v[52:53], v[36:37]
v_pk_mul_f32 v[38:39], v[54:55], v[38:39]
v_pk_mul_f32 v[40:41], v[56:57], v[40:41]
v_pk_mul_f32 v[42:43], v[58:59], v[42:43]
v_pk_mul_f32 v[44:45], v[60:61], v[44:45]
v_pk_mul_f32 v[46:47], v[62:63], v[46:47]
v_pk_fma_f32 v[122:123], v[32:33], v[32:33], v[122:123]
v_pk_fma_f32 v[48:49], v[16:17], v[16:17], s[60:61] neg_lo:[1,0,0] neg_hi:[1,0,0]
v_pk_fma_f32 v[122:123], v[34:35], v[34:35], v[122:123]
v_pk_fma_f32 v[50:51], v[18:19], v[18:19], s[60:61] neg_lo:[1,0,0] neg_hi:[1,0,0]
v_pk_fma_f32 v[122:123], v[36:37], v[36:37], v[122:123]
v_pk_fma_f32 v[52:53], v[20:21], v[20:21], s[60:61] neg_lo:[1,0,0] neg_hi:[1,0,0]
v_pk_fma_f32 v[122:123], v[38:39], v[38:39], v[122:123]
v_pk_fma_f32 v[54:55], v[22:23], v[22:23], s[60:61] neg_lo:[1,0,0] neg_hi:[1,0,0]
v_pk_fma_f32 v[122:123], v[40:41], v[40:41], v[122:123]
v_pk_fma_f32 v[56:57], v[24:25], v[24:25], s[60:61] neg_lo:[1,0,0] neg_hi:[1,0,0]
v_pk_fma_f32 v[122:123], v[42:43], v[42:43], v[122:123]
v_pk_fma_f32 v[58:59], v[26:27], v[26:27], s[60:61] neg_lo:[1,0,0] neg_hi:[1,0,0]
v_pk_fma_f32 v[122:123], v[44:45], v[44:45], v[122:123]
v_pk_fma_f32 v[60:61], v[28:29], v[28:29], s[60:61] neg_lo:[1,0,0] neg_hi:[1,0,0]
v_pk_fma_f32 v[122:123], v[46:47], v[46:47], v[122:123]
v_pk_fma_f32 v[62:63], v[30:31], v[30:31], s[60:61] neg_lo:[1,0,0] neg_hi:[1,0,0]
v_pk_mul_f32 v[48:49], v[48:49], v[16:17]
v_pk_mul_f32 v[50:51], v[50:51], v[18:19]
v_pk_mul_f32 v[52:53], v[52:53], v[20:21]
v_pk_mul_f32 v[54:55], v[54:55], v[22:23]
v_pk_mul_f32 v[56:57], v[56:57], v[24:25]
v_pk_mul_f32 v[58:59], v[58:59], v[26:27]
v_pk_mul_f32 v[60:61], v[60:61], v[28:29]
v_pk_mul_f32 v[62:63], v[62:63], v[30:31]
L_b1_5:
v_cvt_pk_bf16_f32 v248, v32, v33
v_cvt_pk_bf16_f32 v249, v34, v35
v_cvt_pk_bf16_f32 v250, v36, v37
v_cvt_pk_bf16_f32 v251, v38, v39
v_cvt_pk_bf16_f32 v252, v40, v41
v_cvt_pk_bf16_f32 v253, v42, v43
v_cvt_pk_bf16_f32 v254, v44, v45
v_cvt_pk_bf16_f32 v255, v46, v47
s_waitcnt lgkmcnt(0)
v_mfma_f32_32x32x16_bf16 v[32:47], v[64:67], v[88:91], 0
ds_read_b128 v[88:91], v1 offset:8704
ds_write_b64 v3, v[248:249] offset:0
v_exp_f32 v48, v48
v_exp_f32 v49, v49
v_exp_f32 v50, v50
v_mfma_f32_32x32x16_bf16 v[32:47], v[68:71], v[92:95], v[32:47]
ds_read_b128 v[92:95], v1 offset:10240
ds_write_b64 v3, v[250:251] offset:128
v_exp_f32 v51, v51
v_exp_f32 v52, v52
v_mfma_f32_32x32x16_bf16 v[32:47], v[72:75], v[96:99], v[32:47]
ds_read_b128 v[96:99], v1 offset:10752
ds_write_b64 v3, v[252:253] offset:1024
v_exp_f32 v53, v53
v_exp_f32 v54, v54
v_exp_f32 v55, v55
s_waitcnt vmcnt(1)
v_mfma_f32_32x32x16_bf16 v[152:167], v[128:131], v[200:203], 0
v_exp_f32 v56, v56
v_exp_f32 v57, v57
v_exp_f32 v58, v58
v_mfma_f32_32x32x16_bf16 v[152:167], v[132:135], v[204:207], v[152:167]
v_exp_f32 v59, v59
v_exp_f32 v60, v60
v_exp_f32 v61, v61
v_exp_f32 v62, v62
v_exp_f32_e64 v63, v63
v_pk_add_f32 v[48:49], v[48:49], 1.0 op_sel_hi:[1,0]
v_pk_add_f32 v[50:51], v[50:51], 1.0 op_sel_hi:[1,0]
v_pk_add_f32 v[52:53], v[52:53], 1.0 op_sel_hi:[1,0]
v_pk_add_f32 v[54:55], v[54:55], 1.0 op_sel_hi:[1,0]
v_pk_add_f32 v[56:57], v[56:57], 1.0 op_sel_hi:[1,0]
v_pk_add_f32 v[58:59], v[58:59], 1.0 op_sel_hi:[1,0]
v_pk_add_f32 v[60:61], v[60:61], 1.0 op_sel_hi:[1,0]
v_pk_add_f32 v[62:63], v[62:63], 1.0 op_sel_hi:[1,0]
s_waitcnt lgkmcnt(0)
v_mfma_f32_32x32x16_bf16 v[32:47], v[76:79], v[88:91], v[32:47]
ds_read_b128 v[88:91], v1 offset:12288
ds_write_b64 v3, v[254:255] offset:1152
v_rcp_f32 v48, v48
v_rcp_f32 v49, v49
v_rcp_f32_e64 v50, v50
v_mfma_f32_32x32x16_bf16 v[32:47], v[80:83], v[92:95], v[32:47]
ds_read_b128 v[92:95], v1 offset:12800
ds_read_b64_tr_b16 a[88:89], v4 offset:0
ds_read_b64_tr_b16 a[90:91], v4 offset:512
v_rcp_f32 v51, v51
v_rcp_f32 v52, v52
v_mfma_f32_32x32x16_bf16 v[32:47], v[84:87], v[96:99], v[32:47]
ds_read_b128 v[96:99], v1 offset:14336
ds_read_b64_tr_b16 a[92:93], v4 offset:1024
ds_read_b64_tr_b16 a[94:95], v4 offset:1536
v_rcp_f32 v53, v53
v_rcp_f32 v54, v54
v_mfma_f32_32x32x16_bf16 v[168:183], v[136:139], v[208:211], 0
v_rcp_f32 v55, v55
v_rcp_f32 v56, v56
v_rcp_f32 v57, v57
v_mfma_f32_32x32x16_bf16 v[168:183], v[140:143], v[212:215], v[168:183]
v_rcp_f32 v58, v58
v_rcp_f32 v59, v59
v_rcp_f32 v60, v60
v_rcp_f32 v61, v61
v_rcp_f32 v62, v62
v_rcp_f32_e64 v63, v63
v_pk_mul_f32 v[16:17], v[48:49], v[16:17]
v_pk_mul_f32 v[18:19], v[50:51], v[18:19]
v_pk_mul_f32 v[20:21], v[52:53], v[20:21]
v_pk_mul_f32 v[22:23], v[54:55], v[22:23]
v_pk_mul_f32 v[24:25], v[56:57], v[24:25]
v_pk_mul_f32 v[26:27], v[58:59], v[26:27]
v_pk_mul_f32 v[28:29], v[60:61], v[28:29]
v_pk_mul_f32 v[30:31], v[62:63], v[30:31]
v_pk_fma_f32 v[100:101], v[16:17], v[16:17], v[100:101]
v_pk_fma_f32 v[48:49], v[32:33], v[32:33], s[60:61] neg_lo:[1,0,0] neg_hi:[1,0,0]
v_pk_fma_f32 v[100:101], v[18:19], v[18:19], v[100:101]
v_pk_fma_f32 v[50:51], v[34:35], v[34:35], s[60:61] neg_lo:[1,0,0] neg_hi:[1,0,0]
v_pk_fma_f32 v[100:101], v[20:21], v[20:21], v[100:101]
v_pk_fma_f32 v[52:53], v[36:37], v[36:37], s[60:61] neg_lo:[1,0,0] neg_hi:[1,0,0]
v_pk_fma_f32 v[100:101], v[22:23], v[22:23], v[100:101]
v_pk_fma_f32 v[54:55], v[38:39], v[38:39], s[60:61] neg_lo:[1,0,0] neg_hi:[1,0,0]
v_pk_fma_f32 v[100:101], v[24:25], v[24:25], v[100:101]
v_pk_fma_f32 v[56:57], v[40:41], v[40:41], s[60:61] neg_lo:[1,0,0] neg_hi:[1,0,0]
v_pk_fma_f32 v[100:101], v[26:27], v[26:27], v[100:101]
v_pk_fma_f32 v[58:59], v[42:43], v[42:43], s[60:61] neg_lo:[1,0,0] neg_hi:[1,0,0]
v_pk_fma_f32 v[100:101], v[28:29], v[28:29], v[100:101]
v_pk_fma_f32 v[60:61], v[44:45], v[44:45], s[60:61] neg_lo:[1,0,0] neg_hi:[1,0,0]
v_pk_fma_f32 v[100:101], v[30:31], v[30:31], v[100:101]
v_pk_fma_f32 v[62:63], v[46:47], v[46:47], s[60:61] neg_lo:[1,0,0] neg_hi:[1,0,0]
v_pk_mul_f32 v[48:49], v[48:49], v[32:33]
v_pk_mul_f32 v[50:51], v[50:51], v[34:35]
v_pk_mul_f32 v[52:53], v[52:53], v[36:37]
v_pk_mul_f32 v[54:55], v[54:55], v[38:39]
v_pk_mul_f32 v[56:57], v[56:57], v[40:41]
v_pk_mul_f32 v[58:59], v[58:59], v[42:43]
v_pk_mul_f32 v[60:61], v[60:61], v[44:45]
v_pk_mul_f32 v[62:63], v[62:63], v[46:47]
v_cvt_pk_bf16_f32 v248, v16, v17
v_cvt_pk_bf16_f32 v249, v18, v19
v_cvt_pk_bf16_f32 v250, v20, v21
v_cvt_pk_bf16_f32 v251, v22, v23
v_cvt_pk_bf16_f32 v252, v24, v25
v_cvt_pk_bf16_f32 v253, v26, v27
v_cvt_pk_bf16_f32 v254, v28, v29
v_cvt_pk_bf16_f32 v255, v30, v31
s_waitcnt lgkmcnt(0)
v_mfma_f32_32x32x16_bf16 v[16:31], v[64:67], v[88:91], 0
ds_read_b128 v[88:91], v1 offset:14848
ds_write_b64 v3, v[248:249] offset:0
v_exp_f32 v48, v48
v_exp_f32 v49, v49
v_exp_f32 v50, v50
v_mfma_f32_32x32x16_bf16 v[16:31], v[68:71], v[92:95], v[16:31]
ds_read_b128 v[92:95], v1 offset:16384
ds_write_b64 v3, v[250:251] offset:128
v_exp_f32 v51, v51
v_exp_f32 v52, v52
v_mfma_f32_32x32x16_bf16 v[16:31], v[72:75], v[96:99], v[16:31]
ds_read_b128 v[96:99], v1 offset:16896
ds_write_b64 v3, v[252:253] offset:1024
v_exp_f32 v53, v53
v_exp_f32 v54, v54
v_exp_f32 v55, v55
v_mfma_f32_32x32x16_bf16 v[184:199], v[144:147], v[216:219], 0
v_exp_f32 v56, v56
v_exp_f32 v57, v57
v_exp_f32 v58, v58
v_mfma_f32_32x32x16_bf16 v[184:199], v[148:151], v[220:223], v[184:199]
v_exp_f32 v59, v59
v_exp_f32 v60, v60
v_exp_f32 v61, v61
v_exp_f32 v62, v62
v_exp_f32_e64 v63, v63
v_pk_add_f32 v[48:49], v[48:49], 1.0 op_sel_hi:[1,0]
v_pk_add_f32 v[50:51], v[50:51], 1.0 op_sel_hi:[1,0]
v_pk_add_f32 v[52:53], v[52:53], 1.0 op_sel_hi:[1,0]
v_pk_add_f32 v[54:55], v[54:55], 1.0 op_sel_hi:[1,0]
v_pk_add_f32 v[56:57], v[56:57], 1.0 op_sel_hi:[1,0]
v_pk_add_f32 v[58:59], v[58:59], 1.0 op_sel_hi:[1,0]
v_pk_add_f32 v[60:61], v[60:61], 1.0 op_sel_hi:[1,0]
v_pk_add_f32 v[62:63], v[62:63], 1.0 op_sel_hi:[1,0]
s_waitcnt lgkmcnt(0)
v_mfma_f32_32x32x16_bf16 v[16:31], v[76:79], v[88:91], v[16:31]
ds_read_b128 v[88:91], v1 offset:18432
ds_write_b64 v3, v[254:255] offset:1152
v_rcp_f32 v48, v48
v_rcp_f32 v49, v49
v_rcp_f32 v50, v50
v_mfma_f32_32x32x16_bf16 v[16:31], v[80:83], v[92:95], v[16:31]
ds_read_b128 v[92:95], v1 offset:18944
ds_read_b64_tr_b16 a[96:97], v4 offset:0
ds_read_b64_tr_b16 a[98:99], v4 offset:512
s_mov_b32 s64, 44040192
v_rcp_f32_e64 v51, v51
v_mfma_f32_32x32x16_bf16 v[16:31], v[84:87], v[96:99], v[16:31]
ds_read_b128 v[96:99], v1 offset:20480
ds_read_b64_tr_b16 a[100:101], v4 offset:1024
ds_read_b64_tr_b16 a[102:103], v4 offset:1536
buffer_load_dwordx4 v[200:203], v2, s[24:27], s64 offen offset:0
buffer_load_dwordx4 v[204:207], v2, s[24:27], s64 offen offset:16
v_rcp_f32 v52, v52
v_rcp_f32 v53, v53
v_rcp_f32 v54, v54
v_rcp_f32 v55, v55
v_rcp_f32 v56, v56
v_rcp_f32 v57, v57
v_rcp_f32 v58, v58
v_rcp_f32 v59, v59
v_rcp_f32 v60, v60
v_rcp_f32 v61, v61
v_rcp_f32 v62, v62
v_rcp_f32 v63, v63
v_pk_mul_f32 v[32:33], v[48:49], v[32:33]
v_pk_mul_f32 v[34:35], v[50:51], v[34:35]
v_pk_mul_f32 v[36:37], v[52:53], v[36:37]
v_pk_mul_f32 v[38:39], v[54:55], v[38:39]
v_pk_mul_f32 v[40:41], v[56:57], v[40:41]
v_pk_mul_f32 v[42:43], v[58:59], v[42:43]
v_pk_mul_f32 v[44:45], v[60:61], v[44:45]
v_pk_mul_f32 v[46:47], v[62:63], v[46:47]
v_pk_fma_f32 v[102:103], v[32:33], v[32:33], v[102:103]
v_pk_fma_f32 v[48:49], v[16:17], v[16:17], s[60:61] neg_lo:[1,0,0] neg_hi:[1,0,0]
v_pk_fma_f32 v[102:103], v[34:35], v[34:35], v[102:103]
v_pk_fma_f32 v[50:51], v[18:19], v[18:19], s[60:61] neg_lo:[1,0,0] neg_hi:[1,0,0]
v_pk_fma_f32 v[102:103], v[36:37], v[36:37], v[102:103]
v_pk_fma_f32 v[52:53], v[20:21], v[20:21], s[60:61] neg_lo:[1,0,0] neg_hi:[1,0,0]
v_pk_fma_f32 v[102:103], v[38:39], v[38:39], v[102:103]
v_pk_fma_f32 v[54:55], v[22:23], v[22:23], s[60:61] neg_lo:[1,0,0] neg_hi:[1,0,0]
v_pk_fma_f32 v[102:103], v[40:41], v[40:41], v[102:103]
v_pk_fma_f32 v[56:57], v[24:25], v[24:25], s[60:61] neg_lo:[1,0,0] neg_hi:[1,0,0]
v_pk_fma_f32 v[102:103], v[42:43], v[42:43], v[102:103]
v_pk_fma_f32 v[58:59], v[26:27], v[26:27], s[60:61] neg_lo:[1,0,0] neg_hi:[1,0,0]
v_pk_fma_f32 v[102:103], v[44:45], v[44:45], v[102:103]
v_pk_fma_f32 v[60:61], v[28:29], v[28:29], s[60:61] neg_lo:[1,0,0] neg_hi:[1,0,0]
v_pk_fma_f32 v[102:103], v[46:47], v[46:47], v[102:103]
v_pk_fma_f32 v[62:63], v[30:31], v[30:31], s[60:61] neg_lo:[1,0,0] neg_hi:[1,0,0]
v_pk_mul_f32 v[48:49], v[48:49], v[16:17]
v_pk_mul_f32 v[50:51], v[50:51], v[18:19]
v_pk_mul_f32 v[52:53], v[52:53], v[20:21]
v_pk_mul_f32 v[54:55], v[54:55], v[22:23]
v_pk_mul_f32 v[56:57], v[56:57], v[24:25]
v_pk_mul_f32 v[58:59], v[58:59], v[26:27]
v_pk_mul_f32 v[60:61], v[60:61], v[28:29]
v_pk_mul_f32 v[62:63], v[62:63], v[30:31]
v_pk_mul_f32 v[10:11], v[152:153], v[152:153]
v_pk_add_f32 v[8:9], v[152:153], v[154:155]
v_pk_fma_f32 v[10:11], v[154:155], v[154:155], v[10:11]
v_pk_add_f32 v[8:9], v[8:9], v[156:157]
v_pk_fma_f32 v[10:11], v[156:157], v[156:157], v[10:11]
v_pk_add_f32 v[8:9], v[8:9], v[158:159]
v_pk_fma_f32 v[10:11], v[158:159], v[158:159], v[10:11]
v_pk_add_f32 v[8:9], v[8:9], v[160:161]
v_pk_fma_f32 v[10:11], v[160:161], v[160:161], v[10:11]
v_pk_add_f32 v[8:9], v[8:9], v[162:163]
v_pk_fma_f32 v[10:11], v[162:163], v[162:163], v[10:11]
v_pk_add_f32 v[8:9], v[8:9], v[164:165]
v_pk_fma_f32 v[10:11], v[164:165], v[164:165], v[10:11]
v_pk_add_f32 v[8:9], v[8:9], v[166:167]
v_pk_fma_f32 v[10:11], v[166:167], v[166:167], v[10:11]
v_pk_add_f32 v[8:9], v[8:9], v[168:169]
v_pk_fma_f32 v[10:11], v[168:169], v[168:169], v[10:11]
v_pk_add_f32 v[8:9], v[8:9], v[170:171]
v_pk_fma_f32 v[10:11], v[170:171], v[170:171], v[10:11]
v_pk_add_f32 v[8:9], v[8:9], v[172:173]
v_pk_fma_f32 v[10:11], v[172:173], v[172:173], v[10:11]
v_pk_add_f32 v[8:9], v[8:9], v[174:175]
v_pk_fma_f32 v[10:11], v[174:175], v[174:175], v[10:11]
v_pk_add_f32 v[8:9], v[8:9], v[176:177]
v_pk_fma_f32 v[10:11], v[176:177], v[176:177], v[10:11]
v_pk_add_f32 v[8:9], v[8:9], v[178:179]
v_pk_fma_f32 v[10:11], v[178:179], v[178:179], v[10:11]
v_pk_add_f32 v[8:9], v[8:9], v[180:181]
v_pk_fma_f32 v[10:11], v[180:181], v[180:181], v[10:11]
v_pk_add_f32 v[8:9], v[8:9], v[182:183]
v_pk_fma_f32 v[10:11], v[182:183], v[182:183], v[10:11]
v_pk_add_f32 v[8:9], v[8:9], v[184:185]
v_pk_fma_f32 v[10:11], v[184:185], v[184:185], v[10:11]
v_pk_add_f32 v[8:9], v[8:9], v[186:187]
v_pk_fma_f32 v[10:11], v[186:187], v[186:187], v[10:11]
v_pk_add_f32 v[8:9], v[8:9], v[188:189]
v_pk_fma_f32 v[10:11], v[188:189], v[188:189], v[10:11]
v_pk_add_f32 v[8:9], v[8:9], v[190:191]
v_pk_fma_f32 v[10:11], v[190:191], v[190:191], v[10:11]
v_pk_add_f32 v[8:9], v[8:9], v[192:193]
v_pk_fma_f32 v[10:11], v[192:193], v[192:193], v[10:11]
v_pk_add_f32 v[8:9], v[8:9], v[194:195]
v_pk_fma_f32 v[10:11], v[194:195], v[194:195], v[10:11]
v_pk_add_f32 v[8:9], v[8:9], v[196:197]
v_pk_fma_f32 v[10:11], v[196:197], v[196:197], v[10:11]
v_pk_add_f32 v[8:9], v[8:9], v[198:199]
v_pk_fma_f32 v[10:11], v[198:199], v[198:199], v[10:11]
v_cvt_pk_bf16_f32 v248, v32, v33
v_cvt_pk_bf16_f32 v249, v34, v35
v_cvt_pk_bf16_f32 v250, v36, v37
v_cvt_pk_bf16_f32 v251, v38, v39
v_cvt_pk_bf16_f32 v252, v40, v41
v_cvt_pk_bf16_f32 v253, v42, v43
v_cvt_pk_bf16_f32 v254, v44, v45
v_cvt_pk_bf16_f32 v255, v46, v47
s_waitcnt lgkmcnt(0)
v_mfma_f32_32x32x16_bf16 v[32:47], v[64:67], v[88:91], 0
ds_read_b128 v[88:91], v1 offset:20992
ds_write_b64 v3, v[248:249] offset:0
v_exp_f32 v48, v48
v_exp_f32 v49, v49
v_add_f32 v8, v8, v9
v_mfma_f32_32x32x16_bf16 v[32:47], v[68:71], v[92:95], v[32:47]
ds_read_b128 v[92:95], v1 offset:22528
ds_write_b64 v3, v[250:251] offset:128
buffer_load_dwordx4 v[208:211], v2, s[24:27], s64 offen offset:64
v_exp_f32 v50, v50
v_add_f32 v10, v10, v11
v_exp_f32_e64 v51, v51
v_mfma_f32_32x32x16_bf16 v[32:47], v[72:75], v[96:99], v[32:47]
ds_read_b128 v[96:99], v1 offset:23040
ds_write_b64 v3, v[252:253] offset:1024
buffer_load_dwordx4 v[212:215], v2, s[24:27], s64 offen offset:80
v_permlane32_swap_b32 v8, v10
v_exp_f32 v52, v52
v_add_f32 v8, v8, v10
v_exp_f32 v53, v53
v_mov_b32 v10, v8
v_exp_f32 v54, v54
s_nop 0
v_permlane32_swap_b32 v8, v10
v_exp_f32 v55, v55
v_mul_f32 v13, 0x3c2aaaab, v8
v_exp_f32 v56, v56
v_exp_f32 v57, v57
v_mul_f32 v10, 0x3c2aaaab, v10
v_exp_f32 v58, v58
v_fma_f32 v10, -v13, v13, v10
v_exp_f32 v59, v59
v_max_f32 v10, 0, v10
v_exp_f32 v60, v60
v_add_f32 v10, 0x3727c5ac, v10
v_exp_f32 v61, v61
v_rsq_f32 v12, v10
v_exp_f32 v62, v62
v_mul_f32 v12, 0x3eeff558, v12
v_exp_f32 v63, v63
v_mul_f32_e64 v13, v13, v12
v_pk_add_f32 v[48:49], v[48:49], 1.0 op_sel_hi:[1,0]
v_pk_add_f32 v[50:51], v[50:51], 1.0 op_sel_hi:[1,0]
v_pk_add_f32 v[52:53], v[52:53], 1.0 op_sel_hi:[1,0]
v_pk_add_f32 v[54:55], v[54:55], 1.0 op_sel_hi:[1,0]
v_pk_add_f32 v[56:57], v[56:57], 1.0 op_sel_hi:[1,0]
v_pk_add_f32 v[58:59], v[58:59], 1.0 op_sel_hi:[1,0]
v_pk_add_f32 v[60:61], v[60:61], 1.0 op_sel_hi:[1,0]
v_pk_add_f32 v[62:63], v[62:63], 1.0 op_sel_hi:[1,0]
s_waitcnt lgkmcnt(0)
v_mfma_f32_32x32x16_bf16 v[32:47], v[76:79], v[88:91], v[32:47]
ds_read_b128 v[88:91], v1 offset:24576
ds_write_b64 v3, v[254:255] offset:1152
v_rcp_f32 v48, v48
v_rcp_f32 v49, v49
v_rcp_f32_e64 v50, v50
v_mfma_f32_32x32x16_bf16 v[32:47], v[80:83], v[92:95], v[32:47]
ds_read_b128 v[92:95], v1 offset:25088
ds_read_b64_tr_b16 a[104:105], v4 offset:0
ds_read_b64_tr_b16 a[106:107], v4 offset:512
v_rcp_f32 v51, v51
v_rcp_f32 v52, v52
v_mfma_f32_32x32x16_bf16 v[32:47], v[84:87], v[96:99], v[32:47]
ds_read_b128 v[96:99], v1 offset:26624
ds_read_b64_tr_b16 a[108:109], v4 offset:1024
ds_read_b64_tr_b16 a[110:111], v4 offset:1536
buffer_load_dwordx4 v[216:219], v2, s[24:27], s64 offen offset:128
buffer_load_dwordx4 v[220:223], v2, s[24:27], s64 offen offset:144
v_rcp_f32 v53, v53
v_rcp_f32 v54, v54
v_rcp_f32 v55, v55
v_rcp_f32 v56, v56
v_rcp_f32 v57, v57
v_rcp_f32 v58, v58
v_rcp_f32 v59, v59
v_rcp_f32 v60, v60
v_rcp_f32 v61, v61
v_rcp_f32 v62, v62
v_rcp_f32_e64 v63, v63
v_pk_mul_f32 v[16:17], v[48:49], v[16:17]
v_pk_mul_f32 v[18:19], v[50:51], v[18:19]
v_pk_mul_f32 v[20:21], v[52:53], v[20:21]
v_pk_mul_f32 v[22:23], v[54:55], v[22:23]
v_pk_mul_f32 v[24:25], v[56:57], v[24:25]
v_pk_mul_f32 v[26:27], v[58:59], v[26:27]
v_pk_mul_f32 v[28:29], v[60:61], v[28:29]
v_pk_mul_f32 v[30:31], v[62:63], v[30:31]
v_pk_fma_f32 v[104:105], v[16:17], v[16:17], v[104:105]
v_pk_fma_f32 v[48:49], v[32:33], v[32:33], s[60:61] neg_lo:[1,0,0] neg_hi:[1,0,0]
v_pk_fma_f32 v[104:105], v[18:19], v[18:19], v[104:105]
v_pk_fma_f32 v[50:51], v[34:35], v[34:35], s[60:61] neg_lo:[1,0,0] neg_hi:[1,0,0]
v_pk_fma_f32 v[104:105], v[20:21], v[20:21], v[104:105]
v_pk_fma_f32 v[52:53], v[36:37], v[36:37], s[60:61] neg_lo:[1,0,0] neg_hi:[1,0,0]
v_pk_fma_f32 v[104:105], v[22:23], v[22:23], v[104:105]
v_pk_fma_f32 v[54:55], v[38:39], v[38:39], s[60:61] neg_lo:[1,0,0] neg_hi:[1,0,0]
v_pk_fma_f32 v[104:105], v[24:25], v[24:25], v[104:105]
v_pk_fma_f32 v[56:57], v[40:41], v[40:41], s[60:61] neg_lo:[1,0,0] neg_hi:[1,0,0]
v_pk_fma_f32 v[104:105], v[26:27], v[26:27], v[104:105]
v_pk_fma_f32 v[58:59], v[42:43], v[42:43], s[60:61] neg_lo:[1,0,0] neg_hi:[1,0,0]
v_pk_fma_f32 v[104:105], v[28:29], v[28:29], v[104:105]
v_pk_fma_f32 v[60:61], v[44:45], v[44:45], s[60:61] neg_lo:[1,0,0] neg_hi:[1,0,0]
v_pk_fma_f32 v[104:105], v[30:31], v[30:31], v[104:105]
v_pk_fma_f32 v[62:63], v[46:47], v[46:47], s[60:61] neg_lo:[1,0,0] neg_hi:[1,0,0]
v_pk_mul_f32 v[48:49], v[48:49], v[32:33]
v_pk_mul_f32 v[50:51], v[50:51], v[34:35]
v_pk_mul_f32 v[52:53], v[52:53], v[36:37]
v_pk_mul_f32 v[54:55], v[54:55], v[38:39]
v_pk_mul_f32 v[56:57], v[56:57], v[40:41]
v_pk_mul_f32 v[58:59], v[58:59], v[42:43]
v_pk_mul_f32 v[60:61], v[60:61], v[44:45]
v_pk_mul_f32 v[62:63], v[62:63], v[46:47]
v_pk_fma_f32 v[152:153], v[152:153], v[12:13], v[12:13] op_sel:[0,0,1] op_sel_hi:[1,0,1] neg_lo:[0,0,1] neg_hi:[0,0,1]
v_pk_fma_f32 v[154:155], v[154:155], v[12:13], v[12:13] op_sel:[0,0,1] op_sel_hi:[1,0,1] neg_lo:[0,0,1] neg_hi:[0,0,1]
v_pk_fma_f32 v[156:157], v[156:157], v[12:13], v[12:13] op_sel:[0,0,1] op_sel_hi:[1,0,1] neg_lo:[0,0,1] neg_hi:[0,0,1]
v_pk_fma_f32 v[158:159], v[158:159], v[12:13], v[12:13] op_sel:[0,0,1] op_sel_hi:[1,0,1] neg_lo:[0,0,1] neg_hi:[0,0,1]
v_pk_fma_f32 v[160:161], v[160:161], v[12:13], v[12:13] op_sel:[0,0,1] op_sel_hi:[1,0,1] neg_lo:[0,0,1] neg_hi:[0,0,1]
v_pk_fma_f32 v[162:163], v[162:163], v[12:13], v[12:13] op_sel:[0,0,1] op_sel_hi:[1,0,1] neg_lo:[0,0,1] neg_hi:[0,0,1]
v_pk_fma_f32 v[164:165], v[164:165], v[12:13], v[12:13] op_sel:[0,0,1] op_sel_hi:[1,0,1] neg_lo:[0,0,1] neg_hi:[0,0,1]
v_pk_fma_f32 v[166:167], v[166:167], v[12:13], v[12:13] op_sel:[0,0,1] op_sel_hi:[1,0,1] neg_lo:[0,0,1] neg_hi:[0,0,1]
v_pk_fma_f32 v[168:169], v[168:169], v[12:13], v[12:13] op_sel:[0,0,1] op_sel_hi:[1,0,1] neg_lo:[0,0,1] neg_hi:[0,0,1]
v_pk_fma_f32 v[170:171], v[170:171], v[12:13], v[12:13] op_sel:[0,0,1] op_sel_hi:[1,0,1] neg_lo:[0,0,1] neg_hi:[0,0,1]
v_pk_fma_f32 v[172:173], v[172:173], v[12:13], v[12:13] op_sel:[0,0,1] op_sel_hi:[1,0,1] neg_lo:[0,0,1] neg_hi:[0,0,1]
v_pk_fma_f32 v[174:175], v[174:175], v[12:13], v[12:13] op_sel:[0,0,1] op_sel_hi:[1,0,1] neg_lo:[0,0,1] neg_hi:[0,0,1]
v_pk_fma_f32 v[176:177], v[176:177], v[12:13], v[12:13] op_sel:[0,0,1] op_sel_hi:[1,0,1] neg_lo:[0,0,1] neg_hi:[0,0,1]
v_pk_fma_f32 v[178:179], v[178:179], v[12:13], v[12:13] op_sel:[0,0,1] op_sel_hi:[1,0,1] neg_lo:[0,0,1] neg_hi:[0,0,1]
v_pk_fma_f32 v[180:181], v[180:181], v[12:13], v[12:13] op_sel:[0,0,1] op_sel_hi:[1,0,1] neg_lo:[0,0,1] neg_hi:[0,0,1]
v_pk_fma_f32 v[182:183], v[182:183], v[12:13], v[12:13] op_sel:[0,0,1] op_sel_hi:[1,0,1] neg_lo:[0,0,1] neg_hi:[0,0,1]
v_pk_fma_f32 v[184:185], v[184:185], v[12:13], v[12:13] op_sel:[0,0,1] op_sel_hi:[1,0,1] neg_lo:[0,0,1] neg_hi:[0,0,1]
v_pk_fma_f32 v[186:187], v[186:187], v[12:13], v[12:13] op_sel:[0,0,1] op_sel_hi:[1,0,1] neg_lo:[0,0,1] neg_hi:[0,0,1]
v_pk_fma_f32 v[188:189], v[188:189], v[12:13], v[12:13] op_sel:[0,0,1] op_sel_hi:[1,0,1] neg_lo:[0,0,1] neg_hi:[0,0,1]
v_pk_fma_f32 v[190:191], v[190:191], v[12:13], v[12:13] op_sel:[0,0,1] op_sel_hi:[1,0,1] neg_lo:[0,0,1] neg_hi:[0,0,1]
v_pk_fma_f32 v[192:193], v[192:193], v[12:13], v[12:13] op_sel:[0,0,1] op_sel_hi:[1,0,1] neg_lo:[0,0,1] neg_hi:[0,0,1]
v_pk_fma_f32 v[194:195], v[194:195], v[12:13], v[12:13] op_sel:[0,0,1] op_sel_hi:[1,0,1] neg_lo:[0,0,1] neg_hi:[0,0,1]
v_pk_fma_f32 v[196:197], v[196:197], v[12:13], v[12:13] op_sel:[0,0,1] op_sel_hi:[1,0,1] neg_lo:[0,0,1] neg_hi:[0,0,1]
v_pk_fma_f32 v[198:199], v[198:199], v[12:13], v[12:13] op_sel:[0,0,1] op_sel_hi:[1,0,1] neg_lo:[0,0,1] neg_hi:[0,0,1]
v_cvt_pk_bf16_f32 v248, v16, v17
v_cvt_pk_bf16_f32 v249, v18, v19
v_cvt_pk_bf16_f32 v250, v20, v21
v_cvt_pk_bf16_f32 v251, v22, v23
v_cvt_pk_bf16_f32 v252, v24, v25
v_cvt_pk_bf16_f32 v253, v26, v27
v_cvt_pk_bf16_f32 v254, v28, v29
v_cvt_pk_bf16_f32 v255, v30, v31
s_waitcnt lgkmcnt(0)
v_mfma_f32_32x32x16_bf16 v[16:31], v[64:67], v[88:91], 0
ds_read_b128 v[88:91], v1 offset:27136
ds_write_b64 v3, v[248:249] offset:0
v_exp_f32 v48, v48
v_exp_f32_e64 v49, v49
v_cvt_pk_bf16_f32 v128, v152, v153
v_mfma_f32_32x32x16_bf16 v[16:31], v[68:71], v[92:95], v[16:31]
ds_read_b128 v[92:95], v1 offset:28672
ds_write_b64 v3, v[250:251] offset:128
v_exp_f32 v50, v50
v_cvt_pk_bf16_f32 v129, v154, v155
v_exp_f32 v51, v51
v_mfma_f32_32x32x16_bf16 v[16:31], v[72:75], v[96:99], v[16:31]
ds_read_b128 v[96:99], v1 offset:29184
ds_write_b64 v3, v[252:253] offset:1024
v_cvt_pk_bf16_f32 v130, v156, v157
v_exp_f32 v52, v52
v_exp_f32 v53, v53
v_cvt_pk_bf16_f32 v131, v158, v159
v_exp_f32 v54, v54
v_cvt_pk_bf16_f32 v132, v160, v161
v_exp_f32 v55, v55
v_cvt_pk_bf16_f32 v133, v162, v163
v_exp_f32 v56, v56
v_exp_f32 v57, v57
v_cvt_pk_bf16_f32 v134, v164, v165
v_exp_f32 v58, v58
v_cvt_pk_bf16_f32 v135, v166, v167
v_exp_f32 v59, v59
v_cvt_pk_bf16_f32 v136, v168, v169
v_exp_f32 v60, v60
v_exp_f32 v61, v61
v_cvt_pk_bf16_f32 v137, v170, v171
v_exp_f32 v62, v62
v_cvt_pk_bf16_f32 v138, v172, v173
v_exp_f32 v63, v63
v_cvt_pk_bf16_f32 v139, v174, v175
v_pk_add_f32 v[48:49], v[48:49], 1.0 op_sel_hi:[1,0]
v_pk_add_f32 v[50:51], v[50:51], 1.0 op_sel_hi:[1,0]
v_pk_add_f32 v[52:53], v[52:53], 1.0 op_sel_hi:[1,0]
v_pk_add_f32 v[54:55], v[54:55], 1.0 op_sel_hi:[1,0]
v_pk_add_f32 v[56:57], v[56:57], 1.0 op_sel_hi:[1,0]
v_pk_add_f32 v[58:59], v[58:59], 1.0 op_sel_hi:[1,0]
v_pk_add_f32 v[60:61], v[60:61], 1.0 op_sel_hi:[1,0]
v_pk_add_f32 v[62:63], v[62:63], 1.0 op_sel_hi:[1,0]
s_waitcnt lgkmcnt(0)
v_mfma_f32_32x32x16_bf16 v[16:31], v[76:79], v[88:91], v[16:31]
ds_write_b64 v3, v[254:255] offset:1152
v_rcp_f32 v48, v48
v_rcp_f32 v49, v49
v_cvt_pk_bf16_f32 v140, v176, v177
v_rcp_f32 v50, v50
v_mfma_f32_32x32x16_bf16 v[16:31], v[80:83], v[92:95], v[16:31]
ds_read_b64_tr_b16 a[112:113], v4 offset:0
ds_read_b64_tr_b16 a[114:115], v4 offset:512
v_cvt_pk_bf16_f32 v141, v178, v179
v_rcp_f32_e64 v51, v51
v_cvt_pk_bf16_f32 v142, v180, v181
v_mfma_f32_32x32x16_bf16 v[16:31], v[84:87], v[96:99], v[16:31]
ds_read_b64_tr_b16 a[116:117], v4 offset:1024
ds_read_b64_tr_b16 a[118:119], v4 offset:1536
v_rcp_f32 v52, v52
v_rcp_f32 v53, v53
v_cvt_pk_bf16_f32 v143, v182, v183
v_rcp_f32 v54, v54
v_cvt_pk_bf16_f32 v144, v184, v185
v_rcp_f32 v55, v55
v_cvt_pk_bf16_f32 v145, v186, v187
v_rcp_f32 v56, v56
v_rcp_f32 v57, v57
v_cvt_pk_bf16_f32 v146, v188, v189
v_rcp_f32 v58, v58
v_cvt_pk_bf16_f32 v147, v190, v191
v_rcp_f32 v59, v59
v_cvt_pk_bf16_f32 v148, v192, v193
v_rcp_f32 v60, v60
v_rcp_f32 v61, v61
v_cvt_pk_bf16_f32 v149, v194, v195
v_rcp_f32 v62, v62
v_cvt_pk_bf16_f32 v150, v196, v197
v_rcp_f32 v63, v63
v_cvt_pk_bf16_f32 v151, v198, v199
v_pk_mul_f32 v[32:33], v[48:49], v[32:33]
v_pk_mul_f32 v[34:35], v[50:51], v[34:35]
v_pk_mul_f32 v[36:37], v[52:53], v[36:37]
v_pk_mul_f32 v[38:39], v[54:55], v[38:39]
v_pk_mul_f32 v[40:41], v[56:57], v[40:41]
v_pk_mul_f32 v[42:43], v[58:59], v[42:43]
v_pk_mul_f32 v[44:45], v[60:61], v[44:45]
v_pk_mul_f32 v[46:47], v[62:63], v[46:47]
v_pk_fma_f32 v[106:107], v[32:33], v[32:33], v[106:107]
v_pk_fma_f32 v[48:49], v[16:17], v[16:17], s[60:61] neg_lo:[1,0,0] neg_hi:[1,0,0]
v_pk_fma_f32 v[106:107], v[34:35], v[34:35], v[106:107]
v_pk_fma_f32 v[50:51], v[18:19], v[18:19], s[60:61] neg_lo:[1,0,0] neg_hi:[1,0,0]
v_pk_fma_f32 v[106:107], v[36:37], v[36:37], v[106:107]
v_pk_fma_f32 v[52:53], v[20:21], v[20:21], s[60:61] neg_lo:[1,0,0] neg_hi:[1,0,0]
v_pk_fma_f32 v[106:107], v[38:39], v[38:39], v[106:107]
v_pk_fma_f32 v[54:55], v[22:23], v[22:23], s[60:61] neg_lo:[1,0,0] neg_hi:[1,0,0]
v_pk_fma_f32 v[106:107], v[40:41], v[40:41], v[106:107]
v_pk_fma_f32 v[56:57], v[24:25], v[24:25], s[60:61] neg_lo:[1,0,0] neg_hi:[1,0,0]
v_pk_fma_f32 v[106:107], v[42:43], v[42:43], v[106:107]
v_pk_fma_f32 v[58:59], v[26:27], v[26:27], s[60:61] neg_lo:[1,0,0] neg_hi:[1,0,0]
v_pk_fma_f32 v[106:107], v[44:45], v[44:45], v[106:107]
v_pk_fma_f32 v[60:61], v[28:29], v[28:29], s[60:61] neg_lo:[1,0,0] neg_hi:[1,0,0]
v_pk_fma_f32 v[106:107], v[46:47], v[46:47], v[106:107]
v_pk_fma_f32 v[62:63], v[30:31], v[30:31], s[60:61] neg_lo:[1,0,0] neg_hi:[1,0,0]
v_pk_mul_f32 v[48:49], v[48:49], v[16:17]
v_pk_mul_f32 v[50:51], v[50:51], v[18:19]
v_pk_mul_f32 v[52:53], v[52:53], v[20:21]
v_pk_mul_f32 v[54:55], v[54:55], v[22:23]
v_pk_mul_f32 v[56:57], v[56:57], v[24:25]
v_pk_mul_f32 v[58:59], v[58:59], v[26:27]
v_pk_mul_f32 v[60:61], v[60:61], v[28:29]
v_pk_mul_f32 v[62:63], v[62:63], v[30:31]
v_cvt_pk_bf16_f32 v248, v32, v33
v_cvt_pk_bf16_f32 v249, v34, v35
v_cvt_pk_bf16_f32 v250, v36, v37
v_cvt_pk_bf16_f32 v251, v38, v39
v_cvt_pk_bf16_f32 v252, v40, v41
v_cvt_pk_bf16_f32 v253, v42, v43
v_cvt_pk_bf16_f32 v254, v44, v45
v_cvt_pk_bf16_f32 v255, v46, v47
v_mfma_f32_32x32x16_bf16 v[32:47], v[64:67], a[120:123], 0
ds_write_b64 v3, v[248:249] offset:0
v_exp_f32 v48, v48
v_exp_f32 v49, v49
v_exp_f32 v50, v50
v_mfma_f32_32x32x16_bf16 v[32:47], v[68:71], a[124:127], v[32:47]
ds_write_b64 v3, v[250:251] offset:128
v_exp_f32 v51, v51
v_exp_f32 v52, v52
v_exp_f32 v53, v53
v_mfma_f32_32x32x16_bf16 v[32:47], v[72:75], a[128:131], v[32:47]
ds_write_b64 v3, v[252:253] offset:1024
v_exp_f32 v54, v54
v_exp_f32 v55, v55
v_exp_f32 v56, v56
v_exp_f32 v57, v57
v_exp_f32 v58, v58
v_exp_f32 v59, v59
v_exp_f32 v60, v60
v_exp_f32 v61, v61
v_exp_f32 v62, v62
v_exp_f32 v63, v63
v_pk_add_f32 v[48:49], v[48:49], 1.0 op_sel_hi:[1,0]
v_pk_add_f32 v[50:51], v[50:51], 1.0 op_sel_hi:[1,0]
v_pk_add_f32 v[52:53], v[52:53], 1.0 op_sel_hi:[1,0]
v_pk_add_f32 v[54:55], v[54:55], 1.0 op_sel_hi:[1,0]
v_pk_add_f32 v[56:57], v[56:57], 1.0 op_sel_hi:[1,0]
v_pk_add_f32 v[58:59], v[58:59], 1.0 op_sel_hi:[1,0]
v_pk_add_f32 v[60:61], v[60:61], 1.0 op_sel_hi:[1,0]
v_pk_add_f32 v[62:63], v[62:63], 1.0 op_sel_hi:[1,0]
v_mfma_f32_32x32x16_bf16 v[32:47], v[76:79], a[132:135], v[32:47]
ds_write_b64 v3, v[254:255] offset:1152
v_rcp_f32 v48, v48
v_rcp_f32 v49, v49
v_rcp_f32_e64 v50, v50
v_mfma_f32_32x32x16_bf16 v[32:47], v[80:83], a[136:139], v[32:47]
ds_read_b64_tr_b16 a[120:121], v4 offset:0
ds_read_b64_tr_b16 a[122:123], v4 offset:512
v_rcp_f32 v51, v51
v_rcp_f32 v52, v52
v_rcp_f32_e64 v53, v53
v_mfma_f32_32x32x16_bf16 v[32:47], v[84:87], a[140:143], v[32:47]
ds_read_b64_tr_b16 a[124:125], v4 offset:1024
ds_read_b64_tr_b16 a[126:127], v4 offset:1536
v_rcp_f32 v54, v54
v_rcp_f32 v55, v55
v_rcp_f32 v56, v56
v_rcp_f32 v57, v57
v_rcp_f32 v58, v58
v_rcp_f32 v59, v59
v_rcp_f32 v60, v60
v_rcp_f32 v61, v61
v_rcp_f32 v62, v62
v_rcp_f32 v63, v63
v_pk_mul_f32 v[16:17], v[48:49], v[16:17]
v_pk_mul_f32 v[18:19], v[50:51], v[18:19]
v_pk_mul_f32 v[20:21], v[52:53], v[20:21]
v_pk_mul_f32 v[22:23], v[54:55], v[22:23]
v_pk_mul_f32 v[24:25], v[56:57], v[24:25]
v_pk_mul_f32 v[26:27], v[58:59], v[26:27]
v_pk_mul_f32 v[28:29], v[60:61], v[28:29]
v_pk_mul_f32 v[30:31], v[62:63], v[30:31]
v_pk_fma_f32 v[108:109], v[16:17], v[16:17], v[108:109]
v_pk_fma_f32 v[48:49], v[32:33], v[32:33], s[60:61] neg_lo:[1,0,0] neg_hi:[1,0,0]
v_pk_fma_f32 v[108:109], v[18:19], v[18:19], v[108:109]
v_pk_fma_f32 v[50:51], v[34:35], v[34:35], s[60:61] neg_lo:[1,0,0] neg_hi:[1,0,0]
v_pk_fma_f32 v[108:109], v[20:21], v[20:21], v[108:109]
v_pk_fma_f32 v[52:53], v[36:37], v[36:37], s[60:61] neg_lo:[1,0,0] neg_hi:[1,0,0]
v_pk_fma_f32 v[108:109], v[22:23], v[22:23], v[108:109]
v_pk_fma_f32 v[54:55], v[38:39], v[38:39], s[60:61] neg_lo:[1,0,0] neg_hi:[1,0,0]
v_pk_fma_f32 v[108:109], v[24:25], v[24:25], v[108:109]
v_pk_fma_f32 v[56:57], v[40:41], v[40:41], s[60:61] neg_lo:[1,0,0] neg_hi:[1,0,0]
v_pk_fma_f32 v[108:109], v[26:27], v[26:27], v[108:109]
v_pk_fma_f32 v[58:59], v[42:43], v[42:43], s[60:61] neg_lo:[1,0,0] neg_hi:[1,0,0]
v_pk_fma_f32 v[108:109], v[28:29], v[28:29], v[108:109]
v_pk_fma_f32 v[60:61], v[44:45], v[44:45], s[60:61] neg_lo:[1,0,0] neg_hi:[1,0,0]
v_pk_fma_f32 v[108:109], v[30:31], v[30:31], v[108:109]
v_pk_fma_f32 v[62:63], v[46:47], v[46:47], s[60:61] neg_lo:[1,0,0] neg_hi:[1,0,0]
v_pk_mul_f32 v[48:49], v[48:49], v[32:33]
v_pk_mul_f32 v[50:51], v[50:51], v[34:35]
v_pk_mul_f32 v[52:53], v[52:53], v[36:37]
v_pk_mul_f32 v[54:55], v[54:55], v[38:39]
v_pk_mul_f32 v[56:57], v[56:57], v[40:41]
v_pk_mul_f32 v[58:59], v[58:59], v[42:43]
v_pk_mul_f32 v[60:61], v[60:61], v[44:45]
v_pk_mul_f32 v[62:63], v[62:63], v[46:47]
v_cvt_pk_bf16_f32 v248, v16, v17
v_cvt_pk_bf16_f32 v249, v18, v19
v_cvt_pk_bf16_f32 v250, v20, v21
v_cvt_pk_bf16_f32 v251, v22, v23
v_cvt_pk_bf16_f32 v252, v24, v25
v_cvt_pk_bf16_f32 v253, v26, v27
v_cvt_pk_bf16_f32 v254, v28, v29
v_cvt_pk_bf16_f32 v255, v30, v31
v_mfma_f32_32x32x16_bf16 v[16:31], v[64:67], a[144:147], 0
ds_write_b64 v3, v[248:249] offset:0
v_exp_f32 v48, v48
v_exp_f32 v49, v49
v_exp_f32 v50, v50
v_mfma_f32_32x32x16_bf16 v[16:31], v[68:71], a[148:151], v[16:31]
ds_write_b64 v3, v[250:251] offset:128
v_exp_f32 v51, v51
v_exp_f32 v52, v52
v_exp_f32 v53, v53
v_mfma_f32_32x32x16_bf16 v[16:31], v[72:75], a[152:155], v[16:31]
ds_write_b64 v3, v[252:253] offset:1024
v_exp_f32 v54, v54
v_exp_f32 v55, v55
v_exp_f32 v56, v56
v_exp_f32 v57, v57
v_exp_f32 v58, v58
v_exp_f32 v59, v59
v_exp_f32 v60, v60
v_exp_f32 v61, v61
v_exp_f32 v62, v62
v_exp_f32 v63, v63
v_pk_add_f32 v[48:49], v[48:49], 1.0 op_sel_hi:[1,0]
v_pk_add_f32 v[50:51], v[50:51], 1.0 op_sel_hi:[1,0]
v_pk_add_f32 v[52:53], v[52:53], 1.0 op_sel_hi:[1,0]
v_pk_add_f32 v[54:55], v[54:55], 1.0 op_sel_hi:[1,0]
v_pk_add_f32 v[56:57], v[56:57], 1.0 op_sel_hi:[1,0]
v_pk_add_f32 v[58:59], v[58:59], 1.0 op_sel_hi:[1,0]
v_pk_add_f32 v[60:61], v[60:61], 1.0 op_sel_hi:[1,0]
v_pk_add_f32 v[62:63], v[62:63], 1.0 op_sel_hi:[1,0]
v_mfma_f32_32x32x16_bf16 v[16:31], v[76:79], a[156:159], v[16:31]
ds_write_b64 v3, v[254:255] offset:1152
v_rcp_f32 v48, v48
v_rcp_f32 v49, v49
v_rcp_f32_e64 v50, v50
v_mfma_f32_32x32x16_bf16 v[16:31], v[80:83], a[160:163], v[16:31]
ds_read_b64_tr_b16 a[128:129], v4 offset:0
ds_read_b64_tr_b16 a[130:131], v4 offset:512
v_rcp_f32 v51, v51
v_rcp_f32 v52, v52
v_rcp_f32_e64 v53, v53
v_mfma_f32_32x32x16_bf16 v[16:31], v[84:87], a[164:167], v[16:31]
ds_read_b64_tr_b16 a[132:133], v4 offset:1024
ds_read_b64_tr_b16 a[134:135], v4 offset:1536
v_rcp_f32 v54, v54
v_rcp_f32 v55, v55
v_rcp_f32 v56, v56
v_rcp_f32 v57, v57
v_rcp_f32 v58, v58
v_rcp_f32 v59, v59
v_rcp_f32 v60, v60
v_rcp_f32 v61, v61
v_rcp_f32 v62, v62
v_rcp_f32 v63, v63
v_pk_mul_f32 v[32:33], v[48:49], v[32:33]
v_pk_mul_f32 v[34:35], v[50:51], v[34:35]
v_pk_mul_f32 v[36:37], v[52:53], v[36:37]
v_pk_mul_f32 v[38:39], v[54:55], v[38:39]
v_pk_mul_f32 v[40:41], v[56:57], v[40:41]
v_pk_mul_f32 v[42:43], v[58:59], v[42:43]
v_pk_mul_f32 v[44:45], v[60:61], v[44:45]
v_pk_mul_f32 v[46:47], v[62:63], v[46:47]
v_pk_fma_f32 v[110:111], v[32:33], v[32:33], v[110:111]
v_pk_fma_f32 v[48:49], v[16:17], v[16:17], s[60:61] neg_lo:[1,0,0] neg_hi:[1,0,0]
v_pk_fma_f32 v[110:111], v[34:35], v[34:35], v[110:111]
v_pk_fma_f32 v[50:51], v[18:19], v[18:19], s[60:61] neg_lo:[1,0,0] neg_hi:[1,0,0]
v_pk_fma_f32 v[110:111], v[36:37], v[36:37], v[110:111]
v_pk_fma_f32 v[52:53], v[20:21], v[20:21], s[60:61] neg_lo:[1,0,0] neg_hi:[1,0,0]
v_pk_fma_f32 v[110:111], v[38:39], v[38:39], v[110:111]
v_pk_fma_f32 v[54:55], v[22:23], v[22:23], s[60:61] neg_lo:[1,0,0] neg_hi:[1,0,0]
v_pk_fma_f32 v[110:111], v[40:41], v[40:41], v[110:111]
v_pk_fma_f32 v[56:57], v[24:25], v[24:25], s[60:61] neg_lo:[1,0,0] neg_hi:[1,0,0]
v_pk_fma_f32 v[110:111], v[42:43], v[42:43], v[110:111]
v_pk_fma_f32 v[58:59], v[26:27], v[26:27], s[60:61] neg_lo:[1,0,0] neg_hi:[1,0,0]
v_pk_fma_f32 v[110:111], v[44:45], v[44:45], v[110:111]
v_pk_fma_f32 v[60:61], v[28:29], v[28:29], s[60:61] neg_lo:[1,0,0] neg_hi:[1,0,0]
v_pk_fma_f32 v[110:111], v[46:47], v[46:47], v[110:111]
v_pk_fma_f32 v[62:63], v[30:31], v[30:31], s[60:61] neg_lo:[1,0,0] neg_hi:[1,0,0]
v_pk_mul_f32 v[48:49], v[48:49], v[16:17]
v_pk_mul_f32 v[50:51], v[50:51], v[18:19]
v_pk_mul_f32 v[52:53], v[52:53], v[20:21]
v_pk_mul_f32 v[54:55], v[54:55], v[22:23]
v_pk_mul_f32 v[56:57], v[56:57], v[24:25]
v_pk_mul_f32 v[58:59], v[58:59], v[26:27]
v_pk_mul_f32 v[60:61], v[60:61], v[28:29]
v_pk_mul_f32 v[62:63], v[62:63], v[30:31]
v_cvt_pk_bf16_f32 v248, v32, v33
v_cvt_pk_bf16_f32 v249, v34, v35
v_cvt_pk_bf16_f32 v250, v36, v37
v_cvt_pk_bf16_f32 v251, v38, v39
v_cvt_pk_bf16_f32 v252, v40, v41
v_cvt_pk_bf16_f32 v253, v42, v43
v_cvt_pk_bf16_f32 v254, v44, v45
v_cvt_pk_bf16_f32 v255, v46, v47
v_mfma_f32_32x32x16_bf16 v[32:47], v[64:67], a[168:171], 0
ds_write_b64 v3, v[248:249] offset:0
v_exp_f32 v48, v48
v_exp_f32 v49, v49
v_exp_f32_e64 v50, v50
v_mfma_f32_32x32x16_bf16 v[32:47], v[68:71], a[172:175], v[32:47]
ds_write_b64 v3, v[250:251] offset:128
s_add_u32 s74, s87, L_b1_6-L_pc
v_exp_f32 v51, v51
v_exp_f32 v52, v52
v_exp_f32_e64 v53, v53
v_mfma_f32_32x32x16_bf16 v[32:47], v[72:75], a[176:179], v[32:47]
ds_write_b64 v3, v[252:253] offset:1024
v_lshl_add_u32 v14, v0, 3, s74
v_exp_f32 v54, v54
v_exp_f32 v55, v55
v_min_u32 v14, L_pf1-L_pc-4, v14
v_exp_f32 v56, v56
v_exp_f32 v57, v57
v_exp_f32 v58, v58
v_mov_b32 v15, s89
v_exp_f32 v59, v59
v_exp_f32 v60, v60
v_exp_f32 v61, v61
v_add_co_u32 v14, vcc, s88, v14
v_exp_f32 v62, v62
v_exp_f32 v63, v63
v_addc_co_u32_e64 v15, vcc, 0, v15, vcc
v_pk_add_f32 v[48:49], v[48:49], 1.0 op_sel_hi:[1,0]
v_pk_add_f32 v[50:51], v[50:51], 1.0 op_sel_hi:[1,0]
v_pk_add_f32 v[52:53], v[52:53], 1.0 op_sel_hi:[1,0]
v_pk_add_f32 v[54:55], v[54:55], 1.0 op_sel_hi:[1,0]
v_pk_add_f32 v[56:57], v[56:57], 1.0 op_sel_hi:[1,0]
v_pk_add_f32 v[58:59], v[58:59], 1.0 op_sel_hi:[1,0]
v_pk_add_f32 v[60:61], v[60:61], 1.0 op_sel_hi:[1,0]
v_pk_add_f32 v[62:63], v[62:63], 1.0 op_sel_hi:[1,0]
v_mfma_f32_32x32x16_bf16 v[32:47], v[76:79], a[180:183], v[32:47]
ds_write_b64 v3, v[254:255] offset:1152
v_rcp_f32 v48, v48
v_rcp_f32 v49, v49
v_rcp_f32_e64 v50, v50
v_mfma_f32_32x32x16_bf16 v[32:47], v[80:83], a[184:187], v[32:47]
ds_read_b64_tr_b16 a[136:137], v4 offset:0
ds_read_b64_tr_b16 a[138:139], v4 offset:512
v_rcp_f32 v51, v51
v_rcp_f32 v52, v52
v_rcp_f32_e64 v53, v53
v_mfma_f32_32x32x16_bf16 v[32:47], v[84:87], a[188:191], v[32:47]
ds_read_b64_tr_b16 a[140:141], v4 offset:1024
ds_read_b64_tr_b16 a[142:143], v4 offset:1536
s_waitcnt vmcnt(6)
global_load_dword v126, v[14:15], off
v_rcp_f32 v54, v54
v_rcp_f32 v55, v55
v_rcp_f32 v56, v56
v_rcp_f32 v57, v57
v_rcp_f32 v58, v58
v_rcp_f32 v59, v59
v_rcp_f32 v60, v60
v_rcp_f32 v61, v61
v_rcp_f32 v62, v62
v_rcp_f32_e64 v63, v63
v_pk_mul_f32 v[16:17], v[48:49], v[16:17]
v_pk_mul_f32 v[18:19], v[50:51], v[18:19]
v_pk_mul_f32 v[20:21], v[52:53], v[20:21]
v_pk_mul_f32 v[22:23], v[54:55], v[22:23]
v_pk_mul_f32 v[24:25], v[56:57], v[24:25]
v_pk_mul_f32 v[26:27], v[58:59], v[26:27]
v_pk_mul_f32 v[28:29], v[60:61], v[28:29]
v_pk_mul_f32 v[30:31], v[62:63], v[30:31]
v_pk_fma_f32 v[112:113], v[16:17], v[16:17], v[112:113]
v_pk_fma_f32 v[48:49], v[32:33], v[32:33], s[60:61] neg_lo:[1,0,0] neg_hi:[1,0,0]
v_pk_fma_f32 v[112:113], v[18:19], v[18:19], v[112:113]
v_pk_fma_f32 v[50:51], v[34:35], v[34:35], s[60:61] neg_lo:[1,0,0] neg_hi:[1,0,0]
v_pk_fma_f32 v[112:113], v[20:21], v[20:21], v[112:113]
v_pk_fma_f32 v[52:53], v[36:37], v[36:37], s[60:61] neg_lo:[1,0,0] neg_hi:[1,0,0]
v_pk_fma_f32 v[112:113], v[22:23], v[22:23], v[112:113]
v_pk_fma_f32 v[54:55], v[38:39], v[38:39], s[60:61] neg_lo:[1,0,0] neg_hi:[1,0,0]
v_pk_fma_f32 v[112:113], v[24:25], v[24:25], v[112:113]
v_pk_fma_f32 v[56:57], v[40:41], v[40:41], s[60:61] neg_lo:[1,0,0] neg_hi:[1,0,0]
v_pk_fma_f32 v[112:113], v[26:27], v[26:27], v[112:113]
v_pk_fma_f32 v[58:59], v[42:43], v[42:43], s[60:61] neg_lo:[1,0,0] neg_hi:[1,0,0]
v_pk_fma_f32 v[112:113], v[28:29], v[28:29], v[112:113]
v_pk_fma_f32 v[60:61], v[44:45], v[44:45], s[60:61] neg_lo:[1,0,0] neg_hi:[1,0,0]
v_pk_fma_f32 v[112:113], v[30:31], v[30:31], v[112:113]
v_pk_fma_f32 v[62:63], v[46:47], v[46:47], s[60:61] neg_lo:[1,0,0] neg_hi:[1,0,0]
v_pk_mul_f32 v[48:49], v[48:49], v[32:33]
v_pk_mul_f32 v[50:51], v[50:51], v[34:35]
v_pk_mul_f32 v[52:53], v[52:53], v[36:37]
v_pk_mul_f32 v[54:55], v[54:55], v[38:39]
v_pk_mul_f32 v[56:57], v[56:57], v[40:41]
v_pk_mul_f32 v[58:59], v[58:59], v[42:43]
v_pk_mul_f32 v[60:61], v[60:61], v[44:45]
v_pk_mul_f32 v[62:63], v[62:63], v[46:47]
v_cvt_pk_bf16_f32 v248, v16, v17
v_cvt_pk_bf16_f32 v249, v18, v19
v_cvt_pk_bf16_f32 v250, v20, v21
v_cvt_pk_bf16_f32 v251, v22, v23
v_cvt_pk_bf16_f32 v252, v24, v25
v_cvt_pk_bf16_f32 v253, v26, v27
v_cvt_pk_bf16_f32 v254, v28, v29
v_cvt_pk_bf16_f32 v255, v30, v31
v_mfma_f32_32x32x16_bf16 v[16:31], v[64:67], a[192:195], 0
ds_write_b64 v3, v[248:249] offset:0
v_exp_f32 v48, v48
v_exp_f32 v49, v49
v_exp_f32 v50, v50
v_mfma_f32_32x32x16_bf16 v[16:31], v[68:71], a[196:199], v[16:31]
ds_write_b64 v3, v[250:251] offset:128
v_exp_f32 v51, v51
v_exp_f32 v52, v52
v_exp_f32 v53, v53
v_mfma_f32_32x32x16_bf16 v[16:31], v[72:75], a[200:203], v[16:31]
ds_write_b64 v3, v[252:253] offset:1024
v_exp_f32 v54, v54
v_exp_f32 v55, v55
v_exp_f32 v56, v56
v_exp_f32 v57, v57
v_exp_f32 v58, v58
v_exp_f32 v59, v59
v_exp_f32 v60, v60
v_exp_f32 v61, v61
v_exp_f32 v62, v62
v_exp_f32 v63, v63
v_pk_add_f32 v[48:49], v[48:49], 1.0 op_sel_hi:[1,0]
v_pk_add_f32 v[50:51], v[50:51], 1.0 op_sel_hi:[1,0]
v_pk_add_f32 v[52:53], v[52:53], 1.0 op_sel_hi:[1,0]
v_pk_add_f32 v[54:55], v[54:55], 1.0 op_sel_hi:[1,0]
v_pk_add_f32 v[56:57], v[56:57], 1.0 op_sel_hi:[1,0]
v_pk_add_f32 v[58:59], v[58:59], 1.0 op_sel_hi:[1,0]
v_pk_add_f32 v[60:61], v[60:61], 1.0 op_sel_hi:[1,0]
v_pk_add_f32 v[62:63], v[62:63], 1.0 op_sel_hi:[1,0]
v_mfma_f32_32x32x16_bf16 v[16:31], v[76:79], a[204:207], v[16:31]
ds_write_b64 v3, v[254:255] offset:1152
v_rcp_f32 v48, v48
v_rcp_f32 v49, v49
v_rcp_f32_e64 v50, v50
v_mfma_f32_32x32x16_bf16 v[16:31], v[80:83], a[208:211], v[16:31]
ds_read_b64_tr_b16 a[144:145], v4 offset:0
ds_read_b64_tr_b16 a[146:147], v4 offset:512
v_rcp_f32 v51, v51
v_rcp_f32 v52, v52
v_rcp_f32_e64 v53, v53
v_mfma_f32_32x32x16_bf16 v[16:31], v[84:87], a[212:215], v[16:31]
ds_read_b64_tr_b16 a[148:149], v4 offset:1024
ds_read_b64_tr_b16 a[150:151], v4 offset:1536
v_rcp_f32 v54, v54
v_rcp_f32 v55, v55
v_rcp_f32 v56, v56
v_rcp_f32 v57, v57
v_rcp_f32 v58, v58
v_rcp_f32 v59, v59
v_rcp_f32 v60, v60
v_rcp_f32 v61, v61
v_rcp_f32 v62, v62
v_rcp_f32 v63, v63
v_pk_mul_f32 v[32:33], v[48:49], v[32:33]
v_pk_mul_f32 v[34:35], v[50:51], v[34:35]
v_pk_mul_f32 v[36:37], v[52:53], v[36:37]
v_pk_mul_f32 v[38:39], v[54:55], v[38:39]
v_pk_mul_f32 v[40:41], v[56:57], v[40:41]
v_pk_mul_f32 v[42:43], v[58:59], v[42:43]
v_pk_mul_f32 v[44:45], v[60:61], v[44:45]
v_pk_mul_f32 v[46:47], v[62:63], v[46:47]
v_pk_fma_f32 v[114:115], v[32:33], v[32:33], v[114:115]
v_pk_fma_f32 v[48:49], v[16:17], v[16:17], s[60:61] neg_lo:[1,0,0] neg_hi:[1,0,0]
v_pk_fma_f32 v[114:115], v[34:35], v[34:35], v[114:115]
v_pk_fma_f32 v[50:51], v[18:19], v[18:19], s[60:61] neg_lo:[1,0,0] neg_hi:[1,0,0]
v_pk_fma_f32 v[114:115], v[36:37], v[36:37], v[114:115]
v_pk_fma_f32 v[52:53], v[20:21], v[20:21], s[60:61] neg_lo:[1,0,0] neg_hi:[1,0,0]
v_pk_fma_f32 v[114:115], v[38:39], v[38:39], v[114:115]
v_pk_fma_f32 v[54:55], v[22:23], v[22:23], s[60:61] neg_lo:[1,0,0] neg_hi:[1,0,0]
v_pk_fma_f32 v[114:115], v[40:41], v[40:41], v[114:115]
v_pk_fma_f32 v[56:57], v[24:25], v[24:25], s[60:61] neg_lo:[1,0,0] neg_hi:[1,0,0]
v_pk_fma_f32 v[114:115], v[42:43], v[42:43], v[114:115]
v_pk_fma_f32 v[58:59], v[26:27], v[26:27], s[60:61] neg_lo:[1,0,0] neg_hi:[1,0,0]
v_pk_fma_f32 v[114:115], v[44:45], v[44:45], v[114:115]
v_pk_fma_f32 v[60:61], v[28:29], v[28:29], s[60:61] neg_lo:[1,0,0] neg_hi:[1,0,0]
v_pk_fma_f32 v[114:115], v[46:47], v[46:47], v[114:115]
v_pk_fma_f32 v[62:63], v[30:31], v[30:31], s[60:61] neg_lo:[1,0,0] neg_hi:[1,0,0]
v_pk_mul_f32 v[48:49], v[48:49], v[16:17]
v_pk_mul_f32 v[50:51], v[50:51], v[18:19]
v_pk_mul_f32 v[52:53], v[52:53], v[20:21]
v_pk_mul_f32 v[54:55], v[54:55], v[22:23]
v_pk_mul_f32 v[56:57], v[56:57], v[24:25]
v_pk_mul_f32 v[58:59], v[58:59], v[26:27]
v_pk_mul_f32 v[60:61], v[60:61], v[28:29]
v_pk_mul_f32 v[62:63], v[62:63], v[30:31]
v_cvt_pk_bf16_f32 v248, v32, v33
v_cvt_pk_bf16_f32 v249, v34, v35
v_cvt_pk_bf16_f32 v250, v36, v37
v_cvt_pk_bf16_f32 v251, v38, v39
v_cvt_pk_bf16_f32 v252, v40, v41
v_cvt_pk_bf16_f32 v253, v42, v43
v_cvt_pk_bf16_f32 v254, v44, v45
v_cvt_pk_bf16_f32 v255, v46, v47
v_mfma_f32_32x32x16_bf16 v[32:47], v[64:67], a[216:219], 0
ds_write_b64 v3, v[248:249] offset:0
v_exp_f32 v48, v48
v_exp_f32 v49, v49
v_exp_f32 v50, v50
v_mfma_f32_32x32x16_bf16 v[32:47], v[68:71], a[220:223], v[32:47]
ds_write_b64 v3, v[250:251] offset:128
v_exp_f32 v51, v51
v_exp_f32 v52, v52
v_exp_f32 v53, v53
v_mfma_f32_32x32x16_bf16 v[32:47], v[72:75], a[224:227], v[32:47]
ds_write_b64 v3, v[252:253] offset:1024
v_exp_f32 v54, v54
v_exp_f32 v55, v55
v_exp_f32 v56, v56
v_exp_f32 v57, v57
v_exp_f32 v58, v58
v_exp_f32 v59, v59
v_exp_f32 v60, v60
v_exp_f32 v61, v61
v_exp_f32 v62, v62
v_exp_f32 v63, v63
v_pk_add_f32 v[48:49], v[48:49], 1.0 op_sel_hi:[1,0]
v_pk_add_f32 v[50:51], v[50:51], 1.0 op_sel_hi:[1,0]
v_pk_add_f32 v[52:53], v[52:53], 1.0 op_sel_hi:[1,0]
v_pk_add_f32 v[54:55], v[54:55], 1.0 op_sel_hi:[1,0]
v_pk_add_f32 v[56:57], v[56:57], 1.0 op_sel_hi:[1,0]
v_pk_add_f32 v[58:59], v[58:59], 1.0 op_sel_hi:[1,0]
v_pk_add_f32 v[60:61], v[60:61], 1.0 op_sel_hi:[1,0]
v_pk_add_f32 v[62:63], v[62:63], 1.0 op_sel_hi:[1,0]
v_mfma_f32_32x32x16_bf16 v[32:47], v[76:79], a[228:231], v[32:47]
ds_write_b64 v3, v[254:255] offset:1152
v_rcp_f32 v48, v48
v_rcp_f32 v49, v49
v_rcp_f32_e64 v50, v50
v_mfma_f32_32x32x16_bf16 v[32:47], v[80:83], a[232:235], v[32:47]
ds_read_b64_tr_b16 a[152:153], v4 offset:0
ds_read_b64_tr_b16 a[154:155], v4 offset:512
v_rcp_f32 v51, v51
v_rcp_f32 v52, v52
v_rcp_f32_e64 v53, v53
v_mfma_f32_32x32x16_bf16 v[32:47], v[84:87], a[236:239], v[32:47]
ds_read_b64_tr_b16 a[156:157], v4 offset:1024
ds_read_b64_tr_b16 a[158:159], v4 offset:1536
v_rcp_f32 v54, v54
v_rcp_f32 v55, v55
v_rcp_f32 v56, v56
v_rcp_f32 v57, v57
v_rcp_f32 v58, v58
v_rcp_f32 v59, v59
v_rcp_f32 v60, v60
v_rcp_f32 v61, v61
v_rcp_f32 v62, v62
v_rcp_f32 v63, v63
v_pk_mul_f32 v[16:17], v[48:49], v[16:17]
v_pk_mul_f32 v[18:19], v[50:51], v[18:19]
v_pk_mul_f32 v[20:21], v[52:53], v[20:21]
v_pk_mul_f32 v[22:23], v[54:55], v[22:23]
v_pk_mul_f32 v[24:25], v[56:57], v[24:25]
v_pk_mul_f32 v[26:27], v[58:59], v[26:27]
v_pk_mul_f32 v[28:29], v[60:61], v[28:29]
v_pk_mul_f32 v[30:31], v[62:63], v[30:31]
v_pk_fma_f32 v[116:117], v[16:17], v[16:17], v[116:117]
v_pk_fma_f32 v[48:49], v[32:33], v[32:33], s[60:61] neg_lo:[1,0,0] neg_hi:[1,0,0]
v_pk_fma_f32 v[116:117], v[18:19], v[18:19], v[116:117]
v_pk_fma_f32 v[50:51], v[34:35], v[34:35], s[60:61] neg_lo:[1,0,0] neg_hi:[1,0,0]
v_pk_fma_f32 v[116:117], v[20:21], v[20:21], v[116:117]
v_pk_fma_f32 v[52:53], v[36:37], v[36:37], s[60:61] neg_lo:[1,0,0] neg_hi:[1,0,0]
v_pk_fma_f32 v[116:117], v[22:23], v[22:23], v[116:117]
v_pk_fma_f32 v[54:55], v[38:39], v[38:39], s[60:61] neg_lo:[1,0,0] neg_hi:[1,0,0]
v_pk_fma_f32 v[116:117], v[24:25], v[24:25], v[116:117]
v_pk_fma_f32 v[56:57], v[40:41], v[40:41], s[60:61] neg_lo:[1,0,0] neg_hi:[1,0,0]
v_pk_fma_f32 v[116:117], v[26:27], v[26:27], v[116:117]
v_pk_fma_f32 v[58:59], v[42:43], v[42:43], s[60:61] neg_lo:[1,0,0] neg_hi:[1,0,0]
v_pk_fma_f32 v[116:117], v[28:29], v[28:29], v[116:117]
v_pk_fma_f32 v[60:61], v[44:45], v[44:45], s[60:61] neg_lo:[1,0,0] neg_hi:[1,0,0]
v_pk_fma_f32 v[116:117], v[30:31], v[30:31], v[116:117]
v_pk_fma_f32 v[62:63], v[46:47], v[46:47], s[60:61] neg_lo:[1,0,0] neg_hi:[1,0,0]
v_pk_mul_f32 v[48:49], v[48:49], v[32:33]
v_pk_mul_f32 v[50:51], v[50:51], v[34:35]
v_pk_mul_f32 v[52:53], v[52:53], v[36:37]
v_pk_mul_f32 v[54:55], v[54:55], v[38:39]
v_pk_mul_f32 v[56:57], v[56:57], v[40:41]
v_pk_mul_f32 v[58:59], v[58:59], v[42:43]
v_pk_mul_f32 v[60:61], v[60:61], v[44:45]
v_pk_mul_f32 v[62:63], v[62:63], v[46:47]
v_cvt_pk_bf16_f32 v248, v16, v17
v_cvt_pk_bf16_f32 v249, v18, v19
v_cvt_pk_bf16_f32 v250, v20, v21
v_cvt_pk_bf16_f32 v251, v22, v23
v_cvt_pk_bf16_f32 v252, v24, v25
v_cvt_pk_bf16_f32 v253, v26, v27
v_cvt_pk_bf16_f32 v254, v28, v29
v_cvt_pk_bf16_f32 v255, v30, v31
v_mfma_f32_32x32x16_bf16 v[16:31], v[64:67], a[240:243], 0
ds_write_b64 v3, v[248:249] offset:0
v_exp_f32 v48, v48
v_exp_f32 v49, v49
v_exp_f32 v50, v50
v_mfma_f32_32x32x16_bf16 v[16:31], v[68:71], a[244:247], v[16:31]
ds_write_b64 v3, v[250:251] offset:128
v_exp_f32 v51, v51
v_exp_f32 v52, v52
v_exp_f32 v53, v53
v_mfma_f32_32x32x16_bf16 v[16:31], v[72:75], a[248:251], v[16:31]
ds_write_b64 v3, v[252:253] offset:1024
v_exp_f32 v54, v54
v_exp_f32 v55, v55
v_exp_f32 v56, v56
v_exp_f32 v57, v57
v_exp_f32 v58, v58
v_exp_f32 v59, v59
v_exp_f32 v60, v60
v_exp_f32 v61, v61
v_exp_f32 v62, v62
v_exp_f32 v63, v63
v_pk_add_f32 v[48:49], v[48:49], 1.0 op_sel_hi:[1,0]
v_pk_add_f32 v[50:51], v[50:51], 1.0 op_sel_hi:[1,0]
v_pk_add_f32 v[52:53], v[52:53], 1.0 op_sel_hi:[1,0]
v_pk_add_f32 v[54:55], v[54:55], 1.0 op_sel_hi:[1,0]
v_pk_add_f32 v[56:57], v[56:57], 1.0 op_sel_hi:[1,0]
v_pk_add_f32 v[58:59], v[58:59], 1.0 op_sel_hi:[1,0]
v_pk_add_f32 v[60:61], v[60:61], 1.0 op_sel_hi:[1,0]
v_pk_add_f32 v[62:63], v[62:63], 1.0 op_sel_hi:[1,0]
v_mfma_f32_32x32x16_bf16 v[16:31], v[76:79], a[252:255], v[16:31]
ds_read_b128 v[88:91], v7 offset:2048
ds_write_b64 v3, v[254:255] offset:1152
v_rcp_f32 v48, v48
v_rcp_f32 v49, v49
v_rcp_f32_e64 v50, v50
v_mfma_f32_32x32x16_bf16 v[16:31], v[80:83], v[224:227], v[16:31]
ds_read_b128 v[92:95], v7 offset:2560
ds_read_b64_tr_b16 a[160:161], v4 offset:0
ds_read_b64_tr_b16 a[162:163], v4 offset:512
v_rcp_f32 v51, v51
v_rcp_f32 v52, v52
v_mfma_f32_32x32x16_bf16 v[16:31], v[84:87], v[228:231], v[16:31]
ds_read_b128 v[96:99], v7 offset:4096
ds_read_b64_tr_b16 a[164:165], v4 offset:1024
ds_read_b64_tr_b16 a[166:167], v4 offset:1536
v_rcp_f32 v53, v53
v_rcp_f32 v54, v54
v_rcp_f32 v55, v55
v_rcp_f32 v56, v56
v_rcp_f32 v57, v57
v_rcp_f32 v58, v58
v_rcp_f32 v59, v59
v_rcp_f32 v60, v60
v_rcp_f32 v61, v61
v_rcp_f32 v62, v62
v_rcp_f32_e64 v63, v63
v_pk_mul_f32 v[32:33], v[48:49], v[32:33]
v_pk_mul_f32 v[34:35], v[50:51], v[34:35]
v_pk_mul_f32 v[36:37], v[52:53], v[36:37]
v_pk_mul_f32 v[38:39], v[54:55], v[38:39]
v_pk_mul_f32 v[40:41], v[56:57], v[40:41]
v_pk_mul_f32 v[42:43], v[58:59], v[42:43]
v_pk_mul_f32 v[44:45], v[60:61], v[44:45]
v_pk_mul_f32 v[46:47], v[62:63], v[46:47]
v_pk_fma_f32 v[118:119], v[32:33], v[32:33], v[118:119]
v_pk_fma_f32 v[48:49], v[16:17], v[16:17], s[60:61] neg_lo:[1,0,0] neg_hi:[1,0,0]
v_pk_fma_f32 v[118:119], v[34:35], v[34:35], v[118:119]
v_pk_fma_f32 v[50:51], v[18:19], v[18:19], s[60:61] neg_lo:[1,0,0] neg_hi:[1,0,0]
v_pk_fma_f32 v[118:119], v[36:37], v[36:37], v[118:119]
v_pk_fma_f32 v[52:53], v[20:21], v[20:21], s[60:61] neg_lo:[1,0,0] neg_hi:[1,0,0]
v_pk_fma_f32 v[118:119], v[38:39], v[38:39], v[118:119]
v_pk_fma_f32 v[54:55], v[22:23], v[22:23], s[60:61] neg_lo:[1,0,0] neg_hi:[1,0,0]
v_pk_fma_f32 v[118:119], v[40:41], v[40:41], v[118:119]
v_pk_fma_f32 v[56:57], v[24:25], v[24:25], s[60:61] neg_lo:[1,0,0] neg_hi:[1,0,0]
v_pk_fma_f32 v[118:119], v[42:43], v[42:43], v[118:119]
v_pk_fma_f32 v[58:59], v[26:27], v[26:27], s[60:61] neg_lo:[1,0,0] neg_hi:[1,0,0]
v_pk_fma_f32 v[118:119], v[44:45], v[44:45], v[118:119]
v_pk_fma_f32 v[60:61], v[28:29], v[28:29], s[60:61] neg_lo:[1,0,0] neg_hi:[1,0,0]
v_pk_fma_f32 v[118:119], v[46:47], v[46:47], v[118:119]
v_pk_fma_f32 v[62:63], v[30:31], v[30:31], s[60:61] neg_lo:[1,0,0] neg_hi:[1,0,0]
v_pk_mul_f32 v[48:49], v[48:49], v[16:17]
v_pk_mul_f32 v[50:51], v[50:51], v[18:19]
v_pk_mul_f32 v[52:53], v[52:53], v[20:21]
v_pk_mul_f32 v[54:55], v[54:55], v[22:23]
v_pk_mul_f32 v[56:57], v[56:57], v[24:25]
v_pk_mul_f32 v[58:59], v[58:59], v[26:27]
v_pk_mul_f32 v[60:61], v[60:61], v[28:29]
v_pk_mul_f32 v[62:63], v[62:63], v[30:31]
v_cvt_pk_bf16_f32 v248, v32, v33
v_cvt_pk_bf16_f32 v249, v34, v35
v_cvt_pk_bf16_f32 v250, v36, v37
v_cvt_pk_bf16_f32 v251, v38, v39
v_cvt_pk_bf16_f32 v252, v40, v41
v_cvt_pk_bf16_f32 v253, v42, v43
v_cvt_pk_bf16_f32 v254, v44, v45
v_cvt_pk_bf16_f32 v255, v46, v47
s_waitcnt lgkmcnt(0)
v_mfma_f32_32x32x16_bf16 v[32:47], v[64:67], v[88:91], 0
ds_read_b128 v[88:91], v7 offset:4608
ds_write_b64 v3, v[248:249] offset:0
v_exp_f32 v48, v48
v_exp_f32 v49, v49
v_exp_f32 v50, v50
v_mfma_f32_32x32x16_bf16 v[32:47], v[68:71], v[92:95], v[32:47]
ds_read_b128 v[92:95], v7 offset:6144
ds_write_b64 v3, v[250:251] offset:128
v_exp_f32 v51, v51
v_exp_f32 v52, v52
v_mfma_f32_32x32x16_bf16 v[32:47], v[72:75], v[96:99], v[32:47]
ds_read_b128 v[96:99], v7 offset:6656
ds_write_b64 v3, v[252:253] offset:1024
v_exp_f32 v53, v53
v_exp_f32 v54, v54
v_exp_f32 v55, v55
v_exp_f32 v56, v56
v_exp_f32 v57, v57
v_exp_f32 v58, v58
v_exp_f32 v59, v59
v_exp_f32 v60, v60
v_exp_f32 v61, v61
v_exp_f32 v62, v62
v_exp_f32_e64 v63, v63
v_pk_add_f32 v[48:49], v[48:49], 1.0 op_sel_hi:[1,0]
v_pk_add_f32 v[50:51], v[50:51], 1.0 op_sel_hi:[1,0]
v_pk_add_f32 v[52:53], v[52:53], 1.0 op_sel_hi:[1,0]
v_pk_add_f32 v[54:55], v[54:55], 1.0 op_sel_hi:[1,0]
v_pk_add_f32 v[56:57], v[56:57], 1.0 op_sel_hi:[1,0]
v_pk_add_f32 v[58:59], v[58:59], 1.0 op_sel_hi:[1,0]
v_pk_add_f32 v[60:61], v[60:61], 1.0 op_sel_hi:[1,0]
v_pk_add_f32 v[62:63], v[62:63], 1.0 op_sel_hi:[1,0]
s_waitcnt lgkmcnt(0)
v_mfma_f32_32x32x16_bf16 v[32:47], v[76:79], v[88:91], v[32:47]
ds_read_b128 v[88:91], v1 offset:0
ds_write_b64 v3, v[254:255] offset:1152
v_rcp_f32 v48, v48
v_rcp_f32 v49, v49
v_rcp_f32 v50, v50
v_mfma_f32_32x32x16_bf16 v[32:47], v[80:83], v[92:95], v[32:47]
ds_read_b128 v[92:95], v1 offset:512
ds_read_b64_tr_b16 a[168:169], v4 offset:0
ds_read_b64_tr_b16 a[170:171], v4 offset:512
v_rcp_f32 v51, v51
v_rcp_f32 v52, v52
v_mfma_f32_32x32x16_bf16 v[32:47], v[84:87], v[96:99], v[32:47]
ds_read_b128 v[96:99], v1 offset:2048
ds_read_b64_tr_b16 a[172:173], v4 offset:1024
ds_read_b64_tr_b16 a[174:175], v4 offset:1536
v_rcp_f32 v53, v53
v_rcp_f32 v54, v54
v_rcp_f32 v55, v55
v_rcp_f32 v56, v56
v_rcp_f32 v57, v57
v_rcp_f32 v58, v58
v_rcp_f32 v59, v59
v_rcp_f32 v60, v60
v_rcp_f32 v61, v61
v_rcp_f32 v62, v62
v_rcp_f32_e64 v63, v63
v_pk_mul_f32 v[16:17], v[48:49], v[16:17]
v_pk_mul_f32 v[18:19], v[50:51], v[18:19]
v_pk_mul_f32 v[20:21], v[52:53], v[20:21]
v_pk_mul_f32 v[22:23], v[54:55], v[22:23]
v_pk_mul_f32 v[24:25], v[56:57], v[24:25]
v_pk_mul_f32 v[26:27], v[58:59], v[26:27]
v_pk_mul_f32 v[28:29], v[60:61], v[28:29]
v_pk_mul_f32 v[30:31], v[62:63], v[30:31]
v_pk_fma_f32 v[120:121], v[16:17], v[16:17], v[120:121]
v_pk_fma_f32 v[48:49], v[32:33], v[32:33], s[60:61] neg_lo:[1,0,0] neg_hi:[1,0,0]
v_pk_fma_f32 v[120:121], v[18:19], v[18:19], v[120:121]
v_pk_fma_f32 v[50:51], v[34:35], v[34:35], s[60:61] neg_lo:[1,0,0] neg_hi:[1,0,0]
v_pk_fma_f32 v[120:121], v[20:21], v[20:21], v[120:121]
v_pk_fma_f32 v[52:53], v[36:37], v[36:37], s[60:61] neg_lo:[1,0,0] neg_hi:[1,0,0]
v_pk_fma_f32 v[120:121], v[22:23], v[22:23], v[120:121]
v_pk_fma_f32 v[54:55], v[38:39], v[38:39], s[60:61] neg_lo:[1,0,0] neg_hi:[1,0,0]
v_pk_fma_f32 v[120:121], v[24:25], v[24:25], v[120:121]
v_pk_fma_f32 v[56:57], v[40:41], v[40:41], s[60:61] neg_lo:[1,0,0] neg_hi:[1,0,0]
v_pk_fma_f32 v[120:121], v[26:27], v[26:27], v[120:121]
v_pk_fma_f32 v[58:59], v[42:43], v[42:43], s[60:61] neg_lo:[1,0,0] neg_hi:[1,0,0]
v_pk_fma_f32 v[120:121], v[28:29], v[28:29], v[120:121]
v_pk_fma_f32 v[60:61], v[44:45], v[44:45], s[60:61] neg_lo:[1,0,0] neg_hi:[1,0,0]
v_pk_fma_f32 v[120:121], v[30:31], v[30:31], v[120:121]
v_pk_fma_f32 v[62:63], v[46:47], v[46:47], s[60:61] neg_lo:[1,0,0] neg_hi:[1,0,0]
v_pk_mul_f32 v[48:49], v[48:49], v[32:33]
v_pk_mul_f32 v[50:51], v[50:51], v[34:35]
v_pk_mul_f32 v[52:53], v[52:53], v[36:37]
v_pk_mul_f32 v[54:55], v[54:55], v[38:39]
v_pk_mul_f32 v[56:57], v[56:57], v[40:41]
v_pk_mul_f32 v[58:59], v[58:59], v[42:43]
v_pk_mul_f32 v[60:61], v[60:61], v[44:45]
v_pk_mul_f32 v[62:63], v[62:63], v[46:47]
v_cvt_pk_bf16_f32 v248, v16, v17
v_cvt_pk_bf16_f32 v249, v18, v19
v_cvt_pk_bf16_f32 v250, v20, v21
v_cvt_pk_bf16_f32 v251, v22, v23
v_cvt_pk_bf16_f32 v252, v24, v25
v_cvt_pk_bf16_f32 v253, v26, v27
v_cvt_pk_bf16_f32 v254, v28, v29
v_cvt_pk_bf16_f32 v255, v30, v31
s_waitcnt lgkmcnt(0)
v_mfma_f32_32x32x16_bf16 v[16:31], v[128:131], v[88:91], 0
ds_read_b128 v[88:91], v1 offset:2560
ds_write_b64 v3, v[248:249] offset:0
v_exp_f32 v48, v48
v_exp_f32 v49, v49
v_exp_f32 v50, v50
v_mfma_f32_32x32x16_bf16 v[16:31], v[132:135], v[92:95], v[16:31]
ds_read_b128 v[92:95], v1 offset:4096
ds_write_b64 v3, v[250:251] offset:128
ds_read_b128 v[64:67], v5 offset:0
v_exp_f32 v51, v51
v_exp_f32 v52, v52
v_mfma_f32_32x32x16_bf16 v[16:31], v[136:139], v[96:99], v[16:31]
ds_read_b128 v[96:99], v1 offset:4608
ds_write_b64 v3, v[252:253] offset:1024
ds_read_b128 v[68:71], v6 offset:0
ds_read_b128 v[72:75], v5 offset:528
v_exp_f32 v53, v53
v_exp_f32 v54, v54
v_exp_f32 v55, v55
v_exp_f32 v56, v56
v_exp_f32 v57, v57
v_exp_f32 v58, v58
v_exp_f32 v59, v59
v_exp_f32 v60, v60
v_exp_f32 v61, v61
v_exp_f32 v62, v62
v_exp_f32_e64 v63, v63
v_pk_add_f32 v[48:49], v[48:49], 1.0 op_sel_hi:[1,0]
v_pk_add_f32 v[50:51], v[50:51], 1.0 op_sel_hi:[1,0]
v_pk_add_f32 v[52:53], v[52:53], 1.0 op_sel_hi:[1,0]
v_pk_add_f32 v[54:55], v[54:55], 1.0 op_sel_hi:[1,0]
v_pk_add_f32 v[56:57], v[56:57], 1.0 op_sel_hi:[1,0]
v_pk_add_f32 v[58:59], v[58:59], 1.0 op_sel_hi:[1,0]
v_pk_add_f32 v[60:61], v[60:61], 1.0 op_sel_hi:[1,0]
v_pk_add_f32 v[62:63], v[62:63], 1.0 op_sel_hi:[1,0]
s_waitcnt lgkmcnt(0)
v_mfma_f32_32x32x16_bf16 v[16:31], v[140:143], v[88:91], v[16:31]
ds_read_b128 v[88:91], v1 offset:6144
ds_write_b64 v3, v[254:255] offset:1152
v_rcp_f32 v48, v48
v_rcp_f32 v49, v49
v_rcp_f32 v50, v50
v_mfma_f32_32x32x16_bf16 v[16:31], v[144:147], v[92:95], v[16:31]
ds_read_b128 v[92:95], v1 offset:6656
ds_read_b64_tr_b16 a[176:177], v4 offset:0
ds_read_b64_tr_b16 a[178:179], v4 offset:512
ds_read_b128 v[76:79], v6 offset:528
v_rcp_f32_e64 v51, v51
v_mfma_f32_32x32x16_bf16 v[16:31], v[148:151], v[96:99], v[16:31]
ds_read_b128 v[96:99], v1 offset:8192
ds_read_b64_tr_b16 a[180:181], v4 offset:1024
ds_read_b64_tr_b16 a[182:183], v4 offset:1536
ds_read_b128 v[80:83], v5 offset:1056
ds_read_b128 v[84:87], v6 offset:1056
v_rcp_f32 v52, v52
v_rcp_f32 v53, v53
v_rcp_f32 v54, v54
v_rcp_f32 v55, v55
v_rcp_f32 v56, v56
v_rcp_f32 v57, v57
v_rcp_f32 v58, v58
v_rcp_f32 v59, v59
v_rcp_f32 v60, v60
v_rcp_f32 v61, v61
v_rcp_f32 v62, v62
v_rcp_f32 v63, v63
v_pk_mul_f32 v[32:33], v[48:49], v[32:33]
v_pk_mul_f32 v[34:35], v[50:51], v[34:35]
v_pk_mul_f32 v[36:37], v[52:53], v[36:37]
v_pk_mul_f32 v[38:39], v[54:55], v[38:39]
v_pk_mul_f32 v[40:41], v[56:57], v[40:41]
v_pk_mul_f32 v[42:43], v[58:59], v[42:43]
v_pk_mul_f32 v[44:45], v[60:61], v[44:45]
v_pk_mul_f32 v[46:47], v[62:63], v[46:47]
v_pk_fma_f32 v[122:123], v[32:33], v[32:33], v[122:123]
v_pk_fma_f32 v[48:49], v[16:17], v[16:17], s[60:61] neg_lo:[1,0,0] neg_hi:[1,0,0]
v_pk_fma_f32 v[122:123], v[34:35], v[34:35], v[122:123]
v_pk_fma_f32 v[50:51], v[18:19], v[18:19], s[60:61] neg_lo:[1,0,0] neg_hi:[1,0,0]
v_pk_fma_f32 v[122:123], v[36:37], v[36:37], v[122:123]
v_pk_fma_f32 v[52:53], v[20:21], v[20:21], s[60:61] neg_lo:[1,0,0] neg_hi:[1,0,0]
v_pk_fma_f32 v[122:123], v[38:39], v[38:39], v[122:123]
v_pk_fma_f32 v[54:55], v[22:23], v[22:23], s[60:61] neg_lo:[1,0,0] neg_hi:[1,0,0]
v_pk_fma_f32 v[122:123], v[40:41], v[40:41], v[122:123]
v_pk_fma_f32 v[56:57], v[24:25], v[24:25], s[60:61] neg_lo:[1,0,0] neg_hi:[1,0,0]
v_pk_fma_f32 v[122:123], v[42:43], v[42:43], v[122:123]
v_pk_fma_f32 v[58:59], v[26:27], v[26:27], s[60:61] neg_lo:[1,0,0] neg_hi:[1,0,0]
v_pk_fma_f32 v[122:123], v[44:45], v[44:45], v[122:123]
v_pk_fma_f32 v[60:61], v[28:29], v[28:29], s[60:61] neg_lo:[1,0,0] neg_hi:[1,0,0]
v_pk_fma_f32 v[122:123], v[46:47], v[46:47], v[122:123]
v_pk_fma_f32 v[62:63], v[30:31], v[30:31], s[60:61] neg_lo:[1,0,0] neg_hi:[1,0,0]
v_pk_mul_f32 v[48:49], v[48:49], v[16:17]
v_pk_mul_f32 v[50:51], v[50:51], v[18:19]
v_pk_mul_f32 v[52:53], v[52:53], v[20:21]
v_pk_mul_f32 v[54:55], v[54:55], v[22:23]
v_pk_mul_f32 v[56:57], v[56:57], v[24:25]
v_pk_mul_f32 v[58:59], v[58:59], v[26:27]
v_pk_mul_f32 v[60:61], v[60:61], v[28:29]
v_pk_mul_f32 v[62:63], v[62:63], v[30:31]
L_b1_6:
v_cvt_pk_bf16_f32 v248, v32, v33
v_cvt_pk_bf16_f32 v249, v34, v35
v_cvt_pk_bf16_f32 v250, v36, v37
v_cvt_pk_bf16_f32 v251, v38, v39
v_cvt_pk_bf16_f32 v252, v40, v41
v_cvt_pk_bf16_f32 v253, v42, v43
v_cvt_pk_bf16_f32 v254, v44, v45
v_cvt_pk_bf16_f32 v255, v46, v47
s_waitcnt lgkmcnt(0)
v_mfma_f32_32x32x16_bf16 v[32:47], v[128:131], v[88:91], 0
ds_read_b128 v[88:91], v1 offset:8704
ds_write_b64 v3, v[248:249] offset:0
v_exp_f32 v48, v48
v_exp_f32 v49, v49
v_exp_f32 v50, v50
v_mfma_f32_32x32x16_bf16 v[32:47], v[132:135], v[92:95], v[32:47]
ds_read_b128 v[92:95], v1 offset:10240
ds_write_b64 v3, v[250:251] offset:128
v_exp_f32 v51, v51
v_exp_f32 v52, v52
v_mfma_f32_32x32x16_bf16 v[32:47], v[136:139], v[96:99], v[32:47]
ds_read_b128 v[96:99], v1 offset:10752
ds_write_b64 v3, v[252:253] offset:1024
v_exp_f32 v53, v53
v_exp_f32 v54, v54
v_exp_f32 v55, v55
s_waitcnt vmcnt(1)
v_mfma_f32_32x32x16_bf16 v[152:167], v[64:67], v[200:203], 0
v_exp_f32 v56, v56
v_exp_f32 v57, v57
v_exp_f32 v58, v58
v_mfma_f32_32x32x16_bf16 v[152:167], v[68:71], v[204:207], v[152:167]
v_exp_f32 v59, v59
v_exp_f32 v60, v60
v_exp_f32 v61, v61
v_exp_f32 v62, v62
v_exp_f32_e64 v63, v63
v_pk_add_f32 v[48:49], v[48:49], 1.0 op_sel_hi:[1,0]
v_pk_add_f32 v[50:51], v[50:51], 1.0 op_sel_hi:[1,0]
v_pk_add_f32 v[52:53], v[52:53], 1.0 op_sel_hi:[1,0]
v_pk_add_f32 v[54:55], v[54:55], 1.0 op_sel_hi:[1,0]
v_pk_add_f32 v[56:57], v[56:57], 1.0 op_sel_hi:[1,0]
v_pk_add_f32 v[58:59], v[58:59], 1.0 op_sel_hi:[1,0]
v_pk_add_f32 v[60:61], v[60:61], 1.0 op_sel_hi:[1,0]
v_pk_add_f32 v[62:63], v[62:63], 1.0 op_sel_hi:[1,0]
s_waitcnt lgkmcnt(0)
v_mfma_f32_32x32x16_bf16 v[32:47], v[140:143], v[88:91], v[32:47]
ds_read_b128 v[88:91], v1 offset:12288
ds_write_b64 v3, v[254:255] offset:1152
v_rcp_f32 v48, v48
v_rcp_f32 v49, v49
v_rcp_f32_e64 v50, v50
v_mfma_f32_32x32x16_bf16 v[32:47], v[144:147], v[92:95], v[32:47]
ds_read_b128 v[92:95], v1 offset:12800
ds_read_b64_tr_b16 a[184:185], v4 offset:0
ds_read_b64_tr_b16 a[186:187], v4 offset:512
v_rcp_f32 v51, v51
v_rcp_f32 v52, v52
v_mfma_f32_32x32x16_bf16 v[32:47], v[148:151], v[96:99], v[32:47]
ds_read_b128 v[96:99], v1 offset:14336
ds_read_b64_tr_b16 a[188:189], v4 offset:1024
ds_read_b64_tr_b16 a[190:191], v4 offset:1536
v_rcp_f32 v53, v53
v_rcp_f32 v54, v54
v_mfma_f32_32x32x16_bf16 v[168:183], v[72:75], v[208:211], 0
v_rcp_f32 v55, v55
v_rcp_f32 v56, v56
v_rcp_f32 v57, v57
v_mfma_f32_32x32x16_bf16 v[168:183], v[76:79], v[212:215], v[168:183]
v_rcp_f32 v58, v58
v_rcp_f32 v59, v59
v_rcp_f32 v60, v60
v_rcp_f32 v61, v61
v_rcp_f32 v62, v62
v_rcp_f32_e64 v63, v63
v_pk_mul_f32 v[16:17], v[48:49], v[16:17]
v_pk_mul_f32 v[18:19], v[50:51], v[18:19]
v_pk_mul_f32 v[20:21], v[52:53], v[20:21]
v_pk_mul_f32 v[22:23], v[54:55], v[22:23]
v_pk_mul_f32 v[24:25], v[56:57], v[24:25]
v_pk_mul_f32 v[26:27], v[58:59], v[26:27]
v_pk_mul_f32 v[28:29], v[60:61], v[28:29]
v_pk_mul_f32 v[30:31], v[62:63], v[30:31]
v_pk_fma_f32 v[100:101], v[16:17], v[16:17], v[100:101]
v_pk_fma_f32 v[48:49], v[32:33], v[32:33], s[60:61] neg_lo:[1,0,0] neg_hi:[1,0,0]
v_pk_fma_f32 v[100:101], v[18:19], v[18:19], v[100:101]
v_pk_fma_f32 v[50:51], v[34:35], v[34:35], s[60:61] neg_lo:[1,0,0] neg_hi:[1,0,0]
v_pk_fma_f32 v[100:101], v[20:21], v[20:21], v[100:101]
v_pk_fma_f32 v[52:53], v[36:37], v[36:37], s[60:61] neg_lo:[1,0,0] neg_hi:[1,0,0]
v_pk_fma_f32 v[100:101], v[22:23], v[22:23], v[100:101]
v_pk_fma_f32 v[54:55], v[38:39], v[38:39], s[60:61] neg_lo:[1,0,0] neg_hi:[1,0,0]
v_pk_fma_f32 v[100:101], v[24:25], v[24:25], v[100:101]
v_pk_fma_f32 v[56:57], v[40:41], v[40:41], s[60:61] neg_lo:[1,0,0] neg_hi:[1,0,0]
v_pk_fma_f32 v[100:101], v[26:27], v[26:27], v[100:101]
v_pk_fma_f32 v[58:59], v[42:43], v[42:43], s[60:61] neg_lo:[1,0,0] neg_hi:[1,0,0]
v_pk_fma_f32 v[100:101], v[28:29], v[28:29], v[100:101]
v_pk_fma_f32 v[60:61], v[44:45], v[44:45], s[60:61] neg_lo:[1,0,0] neg_hi:[1,0,0]
v_pk_fma_f32 v[100:101], v[30:31], v[30:31], v[100:101]
v_pk_fma_f32 v[62:63], v[46:47], v[46:47], s[60:61] neg_lo:[1,0,0] neg_hi:[1,0,0]
v_pk_mul_f32 v[48:49], v[48:49], v[32:33]
v_pk_mul_f32 v[50:51], v[50:51], v[34:35]
v_pk_mul_f32 v[52:53], v[52:53], v[36:37]
v_pk_mul_f32 v[54:55], v[54:55], v[38:39]
v_pk_mul_f32 v[56:57], v[56:57], v[40:41]
v_pk_mul_f32 v[58:59], v[58:59], v[42:43]
v_pk_mul_f32 v[60:61], v[60:61], v[44:45]
v_pk_mul_f32 v[62:63], v[62:63], v[46:47]
v_cvt_pk_bf16_f32 v248, v16, v17
v_cvt_pk_bf16_f32 v249, v18, v19
v_cvt_pk_bf16_f32 v250, v20, v21
v_cvt_pk_bf16_f32 v251, v22, v23
v_cvt_pk_bf16_f32 v252, v24, v25
v_cvt_pk_bf16_f32 v253, v26, v27
v_cvt_pk_bf16_f32 v254, v28, v29
v_cvt_pk_bf16_f32 v255, v30, v31
s_waitcnt lgkmcnt(0)
v_mfma_f32_32x32x16_bf16 v[16:31], v[128:131], v[88:91], 0
ds_read_b128 v[88:91], v1 offset:14848
ds_write_b64 v3, v[248:249] offset:0
v_exp_f32 v48, v48
v_exp_f32 v49, v49
v_exp_f32 v50, v50
v_mfma_f32_32x32x16_bf16 v[16:31], v[132:135], v[92:95], v[16:31]
ds_read_b128 v[92:95], v1 offset:16384
ds_write_b64 v3, v[250:251] offset:128
v_exp_f32 v51, v51
v_exp_f32 v52, v52
v_mfma_f32_32x32x16_bf16 v[16:31], v[136:139], v[96:99], v[16:31]
ds_read_b128 v[96:99], v1 offset:16896
ds_write_b64 v3, v[252:253] offset:1024
v_exp_f32 v53, v53
v_exp_f32 v54, v54
v_exp_f32 v55, v55
v_mfma_f32_32x32x16_bf16 v[184:199], v[80:83], v[216:219], 0
v_exp_f32 v56, v56
v_exp_f32 v57, v57
v_exp_f32 v58, v58
v_mfma_f32_32x32x16_bf16 v[184:199], v[84:87], v[220:223], v[184:199]
v_exp_f32 v59, v59
v_exp_f32 v60, v60
v_exp_f32 v61, v61
v_exp_f32 v62, v62
v_exp_f32_e64 v63, v63
v_pk_add_f32 v[48:49], v[48:49], 1.0 op_sel_hi:[1,0]
v_pk_add_f32 v[50:51], v[50:51], 1.0 op_sel_hi:[1,0]
v_pk_add_f32 v[52:53], v[52:53], 1.0 op_sel_hi:[1,0]
v_pk_add_f32 v[54:55], v[54:55], 1.0 op_sel_hi:[1,0]
v_pk_add_f32 v[56:57], v[56:57], 1.0 op_sel_hi:[1,0]
v_pk_add_f32 v[58:59], v[58:59], 1.0 op_sel_hi:[1,0]
v_pk_add_f32 v[60:61], v[60:61], 1.0 op_sel_hi:[1,0]
v_pk_add_f32 v[62:63], v[62:63], 1.0 op_sel_hi:[1,0]
s_waitcnt lgkmcnt(0)
v_mfma_f32_32x32x16_bf16 v[16:31], v[140:143], v[88:91], v[16:31]
ds_read_b128 v[88:91], v1 offset:18432
ds_write_b64 v3, v[254:255] offset:1152
v_rcp_f32 v48, v48
v_rcp_f32 v49, v49
v_rcp_f32 v50, v50
v_mfma_f32_32x32x16_bf16 v[16:31], v[144:147], v[92:95], v[16:31]
ds_read_b128 v[92:95], v1 offset:18944
ds_read_b64_tr_b16 a[192:193], v4 offset:0
ds_read_b64_tr_b16 a[194:195], v4 offset:512
v_rcp_f32 v51, v51
v_rcp_f32 v52, v52
v_mfma_f32_32x32x16_bf16 v[16:31], v[148:151], v[96:99], v[16:31]
ds_read_b128 v[96:99], v1 offset:20480
ds_read_b64_tr_b16 a[196:197], v4 offset:1024
ds_read_b64_tr_b16 a[198:199], v4 offset:1536
v_rcp_f32 v53, v53
v_rcp_f32 v54, v54
v_rcp_f32 v55, v55
v_rcp_f32 v56, v56
v_rcp_f32 v57, v57
v_rcp_f32 v58, v58
v_rcp_f32 v59, v59
v_rcp_f32 v60, v60
v_rcp_f32 v61, v61
v_rcp_f32 v62, v62
v_rcp_f32_e64 v63, v63
v_pk_mul_f32 v[32:33], v[48:49], v[32:33]
v_pk_mul_f32 v[34:35], v[50:51], v[34:35]
v_pk_mul_f32 v[36:37], v[52:53], v[36:37]
v_pk_mul_f32 v[38:39], v[54:55], v[38:39]
v_pk_mul_f32 v[40:41], v[56:57], v[40:41]
v_pk_mul_f32 v[42:43], v[58:59], v[42:43]
v_pk_mul_f32 v[44:45], v[60:61], v[44:45]
v_pk_mul_f32 v[46:47], v[62:63], v[46:47]
v_pk_fma_f32 v[102:103], v[32:33], v[32:33], v[102:103]
v_pk_fma_f32 v[48:49], v[16:17], v[16:17], s[60:61] neg_lo:[1,0,0] neg_hi:[1,0,0]
v_pk_fma_f32 v[102:103], v[34:35], v[34:35], v[102:103]
v_pk_fma_f32 v[50:51], v[18:19], v[18:19], s[60:61] neg_lo:[1,0,0] neg_hi:[1,0,0]
v_pk_fma_f32 v[102:103], v[36:37], v[36:37], v[102:103]
v_pk_fma_f32 v[52:53], v[20:21], v[20:21], s[60:61] neg_lo:[1,0,0] neg_hi:[1,0,0]
v_pk_fma_f32 v[102:103], v[38:39], v[38:39], v[102:103]
v_pk_fma_f32 v[54:55], v[22:23], v[22:23], s[60:61] neg_lo:[1,0,0] neg_hi:[1,0,0]
v_pk_fma_f32 v[102:103], v[40:41], v[40:41], v[102:103]
v_pk_fma_f32 v[56:57], v[24:25], v[24:25], s[60:61] neg_lo:[1,0,0] neg_hi:[1,0,0]
v_pk_fma_f32 v[102:103], v[42:43], v[42:43], v[102:103]
v_pk_fma_f32 v[58:59], v[26:27], v[26:27], s[60:61] neg_lo:[1,0,0] neg_hi:[1,0,0]
v_pk_fma_f32 v[102:103], v[44:45], v[44:45], v[102:103]
v_pk_fma_f32 v[60:61], v[28:29], v[28:29], s[60:61] neg_lo:[1,0,0] neg_hi:[1,0,0]
v_pk_fma_f32 v[102:103], v[46:47], v[46:47], v[102:103]
v_pk_fma_f32 v[62:63], v[30:31], v[30:31], s[60:61] neg_lo:[1,0,0] neg_hi:[1,0,0]
v_pk_mul_f32 v[48:49], v[48:49], v[16:17]
v_pk_mul_f32 v[50:51], v[50:51], v[18:19]
v_pk_mul_f32 v[52:53], v[52:53], v[20:21]
v_pk_mul_f32 v[54:55], v[54:55], v[22:23]
v_pk_mul_f32 v[56:57], v[56:57], v[24:25]
v_pk_mul_f32 v[58:59], v[58:59], v[26:27]
v_pk_mul_f32 v[60:61], v[60:61], v[28:29]
v_pk_mul_f32 v[62:63], v[62:63], v[30:31]
v_pk_mul_f32 v[10:11], v[152:153], v[152:153]
v_pk_add_f32 v[8:9], v[152:153], v[154:155]
v_pk_fma_f32 v[10:11], v[154:155], v[154:155], v[10:11]
v_pk_add_f32 v[8:9], v[8:9], v[156:157]
v_pk_fma_f32 v[10:11], v[156:157], v[156:157], v[10:11]
v_pk_add_f32 v[8:9], v[8:9], v[158:159]
v_pk_fma_f32 v[10:11], v[158:159], v[158:159], v[10:11]
v_pk_add_f32 v[8:9], v[8:9], v[160:161]
v_pk_fma_f32 v[10:11], v[160:161], v[160:161], v[10:11]
v_pk_add_f32 v[8:9], v[8:9], v[162:163]
v_pk_fma_f32 v[10:11], v[162:163], v[162:163], v[10:11]
v_pk_add_f32 v[8:9], v[8:9], v[164:165]
v_pk_fma_f32 v[10:11], v[164:165], v[164:165], v[10:11]
v_pk_add_f32 v[8:9], v[8:9], v[166:167]
v_pk_fma_f32 v[10:11], v[166:167], v[166:167], v[10:11]
v_pk_add_f32 v[8:9], v[8:9], v[168:169]
v_pk_fma_f32 v[10:11], v[168:169], v[168:169], v[10:11]
v_pk_add_f32 v[8:9], v[8:9], v[170:171]
v_pk_fma_f32 v[10:11], v[170:171], v[170:171], v[10:11]
v_pk_add_f32 v[8:9], v[8:9], v[172:173]
v_pk_fma_f32 v[10:11], v[172:173], v[172:173], v[10:11]
v_pk_add_f32 v[8:9], v[8:9], v[174:175]
v_pk_fma_f32 v[10:11], v[174:175], v[174:175], v[10:11]
v_pk_add_f32 v[8:9], v[8:9], v[176:177]
v_pk_fma_f32 v[10:11], v[176:177], v[176:177], v[10:11]
v_pk_add_f32 v[8:9], v[8:9], v[178:179]
v_pk_fma_f32 v[10:11], v[178:179], v[178:179], v[10:11]
v_pk_add_f32 v[8:9], v[8:9], v[180:181]
v_pk_fma_f32 v[10:11], v[180:181], v[180:181], v[10:11]
v_pk_add_f32 v[8:9], v[8:9], v[182:183]
v_pk_fma_f32 v[10:11], v[182:183], v[182:183], v[10:11]
v_pk_add_f32 v[8:9], v[8:9], v[184:185]
v_pk_fma_f32 v[10:11], v[184:185], v[184:185], v[10:11]
v_pk_add_f32 v[8:9], v[8:9], v[186:187]
v_pk_fma_f32 v[10:11], v[186:187], v[186:187], v[10:11]
v_pk_add_f32 v[8:9], v[8:9], v[188:189]
v_pk_fma_f32 v[10:11], v[188:189], v[188:189], v[10:11]
v_pk_add_f32 v[8:9], v[8:9], v[190:191]
v_pk_fma_f32 v[10:11], v[190:191], v[190:191], v[10:11]
v_pk_add_f32 v[8:9], v[8:9], v[192:193]
v_pk_fma_f32 v[10:11], v[192:193], v[192:193], v[10:11]
v_pk_add_f32 v[8:9], v[8:9], v[194:195]
v_pk_fma_f32 v[10:11], v[194:195], v[194:195], v[10:11]
v_pk_add_f32 v[8:9], v[8:9], v[196:197]
v_pk_fma_f32 v[10:11], v[196:197], v[196:197], v[10:11]
v_pk_add_f32 v[8:9], v[8:9], v[198:199]
v_pk_fma_f32 v[10:11], v[198:199], v[198:199], v[10:11]
v_cvt_pk_bf16_f32 v248, v32, v33
v_cvt_pk_bf16_f32 v249, v34, v35
v_cvt_pk_bf16_f32 v250, v36, v37
v_cvt_pk_bf16_f32 v251, v38, v39
v_cvt_pk_bf16_f32 v252, v40, v41
v_cvt_pk_bf16_f32 v253, v42, v43
v_cvt_pk_bf16_f32 v254, v44, v45
v_cvt_pk_bf16_f32 v255, v46, v47
s_waitcnt lgkmcnt(0)
v_mfma_f32_32x32x16_bf16 v[32:47], v[128:131], v[88:91], 0
ds_read_b128 v[88:91], v1 offset:20992
ds_write_b64 v3, v[248:249] offset:0
v_exp_f32 v48, v48
v_exp_f32 v49, v49
v_add_f32 v8, v8, v9
v_mfma_f32_32x32x16_bf16 v[32:47], v[132:135], v[92:95], v[32:47]
ds_read_b128 v[92:95], v1 offset:22528
ds_write_b64 v3, v[250:251] offset:128
v_exp_f32 v50, v50
v_add_f32 v10, v10, v11
v_exp_f32_e64 v51, v51
v_mfma_f32_32x32x16_bf16 v[32:47], v[136:139], v[96:99], v[32:47]
ds_read_b128 v[96:99], v1 offset:23040
ds_write_b64 v3, v[252:253] offset:1024
v_permlane32_swap_b32 v8, v10
v_exp_f32 v52, v52
v_add_f32 v8, v8, v10
v_exp_f32 v53, v53
v_mov_b32 v10, v8
v_exp_f32 v54, v54
s_nop 0
v_permlane32_swap_b32 v8, v10
v_exp_f32 v55, v55
v_mul_f32 v13, 0x3c2aaaab, v8
v_exp_f32 v56, v56
v_exp_f32 v57, v57
v_mul_f32 v10, 0x3c2aaaab, v10
v_exp_f32 v58, v58
v_fma_f32 v10, -v13, v13, v10
v_exp_f32 v59, v59
v_max_f32 v10, 0, v10
v_exp_f32 v60, v60
v_add_f32 v10, 0x3727c5ac, v10
v_exp_f32 v61, v61
v_rsq_f32 v12, v10
v_exp_f32 v62, v62
v_mul_f32 v12, 0x3eeff558, v12
v_exp_f32 v63, v63
v_mul_f32_e64 v13, v13, v12
v_pk_add_f32 v[48:49], v[48:49], 1.0 op_sel_hi:[1,0]
v_pk_add_f32 v[50:51], v[50:51], 1.0 op_sel_hi:[1,0]
v_pk_add_f32 v[52:53], v[52:53], 1.0 op_sel_hi:[1,0]
v_pk_add_f32 v[54:55], v[54:55], 1.0 op_sel_hi:[1,0]
v_pk_add_f32 v[56:57], v[56:57], 1.0 op_sel_hi:[1,0]
v_pk_add_f32 v[58:59], v[58:59], 1.0 op_sel_hi:[1,0]
v_pk_add_f32 v[60:61], v[60:61], 1.0 op_sel_hi:[1,0]
v_pk_add_f32 v[62:63], v[62:63], 1.0 op_sel_hi:[1,0]
s_waitcnt lgkmcnt(0)
v_mfma_f32_32x32x16_bf16 v[32:47], v[140:143], v[88:91], v[32:47]
ds_read_b128 v[88:91], v1 offset:24576
ds_write_b64 v3, v[254:255] offset:1152
v_rcp_f32 v48, v48
v_rcp_f32 v49, v49
v_rcp_f32_e64 v50, v50
v_mfma_f32_32x32x16_bf16 v[32:47], v[144:147], v[92:95], v[32:47]
ds_read_b128 v[92:95], v1 offset:25088
ds_read_b64_tr_b16 a[200:201], v4 offset:0
ds_read_b64_tr_b16 a[202:203], v4 offset:512
v_rcp_f32 v51, v51
v_rcp_f32 v52, v52
v_mfma_f32_32x32x16_bf16 v[32:47], v[148:151], v[96:99], v[32:47]
ds_read_b128 v[96:99], v1 offset:26624
ds_read_b64_tr_b16 a[204:205], v4 offset:1024
ds_read_b64_tr_b16 a[206:207], v4 offset:1536
v_rcp_f32 v53, v53
v_rcp_f32 v54, v54
v_rcp_f32 v55, v55
v_rcp_f32 v56, v56
v_rcp_f32 v57, v57
v_rcp_f32 v58, v58
v_rcp_f32 v59, v59
v_rcp_f32 v60, v60
v_rcp_f32 v61, v61
v_rcp_f32 v62, v62
v_rcp_f32_e64 v63, v63
v_pk_mul_f32 v[16:17], v[48:49], v[16:17]
v_pk_mul_f32 v[18:19], v[50:51], v[18:19]
v_pk_mul_f32 v[20:21], v[52:53], v[20:21]
v_pk_mul_f32 v[22:23], v[54:55], v[22:23]
v_pk_mul_f32 v[24:25], v[56:57], v[24:25]
v_pk_mul_f32 v[26:27], v[58:59], v[26:27]
v_pk_mul_f32 v[28:29], v[60:61], v[28:29]
v_pk_mul_f32 v[30:31], v[62:63], v[30:31]
v_pk_fma_f32 v[104:105], v[16:17], v[16:17], v[104:105]
v_pk_fma_f32 v[48:49], v[32:33], v[32:33], s[60:61] neg_lo:[1,0,0] neg_hi:[1,0,0]
v_pk_fma_f32 v[104:105], v[18:19], v[18:19], v[104:105]
v_pk_fma_f32 v[50:51], v[34:35], v[34:35], s[60:61] neg_lo:[1,0,0] neg_hi:[1,0,0]
v_pk_fma_f32 v[104:105], v[20:21], v[20:21], v[104:105]
v_pk_fma_f32 v[52:53], v[36:37], v[36:37], s[60:61] neg_lo:[1,0,0] neg_hi:[1,0,0]
v_pk_fma_f32 v[104:105], v[22:23], v[22:23], v[104:105]
v_pk_fma_f32 v[54:55], v[38:39], v[38:39], s[60:61] neg_lo:[1,0,0] neg_hi:[1,0,0]
v_pk_fma_f32 v[104:105], v[24:25], v[24:25], v[104:105]
v_pk_fma_f32 v[56:57], v[40:41], v[40:41], s[60:61] neg_lo:[1,0,0] neg_hi:[1,0,0]
v_pk_fma_f32 v[104:105], v[26:27], v[26:27], v[104:105]
v_pk_fma_f32 v[58:59], v[42:43], v[42:43], s[60:61] neg_lo:[1,0,0] neg_hi:[1,0,0]
v_pk_fma_f32 v[104:105], v[28:29], v[28:29], v[104:105]
v_pk_fma_f32 v[60:61], v[44:45], v[44:45], s[60:61] neg_lo:[1,0,0] neg_hi:[1,0,0]
v_pk_fma_f32 v[104:105], v[30:31], v[30:31], v[104:105]
v_pk_fma_f32 v[62:63], v[46:47], v[46:47], s[60:61] neg_lo:[1,0,0] neg_hi:[1,0,0]
v_pk_mul_f32 v[48:49], v[48:49], v[32:33]
v_pk_mul_f32 v[50:51], v[50:51], v[34:35]
v_pk_mul_f32 v[52:53], v[52:53], v[36:37]
v_pk_mul_f32 v[54:55], v[54:55], v[38:39]
v_pk_mul_f32 v[56:57], v[56:57], v[40:41]
v_pk_mul_f32 v[58:59], v[58:59], v[42:43]
v_pk_mul_f32 v[60:61], v[60:61], v[44:45]
v_pk_mul_f32 v[62:63], v[62:63], v[46:47]
v_pk_fma_f32 v[152:153], v[152:153], v[12:13], v[12:13] op_sel:[0,0,1] op_sel_hi:[1,0,1] neg_lo:[0,0,1] neg_hi:[0,0,1]
v_pk_fma_f32 v[154:155], v[154:155], v[12:13], v[12:13] op_sel:[0,0,1] op_sel_hi:[1,0,1] neg_lo:[0,0,1] neg_hi:[0,0,1]
v_pk_fma_f32 v[156:157], v[156:157], v[12:13], v[12:13] op_sel:[0,0,1] op_sel_hi:[1,0,1] neg_lo:[0,0,1] neg_hi:[0,0,1]
v_pk_fma_f32 v[158:159], v[158:159], v[12:13], v[12:13] op_sel:[0,0,1] op_sel_hi:[1,0,1] neg_lo:[0,0,1] neg_hi:[0,0,1]
v_pk_fma_f32 v[160:161], v[160:161], v[12:13], v[12:13] op_sel:[0,0,1] op_sel_hi:[1,0,1] neg_lo:[0,0,1] neg_hi:[0,0,1]
v_pk_fma_f32 v[162:163], v[162:163], v[12:13], v[12:13] op_sel:[0,0,1] op_sel_hi:[1,0,1] neg_lo:[0,0,1] neg_hi:[0,0,1]
v_pk_fma_f32 v[164:165], v[164:165], v[12:13], v[12:13] op_sel:[0,0,1] op_sel_hi:[1,0,1] neg_lo:[0,0,1] neg_hi:[0,0,1]
v_pk_fma_f32 v[166:167], v[166:167], v[12:13], v[12:13] op_sel:[0,0,1] op_sel_hi:[1,0,1] neg_lo:[0,0,1] neg_hi:[0,0,1]
v_pk_fma_f32 v[168:169], v[168:169], v[12:13], v[12:13] op_sel:[0,0,1] op_sel_hi:[1,0,1] neg_lo:[0,0,1] neg_hi:[0,0,1]
v_pk_fma_f32 v[170:171], v[170:171], v[12:13], v[12:13] op_sel:[0,0,1] op_sel_hi:[1,0,1] neg_lo:[0,0,1] neg_hi:[0,0,1]
v_pk_fma_f32 v[172:173], v[172:173], v[12:13], v[12:13] op_sel:[0,0,1] op_sel_hi:[1,0,1] neg_lo:[0,0,1] neg_hi:[0,0,1]
v_pk_fma_f32 v[174:175], v[174:175], v[12:13], v[12:13] op_sel:[0,0,1] op_sel_hi:[1,0,1] neg_lo:[0,0,1] neg_hi:[0,0,1]
v_pk_fma_f32 v[176:177], v[176:177], v[12:13], v[12:13] op_sel:[0,0,1] op_sel_hi:[1,0,1] neg_lo:[0,0,1] neg_hi:[0,0,1]
v_pk_fma_f32 v[178:179], v[178:179], v[12:13], v[12:13] op_sel:[0,0,1] op_sel_hi:[1,0,1] neg_lo:[0,0,1] neg_hi:[0,0,1]
v_pk_fma_f32 v[180:181], v[180:181], v[12:13], v[12:13] op_sel:[0,0,1] op_sel_hi:[1,0,1] neg_lo:[0,0,1] neg_hi:[0,0,1]
v_pk_fma_f32 v[182:183], v[182:183], v[12:13], v[12:13] op_sel:[0,0,1] op_sel_hi:[1,0,1] neg_lo:[0,0,1] neg_hi:[0,0,1]
v_pk_fma_f32 v[184:185], v[184:185], v[12:13], v[12:13] op_sel:[0,0,1] op_sel_hi:[1,0,1] neg_lo:[0,0,1] neg_hi:[0,0,1]
v_pk_fma_f32 v[186:187], v[186:187], v[12:13], v[12:13] op_sel:[0,0,1] op_sel_hi:[1,0,1] neg_lo:[0,0,1] neg_hi:[0,0,1]
v_pk_fma_f32 v[188:189], v[188:189], v[12:13], v[12:13] op_sel:[0,0,1] op_sel_hi:[1,0,1] neg_lo:[0,0,1] neg_hi:[0,0,1]
v_pk_fma_f32 v[190:191], v[190:191], v[12:13], v[12:13] op_sel:[0,0,1] op_sel_hi:[1,0,1] neg_lo:[0,0,1] neg_hi:[0,0,1]
v_pk_fma_f32 v[192:193], v[192:193], v[12:13], v[12:13] op_sel:[0,0,1] op_sel_hi:[1,0,1] neg_lo:[0,0,1] neg_hi:[0,0,1]
v_pk_fma_f32 v[194:195], v[194:195], v[12:13], v[12:13] op_sel:[0,0,1] op_sel_hi:[1,0,1] neg_lo:[0,0,1] neg_hi:[0,0,1]
v_pk_fma_f32 v[196:197], v[196:197], v[12:13], v[12:13] op_sel:[0,0,1] op_sel_hi:[1,0,1] neg_lo:[0,0,1] neg_hi:[0,0,1]
v_pk_fma_f32 v[198:199], v[198:199], v[12:13], v[12:13] op_sel:[0,0,1] op_sel_hi:[1,0,1] neg_lo:[0,0,1] neg_hi:[0,0,1]
v_cvt_pk_bf16_f32 v248, v16, v17
v_cvt_pk_bf16_f32 v249, v18, v19
v_cvt_pk_bf16_f32 v250, v20, v21
v_cvt_pk_bf16_f32 v251, v22, v23
v_cvt_pk_bf16_f32 v252, v24, v25
v_cvt_pk_bf16_f32 v253, v26, v27
v_cvt_pk_bf16_f32 v254, v28, v29
v_cvt_pk_bf16_f32 v255, v30, v31
s_waitcnt lgkmcnt(0)
v_mfma_f32_32x32x16_bf16 v[16:31], v[128:131], v[88:91], 0
ds_read_b128 v[88:91], v1 offset:27136
ds_write_b64 v3, v[248:249] offset:0
v_exp_f32 v48, v48
v_exp_f32_e64 v49, v49
v_cvt_pk_bf16_f32 v64, v152, v153
v_mfma_f32_32x32x16_bf16 v[16:31], v[132:135], v[92:95], v[16:31]
ds_read_b128 v[92:95], v1 offset:28672
ds_write_b64 v3, v[250:251] offset:128
v_exp_f32 v50, v50
v_cvt_pk_bf16_f32 v65, v154, v155
v_exp_f32 v51, v51
v_mfma_f32_32x32x16_bf16 v[16:31], v[136:139], v[96:99], v[16:31]
ds_read_b128 v[96:99], v1 offset:29184
ds_write_b64 v3, v[252:253] offset:1024
v_cvt_pk_bf16_f32 v66, v156, v157
v_exp_f32 v52, v52
v_exp_f32 v53, v53
v_cvt_pk_bf16_f32 v67, v158, v159
v_exp_f32 v54, v54
v_cvt_pk_bf16_f32 v68, v160, v161
v_exp_f32 v55, v55
v_cvt_pk_bf16_f32 v69, v162, v163
v_exp_f32 v56, v56
v_exp_f32 v57, v57
v_cvt_pk_bf16_f32 v70, v164, v165
v_exp_f32 v58, v58
v_cvt_pk_bf16_f32 v71, v166, v167
v_exp_f32 v59, v59
v_cvt_pk_bf16_f32 v72, v168, v169
v_exp_f32 v60, v60
v_exp_f32 v61, v61
v_cvt_pk_bf16_f32 v73, v170, v171
v_exp_f32 v62, v62
v_cvt_pk_bf16_f32 v74, v172, v173
v_exp_f32_e64 v63, v63
v_cvt_pk_bf16_f32 v75, v174, v175
v_pk_add_f32 v[48:49], v[48:49], 1.0 op_sel_hi:[1,0]
v_pk_add_f32 v[50:51], v[50:51], 1.0 op_sel_hi:[1,0]
v_pk_add_f32 v[52:53], v[52:53], 1.0 op_sel_hi:[1,0]
v_pk_add_f32 v[54:55], v[54:55], 1.0 op_sel_hi:[1,0]
v_pk_add_f32 v[56:57], v[56:57], 1.0 op_sel_hi:[1,0]
v_pk_add_f32 v[58:59], v[58:59], 1.0 op_sel_hi:[1,0]
v_pk_add_f32 v[60:61], v[60:61], 1.0 op_sel_hi:[1,0]
v_pk_add_f32 v[62:63], v[62:63], 1.0 op_sel_hi:[1,0]
s_waitcnt lgkmcnt(0)
v_mfma_f32_32x32x16_bf16 v[16:31], v[140:143], v[88:91], v[16:31]
ds_read_b128 v[88:91], v1 offset:30720
ds_write_b64 v3, v[254:255] offset:1152
v_rcp_f32 v48, v48
v_rcp_f32 v49, v49
v_cvt_pk_bf16_f32 v76, v176, v177
v_mfma_f32_32x32x16_bf16 v[16:31], v[144:147], v[92:95], v[16:31]
ds_read_b128 v[92:95], v1 offset:31232
ds_read_b64_tr_b16 a[208:209], v4 offset:0
ds_read_b64_tr_b16 a[210:211], v4 offset:512
v_rcp_f32 v50, v50
v_cvt_pk_bf16_f32 v77, v178, v179
v_rcp_f32 v51, v51
v_mfma_f32_32x32x16_bf16 v[16:31], v[148:151], v[96:99], v[16:31]
ds_read_b128 v[96:99], v1 offset:32768
ds_read_b64_tr_b16 a[212:213], v4 offset:1024
ds_read_b64_tr_b16 a[214:215], v4 offset:1536
v_cvt_pk_bf16_f32 v78, v180, v181
v_rcp_f32 v52, v52
v_rcp_f32 v53, v53
v_cvt_pk_bf16_f32 v79, v182, v183
v_rcp_f32 v54, v54
v_cvt_pk_bf16_f32 v80, v184, v185
v_rcp_f32 v55, v55
v_cvt_pk_bf16_f32 v81, v186, v187
v_rcp_f32 v56, v56
v_rcp_f32 v57, v57
v_cvt_pk_bf16_f32 v82, v188, v189
v_rcp_f32 v58, v58
v_cvt_pk_bf16_f32 v83, v190, v191
v_rcp_f32 v59, v59
v_cvt_pk_bf16_f32 v84, v192, v193
v_rcp_f32 v60, v60
v_rcp_f32 v61, v61
v_cvt_pk_bf16_f32 v85, v194, v195
v_rcp_f32 v62, v62
v_cvt_pk_bf16_f32 v86, v196, v197
v_rcp_f32 v63, v63
v_cvt_pk_bf16_f32 v87, v198, v199
v_pk_mul_f32 v[32:33], v[48:49], v[32:33]
v_pk_mul_f32 v[34:35], v[50:51], v[34:35]
v_pk_mul_f32 v[36:37], v[52:53], v[36:37]
v_pk_mul_f32 v[38:39], v[54:55], v[38:39]
v_pk_mul_f32 v[40:41], v[56:57], v[40:41]
v_pk_mul_f32 v[42:43], v[58:59], v[42:43]
v_pk_mul_f32 v[44:45], v[60:61], v[44:45]
v_pk_mul_f32 v[46:47], v[62:63], v[46:47]
v_pk_fma_f32 v[106:107], v[32:33], v[32:33], v[106:107]
v_pk_fma_f32 v[48:49], v[16:17], v[16:17], s[60:61] neg_lo:[1,0,0] neg_hi:[1,0,0]
v_pk_fma_f32 v[106:107], v[34:35], v[34:35], v[106:107]
v_pk_fma_f32 v[50:51], v[18:19], v[18:19], s[60:61] neg_lo:[1,0,0] neg_hi:[1,0,0]
v_pk_fma_f32 v[106:107], v[36:37], v[36:37], v[106:107]
v_pk_fma_f32 v[52:53], v[20:21], v[20:21], s[60:61] neg_lo:[1,0,0] neg_hi:[1,0,0]
v_pk_fma_f32 v[106:107], v[38:39], v[38:39], v[106:107]
v_pk_fma_f32 v[54:55], v[22:23], v[22:23], s[60:61] neg_lo:[1,0,0] neg_hi:[1,0,0]
v_pk_fma_f32 v[106:107], v[40:41], v[40:41], v[106:107]
v_pk_fma_f32 v[56:57], v[24:25], v[24:25], s[60:61] neg_lo:[1,0,0] neg_hi:[1,0,0]
v_pk_fma_f32 v[106:107], v[42:43], v[42:43], v[106:107]
v_pk_fma_f32 v[58:59], v[26:27], v[26:27], s[60:61] neg_lo:[1,0,0] neg_hi:[1,0,0]
v_pk_fma_f32 v[106:107], v[44:45], v[44:45], v[106:107]
v_pk_fma_f32 v[60:61], v[28:29], v[28:29], s[60:61] neg_lo:[1,0,0] neg_hi:[1,0,0]
v_pk_fma_f32 v[106:107], v[46:47], v[46:47], v[106:107]
v_pk_fma_f32 v[62:63], v[30:31], v[30:31], s[60:61] neg_lo:[1,0,0] neg_hi:[1,0,0]
v_pk_mul_f32 v[48:49], v[48:49], v[16:17]
v_pk_mul_f32 v[50:51], v[50:51], v[18:19]
v_pk_mul_f32 v[52:53], v[52:53], v[20:21]
v_pk_mul_f32 v[54:55], v[54:55], v[22:23]
v_pk_mul_f32 v[56:57], v[56:57], v[24:25]
v_pk_mul_f32 v[58:59], v[58:59], v[26:27]
v_pk_mul_f32 v[60:61], v[60:61], v[28:29]
v_pk_mul_f32 v[62:63], v[62:63], v[30:31]
v_cvt_pk_bf16_f32 v248, v32, v33
v_cvt_pk_bf16_f32 v249, v34, v35
v_cvt_pk_bf16_f32 v250, v36, v37
v_cvt_pk_bf16_f32 v251, v38, v39
v_cvt_pk_bf16_f32 v252, v40, v41
v_cvt_pk_bf16_f32 v253, v42, v43
v_cvt_pk_bf16_f32 v254, v44, v45
v_cvt_pk_bf16_f32 v255, v46, v47
s_waitcnt lgkmcnt(0)
v_mfma_f32_32x32x16_bf16 v[32:47], v[128:131], v[88:91], 0
ds_read_b128 v[88:91], v1 offset:33280
ds_write_b64 v3, v[248:249] offset:0
v_exp_f32 v48, v48
v_exp_f32 v49, v49
v_exp_f32 v50, v50
v_mfma_f32_32x32x16_bf16 v[32:47], v[132:135], v[92:95], v[32:47]
ds_read_b128 v[92:95], v1 offset:34816
ds_write_b64 v3, v[250:251] offset:128
v_exp_f32 v51, v51
v_exp_f32 v52, v52
v_mfma_f32_32x32x16_bf16 v[32:47], v[136:139], v[96:99], v[32:47]
ds_read_b128 v[96:99], v1 offset:35328
ds_write_b64 v3, v[252:253] offset:1024
v_exp_f32 v53, v53
v_exp_f32 v54, v54
v_exp_f32 v55, v55
v_exp_f32 v56, v56
v_exp_f32 v57, v57
v_exp_f32 v58, v58
v_exp_f32 v59, v59
v_exp_f32 v60, v60
v_exp_f32 v61, v61
v_exp_f32 v62, v62
v_exp_f32_e64 v63, v63
v_pk_add_f32 v[48:49], v[48:49], 1.0 op_sel_hi:[1,0]
v_pk_add_f32 v[50:51], v[50:51], 1.0 op_sel_hi:[1,0]
v_pk_add_f32 v[52:53], v[52:53], 1.0 op_sel_hi:[1,0]
v_pk_add_f32 v[54:55], v[54:55], 1.0 op_sel_hi:[1,0]
v_pk_add_f32 v[56:57], v[56:57], 1.0 op_sel_hi:[1,0]
v_pk_add_f32 v[58:59], v[58:59], 1.0 op_sel_hi:[1,0]
v_pk_add_f32 v[60:61], v[60:61], 1.0 op_sel_hi:[1,0]
v_pk_add_f32 v[62:63], v[62:63], 1.0 op_sel_hi:[1,0]
s_waitcnt lgkmcnt(0)
v_mfma_f32_32x32x16_bf16 v[32:47], v[140:143], v[88:91], v[32:47]
ds_read_b128 v[88:91], v1 offset:36864
ds_write_b64 v3, v[254:255] offset:1152
v_rcp_f32 v48, v48
v_rcp_f32 v49, v49
v_rcp_f32 v50, v50
v_mfma_f32_32x32x16_bf16 v[32:47], v[144:147], v[92:95], v[32:47]
ds_read_b128 v[92:95], v1 offset:37376
ds_read_b64_tr_b16 a[216:217], v4 offset:0
ds_read_b64_tr_b16 a[218:219], v4 offset:512
v_rcp_f32 v51, v51
v_rcp_f32 v52, v52
v_mfma_f32_32x32x16_bf16 v[32:47], v[148:151], v[96:99], v[32:47]
ds_read_b128 v[96:99], v1 offset:38912
ds_read_b64_tr_b16 a[220:221], v4 offset:1024
ds_read_b64_tr_b16 a[222:223], v4 offset:1536
v_rcp_f32 v53, v53
v_rcp_f32 v54, v54
v_rcp_f32 v55, v55
v_rcp_f32 v56, v56
v_rcp_f32 v57, v57
v_rcp_f32 v58, v58
v_rcp_f32 v59, v59
v_rcp_f32 v60, v60
v_rcp_f32 v61, v61
v_rcp_f32 v62, v62
v_rcp_f32_e64 v63, v63
v_pk_mul_f32 v[16:17], v[48:49], v[16:17]
v_pk_mul_f32 v[18:19], v[50:51], v[18:19]
v_pk_mul_f32 v[20:21], v[52:53], v[20:21]
v_pk_mul_f32 v[22:23], v[54:55], v[22:23]
v_pk_mul_f32 v[24:25], v[56:57], v[24:25]
v_pk_mul_f32 v[26:27], v[58:59], v[26:27]
v_pk_mul_f32 v[28:29], v[60:61], v[28:29]
v_pk_mul_f32 v[30:31], v[62:63], v[30:31]
v_pk_fma_f32 v[108:109], v[16:17], v[16:17], v[108:109]
v_pk_fma_f32 v[48:49], v[32:33], v[32:33], s[60:61] neg_lo:[1,0,0] neg_hi:[1,0,0]
v_pk_fma_f32 v[108:109], v[18:19], v[18:19], v[108:109]
v_pk_fma_f32 v[50:51], v[34:35], v[34:35], s[60:61] neg_lo:[1,0,0] neg_hi:[1,0,0]
v_pk_fma_f32 v[108:109], v[20:21], v[20:21], v[108:109]
v_pk_fma_f32 v[52:53], v[36:37], v[36:37], s[60:61] neg_lo:[1,0,0] neg_hi:[1,0,0]
v_pk_fma_f32 v[108:109], v[22:23], v[22:23], v[108:109]
v_pk_fma_f32 v[54:55], v[38:39], v[38:39], s[60:61] neg_lo:[1,0,0] neg_hi:[1,0,0]
v_pk_fma_f32 v[108:109], v[24:25], v[24:25], v[108:109]
v_pk_fma_f32 v[56:57], v[40:41], v[40:41], s[60:61] neg_lo:[1,0,0] neg_hi:[1,0,0]
v_pk_fma_f32 v[108:109], v[26:27], v[26:27], v[108:109]
v_pk_fma_f32 v[58:59], v[42:43], v[42:43], s[60:61] neg_lo:[1,0,0] neg_hi:[1,0,0]
v_pk_fma_f32 v[108:109], v[28:29], v[28:29], v[108:109]
v_pk_fma_f32 v[60:61], v[44:45], v[44:45], s[60:61] neg_lo:[1,0,0] neg_hi:[1,0,0]
v_pk_fma_f32 v[108:109], v[30:31], v[30:31], v[108:109]
v_pk_fma_f32 v[62:63], v[46:47], v[46:47], s[60:61] neg_lo:[1,0,0] neg_hi:[1,0,0]
v_pk_mul_f32 v[48:49], v[48:49], v[32:33]
v_pk_mul_f32 v[50:51], v[50:51], v[34:35]
v_pk_mul_f32 v[52:53], v[52:53], v[36:37]
v_pk_mul_f32 v[54:55], v[54:55], v[38:39]
v_pk_mul_f32 v[56:57], v[56:57], v[40:41]
v_pk_mul_f32 v[58:59], v[58:59], v[42:43]
v_pk_mul_f32 v[60:61], v[60:61], v[44:45]
v_pk_mul_f32 v[62:63], v[62:63], v[46:47]
v_cvt_pk_bf16_f32 v248, v16, v17
v_cvt_pk_bf16_f32 v249, v18, v19
v_cvt_pk_bf16_f32 v250, v20, v21
v_cvt_pk_bf16_f32 v251, v22, v23
v_cvt_pk_bf16_f32 v252, v24, v25
v_cvt_pk_bf16_f32 v253, v26, v27
v_cvt_pk_bf16_f32 v254, v28, v29
v_cvt_pk_bf16_f32 v255, v30, v31
s_waitcnt lgkmcnt(0)
v_mfma_f32_32x32x16_bf16 v[16:31], v[128:131], v[88:91], 0
ds_read_b128 v[88:91], v1 offset:39424
ds_write_b64 v3, v[248:249] offset:0
v_exp_f32 v48, v48
v_exp_f32 v49, v49
v_exp_f32 v50, v50
v_mfma_f32_32x32x16_bf16 v[16:31], v[132:135], v[92:95], v[16:31]
ds_read_b128 v[92:95], v1 offset:40960
ds_write_b64 v3, v[250:251] offset:128
v_exp_f32 v51, v51
v_exp_f32 v52, v52
v_mfma_f32_32x32x16_bf16 v[16:31], v[136:139], v[96:99], v[16:31]
ds_read_b128 v[96:99], v1 offset:41472
ds_write_b64 v3, v[252:253] offset:1024
v_exp_f32 v53, v53
v_exp_f32 v54, v54
v_exp_f32 v55, v55
v_exp_f32 v56, v56
v_exp_f32 v57, v57
v_exp_f32 v58, v58
v_exp_f32 v59, v59
v_exp_f32 v60, v60
v_exp_f32 v61, v61
v_exp_f32 v62, v62
v_exp_f32_e64 v63, v63
v_pk_add_f32 v[48:49], v[48:49], 1.0 op_sel_hi:[1,0]
v_pk_add_f32 v[50:51], v[50:51], 1.0 op_sel_hi:[1,0]
v_pk_add_f32 v[52:53], v[52:53], 1.0 op_sel_hi:[1,0]
v_pk_add_f32 v[54:55], v[54:55], 1.0 op_sel_hi:[1,0]
v_pk_add_f32 v[56:57], v[56:57], 1.0 op_sel_hi:[1,0]
v_pk_add_f32 v[58:59], v[58:59], 1.0 op_sel_hi:[1,0]
v_pk_add_f32 v[60:61], v[60:61], 1.0 op_sel_hi:[1,0]
v_pk_add_f32 v[62:63], v[62:63], 1.0 op_sel_hi:[1,0]
s_waitcnt lgkmcnt(0)
v_mfma_f32_32x32x16_bf16 v[16:31], v[140:143], v[88:91], v[16:31]
ds_read_b128 v[88:91], v1 offset:43008
ds_write_b64 v3, v[254:255] offset:1152
v_rcp_f32 v48, v48
v_rcp_f32 v49, v49
v_rcp_f32 v50, v50
v_mfma_f32_32x32x16_bf16 v[16:31], v[144:147], v[92:95], v[16:31]
ds_read_b128 v[92:95], v1 offset:43520
ds_read_b64_tr_b16 a[224:225], v4 offset:0
ds_read_b64_tr_b16 a[226:227], v4 offset:512
v_rcp_f32 v51, v51
v_rcp_f32 v52, v52
v_mfma_f32_32x32x16_bf16 v[16:31], v[148:151], v[96:99], v[16:31]
ds_read_b128 v[96:99], v1 offset:45056
ds_read_b64_tr_b16 a[228:229], v4 offset:1024
ds_read_b64_tr_b16 a[230:231], v4 offset:1536
v_rcp_f32 v53, v53
v_rcp_f32 v54, v54
v_rcp_f32 v55, v55
v_rcp_f32 v56, v56
v_rcp_f32 v57, v57
v_rcp_f32 v58, v58
v_rcp_f32 v59, v59
v_rcp_f32 v60, v60
v_rcp_f32 v61, v61
v_rcp_f32 v62, v62
v_rcp_f32_e64 v63, v63
v_pk_mul_f32 v[32:33], v[48:49], v[32:33]
v_pk_mul_f32 v[34:35], v[50:51], v[34:35]
v_pk_mul_f32 v[36:37], v[52:53], v[36:37]
v_pk_mul_f32 v[38:39], v[54:55], v[38:39]
v_pk_mul_f32 v[40:41], v[56:57], v[40:41]
v_pk_mul_f32 v[42:43], v[58:59], v[42:43]
v_pk_mul_f32 v[44:45], v[60:61], v[44:45]
v_pk_mul_f32 v[46:47], v[62:63], v[46:47]
v_pk_fma_f32 v[110:111], v[32:33], v[32:33], v[110:111]
v_pk_fma_f32 v[48:49], v[16:17], v[16:17], s[60:61] neg_lo:[1,0,0] neg_hi:[1,0,0]
v_pk_fma_f32 v[110:111], v[34:35], v[34:35], v[110:111]
v_pk_fma_f32 v[50:51], v[18:19], v[18:19], s[60:61] neg_lo:[1,0,0] neg_hi:[1,0,0]
v_pk_fma_f32 v[110:111], v[36:37], v[36:37], v[110:111]
v_pk_fma_f32 v[52:53], v[20:21], v[20:21], s[60:61] neg_lo:[1,0,0] neg_hi:[1,0,0]
v_pk_fma_f32 v[110:111], v[38:39], v[38:39], v[110:111]
v_pk_fma_f32 v[54:55], v[22:23], v[22:23], s[60:61] neg_lo:[1,0,0] neg_hi:[1,0,0]
v_pk_fma_f32 v[110:111], v[40:41], v[40:41], v[110:111]
v_pk_fma_f32 v[56:57], v[24:25], v[24:25], s[60:61] neg_lo:[1,0,0] neg_hi:[1,0,0]
v_pk_fma_f32 v[110:111], v[42:43], v[42:43], v[110:111]
v_pk_fma_f32 v[58:59], v[26:27], v[26:27], s[60:61] neg_lo:[1,0,0] neg_hi:[1,0,0]
v_pk_fma_f32 v[110:111], v[44:45], v[44:45], v[110:111]
v_pk_fma_f32 v[60:61], v[28:29], v[28:29], s[60:61] neg_lo:[1,0,0] neg_hi:[1,0,0]
v_pk_fma_f32 v[110:111], v[46:47], v[46:47], v[110:111]
v_pk_fma_f32 v[62:63], v[30:31], v[30:31], s[60:61] neg_lo:[1,0,0] neg_hi:[1,0,0]
v_pk_mul_f32 v[48:49], v[48:49], v[16:17]
v_pk_mul_f32 v[50:51], v[50:51], v[18:19]
v_pk_mul_f32 v[52:53], v[52:53], v[20:21]
v_pk_mul_f32 v[54:55], v[54:55], v[22:23]
v_pk_mul_f32 v[56:57], v[56:57], v[24:25]
v_pk_mul_f32 v[58:59], v[58:59], v[26:27]
v_pk_mul_f32 v[60:61], v[60:61], v[28:29]
v_pk_mul_f32 v[62:63], v[62:63], v[30:31]
v_cvt_pk_bf16_f32 v248, v32, v33
v_cvt_pk_bf16_f32 v249, v34, v35
v_cvt_pk_bf16_f32 v250, v36, v37
v_cvt_pk_bf16_f32 v251, v38, v39
v_cvt_pk_bf16_f32 v252, v40, v41
v_cvt_pk_bf16_f32 v253, v42, v43
v_cvt_pk_bf16_f32 v254, v44, v45
v_cvt_pk_bf16_f32 v255, v46, v47
s_waitcnt lgkmcnt(0)
v_mfma_f32_32x32x16_bf16 v[32:47], v[128:131], v[88:91], 0
ds_read_b128 v[88:91], v1 offset:45568
ds_write_b64 v3, v[248:249] offset:0
v_exp_f32 v48, v48
v_exp_f32 v49, v49
v_exp_f32 v50, v50
v_mfma_f32_32x32x16_bf16 v[32:47], v[132:135], v[92:95], v[32:47]
ds_read_b128 v[92:95], v1 offset:47104
ds_write_b64 v3, v[250:251] offset:128
s_add_u32 s74, s87, L_b1_7-L_pc
v_exp_f32 v51, v51
v_exp_f32 v52, v52
v_mfma_f32_32x32x16_bf16 v[32:47], v[136:139], v[96:99], v[32:47]
ds_read_b128 v[96:99], v1 offset:47616
ds_write_b64 v3, v[252:253] offset:1024
v_exp_f32 v53, v53
v_lshl_add_u32 v14, v0, 3, s74
v_exp_f32 v54, v54
v_exp_f32 v55, v55
v_min_u32 v14, L_pf1-L_pc-4, v14
v_exp_f32 v56, v56
v_exp_f32 v57, v57
v_exp_f32 v58, v58
v_mov_b32 v15, s89
v_exp_f32 v59, v59
v_exp_f32 v60, v60
v_exp_f32 v61, v61
v_add_co_u32 v14, vcc, s88, v14
v_exp_f32 v62, v62
v_exp_f32 v63, v63
v_addc_co_u32_e64 v15, vcc, 0, v15, vcc
v_pk_add_f32 v[48:49], v[48:49], 1.0 op_sel_hi:[1,0]
v_pk_add_f32 v[50:51], v[50:51], 1.0 op_sel_hi:[1,0]
v_pk_add_f32 v[52:53], v[52:53], 1.0 op_sel_hi:[1,0]
v_pk_add_f32 v[54:55], v[54:55], 1.0 op_sel_hi:[1,0]
v_pk_add_f32 v[56:57], v[56:57], 1.0 op_sel_hi:[1,0]
v_pk_add_f32 v[58:59], v[58:59], 1.0 op_sel_hi:[1,0]
v_pk_add_f32 v[60:61], v[60:61], 1.0 op_sel_hi:[1,0]
v_pk_add_f32 v[62:63], v[62:63], 1.0 op_sel_hi:[1,0]
s_waitcnt lgkmcnt(0)
v_mfma_f32_32x32x16_bf16 v[32:47], v[140:143], v[88:91], v[32:47]
ds_read_b128 v[88:91], v1 offset:49152
ds_write_b64 v3, v[254:255] offset:1152
v_rcp_f32 v48, v48
v_rcp_f32 v49, v49
v_rcp_f32_e64 v50, v50
v_mfma_f32_32x32x16_bf16 v[32:47], v[144:147], v[92:95], v[32:47]
ds_read_b128 v[92:95], v1 offset:49664
ds_read_b64_tr_b16 a[232:233], v4 offset:0
ds_read_b64_tr_b16 a[234:235], v4 offset:512
v_rcp_f32 v51, v51
v_rcp_f32 v52, v52
v_mfma_f32_32x32x16_bf16 v[32:47], v[148:151], v[96:99], v[32:47]
ds_read_b128 v[96:99], v1 offset:51200
ds_read_b64_tr_b16 a[236:237], v4 offset:1024
ds_read_b64_tr_b16 a[238:239], v4 offset:1536
s_waitcnt vmcnt(0)
global_load_dword v126, v[14:15], off
v_rcp_f32 v53, v53
v_rcp_f32 v54, v54
v_rcp_f32 v55, v55
v_rcp_f32 v56, v56
v_rcp_f32 v57, v57
v_rcp_f32 v58, v58
v_rcp_f32 v59, v59
v_rcp_f32 v60, v60
v_rcp_f32 v61, v61
v_rcp_f32 v62, v62
v_rcp_f32 v63, v63
v_pk_mul_f32 v[16:17], v[48:49], v[16:17]
v_pk_mul_f32 v[18:19], v[50:51], v[18:19]
v_pk_mul_f32 v[20:21], v[52:53], v[20:21]
v_pk_mul_f32 v[22:23], v[54:55], v[22:23]
v_pk_mul_f32 v[24:25], v[56:57], v[24:25]
v_pk_mul_f32 v[26:27], v[58:59], v[26:27]
v_pk_mul_f32 v[28:29], v[60:61], v[28:29]
v_pk_mul_f32 v[30:31], v[62:63], v[30:31]
v_pk_fma_f32 v[112:113], v[16:17], v[16:17], v[112:113]
v_pk_fma_f32 v[48:49], v[32:33], v[32:33], s[60:61] neg_lo:[1,0,0] neg_hi:[1,0,0]
v_pk_fma_f32 v[112:113], v[18:19], v[18:19], v[112:113]
v_pk_fma_f32 v[50:51], v[34:35], v[34:35], s[60:61] neg_lo:[1,0,0] neg_hi:[1,0,0]
v_pk_fma_f32 v[112:113], v[20:21], v[20:21], v[112:113]
v_pk_fma_f32 v[52:53], v[36:37], v[36:37], s[60:61] neg_lo:[1,0,0] neg_hi:[1,0,0]
v_pk_fma_f32 v[112:113], v[22:23], v[22:23], v[112:113]
v_pk_fma_f32 v[54:55], v[38:39], v[38:39], s[60:61] neg_lo:[1,0,0] neg_hi:[1,0,0]
v_pk_fma_f32 v[112:113], v[24:25], v[24:25], v[112:113]
v_pk_fma_f32 v[56:57], v[40:41], v[40:41], s[60:61] neg_lo:[1,0,0] neg_hi:[1,0,0]
v_pk_fma_f32 v[112:113], v[26:27], v[26:27], v[112:113]
v_pk_fma_f32 v[58:59], v[42:43], v[42:43], s[60:61] neg_lo:[1,0,0] neg_hi:[1,0,0]
v_pk_fma_f32 v[112:113], v[28:29], v[28:29], v[112:113]
v_pk_fma_f32 v[60:61], v[44:45], v[44:45], s[60:61] neg_lo:[1,0,0] neg_hi:[1,0,0]
v_pk_fma_f32 v[112:113], v[30:31], v[30:31], v[112:113]
v_pk_fma_f32 v[62:63], v[46:47], v[46:47], s[60:61] neg_lo:[1,0,0] neg_hi:[1,0,0]
v_pk_mul_f32 v[48:49], v[48:49], v[32:33]
v_pk_mul_f32 v[50:51], v[50:51], v[34:35]
v_pk_mul_f32 v[52:53], v[52:53], v[36:37]
v_pk_mul_f32 v[54:55], v[54:55], v[38:39]
v_pk_mul_f32 v[56:57], v[56:57], v[40:41]
v_pk_mul_f32 v[58:59], v[58:59], v[42:43]
v_pk_mul_f32 v[60:61], v[60:61], v[44:45]
v_pk_mul_f32 v[62:63], v[62:63], v[46:47]
v_cvt_pk_bf16_f32 v248, v16, v17
v_cvt_pk_bf16_f32 v249, v18, v19
v_cvt_pk_bf16_f32 v250, v20, v21
v_cvt_pk_bf16_f32 v251, v22, v23
v_cvt_pk_bf16_f32 v252, v24, v25
v_cvt_pk_bf16_f32 v253, v26, v27
v_cvt_pk_bf16_f32 v254, v28, v29
v_cvt_pk_bf16_f32 v255, v30, v31
s_waitcnt lgkmcnt(0)
v_mfma_f32_32x32x16_bf16 v[16:31], v[128:131], v[88:91], 0
ds_read_b128 v[88:91], v1 offset:51712
ds_write_b64 v3, v[248:249] offset:0
v_exp_f32 v48, v48
v_exp_f32 v49, v49
v_exp_f32 v50, v50
v_mfma_f32_32x32x16_bf16 v[16:31], v[132:135], v[92:95], v[16:31]
ds_read_b128 v[92:95], v1 offset:53248
ds_write_b64 v3, v[250:251] offset:128
v_exp_f32 v51, v51
v_exp_f32 v52, v52
v_mfma_f32_32x32x16_bf16 v[16:31], v[136:139], v[96:99], v[16:31]
ds_read_b128 v[96:99], v1 offset:53760
ds_write_b64 v3, v[252:253] offset:1024
v_exp_f32 v53, v53
v_exp_f32 v54, v54
v_exp_f32 v55, v55
v_exp_f32 v56, v56
v_exp_f32 v57, v57
v_exp_f32 v58, v58
v_exp_f32 v59, v59
v_exp_f32 v60, v60
v_exp_f32 v61, v61
v_exp_f32 v62, v62
v_exp_f32_e64 v63, v63
v_pk_add_f32 v[48:49], v[48:49], 1.0 op_sel_hi:[1,0]
v_pk_add_f32 v[50:51], v[50:51], 1.0 op_sel_hi:[1,0]
v_pk_add_f32 v[52:53], v[52:53], 1.0 op_sel_hi:[1,0]
v_pk_add_f32 v[54:55], v[54:55], 1.0 op_sel_hi:[1,0]
v_pk_add_f32 v[56:57], v[56:57], 1.0 op_sel_hi:[1,0]
v_pk_add_f32 v[58:59], v[58:59], 1.0 op_sel_hi:[1,0]
v_pk_add_f32 v[60:61], v[60:61], 1.0 op_sel_hi:[1,0]
v_pk_add_f32 v[62:63], v[62:63], 1.0 op_sel_hi:[1,0]
s_waitcnt lgkmcnt(0)
v_mfma_f32_32x32x16_bf16 v[16:31], v[140:143], v[88:91], v[16:31]
ds_read_b128 v[88:91], v1 offset:55296
ds_write_b64 v3, v[254:255] offset:1152
v_rcp_f32 v48, v48
v_rcp_f32 v49, v49
v_rcp_f32 v50, v50
v_mfma_f32_32x32x16_bf16 v[16:31], v[144:147], v[92:95], v[16:31]
ds_read_b128 v[92:95], v1 offset:55808
ds_read_b64_tr_b16 a[240:241], v4 offset:0
ds_read_b64_tr_b16 a[242:243], v4 offset:512
v_rcp_f32 v51, v51
v_rcp_f32 v52, v52
v_mfma_f32_32x32x16_bf16 v[16:31], v[148:151], v[96:99], v[16:31]
ds_read_b128 v[96:99], v1 offset:57344
ds_read_b64_tr_b16 a[244:245], v4 offset:1024
ds_read_b64_tr_b16 a[246:247], v4 offset:1536
v_rcp_f32 v53, v53
v_rcp_f32 v54, v54
v_rcp_f32 v55, v55
v_rcp_f32 v56, v56
v_rcp_f32 v57, v57
v_rcp_f32 v58, v58
v_rcp_f32 v59, v59
v_rcp_f32 v60, v60
v_rcp_f32 v61, v61
v_rcp_f32 v62, v62
v_rcp_f32_e64 v63, v63
v_pk_mul_f32 v[32:33], v[48:49], v[32:33]
v_pk_mul_f32 v[34:35], v[50:51], v[34:35]
v_pk_mul_f32 v[36:37], v[52:53], v[36:37]
v_pk_mul_f32 v[38:39], v[54:55], v[38:39]
v_pk_mul_f32 v[40:41], v[56:57], v[40:41]
v_pk_mul_f32 v[42:43], v[58:59], v[42:43]
v_pk_mul_f32 v[44:45], v[60:61], v[44:45]
v_pk_mul_f32 v[46:47], v[62:63], v[46:47]
v_pk_fma_f32 v[114:115], v[32:33], v[32:33], v[114:115]
v_pk_fma_f32 v[48:49], v[16:17], v[16:17], s[60:61] neg_lo:[1,0,0] neg_hi:[1,0,0]
v_pk_fma_f32 v[114:115], v[34:35], v[34:35], v[114:115]
v_pk_fma_f32 v[50:51], v[18:19], v[18:19], s[60:61] neg_lo:[1,0,0] neg_hi:[1,0,0]
v_pk_fma_f32 v[114:115], v[36:37], v[36:37], v[114:115]
v_pk_fma_f32 v[52:53], v[20:21], v[20:21], s[60:61] neg_lo:[1,0,0] neg_hi:[1,0,0]
v_pk_fma_f32 v[114:115], v[38:39], v[38:39], v[114:115]
v_pk_fma_f32 v[54:55], v[22:23], v[22:23], s[60:61] neg_lo:[1,0,0] neg_hi:[1,0,0]
v_pk_fma_f32 v[114:115], v[40:41], v[40:41], v[114:115]
v_pk_fma_f32 v[56:57], v[24:25], v[24:25], s[60:61] neg_lo:[1,0,0] neg_hi:[1,0,0]
v_pk_fma_f32 v[114:115], v[42:43], v[42:43], v[114:115]
v_pk_fma_f32 v[58:59], v[26:27], v[26:27], s[60:61] neg_lo:[1,0,0] neg_hi:[1,0,0]
v_pk_fma_f32 v[114:115], v[44:45], v[44:45], v[114:115]
v_pk_fma_f32 v[60:61], v[28:29], v[28:29], s[60:61] neg_lo:[1,0,0] neg_hi:[1,0,0]
v_pk_fma_f32 v[114:115], v[46:47], v[46:47], v[114:115]
v_pk_fma_f32 v[62:63], v[30:31], v[30:31], s[60:61] neg_lo:[1,0,0] neg_hi:[1,0,0]
v_pk_mul_f32 v[48:49], v[48:49], v[16:17]
v_pk_mul_f32 v[50:51], v[50:51], v[18:19]
v_pk_mul_f32 v[52:53], v[52:53], v[20:21]
v_pk_mul_f32 v[54:55], v[54:55], v[22:23]
v_pk_mul_f32 v[56:57], v[56:57], v[24:25]
v_pk_mul_f32 v[58:59], v[58:59], v[26:27]
v_pk_mul_f32 v[60:61], v[60:61], v[28:29]
v_pk_mul_f32 v[62:63], v[62:63], v[30:31]
v_cvt_pk_bf16_f32 v248, v32, v33
v_cvt_pk_bf16_f32 v249, v34, v35
v_cvt_pk_bf16_f32 v250, v36, v37
v_cvt_pk_bf16_f32 v251, v38, v39
v_cvt_pk_bf16_f32 v252, v40, v41
v_cvt_pk_bf16_f32 v253, v42, v43
v_cvt_pk_bf16_f32 v254, v44, v45
v_cvt_pk_bf16_f32 v255, v46, v47
s_waitcnt lgkmcnt(0)
v_mfma_f32_32x32x16_bf16 v[32:47], v[128:131], v[88:91], 0
ds_read_b128 v[88:91], v1 offset:57856
ds_write_b64 v3, v[248:249] offset:0
v_exp_f32 v48, v48
v_exp_f32 v49, v49
v_exp_f32 v50, v50
v_mfma_f32_32x32x16_bf16 v[32:47], v[132:135], v[92:95], v[32:47]
ds_read_b128 v[92:95], v1 offset:59392
ds_write_b64 v3, v[250:251] offset:128
v_exp_f32 v51, v51
v_exp_f32 v52, v52
v_mfma_f32_32x32x16_bf16 v[32:47], v[136:139], v[96:99], v[32:47]
ds_read_b128 v[96:99], v1 offset:59904
ds_write_b64 v3, v[252:253] offset:1024
v_exp_f32 v53, v53
v_exp_f32 v54, v54
v_exp_f32 v55, v55
v_exp_f32 v56, v56
v_exp_f32 v57, v57
v_exp_f32 v58, v58
v_exp_f32 v59, v59
v_exp_f32 v60, v60
v_exp_f32 v61, v61
v_exp_f32 v62, v62
v_exp_f32_e64 v63, v63
v_pk_add_f32 v[48:49], v[48:49], 1.0 op_sel_hi:[1,0]
v_pk_add_f32 v[50:51], v[50:51], 1.0 op_sel_hi:[1,0]
v_pk_add_f32 v[52:53], v[52:53], 1.0 op_sel_hi:[1,0]
v_pk_add_f32 v[54:55], v[54:55], 1.0 op_sel_hi:[1,0]
v_pk_add_f32 v[56:57], v[56:57], 1.0 op_sel_hi:[1,0]
v_pk_add_f32 v[58:59], v[58:59], 1.0 op_sel_hi:[1,0]
v_pk_add_f32 v[60:61], v[60:61], 1.0 op_sel_hi:[1,0]
v_pk_add_f32 v[62:63], v[62:63], 1.0 op_sel_hi:[1,0]
s_waitcnt lgkmcnt(0)
v_mfma_f32_32x32x16_bf16 v[32:47], v[140:143], v[88:91], v[32:47]
ds_read_b128 v[88:91], v1 offset:61440
ds_write_b64 v3, v[254:255] offset:1152
v_rcp_f32 v48, v48
v_rcp_f32 v49, v49
v_rcp_f32 v50, v50
v_mfma_f32_32x32x16_bf16 v[32:47], v[144:147], v[92:95], v[32:47]
ds_read_b128 v[92:95], v1 offset:61952
ds_read_b64_tr_b16 a[248:249], v4 offset:0
ds_read_b64_tr_b16 a[250:251], v4 offset:512
v_rcp_f32 v51, v51
v_rcp_f32 v52, v52
v_mfma_f32_32x32x16_bf16 v[32:47], v[148:151], v[96:99], v[32:47]
ds_read_b128 v[96:99], v1 offset:63488
ds_read_b64_tr_b16 a[252:253], v4 offset:1024
ds_read_b64_tr_b16 a[254:255], v4 offset:1536
v_rcp_f32 v53, v53
v_rcp_f32 v54, v54
v_rcp_f32 v55, v55
v_rcp_f32 v56, v56
v_rcp_f32 v57, v57
v_rcp_f32 v58, v58
v_rcp_f32 v59, v59
v_rcp_f32 v60, v60
v_rcp_f32 v61, v61
v_rcp_f32 v62, v62
v_rcp_f32_e64 v63, v63
v_pk_mul_f32 v[16:17], v[48:49], v[16:17]
v_pk_mul_f32 v[18:19], v[50:51], v[18:19]
v_pk_mul_f32 v[20:21], v[52:53], v[20:21]
v_pk_mul_f32 v[22:23], v[54:55], v[22:23]
v_pk_mul_f32 v[24:25], v[56:57], v[24:25]
v_pk_mul_f32 v[26:27], v[58:59], v[26:27]
v_pk_mul_f32 v[28:29], v[60:61], v[28:29]
v_pk_mul_f32 v[30:31], v[62:63], v[30:31]
v_pk_fma_f32 v[116:117], v[16:17], v[16:17], v[116:117]
v_pk_fma_f32 v[48:49], v[32:33], v[32:33], s[60:61] neg_lo:[1,0,0] neg_hi:[1,0,0]
v_pk_fma_f32 v[116:117], v[18:19], v[18:19], v[116:117]
v_pk_fma_f32 v[50:51], v[34:35], v[34:35], s[60:61] neg_lo:[1,0,0] neg_hi:[1,0,0]
v_pk_fma_f32 v[116:117], v[20:21], v[20:21], v[116:117]
v_pk_fma_f32 v[52:53], v[36:37], v[36:37], s[60:61] neg_lo:[1,0,0] neg_hi:[1,0,0]
v_pk_fma_f32 v[116:117], v[22:23], v[22:23], v[116:117]
v_pk_fma_f32 v[54:55], v[38:39], v[38:39], s[60:61] neg_lo:[1,0,0] neg_hi:[1,0,0]
v_pk_fma_f32 v[116:117], v[24:25], v[24:25], v[116:117]
v_pk_fma_f32 v[56:57], v[40:41], v[40:41], s[60:61] neg_lo:[1,0,0] neg_hi:[1,0,0]
v_pk_fma_f32 v[116:117], v[26:27], v[26:27], v[116:117]
v_pk_fma_f32 v[58:59], v[42:43], v[42:43], s[60:61] neg_lo:[1,0,0] neg_hi:[1,0,0]
v_pk_fma_f32 v[116:117], v[28:29], v[28:29], v[116:117]
v_pk_fma_f32 v[60:61], v[44:45], v[44:45], s[60:61] neg_lo:[1,0,0] neg_hi:[1,0,0]
v_pk_fma_f32 v[116:117], v[30:31], v[30:31], v[116:117]
v_pk_fma_f32 v[62:63], v[46:47], v[46:47], s[60:61] neg_lo:[1,0,0] neg_hi:[1,0,0]
v_pk_mul_f32 v[48:49], v[48:49], v[32:33]
v_pk_mul_f32 v[50:51], v[50:51], v[34:35]
v_pk_mul_f32 v[52:53], v[52:53], v[36:37]
v_pk_mul_f32 v[54:55], v[54:55], v[38:39]
v_pk_mul_f32 v[56:57], v[56:57], v[40:41]
v_pk_mul_f32 v[58:59], v[58:59], v[42:43]
v_pk_mul_f32 v[60:61], v[60:61], v[44:45]
v_pk_mul_f32 v[62:63], v[62:63], v[46:47]
v_cvt_pk_bf16_f32 v224, v16, v17
v_cvt_pk_bf16_f32 v225, v18, v19
v_cvt_pk_bf16_f32 v226, v20, v21
v_cvt_pk_bf16_f32 v227, v22, v23
v_cvt_pk_bf16_f32 v228, v24, v25
v_cvt_pk_bf16_f32 v229, v26, v27
v_cvt_pk_bf16_f32 v230, v28, v29
v_cvt_pk_bf16_f32 v231, v30, v31
s_waitcnt lgkmcnt(0)
v_mfma_f32_32x32x16_bf16 v[16:31], v[128:131], v[88:91], 0
ds_read_b128 v[88:91], v1 offset:64000
ds_write_b64 v3, v[224:225] offset:0
v_exp_f32 v48, v48
v_exp_f32 v49, v49
v_exp_f32 v50, v50
v_mfma_f32_32x32x16_bf16 v[16:31], v[132:135], v[92:95], v[16:31]
ds_read_b128 v[92:95], v7 offset:0
ds_write_b64 v3, v[226:227] offset:128
v_exp_f32 v51, v51
v_exp_f32 v52, v52
v_mfma_f32_32x32x16_bf16 v[16:31], v[136:139], v[96:99], v[16:31]
ds_read_b128 v[96:99], v7 offset:512
ds_write_b64 v3, v[228:229] offset:1024
v_exp_f32 v53, v53
v_exp_f32 v54, v54
v_exp_f32 v55, v55
v_exp_f32 v56, v56
v_exp_f32 v57, v57
v_exp_f32 v58, v58
v_exp_f32 v59, v59
v_exp_f32 v60, v60
v_exp_f32 v61, v61
v_exp_f32 v62, v62
v_exp_f32_e64 v63, v63
v_pk_add_f32 v[48:49], v[48:49], 1.0 op_sel_hi:[1,0]
v_pk_add_f32 v[50:51], v[50:51], 1.0 op_sel_hi:[1,0]
v_pk_add_f32 v[52:53], v[52:53], 1.0 op_sel_hi:[1,0]
v_pk_add_f32 v[54:55], v[54:55], 1.0 op_sel_hi:[1,0]
v_pk_add_f32 v[56:57], v[56:57], 1.0 op_sel_hi:[1,0]
v_pk_add_f32 v[58:59], v[58:59], 1.0 op_sel_hi:[1,0]
v_pk_add_f32 v[60:61], v[60:61], 1.0 op_sel_hi:[1,0]
v_pk_add_f32 v[62:63], v[62:63], 1.0 op_sel_hi:[1,0]
s_waitcnt lgkmcnt(0)
v_mfma_f32_32x32x16_bf16 v[16:31], v[140:143], v[88:91], v[16:31]
ds_read_b128 v[88:91], v7 offset:2048
ds_write_b64 v3, v[230:231] offset:1152
v_rcp_f32 v48, v48
v_rcp_f32 v49, v49
v_rcp_f32 v50, v50
v_mfma_f32_32x32x16_bf16 v[16:31], v[144:147], v[92:95], v[16:31]
ds_read_b128 v[92:95], v7 offset:2560
ds_read_b64_tr_b16 v[224:225], v4 offset:0
ds_read_b64_tr_b16 v[226:227], v4 offset:512
v_rcp_f32 v51, v51
v_rcp_f32 v52, v52
v_mfma_f32_32x32x16_bf16 v[16:31], v[148:151], v[96:99], v[16:31]
ds_read_b128 v[96:99], v7 offset:4096
ds_read_b64_tr_b16 v[228:229], v4 offset:1024
ds_read_b64_tr_b16 v[230:231], v4 offset:1536
v_rcp_f32 v53, v53
v_rcp_f32 v54, v54
v_rcp_f32 v55, v55
v_rcp_f32 v56, v56
v_rcp_f32 v57, v57
v_rcp_f32 v58, v58
v_rcp_f32 v59, v59
v_rcp_f32 v60, v60
v_rcp_f32 v61, v61
v_rcp_f32 v62, v62
v_rcp_f32_e64 v63, v63
v_pk_mul_f32 v[32:33], v[48:49], v[32:33]
v_pk_mul_f32 v[34:35], v[50:51], v[34:35]
v_pk_mul_f32 v[36:37], v[52:53], v[36:37]
v_pk_mul_f32 v[38:39], v[54:55], v[38:39]
v_pk_mul_f32 v[40:41], v[56:57], v[40:41]
v_pk_mul_f32 v[42:43], v[58:59], v[42:43]
v_pk_mul_f32 v[44:45], v[60:61], v[44:45]
v_pk_mul_f32 v[46:47], v[62:63], v[46:47]
v_pk_fma_f32 v[118:119], v[32:33], v[32:33], v[118:119]
v_pk_fma_f32 v[48:49], v[16:17], v[16:17], s[60:61] neg_lo:[1,0,0] neg_hi:[1,0,0]
v_pk_fma_f32 v[118:119], v[34:35], v[34:35], v[118:119]
v_pk_fma_f32 v[50:51], v[18:19], v[18:19], s[60:61] neg_lo:[1,0,0] neg_hi:[1,0,0]
v_pk_fma_f32 v[118:119], v[36:37], v[36:37], v[118:119]
v_pk_fma_f32 v[52:53], v[20:21], v[20:21], s[60:61] neg_lo:[1,0,0] neg_hi:[1,0,0]
v_pk_fma_f32 v[118:119], v[38:39], v[38:39], v[118:119]
v_pk_fma_f32 v[54:55], v[22:23], v[22:23], s[60:61] neg_lo:[1,0,0] neg_hi:[1,0,0]
v_pk_fma_f32 v[118:119], v[40:41], v[40:41], v[118:119]
v_pk_fma_f32 v[56:57], v[24:25], v[24:25], s[60:61] neg_lo:[1,0,0] neg_hi:[1,0,0]
v_pk_fma_f32 v[118:119], v[42:43], v[42:43], v[118:119]
v_pk_fma_f32 v[58:59], v[26:27], v[26:27], s[60:61] neg_lo:[1,0,0] neg_hi:[1,0,0]
v_pk_fma_f32 v[118:119], v[44:45], v[44:45], v[118:119]
v_pk_fma_f32 v[60:61], v[28:29], v[28:29], s[60:61] neg_lo:[1,0,0] neg_hi:[1,0,0]
v_pk_fma_f32 v[118:119], v[46:47], v[46:47], v[118:119]
v_pk_fma_f32 v[62:63], v[30:31], v[30:31], s[60:61] neg_lo:[1,0,0] neg_hi:[1,0,0]
v_pk_mul_f32 v[48:49], v[48:49], v[16:17]
v_pk_mul_f32 v[50:51], v[50:51], v[18:19]
v_pk_mul_f32 v[52:53], v[52:53], v[20:21]
v_pk_mul_f32 v[54:55], v[54:55], v[22:23]
v_pk_mul_f32 v[56:57], v[56:57], v[24:25]
v_pk_mul_f32 v[58:59], v[58:59], v[26:27]
v_pk_mul_f32 v[60:61], v[60:61], v[28:29]
v_pk_mul_f32 v[62:63], v[62:63], v[30:31]
v_cvt_pk_bf16_f32 v232, v32, v33
v_cvt_pk_bf16_f32 v233, v34, v35
v_cvt_pk_bf16_f32 v234, v36, v37
v_cvt_pk_bf16_f32 v235, v38, v39
v_cvt_pk_bf16_f32 v236, v40, v41
v_cvt_pk_bf16_f32 v237, v42, v43
v_cvt_pk_bf16_f32 v238, v44, v45
v_cvt_pk_bf16_f32 v239, v46, v47
s_waitcnt lgkmcnt(0)
v_mfma_f32_32x32x16_bf16 v[32:47], v[128:131], v[88:91], 0
ds_read_b128 v[88:91], v7 offset:4608
ds_write_b64 v3, v[232:233] offset:0
v_exp_f32 v48, v48
v_exp_f32 v49, v49
v_exp_f32 v50, v50
v_mfma_f32_32x32x16_bf16 v[32:47], v[132:135], v[92:95], v[32:47]
ds_read_b128 v[92:95], v7 offset:6144
ds_write_b64 v3, v[234:235] offset:128
v_exp_f32 v51, v51
v_exp_f32 v52, v52
v_mfma_f32_32x32x16_bf16 v[32:47], v[136:139], v[96:99], v[32:47]
ds_read_b128 v[96:99], v7 offset:6656
ds_write_b64 v3, v[236:237] offset:1024
v_exp_f32 v53, v53
v_exp_f32 v54, v54
v_exp_f32 v55, v55
v_exp_f32 v56, v56
v_exp_f32 v57, v57
v_exp_f32 v58, v58
v_exp_f32 v59, v59
v_exp_f32 v60, v60
v_exp_f32 v61, v61
v_exp_f32 v62, v62
v_exp_f32_e64 v63, v63
v_pk_add_f32 v[48:49], v[48:49], 1.0 op_sel_hi:[1,0]
v_pk_add_f32 v[50:51], v[50:51], 1.0 op_sel_hi:[1,0]
v_pk_add_f32 v[52:53], v[52:53], 1.0 op_sel_hi:[1,0]
v_pk_add_f32 v[54:55], v[54:55], 1.0 op_sel_hi:[1,0]
v_pk_add_f32 v[56:57], v[56:57], 1.0 op_sel_hi:[1,0]
v_pk_add_f32 v[58:59], v[58:59], 1.0 op_sel_hi:[1,0]
v_pk_add_f32 v[60:61], v[60:61], 1.0 op_sel_hi:[1,0]
v_pk_add_f32 v[62:63], v[62:63], 1.0 op_sel_hi:[1,0]
s_waitcnt lgkmcnt(0)
v_mfma_f32_32x32x16_bf16 v[32:47], v[140:143], v[88:91], v[32:47]
ds_read_b128 v[88:91], v1 offset:0
ds_write_b64 v3, v[238:239] offset:1152
v_rcp_f32 v48, v48
v_rcp_f32 v49, v49
v_rcp_f32 v50, v50
v_mfma_f32_32x32x16_bf16 v[32:47], v[144:147], v[92:95], v[32:47]
ds_read_b128 v[92:95], v1 offset:512
ds_read_b64_tr_b16 v[232:233], v4 offset:0
ds_read_b64_tr_b16 v[234:235], v4 offset:512
v_rcp_f32 v51, v51
v_rcp_f32 v52, v52
v_mfma_f32_32x32x16_bf16 v[32:47], v[148:151], v[96:99], v[32:47]
ds_read_b128 v[96:99], v1 offset:2048
ds_read_b64_tr_b16 v[236:237], v4 offset:1024
ds_read_b64_tr_b16 v[238:239], v4 offset:1536
v_rcp_f32 v53, v53
v_rcp_f32 v54, v54
v_rcp_f32 v55, v55
v_rcp_f32 v56, v56
v_rcp_f32 v57, v57
v_rcp_f32 v58, v58
v_rcp_f32 v59, v59
v_rcp_f32 v60, v60
v_rcp_f32 v61, v61
v_rcp_f32 v62, v62
v_rcp_f32_e64 v63, v63
v_pk_mul_f32 v[16:17], v[48:49], v[16:17]
v_pk_mul_f32 v[18:19], v[50:51], v[18:19]
v_pk_mul_f32 v[20:21], v[52:53], v[20:21]
v_pk_mul_f32 v[22:23], v[54:55], v[22:23]
v_pk_mul_f32 v[24:25], v[56:57], v[24:25]
v_pk_mul_f32 v[26:27], v[58:59], v[26:27]
v_pk_mul_f32 v[28:29], v[60:61], v[28:29]
v_pk_mul_f32 v[30:31], v[62:63], v[30:31]
v_pk_fma_f32 v[120:121], v[16:17], v[16:17], v[120:121]
v_pk_fma_f32 v[48:49], v[32:33], v[32:33], s[60:61] neg_lo:[1,0,0] neg_hi:[1,0,0]
v_pk_fma_f32 v[120:121], v[18:19], v[18:19], v[120:121]
v_pk_fma_f32 v[50:51], v[34:35], v[34:35], s[60:61] neg_lo:[1,0,0] neg_hi:[1,0,0]
v_pk_fma_f32 v[120:121], v[20:21], v[20:21], v[120:121]
v_pk_fma_f32 v[52:53], v[36:37], v[36:37], s[60:61] neg_lo:[1,0,0] neg_hi:[1,0,0]
v_pk_fma_f32 v[120:121], v[22:23], v[22:23], v[120:121]
v_pk_fma_f32 v[54:55], v[38:39], v[38:39], s[60:61] neg_lo:[1,0,0] neg_hi:[1,0,0]
v_pk_fma_f32 v[120:121], v[24:25], v[24:25], v[120:121]
v_pk_fma_f32 v[56:57], v[40:41], v[40:41], s[60:61] neg_lo:[1,0,0] neg_hi:[1,0,0]
v_pk_fma_f32 v[120:121], v[26:27], v[26:27], v[120:121]
v_pk_fma_f32 v[58:59], v[42:43], v[42:43], s[60:61] neg_lo:[1,0,0] neg_hi:[1,0,0]
v_pk_fma_f32 v[120:121], v[28:29], v[28:29], v[120:121]
v_pk_fma_f32 v[60:61], v[44:45], v[44:45], s[60:61] neg_lo:[1,0,0] neg_hi:[1,0,0]
v_pk_fma_f32 v[120:121], v[30:31], v[30:31], v[120:121]
v_pk_fma_f32 v[62:63], v[46:47], v[46:47], s[60:61] neg_lo:[1,0,0] neg_hi:[1,0,0]
v_pk_mul_f32 v[48:49], v[48:49], v[32:33]
v_pk_mul_f32 v[50:51], v[50:51], v[34:35]
v_pk_mul_f32 v[52:53], v[52:53], v[36:37]
v_pk_mul_f32 v[54:55], v[54:55], v[38:39]
v_pk_mul_f32 v[56:57], v[56:57], v[40:41]
v_pk_mul_f32 v[58:59], v[58:59], v[42:43]
v_pk_mul_f32 v[60:61], v[60:61], v[44:45]
v_pk_mul_f32 v[62:63], v[62:63], v[46:47]
v_cvt_pk_bf16_f32 v240, v16, v17
v_cvt_pk_bf16_f32 v241, v18, v19
v_cvt_pk_bf16_f32 v242, v20, v21
v_cvt_pk_bf16_f32 v243, v22, v23
v_cvt_pk_bf16_f32 v244, v24, v25
v_cvt_pk_bf16_f32 v245, v26, v27
v_cvt_pk_bf16_f32 v246, v28, v29
v_cvt_pk_bf16_f32 v247, v30, v31
s_waitcnt lgkmcnt(0)
v_mfma_f32_32x32x16_bf16 v[16:31], v[64:67], v[88:91], 0
ds_read_b128 v[88:91], v1 offset:2560
ds_write_b64 v3, v[240:241] offset:0
v_exp_f32 v48, v48
v_exp_f32 v49, v49
v_exp_f32 v50, v50
v_mfma_f32_32x32x16_bf16 v[16:31], v[68:71], v[92:95], v[16:31]
ds_read_b128 v[92:95], v1 offset:4096
ds_write_b64 v3, v[242:243] offset:128
v_exp_f32 v51, v51
v_exp_f32 v52, v52
v_mfma_f32_32x32x16_bf16 v[16:31], v[72:75], v[96:99], v[16:31]
ds_read_b128 v[96:99], v1 offset:4608
ds_write_b64 v3, v[244:245] offset:1024
v_exp_f32 v53, v53
v_exp_f32 v54, v54
v_exp_f32 v55, v55
v_exp_f32 v56, v56
v_exp_f32 v57, v57
v_exp_f32 v58, v58
v_exp_f32 v59, v59
v_exp_f32 v60, v60
v_exp_f32 v61, v61
v_exp_f32 v62, v62
v_exp_f32_e64 v63, v63
v_pk_add_f32 v[48:49], v[48:49], 1.0 op_sel_hi:[1,0]
v_pk_add_f32 v[50:51], v[50:51], 1.0 op_sel_hi:[1,0]
v_pk_add_f32 v[52:53], v[52:53], 1.0 op_sel_hi:[1,0]
v_pk_add_f32 v[54:55], v[54:55], 1.0 op_sel_hi:[1,0]
v_pk_add_f32 v[56:57], v[56:57], 1.0 op_sel_hi:[1,0]
v_pk_add_f32 v[58:59], v[58:59], 1.0 op_sel_hi:[1,0]
v_pk_add_f32 v[60:61], v[60:61], 1.0 op_sel_hi:[1,0]
v_pk_add_f32 v[62:63], v[62:63], 1.0 op_sel_hi:[1,0]
s_waitcnt lgkmcnt(0)
v_mfma_f32_32x32x16_bf16 v[16:31], v[76:79], v[88:91], v[16:31]
ds_read_b128 v[88:91], v1 offset:6144
ds_write_b64 v3, v[246:247] offset:1152
v_rcp_f32 v48, v48
v_rcp_f32 v49, v49
v_rcp_f32 v50, v50
v_mfma_f32_32x32x16_bf16 v[16:31], v[80:83], v[92:95], v[16:31]
ds_read_b128 v[92:95], v1 offset:6656
ds_read_b64_tr_b16 v[240:241], v4 offset:0
ds_read_b64_tr_b16 v[242:243], v4 offset:512
v_rcp_f32 v51, v51
v_rcp_f32 v52, v52
v_mfma_f32_32x32x16_bf16 v[16:31], v[84:87], v[96:99], v[16:31]
ds_read_b128 v[96:99], v1 offset:8192
ds_read_b64_tr_b16 v[244:245], v4 offset:1024
ds_read_b64_tr_b16 v[246:247], v4 offset:1536
v_rcp_f32 v53, v53
v_rcp_f32 v54, v54
v_rcp_f32 v55, v55
v_rcp_f32 v56, v56
v_rcp_f32 v57, v57
v_rcp_f32 v58, v58
v_rcp_f32 v59, v59
v_rcp_f32 v60, v60
v_rcp_f32 v61, v61
v_rcp_f32 v62, v62
v_rcp_f32_e64 v63, v63
v_pk_mul_f32 v[32:33], v[48:49], v[32:33]
v_pk_mul_f32 v[34:35], v[50:51], v[34:35]
v_pk_mul_f32 v[36:37], v[52:53], v[36:37]
v_pk_mul_f32 v[38:39], v[54:55], v[38:39]
v_pk_mul_f32 v[40:41], v[56:57], v[40:41]
v_pk_mul_f32 v[42:43], v[58:59], v[42:43]
v_pk_mul_f32 v[44:45], v[60:61], v[44:45]
v_pk_mul_f32 v[46:47], v[62:63], v[46:47]
v_pk_fma_f32 v[122:123], v[32:33], v[32:33], v[122:123]
v_pk_fma_f32 v[48:49], v[16:17], v[16:17], s[60:61] neg_lo:[1,0,0] neg_hi:[1,0,0]
v_pk_fma_f32 v[122:123], v[34:35], v[34:35], v[122:123]
v_pk_fma_f32 v[50:51], v[18:19], v[18:19], s[60:61] neg_lo:[1,0,0] neg_hi:[1,0,0]
v_pk_fma_f32 v[122:123], v[36:37], v[36:37], v[122:123]
v_pk_fma_f32 v[52:53], v[20:21], v[20:21], s[60:61] neg_lo:[1,0,0] neg_hi:[1,0,0]
v_pk_fma_f32 v[122:123], v[38:39], v[38:39], v[122:123]
v_pk_fma_f32 v[54:55], v[22:23], v[22:23], s[60:61] neg_lo:[1,0,0] neg_hi:[1,0,0]
v_pk_fma_f32 v[122:123], v[40:41], v[40:41], v[122:123]
v_pk_fma_f32 v[56:57], v[24:25], v[24:25], s[60:61] neg_lo:[1,0,0] neg_hi:[1,0,0]
v_pk_fma_f32 v[122:123], v[42:43], v[42:43], v[122:123]
v_pk_fma_f32 v[58:59], v[26:27], v[26:27], s[60:61] neg_lo:[1,0,0] neg_hi:[1,0,0]
v_pk_fma_f32 v[122:123], v[44:45], v[44:45], v[122:123]
v_pk_fma_f32 v[60:61], v[28:29], v[28:29], s[60:61] neg_lo:[1,0,0] neg_hi:[1,0,0]
v_pk_fma_f32 v[122:123], v[46:47], v[46:47], v[122:123]
v_pk_fma_f32 v[62:63], v[30:31], v[30:31], s[60:61] neg_lo:[1,0,0] neg_hi:[1,0,0]
v_pk_mul_f32 v[48:49], v[48:49], v[16:17]
v_pk_mul_f32 v[50:51], v[50:51], v[18:19]
v_pk_mul_f32 v[52:53], v[52:53], v[20:21]
v_pk_mul_f32 v[54:55], v[54:55], v[22:23]
v_pk_mul_f32 v[56:57], v[56:57], v[24:25]
v_pk_mul_f32 v[58:59], v[58:59], v[26:27]
v_pk_mul_f32 v[60:61], v[60:61], v[28:29]
v_pk_mul_f32 v[62:63], v[62:63], v[30:31]
L_b1_7:
v_cvt_pk_bf16_f32 v248, v32, v33
v_cvt_pk_bf16_f32 v249, v34, v35
v_cvt_pk_bf16_f32 v250, v36, v37
v_cvt_pk_bf16_f32 v251, v38, v39
v_cvt_pk_bf16_f32 v252, v40, v41
v_cvt_pk_bf16_f32 v253, v42, v43
v_cvt_pk_bf16_f32 v254, v44, v45
v_cvt_pk_bf16_f32 v255, v46, v47
s_waitcnt lgkmcnt(0)
v_mfma_f32_32x32x16_bf16 v[32:47], v[64:67], v[88:91], 0
ds_read_b128 v[88:91], v1 offset:8704
ds_write_b64 v3, v[248:249] offset:0
v_exp_f32 v48, v48
v_exp_f32 v49, v49
v_exp_f32 v50, v50
v_mfma_f32_32x32x16_bf16 v[32:47], v[68:71], v[92:95], v[32:47]
ds_read_b128 v[92:95], v1 offset:10240
ds_write_b64 v3, v[250:251] offset:128
v_exp_f32 v51, v51
v_exp_f32 v52, v52
v_mfma_f32_32x32x16_bf16 v[32:47], v[72:75], v[96:99], v[32:47]
ds_read_b128 v[96:99], v1 offset:10752
ds_write_b64 v3, v[252:253] offset:1024
v_exp_f32 v53, v53
v_exp_f32 v54, v54
v_exp_f32 v55, v55
v_exp_f32 v56, v56
v_exp_f32 v57, v57
v_exp_f32 v58, v58
v_exp_f32 v59, v59
v_exp_f32 v60, v60
v_exp_f32 v61, v61
v_exp_f32 v62, v62
v_exp_f32_e64 v63, v63
v_pk_add_f32 v[48:49], v[48:49], 1.0 op_sel_hi:[1,0]
v_pk_add_f32 v[50:51], v[50:51], 1.0 op_sel_hi:[1,0]
v_pk_add_f32 v[52:53], v[52:53], 1.0 op_sel_hi:[1,0]
v_pk_add_f32 v[54:55], v[54:55], 1.0 op_sel_hi:[1,0]
v_pk_add_f32 v[56:57], v[56:57], 1.0 op_sel_hi:[1,0]
v_pk_add_f32 v[58:59], v[58:59], 1.0 op_sel_hi:[1,0]
v_pk_add_f32 v[60:61], v[60:61], 1.0 op_sel_hi:[1,0]
v_pk_add_f32 v[62:63], v[62:63], 1.0 op_sel_hi:[1,0]
s_waitcnt lgkmcnt(0)
v_mfma_f32_32x32x16_bf16 v[32:47], v[76:79], v[88:91], v[32:47]
ds_read_b128 v[88:91], v1 offset:12288
ds_write_b64 v3, v[254:255] offset:1152
v_rcp_f32 v48, v48
v_rcp_f32 v49, v49
v_rcp_f32 v50, v50
v_mfma_f32_32x32x16_bf16 v[32:47], v[80:83], v[92:95], v[32:47]
ds_read_b128 v[92:95], v1 offset:12800
ds_read_b64_tr_b16 v[248:249], v4 offset:0
ds_read_b64_tr_b16 v[250:251], v4 offset:512
v_rcp_f32 v51, v51
v_rcp_f32 v52, v52
v_mfma_f32_32x32x16_bf16 v[32:47], v[84:87], v[96:99], v[32:47]
ds_read_b128 v[96:99], v1 offset:14336
ds_read_b64_tr_b16 v[252:253], v4 offset:1024
ds_read_b64_tr_b16 v[254:255], v4 offset:1536
v_rcp_f32 v53, v53
v_rcp_f32 v54, v54
v_rcp_f32 v55, v55
v_rcp_f32 v56, v56
v_rcp_f32 v57, v57
v_rcp_f32 v58, v58
v_rcp_f32 v59, v59
v_rcp_f32 v60, v60
v_rcp_f32 v61, v61
v_rcp_f32 v62, v62
v_rcp_f32_e64 v63, v63
v_pk_mul_f32 v[16:17], v[48:49], v[16:17]
v_pk_mul_f32 v[18:19], v[50:51], v[18:19]
v_pk_mul_f32 v[20:21], v[52:53], v[20:21]
v_pk_mul_f32 v[22:23], v[54:55], v[22:23]
v_pk_mul_f32 v[24:25], v[56:57], v[24:25]
v_pk_mul_f32 v[26:27], v[58:59], v[26:27]
v_pk_mul_f32 v[28:29], v[60:61], v[28:29]
v_pk_mul_f32 v[30:31], v[62:63], v[30:31]
v_pk_fma_f32 v[100:101], v[16:17], v[16:17], v[100:101]
v_pk_fma_f32 v[48:49], v[32:33], v[32:33], s[60:61] neg_lo:[1,0,0] neg_hi:[1,0,0]
v_pk_fma_f32 v[100:101], v[18:19], v[18:19], v[100:101]
v_pk_fma_f32 v[50:51], v[34:35], v[34:35], s[60:61] neg_lo:[1,0,0] neg_hi:[1,0,0]
v_pk_fma_f32 v[100:101], v[20:21], v[20:21], v[100:101]
v_pk_fma_f32 v[52:53], v[36:37], v[36:37], s[60:61] neg_lo:[1,0,0] neg_hi:[1,0,0]
v_pk_fma_f32 v[100:101], v[22:23], v[22:23], v[100:101]
v_pk_fma_f32 v[54:55], v[38:39], v[38:39], s[60:61] neg_lo:[1,0,0] neg_hi:[1,0,0]
v_pk_fma_f32 v[100:101], v[24:25], v[24:25], v[100:101]
v_pk_fma_f32 v[56:57], v[40:41], v[40:41], s[60:61] neg_lo:[1,0,0] neg_hi:[1,0,0]
v_pk_fma_f32 v[100:101], v[26:27], v[26:27], v[100:101]
v_pk_fma_f32 v[58:59], v[42:43], v[42:43], s[60:61] neg_lo:[1,0,0] neg_hi:[1,0,0]
v_pk_fma_f32 v[100:101], v[28:29], v[28:29], v[100:101]
v_pk_fma_f32 v[60:61], v[44:45], v[44:45], s[60:61] neg_lo:[1,0,0] neg_hi:[1,0,0]
v_pk_fma_f32 v[100:101], v[30:31], v[30:31], v[100:101]
v_pk_fma_f32 v[62:63], v[46:47], v[46:47], s[60:61] neg_lo:[1,0,0] neg_hi:[1,0,0]
v_pk_mul_f32 v[48:49], v[48:49], v[32:33]
v_pk_mul_f32 v[50:51], v[50:51], v[34:35]
v_pk_mul_f32 v[52:53], v[52:53], v[36:37]
v_pk_mul_f32 v[54:55], v[54:55], v[38:39]
v_pk_mul_f32 v[56:57], v[56:57], v[40:41]
v_pk_mul_f32 v[58:59], v[58:59], v[42:43]
v_pk_mul_f32 v[60:61], v[60:61], v[44:45]
v_pk_mul_f32 v[62:63], v[62:63], v[46:47]
v_cvt_pk_bf16_f32 v128, v16, v17
v_cvt_pk_bf16_f32 v129, v18, v19
v_cvt_pk_bf16_f32 v130, v20, v21
v_cvt_pk_bf16_f32 v131, v22, v23
v_cvt_pk_bf16_f32 v132, v24, v25
v_cvt_pk_bf16_f32 v133, v26, v27
v_cvt_pk_bf16_f32 v134, v28, v29
v_cvt_pk_bf16_f32 v135, v30, v31
s_waitcnt lgkmcnt(0)
v_mfma_f32_32x32x16_bf16 v[16:31], v[64:67], v[88:91], 0
ds_read_b128 v[88:91], v1 offset:14848
ds_write_b64 v3, v[128:129] offset:0
v_exp_f32 v48, v48
v_exp_f32 v49, v49
v_exp_f32 v50, v50
v_mfma_f32_32x32x16_bf16 v[16:31], v[68:71], v[92:95], v[16:31]
ds_read_b128 v[92:95], v1 offset:16384
ds_write_b64 v3, v[130:131] offset:128
v_exp_f32 v51, v51
v_exp_f32 v52, v52
v_mfma_f32_32x32x16_bf16 v[16:31], v[72:75], v[96:99], v[16:31]
ds_read_b128 v[96:99], v1 offset:16896
ds_write_b64 v3, v[132:133] offset:1024
v_exp_f32 v53, v53
v_exp_f32 v54, v54
v_exp_f32 v55, v55
v_exp_f32 v56, v56
v_exp_f32 v57, v57
v_exp_f32 v58, v58
v_exp_f32 v59, v59
v_exp_f32 v60, v60
v_exp_f32 v61, v61
v_exp_f32 v62, v62
v_exp_f32_e64 v63, v63
v_pk_add_f32 v[48:49], v[48:49], 1.0 op_sel_hi:[1,0]
v_pk_add_f32 v[50:51], v[50:51], 1.0 op_sel_hi:[1,0]
v_pk_add_f32 v[52:53], v[52:53], 1.0 op_sel_hi:[1,0]
v_pk_add_f32 v[54:55], v[54:55], 1.0 op_sel_hi:[1,0]
v_pk_add_f32 v[56:57], v[56:57], 1.0 op_sel_hi:[1,0]
v_pk_add_f32 v[58:59], v[58:59], 1.0 op_sel_hi:[1,0]
v_pk_add_f32 v[60:61], v[60:61], 1.0 op_sel_hi:[1,0]
v_pk_add_f32 v[62:63], v[62:63], 1.0 op_sel_hi:[1,0]
s_waitcnt lgkmcnt(0)
v_mfma_f32_32x32x16_bf16 v[16:31], v[76:79], v[88:91], v[16:31]
ds_read_b128 v[88:91], v1 offset:18432
ds_write_b64 v3, v[134:135] offset:1152
v_rcp_f32 v48, v48
v_rcp_f32 v49, v49
v_rcp_f32 v50, v50
v_mfma_f32_32x32x16_bf16 v[16:31], v[80:83], v[92:95], v[16:31]
ds_read_b128 v[92:95], v1 offset:18944
ds_read_b64_tr_b16 v[128:129], v4 offset:0
ds_read_b64_tr_b16 v[130:131], v4 offset:512
v_rcp_f32 v51, v51
v_rcp_f32 v52, v52
v_mfma_f32_32x32x16_bf16 v[16:31], v[84:87], v[96:99], v[16:31]
ds_read_b128 v[96:99], v1 offset:20480
ds_read_b64_tr_b16 v[132:133], v4 offset:1024
ds_read_b64_tr_b16 v[134:135], v4 offset:1536
v_rcp_f32 v53, v53
v_rcp_f32 v54, v54
v_rcp_f32 v55, v55
v_rcp_f32 v56, v56
v_rcp_f32 v57, v57
v_rcp_f32 v58, v58
v_rcp_f32 v59, v59
v_rcp_f32 v60, v60
v_rcp_f32 v61, v61
v_rcp_f32 v62, v62
v_rcp_f32_e64 v63, v63
v_pk_mul_f32 v[32:33], v[48:49], v[32:33]
v_pk_mul_f32 v[34:35], v[50:51], v[34:35]
v_pk_mul_f32 v[36:37], v[52:53], v[36:37]
v_pk_mul_f32 v[38:39], v[54:55], v[38:39]
v_pk_mul_f32 v[40:41], v[56:57], v[40:41]
v_pk_mul_f32 v[42:43], v[58:59], v[42:43]
v_pk_mul_f32 v[44:45], v[60:61], v[44:45]
v_pk_mul_f32 v[46:47], v[62:63], v[46:47]
v_pk_fma_f32 v[102:103], v[32:33], v[32:33], v[102:103]
v_pk_fma_f32 v[48:49], v[16:17], v[16:17], s[60:61] neg_lo:[1,0,0] neg_hi:[1,0,0]
v_pk_fma_f32 v[102:103], v[34:35], v[34:35], v[102:103]
v_pk_fma_f32 v[50:51], v[18:19], v[18:19], s[60:61] neg_lo:[1,0,0] neg_hi:[1,0,0]
v_pk_fma_f32 v[102:103], v[36:37], v[36:37], v[102:103]
v_pk_fma_f32 v[52:53], v[20:21], v[20:21], s[60:61] neg_lo:[1,0,0] neg_hi:[1,0,0]
v_pk_fma_f32 v[102:103], v[38:39], v[38:39], v[102:103]
v_pk_fma_f32 v[54:55], v[22:23], v[22:23], s[60:61] neg_lo:[1,0,0] neg_hi:[1,0,0]
v_pk_fma_f32 v[102:103], v[40:41], v[40:41], v[102:103]
v_pk_fma_f32 v[56:57], v[24:25], v[24:25], s[60:61] neg_lo:[1,0,0] neg_hi:[1,0,0]
v_pk_fma_f32 v[102:103], v[42:43], v[42:43], v[102:103]
v_pk_fma_f32 v[58:59], v[26:27], v[26:27], s[60:61] neg_lo:[1,0,0] neg_hi:[1,0,0]
v_pk_fma_f32 v[102:103], v[44:45], v[44:45], v[102:103]
v_pk_fma_f32 v[60:61], v[28:29], v[28:29], s[60:61] neg_lo:[1,0,0] neg_hi:[1,0,0]
v_pk_fma_f32 v[102:103], v[46:47], v[46:47], v[102:103]
v_pk_fma_f32 v[62:63], v[30:31], v[30:31], s[60:61] neg_lo:[1,0,0] neg_hi:[1,0,0]
v_pk_mul_f32 v[48:49], v[48:49], v[16:17]
v_pk_mul_f32 v[50:51], v[50:51], v[18:19]
v_pk_mul_f32 v[52:53], v[52:53], v[20:21]
v_pk_mul_f32 v[54:55], v[54:55], v[22:23]
v_pk_mul_f32 v[56:57], v[56:57], v[24:25]
v_pk_mul_f32 v[58:59], v[58:59], v[26:27]
v_pk_mul_f32 v[60:61], v[60:61], v[28:29]
v_pk_mul_f32 v[62:63], v[62:63], v[30:31]
v_cvt_pk_bf16_f32 v136, v32, v33
v_cvt_pk_bf16_f32 v137, v34, v35
v_cvt_pk_bf16_f32 v138, v36, v37
v_cvt_pk_bf16_f32 v139, v38, v39
v_cvt_pk_bf16_f32 v140, v40, v41
v_cvt_pk_bf16_f32 v141, v42, v43
v_cvt_pk_bf16_f32 v142, v44, v45
v_cvt_pk_bf16_f32 v143, v46, v47
s_waitcnt lgkmcnt(0)
v_mfma_f32_32x32x16_bf16 v[32:47], v[64:67], v[88:91], 0
ds_read_b128 v[88:91], v1 offset:20992
ds_write_b64 v3, v[136:137] offset:0
v_exp_f32 v48, v48
v_exp_f32 v49, v49
v_exp_f32 v50, v50
v_mfma_f32_32x32x16_bf16 v[32:47], v[68:71], v[92:95], v[32:47]
ds_read_b128 v[92:95], v1 offset:22528
ds_write_b64 v3, v[138:139] offset:128
v_exp_f32 v51, v51
v_exp_f32 v52, v52
v_mfma_f32_32x32x16_bf16 v[32:47], v[72:75], v[96:99], v[32:47]
ds_read_b128 v[96:99], v1 offset:23040
ds_write_b64 v3, v[140:141] offset:1024
v_exp_f32 v53, v53
v_exp_f32 v54, v54
v_exp_f32 v55, v55
v_exp_f32 v56, v56
v_exp_f32 v57, v57
v_exp_f32 v58, v58
v_exp_f32 v59, v59
v_exp_f32 v60, v60
v_exp_f32 v61, v61
v_exp_f32 v62, v62
v_exp_f32_e64 v63, v63
v_pk_add_f32 v[48:49], v[48:49], 1.0 op_sel_hi:[1,0]
v_pk_add_f32 v[50:51], v[50:51], 1.0 op_sel_hi:[1,0]
v_pk_add_f32 v[52:53], v[52:53], 1.0 op_sel_hi:[1,0]
v_pk_add_f32 v[54:55], v[54:55], 1.0 op_sel_hi:[1,0]
v_pk_add_f32 v[56:57], v[56:57], 1.0 op_sel_hi:[1,0]
v_pk_add_f32 v[58:59], v[58:59], 1.0 op_sel_hi:[1,0]
v_pk_add_f32 v[60:61], v[60:61], 1.0 op_sel_hi:[1,0]
v_pk_add_f32 v[62:63], v[62:63], 1.0 op_sel_hi:[1,0]
s_waitcnt lgkmcnt(0)
v_mfma_f32_32x32x16_bf16 v[32:47], v[76:79], v[88:91], v[32:47]
ds_read_b128 v[88:91], v1 offset:24576
ds_write_b64 v3, v[142:143] offset:1152
v_rcp_f32 v48, v48
v_rcp_f32 v49, v49
v_rcp_f32 v50, v50
v_mfma_f32_32x32x16_bf16 v[32:47], v[80:83], v[92:95], v[32:47]
ds_read_b128 v[92:95], v1 offset:25088
ds_read_b64_tr_b16 v[136:137], v4 offset:0
ds_read_b64_tr_b16 v[138:139], v4 offset:512
v_rcp_f32 v51, v51
v_rcp_f32 v52, v52
v_mfma_f32_32x32x16_bf16 v[32:47], v[84:87], v[96:99], v[32:47]
ds_read_b128 v[96:99], v1 offset:26624
ds_read_b64_tr_b16 v[140:141], v4 offset:1024
ds_read_b64_tr_b16 v[142:143], v4 offset:1536
v_rcp_f32 v53, v53
v_rcp_f32 v54, v54
v_rcp_f32 v55, v55
v_rcp_f32 v56, v56
v_rcp_f32 v57, v57
v_rcp_f32 v58, v58
v_rcp_f32 v59, v59
v_rcp_f32 v60, v60
v_rcp_f32 v61, v61
v_rcp_f32 v62, v62
v_rcp_f32_e64 v63, v63
v_pk_mul_f32 v[16:17], v[48:49], v[16:17]
v_pk_mul_f32 v[18:19], v[50:51], v[18:19]
v_pk_mul_f32 v[20:21], v[52:53], v[20:21]
v_pk_mul_f32 v[22:23], v[54:55], v[22:23]
v_pk_mul_f32 v[24:25], v[56:57], v[24:25]
v_pk_mul_f32 v[26:27], v[58:59], v[26:27]
v_pk_mul_f32 v[28:29], v[60:61], v[28:29]
v_pk_mul_f32 v[30:31], v[62:63], v[30:31]
v_pk_fma_f32 v[104:105], v[16:17], v[16:17], v[104:105]
v_pk_fma_f32 v[48:49], v[32:33], v[32:33], s[60:61] neg_lo:[1,0,0] neg_hi:[1,0,0]
v_pk_fma_f32 v[104:105], v[18:19], v[18:19], v[104:105]
v_pk_fma_f32 v[50:51], v[34:35], v[34:35], s[60:61] neg_lo:[1,0,0] neg_hi:[1,0,0]
v_pk_fma_f32 v[104:105], v[20:21], v[20:21], v[104:105]
v_pk_fma_f32 v[52:53], v[36:37], v[36:37], s[60:61] neg_lo:[1,0,0] neg_hi:[1,0,0]
v_pk_fma_f32 v[104:105], v[22:23], v[22:23], v[104:105]
v_pk_fma_f32 v[54:55], v[38:39], v[38:39], s[60:61] neg_lo:[1,0,0] neg_hi:[1,0,0]
v_pk_fma_f32 v[104:105], v[24:25], v[24:25], v[104:105]
v_pk_fma_f32 v[56:57], v[40:41], v[40:41], s[60:61] neg_lo:[1,0,0] neg_hi:[1,0,0]
v_pk_fma_f32 v[104:105], v[26:27], v[26:27], v[104:105]
v_pk_fma_f32 v[58:59], v[42:43], v[42:43], s[60:61] neg_lo:[1,0,0] neg_hi:[1,0,0]
v_pk_fma_f32 v[104:105], v[28:29], v[28:29], v[104:105]
v_pk_fma_f32 v[60:61], v[44:45], v[44:45], s[60:61] neg_lo:[1,0,0] neg_hi:[1,0,0]
v_pk_fma_f32 v[104:105], v[30:31], v[30:31], v[104:105]
v_pk_fma_f32 v[62:63], v[46:47], v[46:47], s[60:61] neg_lo:[1,0,0] neg_hi:[1,0,0]
v_pk_mul_f32 v[48:49], v[48:49], v[32:33]
v_pk_mul_f32 v[50:51], v[50:51], v[34:35]
v_pk_mul_f32 v[52:53], v[52:53], v[36:37]
v_pk_mul_f32 v[54:55], v[54:55], v[38:39]
v_pk_mul_f32 v[56:57], v[56:57], v[40:41]
v_pk_mul_f32 v[58:59], v[58:59], v[42:43]
v_pk_mul_f32 v[60:61], v[60:61], v[44:45]
v_pk_mul_f32 v[62:63], v[62:63], v[46:47]
v_cvt_pk_bf16_f32 v144, v16, v17
v_cvt_pk_bf16_f32 v145, v18, v19
v_cvt_pk_bf16_f32 v146, v20, v21
v_cvt_pk_bf16_f32 v147, v22, v23
v_cvt_pk_bf16_f32 v148, v24, v25
v_cvt_pk_bf16_f32 v149, v26, v27
v_cvt_pk_bf16_f32 v150, v28, v29
v_cvt_pk_bf16_f32 v151, v30, v31
s_waitcnt lgkmcnt(0)
v_mfma_f32_32x32x16_bf16 v[16:31], v[64:67], v[88:91], 0
ds_read_b128 v[88:91], v1 offset:27136
ds_write_b64 v3, v[144:145] offset:0
v_exp_f32 v48, v48
v_exp_f32 v49, v49
v_exp_f32 v50, v50
v_mfma_f32_32x32x16_bf16 v[16:31], v[68:71], v[92:95], v[16:31]
ds_read_b128 v[92:95], v1 offset:28672
ds_write_b64 v3, v[146:147] offset:128
v_exp_f32 v51, v51
v_exp_f32 v52, v52
v_mfma_f32_32x32x16_bf16 v[16:31], v[72:75], v[96:99], v[16:31]
ds_read_b128 v[96:99], v1 offset:29184
ds_write_b64 v3, v[148:149] offset:1024
v_exp_f32 v53, v53
v_exp_f32 v54, v54
v_exp_f32 v55, v55
v_exp_f32 v56, v56
v_exp_f32 v57, v57
v_exp_f32 v58, v58
v_exp_f32 v59, v59
v_exp_f32 v60, v60
v_exp_f32 v61, v61
v_exp_f32 v62, v62
v_exp_f32_e64 v63, v63
v_pk_add_f32 v[48:49], v[48:49], 1.0 op_sel_hi:[1,0]
v_pk_add_f32 v[50:51], v[50:51], 1.0 op_sel_hi:[1,0]
v_pk_add_f32 v[52:53], v[52:53], 1.0 op_sel_hi:[1,0]
v_pk_add_f32 v[54:55], v[54:55], 1.0 op_sel_hi:[1,0]
v_pk_add_f32 v[56:57], v[56:57], 1.0 op_sel_hi:[1,0]
v_pk_add_f32 v[58:59], v[58:59], 1.0 op_sel_hi:[1,0]
v_pk_add_f32 v[60:61], v[60:61], 1.0 op_sel_hi:[1,0]
v_pk_add_f32 v[62:63], v[62:63], 1.0 op_sel_hi:[1,0]
s_waitcnt lgkmcnt(0)
v_mfma_f32_32x32x16_bf16 v[16:31], v[76:79], v[88:91], v[16:31]
ds_read_b128 v[88:91], v1 offset:30720
ds_write_b64 v3, v[150:151] offset:1152
v_rcp_f32 v48, v48
v_rcp_f32 v49, v49
v_rcp_f32 v50, v50
v_mfma_f32_32x32x16_bf16 v[16:31], v[80:83], v[92:95], v[16:31]
ds_read_b128 v[92:95], v1 offset:31232
ds_read_b64_tr_b16 v[144:145], v4 offset:0
ds_read_b64_tr_b16 v[146:147], v4 offset:512
v_rcp_f32 v51, v51
v_rcp_f32 v52, v52
v_mfma_f32_32x32x16_bf16 v[16:31], v[84:87], v[96:99], v[16:31]
ds_read_b128 v[96:99], v1 offset:32768
ds_read_b64_tr_b16 v[148:149], v4 offset:1024
ds_read_b64_tr_b16 v[150:151], v4 offset:1536
v_rcp_f32 v53, v53
v_rcp_f32 v54, v54
v_rcp_f32 v55, v55
v_rcp_f32 v56, v56
v_rcp_f32 v57, v57
v_rcp_f32 v58, v58
v_rcp_f32 v59, v59
v_rcp_f32 v60, v60
v_rcp_f32 v61, v61
v_rcp_f32 v62, v62
v_rcp_f32_e64 v63, v63
v_pk_mul_f32 v[32:33], v[48:49], v[32:33]
v_pk_mul_f32 v[34:35], v[50:51], v[34:35]
v_pk_mul_f32 v[36:37], v[52:53], v[36:37]
v_pk_mul_f32 v[38:39], v[54:55], v[38:39]
v_pk_mul_f32 v[40:41], v[56:57], v[40:41]
v_pk_mul_f32 v[42:43], v[58:59], v[42:43]
v_pk_mul_f32 v[44:45], v[60:61], v[44:45]
v_pk_mul_f32 v[46:47], v[62:63], v[46:47]
v_pk_fma_f32 v[106:107], v[32:33], v[32:33], v[106:107]
v_pk_fma_f32 v[48:49], v[16:17], v[16:17], s[60:61] neg_lo:[1,0,0] neg_hi:[1,0,0]
v_pk_fma_f32 v[106:107], v[34:35], v[34:35], v[106:107]
v_pk_fma_f32 v[50:51], v[18:19], v[18:19], s[60:61] neg_lo:[1,0,0] neg_hi:[1,0,0]
v_pk_fma_f32 v[106:107], v[36:37], v[36:37], v[106:107]
v_pk_fma_f32 v[52:53], v[20:21], v[20:21], s[60:61] neg_lo:[1,0,0] neg_hi:[1,0,0]
v_pk_fma_f32 v[106:107], v[38:39], v[38:39], v[106:107]
v_pk_fma_f32 v[54:55], v[22:23], v[22:23], s[60:61] neg_lo:[1,0,0] neg_hi:[1,0,0]
v_pk_fma_f32 v[106:107], v[40:41], v[40:41], v[106:107]
v_pk_fma_f32 v[56:57], v[24:25], v[24:25], s[60:61] neg_lo:[1,0,0] neg_hi:[1,0,0]
v_pk_fma_f32 v[106:107], v[42:43], v[42:43], v[106:107]
v_pk_fma_f32 v[58:59], v[26:27], v[26:27], s[60:61] neg_lo:[1,0,0] neg_hi:[1,0,0]
v_pk_fma_f32 v[106:107], v[44:45], v[44:45], v[106:107]
v_pk_fma_f32 v[60:61], v[28:29], v[28:29], s[60:61] neg_lo:[1,0,0] neg_hi:[1,0,0]
v_pk_fma_f32 v[106:107], v[46:47], v[46:47], v[106:107]
v_pk_fma_f32 v[62:63], v[30:31], v[30:31], s[60:61] neg_lo:[1,0,0] neg_hi:[1,0,0]
v_pk_mul_f32 v[48:49], v[48:49], v[16:17]
v_pk_mul_f32 v[50:51], v[50:51], v[18:19]
v_pk_mul_f32 v[52:53], v[52:53], v[20:21]
v_pk_mul_f32 v[54:55], v[54:55], v[22:23]
v_pk_mul_f32 v[56:57], v[56:57], v[24:25]
v_pk_mul_f32 v[58:59], v[58:59], v[26:27]
v_pk_mul_f32 v[60:61], v[60:61], v[28:29]
v_pk_mul_f32 v[62:63], v[62:63], v[30:31]
v_cvt_pk_bf16_f32 v152, v32, v33
v_cvt_pk_bf16_f32 v153, v34, v35
v_cvt_pk_bf16_f32 v154, v36, v37
v_cvt_pk_bf16_f32 v155, v38, v39
v_cvt_pk_bf16_f32 v156, v40, v41
v_cvt_pk_bf16_f32 v157, v42, v43
v_cvt_pk_bf16_f32 v158, v44, v45
v_cvt_pk_bf16_f32 v159, v46, v47
s_waitcnt lgkmcnt(0)
v_mfma_f32_32x32x16_bf16 v[32:47], v[64:67], v[88:91], 0
ds_read_b128 v[88:91], v1 offset:33280
ds_write_b64 v3, v[152:153] offset:0
v_exp_f32 v48, v48
v_exp_f32 v49, v49
v_exp_f32 v50, v50
v_mfma_f32_32x32x16_bf16 v[32:47], v[68:71], v[92:95], v[32:47]
ds_read_b128 v[92:95], v1 offset:34816
ds_write_b64 v3, v[154:155] offset:128
v_exp_f32 v51, v51
v_exp_f32 v52, v52
v_mfma_f32_32x32x16_bf16 v[32:47], v[72:75], v[96:99], v[32:47]
ds_read_b128 v[96:99], v1 offset:35328
ds_write_b64 v3, v[156:157] offset:1024
v_exp_f32 v53, v53
v_exp_f32 v54, v54
v_exp_f32 v55, v55
v_exp_f32 v56, v56
v_exp_f32 v57, v57
v_exp_f32 v58, v58
v_exp_f32 v59, v59
v_exp_f32 v60, v60
v_exp_f32 v61, v61
v_exp_f32 v62, v62
v_exp_f32_e64 v63, v63
v_lshl_add_u32 v14, v0, 3, s87
v_pk_add_f32 v[48:49], v[48:49], 1.0 op_sel_hi:[1,0]
v_pk_add_f32 v[50:51], v[50:51], 1.0 op_sel_hi:[1,0]
v_pk_add_f32 v[52:53], v[52:53], 1.0 op_sel_hi:[1,0]
v_pk_add_f32 v[54:55], v[54:55], 1.0 op_sel_hi:[1,0]
v_pk_add_f32 v[56:57], v[56:57], 1.0 op_sel_hi:[1,0]
v_pk_add_f32 v[58:59], v[58:59], 1.0 op_sel_hi:[1,0]
v_pk_add_f32 v[60:61], v[60:61], 1.0 op_sel_hi:[1,0]
v_pk_add_f32 v[62:63], v[62:63], 1.0 op_sel_hi:[1,0]
s_waitcnt lgkmcnt(0)
v_mfma_f32_32x32x16_bf16 v[32:47], v[76:79], v[88:91], v[32:47]
ds_read_b128 v[88:91], v1 offset:36864
ds_write_b64 v3, v[158:159] offset:1152
v_rcp_f32 v48, v48
v_rcp_f32 v49, v49
v_rcp_f32_e64 v50, v50
v_mfma_f32_32x32x16_bf16 v[32:47], v[80:83], v[92:95], v[32:47]
ds_read_b128 v[92:95], v1 offset:37376
ds_read_b64_tr_b16 v[152:153], v4 offset:0
ds_read_b64_tr_b16 v[154:155], v4 offset:512
s_mov_b32 s75, 0
buffer_load_dword v8, v14, s[36:39], 0 offen
s_mov_b32 s75, 32768
v_mfma_f32_32x32x16_bf16 v[32:47], v[84:87], v[96:99], v[32:47]
ds_read_b128 v[96:99], v1 offset:38912
ds_read_b64_tr_b16 v[156:157], v4 offset:1024
ds_read_b64_tr_b16 v[158:159], v4 offset:1536
buffer_load_dword v9, v14, s[36:39], s75 offen
s_mov_b32 s75, 65536
buffer_load_dword v10, v14, s[36:39], s75 offen
v_rcp_f32 v51, v51
v_rcp_f32 v52, v52
v_rcp_f32 v53, v53
v_rcp_f32 v54, v54
v_rcp_f32 v55, v55
v_rcp_f32 v56, v56
v_rcp_f32 v57, v57
v_rcp_f32 v58, v58
v_rcp_f32 v59, v59
v_rcp_f32 v60, v60
v_rcp_f32 v61, v61
v_rcp_f32 v62, v62
v_rcp_f32_e64 v63, v63
v_pk_mul_f32 v[16:17], v[48:49], v[16:17]
v_pk_mul_f32 v[18:19], v[50:51], v[18:19]
v_pk_mul_f32 v[20:21], v[52:53], v[20:21]
v_pk_mul_f32 v[22:23], v[54:55], v[22:23]
v_pk_mul_f32 v[24:25], v[56:57], v[24:25]
v_pk_mul_f32 v[26:27], v[58:59], v[26:27]
v_pk_mul_f32 v[28:29], v[60:61], v[28:29]
v_pk_mul_f32 v[30:31], v[62:63], v[30:31]
v_pk_fma_f32 v[108:109], v[16:17], v[16:17], v[108:109]
v_pk_fma_f32 v[48:49], v[32:33], v[32:33], s[60:61] neg_lo:[1,0,0] neg_hi:[1,0,0]
v_pk_fma_f32 v[108:109], v[18:19], v[18:19], v[108:109]
v_pk_fma_f32 v[50:51], v[34:35], v[34:35], s[60:61] neg_lo:[1,0,0] neg_hi:[1,0,0]
v_pk_fma_f32 v[108:109], v[20:21], v[20:21], v[108:109]
v_pk_fma_f32 v[52:53], v[36:37], v[36:37], s[60:61] neg_lo:[1,0,0] neg_hi:[1,0,0]
v_pk_fma_f32 v[108:109], v[22:23], v[22:23], v[108:109]
v_pk_fma_f32 v[54:55], v[38:39], v[38:39], s[60:61] neg_lo:[1,0,0] neg_hi:[1,0,0]
v_pk_fma_f32 v[108:109], v[24:25], v[24:25], v[108:109]
v_pk_fma_f32 v[56:57], v[40:41], v[40:41], s[60:61] neg_lo:[1,0,0] neg_hi:[1,0,0]
v_pk_fma_f32 v[108:109], v[26:27], v[26:27], v[108:109]
v_pk_fma_f32 v[58:59], v[42:43], v[42:43], s[60:61] neg_lo:[1,0,0] neg_hi:[1,0,0]
v_pk_fma_f32 v[108:109], v[28:29], v[28:29], v[108:109]
v_pk_fma_f32 v[60:61], v[44:45], v[44:45], s[60:61] neg_lo:[1,0,0] neg_hi:[1,0,0]
v_pk_fma_f32 v[108:109], v[30:31], v[30:31], v[108:109]
v_pk_fma_f32 v[62:63], v[46:47], v[46:47], s[60:61] neg_lo:[1,0,0] neg_hi:[1,0,0]
v_pk_mul_f32 v[48:49], v[48:49], v[32:33]
v_pk_mul_f32 v[50:51], v[50:51], v[34:35]
v_pk_mul_f32 v[52:53], v[52:53], v[36:37]
v_pk_mul_f32 v[54:55], v[54:55], v[38:39]
v_pk_mul_f32 v[56:57], v[56:57], v[40:41]
v_pk_mul_f32 v[58:59], v[58:59], v[42:43]
v_pk_mul_f32 v[60:61], v[60:61], v[44:45]
v_pk_mul_f32 v[62:63], v[62:63], v[46:47]
v_cvt_pk_bf16_f32 v160, v16, v17
v_cvt_pk_bf16_f32 v161, v18, v19
v_cvt_pk_bf16_f32 v162, v20, v21
v_cvt_pk_bf16_f32 v163, v22, v23
v_cvt_pk_bf16_f32 v164, v24, v25
v_cvt_pk_bf16_f32 v165, v26, v27
v_cvt_pk_bf16_f32 v166, v28, v29
v_cvt_pk_bf16_f32 v167, v30, v31
s_waitcnt lgkmcnt(0)
v_mfma_f32_32x32x16_bf16 v[16:31], v[64:67], v[88:91], 0
ds_read_b128 v[88:91], v1 offset:39424
ds_write_b64 v3, v[160:161] offset:0
v_exp_f32 v48, v48
v_exp_f32 v49, v49
v_exp_f32 v50, v50
v_mfma_f32_32x32x16_bf16 v[16:31], v[68:71], v[92:95], v[16:31]
ds_read_b128 v[92:95], v1 offset:40960
ds_write_b64 v3, v[162:163] offset:128
v_exp_f32 v51, v51
v_exp_f32 v52, v52
v_mfma_f32_32x32x16_bf16 v[16:31], v[72:75], v[96:99], v[16:31]
ds_read_b128 v[96:99], v1 offset:41472
ds_write_b64 v3, v[164:165] offset:1024
v_exp_f32 v53, v53
v_exp_f32 v54, v54
v_exp_f32 v55, v55
v_exp_f32 v56, v56
v_exp_f32 v57, v57
v_exp_f32 v58, v58
v_exp_f32 v59, v59
v_exp_f32 v60, v60
v_exp_f32 v61, v61
v_exp_f32 v62, v62
v_exp_f32_e64 v63, v63
v_pk_add_f32 v[48:49], v[48:49], 1.0 op_sel_hi:[1,0]
v_pk_add_f32 v[50:51], v[50:51], 1.0 op_sel_hi:[1,0]
v_pk_add_f32 v[52:53], v[52:53], 1.0 op_sel_hi:[1,0]
v_pk_add_f32 v[54:55], v[54:55], 1.0 op_sel_hi:[1,0]
v_pk_add_f32 v[56:57], v[56:57], 1.0 op_sel_hi:[1,0]
v_pk_add_f32 v[58:59], v[58:59], 1.0 op_sel_hi:[1,0]
v_pk_add_f32 v[60:61], v[60:61], 1.0 op_sel_hi:[1,0]
v_pk_add_f32 v[62:63], v[62:63], 1.0 op_sel_hi:[1,0]
s_waitcnt lgkmcnt(0)
v_mfma_f32_32x32x16_bf16 v[16:31], v[76:79], v[88:91], v[16:31]
ds_read_b128 v[88:91], v1 offset:43008
ds_write_b64 v3, v[166:167] offset:1152
v_rcp_f32 v48, v48
v_rcp_f32 v49, v49
v_rcp_f32 v50, v50
v_mfma_f32_32x32x16_bf16 v[16:31], v[80:83], v[92:95], v[16:31]
ds_read_b128 v[92:95], v1 offset:43520
ds_read_b64_tr_b16 v[160:161], v4 offset:0
ds_read_b64_tr_b16 v[162:163], v4 offset:512
v_rcp_f32 v51, v51
v_rcp_f32 v52, v52
v_mfma_f32_32x32x16_bf16 v[16:31], v[84:87], v[96:99], v[16:31]
ds_read_b128 v[96:99], v1 offset:45056
ds_read_b64_tr_b16 v[164:165], v4 offset:1024
ds_read_b64_tr_b16 v[166:167], v4 offset:1536
v_rcp_f32 v53, v53
v_rcp_f32 v54, v54
v_rcp_f32 v55, v55
v_rcp_f32 v56, v56
v_rcp_f32 v57, v57
v_rcp_f32 v58, v58
v_rcp_f32 v59, v59
v_rcp_f32 v60, v60
v_rcp_f32 v61, v61
v_rcp_f32 v62, v62
v_rcp_f32_e64 v63, v63
v_pk_mul_f32 v[32:33], v[48:49], v[32:33]
v_pk_mul_f32 v[34:35], v[50:51], v[34:35]
v_pk_mul_f32 v[36:37], v[52:53], v[36:37]
v_pk_mul_f32 v[38:39], v[54:55], v[38:39]
v_pk_mul_f32 v[40:41], v[56:57], v[40:41]
v_pk_mul_f32 v[42:43], v[58:59], v[42:43]
v_pk_mul_f32 v[44:45], v[60:61], v[44:45]
v_pk_mul_f32 v[46:47], v[62:63], v[46:47]
v_pk_fma_f32 v[110:111], v[32:33], v[32:33], v[110:111]
v_pk_fma_f32 v[48:49], v[16:17], v[16:17], s[60:61] neg_lo:[1,0,0] neg_hi:[1,0,0]
v_pk_fma_f32 v[110:111], v[34:35], v[34:35], v[110:111]
v_pk_fma_f32 v[50:51], v[18:19], v[18:19], s[60:61] neg_lo:[1,0,0] neg_hi:[1,0,0]
v_pk_fma_f32 v[110:111], v[36:37], v[36:37], v[110:111]
v_pk_fma_f32 v[52:53], v[20:21], v[20:21], s[60:61] neg_lo:[1,0,0] neg_hi:[1,0,0]
v_pk_fma_f32 v[110:111], v[38:39], v[38:39], v[110:111]
v_pk_fma_f32 v[54:55], v[22:23], v[22:23], s[60:61] neg_lo:[1,0,0] neg_hi:[1,0,0]
v_pk_fma_f32 v[110:111], v[40:41], v[40:41], v[110:111]
v_pk_fma_f32 v[56:57], v[24:25], v[24:25], s[60:61] neg_lo:[1,0,0] neg_hi:[1,0,0]
v_pk_fma_f32 v[110:111], v[42:43], v[42:43], v[110:111]
v_pk_fma_f32 v[58:59], v[26:27], v[26:27], s[60:61] neg_lo:[1,0,0] neg_hi:[1,0,0]
v_pk_fma_f32 v[110:111], v[44:45], v[44:45], v[110:111]
v_pk_fma_f32 v[60:61], v[28:29], v[28:29], s[60:61] neg_lo:[1,0,0] neg_hi:[1,0,0]
v_pk_fma_f32 v[110:111], v[46:47], v[46:47], v[110:111]
v_pk_fma_f32 v[62:63], v[30:31], v[30:31], s[60:61] neg_lo:[1,0,0] neg_hi:[1,0,0]
v_pk_mul_f32 v[48:49], v[48:49], v[16:17]
v_pk_mul_f32 v[50:51], v[50:51], v[18:19]
v_pk_mul_f32 v[52:53], v[52:53], v[20:21]
v_pk_mul_f32 v[54:55], v[54:55], v[22:23]
v_pk_mul_f32 v[56:57], v[56:57], v[24:25]
v_pk_mul_f32 v[58:59], v[58:59], v[26:27]
v_pk_mul_f32 v[60:61], v[60:61], v[28:29]
v_pk_mul_f32 v[62:63], v[62:63], v[30:31]
v_cvt_pk_bf16_f32 v168, v32, v33
v_cvt_pk_bf16_f32 v169, v34, v35
v_cvt_pk_bf16_f32 v170, v36, v37
v_cvt_pk_bf16_f32 v171, v38, v39
v_cvt_pk_bf16_f32 v172, v40, v41
v_cvt_pk_bf16_f32 v173, v42, v43
v_cvt_pk_bf16_f32 v174, v44, v45
v_cvt_pk_bf16_f32 v175, v46, v47
s_waitcnt lgkmcnt(0)
v_mfma_f32_32x32x16_bf16 v[32:47], v[64:67], v[88:91], 0
ds_read_b128 v[88:91], v1 offset:45568
ds_write_b64 v3, v[168:169] offset:0
v_exp_f32 v48, v48
v_exp_f32 v49, v49
v_exp_f32 v50, v50
v_mfma_f32_32x32x16_bf16 v[32:47], v[68:71], v[92:95], v[32:47]
ds_read_b128 v[92:95], v1 offset:47104
ds_write_b64 v3, v[170:171] offset:128
s_add_u32 s74, s87, L_sync-L_pc
v_exp_f32 v51, v51
v_exp_f32 v52, v52
v_mfma_f32_32x32x16_bf16 v[32:47], v[72:75], v[96:99], v[32:47]
ds_read_b128 v[96:99], v1 offset:47616
ds_write_b64 v3, v[172:173] offset:1024
v_exp_f32 v53, v53
v_lshl_add_u32 v14, v0, 3, s74
v_exp_f32 v54, v54
v_exp_f32 v55, v55
v_min_u32 v14, L_pf1-L_pc-4, v14
v_exp_f32 v56, v56
v_exp_f32 v57, v57
v_exp_f32 v58, v58
v_mov_b32 v15, s89
v_exp_f32 v59, v59
v_exp_f32 v60, v60
v_exp_f32 v61, v61
v_add_co_u32 v14, vcc, s88, v14
v_exp_f32 v62, v62
v_exp_f32 v63, v63
v_addc_co_u32_e64 v15, vcc, 0, v15, vcc
v_pk_add_f32 v[48:49], v[48:49], 1.0 op_sel_hi:[1,0]
v_pk_add_f32 v[50:51], v[50:51], 1.0 op_sel_hi:[1,0]
v_pk_add_f32 v[52:53], v[52:53], 1.0 op_sel_hi:[1,0]
v_pk_add_f32 v[54:55], v[54:55], 1.0 op_sel_hi:[1,0]
v_pk_add_f32 v[56:57], v[56:57], 1.0 op_sel_hi:[1,0]
v_pk_add_f32 v[58:59], v[58:59], 1.0 op_sel_hi:[1,0]
v_pk_add_f32 v[60:61], v[60:61], 1.0 op_sel_hi:[1,0]
v_pk_add_f32 v[62:63], v[62:63], 1.0 op_sel_hi:[1,0]
s_waitcnt lgkmcnt(0)
v_mfma_f32_32x32x16_bf16 v[32:47], v[76:79], v[88:91], v[32:47]
ds_read_b128 v[88:91], v1 offset:49152
ds_write_b64 v3, v[174:175] offset:1152
v_rcp_f32 v48, v48
v_rcp_f32 v49, v49
v_rcp_f32_e64 v50, v50
v_mfma_f32_32x32x16_bf16 v[32:47], v[80:83], v[92:95], v[32:47]
ds_read_b128 v[92:95], v1 offset:49664
ds_read_b64_tr_b16 v[168:169], v4 offset:0
ds_read_b64_tr_b16 v[170:171], v4 offset:512
v_rcp_f32 v51, v51
v_rcp_f32 v52, v52
v_mfma_f32_32x32x16_bf16 v[32:47], v[84:87], v[96:99], v[32:47]
ds_read_b128 v[96:99], v1 offset:51200
ds_read_b64_tr_b16 v[172:173], v4 offset:1024
ds_read_b64_tr_b16 v[174:175], v4 offset:1536
s_waitcnt vmcnt(3)
global_load_dword v126, v[14:15], off
v_rcp_f32 v53, v53
v_rcp_f32 v54, v54
v_rcp_f32 v55, v55
v_rcp_f32 v56, v56
v_rcp_f32 v57, v57
v_rcp_f32 v58, v58
v_rcp_f32 v59, v59
v_rcp_f32 v60, v60
v_rcp_f32 v61, v61
v_rcp_f32 v62, v62
v_rcp_f32 v63, v63
v_pk_mul_f32 v[16:17], v[48:49], v[16:17]
v_pk_mul_f32 v[18:19], v[50:51], v[18:19]
v_pk_mul_f32 v[20:21], v[52:53], v[20:21]
v_pk_mul_f32 v[22:23], v[54:55], v[22:23]
v_pk_mul_f32 v[24:25], v[56:57], v[24:25]
v_pk_mul_f32 v[26:27], v[58:59], v[26:27]
v_pk_mul_f32 v[28:29], v[60:61], v[28:29]
v_pk_mul_f32 v[30:31], v[62:63], v[30:31]
v_pk_fma_f32 v[112:113], v[16:17], v[16:17], v[112:113]
v_pk_fma_f32 v[48:49], v[32:33], v[32:33], s[60:61] neg_lo:[1,0,0] neg_hi:[1,0,0]
v_pk_fma_f32 v[112:113], v[18:19], v[18:19], v[112:113]
v_pk_fma_f32 v[50:51], v[34:35], v[34:35], s[60:61] neg_lo:[1,0,0] neg_hi:[1,0,0]
v_pk_fma_f32 v[112:113], v[20:21], v[20:21], v[112:113]
v_pk_fma_f32 v[52:53], v[36:37], v[36:37], s[60:61] neg_lo:[1,0,0] neg_hi:[1,0,0]
v_pk_fma_f32 v[112:113], v[22:23], v[22:23], v[112:113]
v_pk_fma_f32 v[54:55], v[38:39], v[38:39], s[60:61] neg_lo:[1,0,0] neg_hi:[1,0,0]
v_pk_fma_f32 v[112:113], v[24:25], v[24:25], v[112:113]
v_pk_fma_f32 v[56:57], v[40:41], v[40:41], s[60:61] neg_lo:[1,0,0] neg_hi:[1,0,0]
v_pk_fma_f32 v[112:113], v[26:27], v[26:27], v[112:113]
v_pk_fma_f32 v[58:59], v[42:43], v[42:43], s[60:61] neg_lo:[1,0,0] neg_hi:[1,0,0]
v_pk_fma_f32 v[112:113], v[28:29], v[28:29], v[112:113]
v_pk_fma_f32 v[60:61], v[44:45], v[44:45], s[60:61] neg_lo:[1,0,0] neg_hi:[1,0,0]
v_pk_fma_f32 v[112:113], v[30:31], v[30:31], v[112:113]
v_pk_fma_f32 v[62:63], v[46:47], v[46:47], s[60:61] neg_lo:[1,0,0] neg_hi:[1,0,0]
v_pk_mul_f32 v[48:49], v[48:49], v[32:33]
v_pk_mul_f32 v[50:51], v[50:51], v[34:35]
v_pk_mul_f32 v[52:53], v[52:53], v[36:37]
v_pk_mul_f32 v[54:55], v[54:55], v[38:39]
v_pk_mul_f32 v[56:57], v[56:57], v[40:41]
v_pk_mul_f32 v[58:59], v[58:59], v[42:43]
v_pk_mul_f32 v[60:61], v[60:61], v[44:45]
v_pk_mul_f32 v[62:63], v[62:63], v[46:47]
v_cvt_pk_bf16_f32 v176, v16, v17
v_cvt_pk_bf16_f32 v177, v18, v19
v_cvt_pk_bf16_f32 v178, v20, v21
v_cvt_pk_bf16_f32 v179, v22, v23
v_cvt_pk_bf16_f32 v180, v24, v25
v_cvt_pk_bf16_f32 v181, v26, v27
v_cvt_pk_bf16_f32 v182, v28, v29
v_cvt_pk_bf16_f32 v183, v30, v31
s_waitcnt lgkmcnt(0)
v_mfma_f32_32x32x16_bf16 v[16:31], v[64:67], v[88:91], 0
ds_read_b128 v[88:91], v1 offset:51712
ds_write_b64 v3, v[176:177] offset:0
v_exp_f32 v48, v48
v_exp_f32 v49, v49
v_exp_f32 v50, v50
v_mfma_f32_32x32x16_bf16 v[16:31], v[68:71], v[92:95], v[16:31]
ds_read_b128 v[92:95], v1 offset:53248
ds_write_b64 v3, v[178:179] offset:128
v_exp_f32 v51, v51
v_exp_f32 v52, v52
v_mfma_f32_32x32x16_bf16 v[16:31], v[72:75], v[96:99], v[16:31]
ds_read_b128 v[96:99], v1 offset:53760
ds_write_b64 v3, v[180:181] offset:1024
v_exp_f32 v53, v53
v_exp_f32 v54, v54
v_exp_f32 v55, v55
v_exp_f32 v56, v56
v_exp_f32 v57, v57
v_exp_f32 v58, v58
v_exp_f32 v59, v59
v_exp_f32 v60, v60
v_exp_f32 v61, v61
v_exp_f32 v62, v62
v_exp_f32_e64 v63, v63
v_pk_add_f32 v[48:49], v[48:49], 1.0 op_sel_hi:[1,0]
v_pk_add_f32 v[50:51], v[50:51], 1.0 op_sel_hi:[1,0]
v_pk_add_f32 v[52:53], v[52:53], 1.0 op_sel_hi:[1,0]
v_pk_add_f32 v[54:55], v[54:55], 1.0 op_sel_hi:[1,0]
v_pk_add_f32 v[56:57], v[56:57], 1.0 op_sel_hi:[1,0]
v_pk_add_f32 v[58:59], v[58:59], 1.0 op_sel_hi:[1,0]
v_pk_add_f32 v[60:61], v[60:61], 1.0 op_sel_hi:[1,0]
v_pk_add_f32 v[62:63], v[62:63], 1.0 op_sel_hi:[1,0]
s_waitcnt lgkmcnt(0)
v_mfma_f32_32x32x16_bf16 v[16:31], v[76:79], v[88:91], v[16:31]
ds_read_b128 v[88:91], v1 offset:55296
ds_write_b64 v3, v[182:183] offset:1152
v_rcp_f32 v48, v48
v_rcp_f32 v49, v49
v_rcp_f32 v50, v50
v_mfma_f32_32x32x16_bf16 v[16:31], v[80:83], v[92:95], v[16:31]
ds_read_b128 v[92:95], v1 offset:55808
ds_read_b64_tr_b16 v[176:177], v4 offset:0
ds_read_b64_tr_b16 v[178:179], v4 offset:512
v_rcp_f32 v51, v51
v_rcp_f32 v52, v52
v_mfma_f32_32x32x16_bf16 v[16:31], v[84:87], v[96:99], v[16:31]
ds_read_b128 v[96:99], v1 offset:57344
ds_read_b64_tr_b16 v[180:181], v4 offset:1024
ds_read_b64_tr_b16 v[182:183], v4 offset:1536
v_rcp_f32 v53, v53
v_rcp_f32 v54, v54
v_rcp_f32 v55, v55
v_rcp_f32 v56, v56
v_rcp_f32 v57, v57
v_rcp_f32 v58, v58
v_rcp_f32 v59, v59
v_rcp_f32 v60, v60
v_rcp_f32 v61, v61
v_rcp_f32 v62, v62
v_rcp_f32_e64 v63, v63
v_pk_mul_f32 v[32:33], v[48:49], v[32:33]
v_pk_mul_f32 v[34:35], v[50:51], v[34:35]
v_pk_mul_f32 v[36:37], v[52:53], v[36:37]
v_pk_mul_f32 v[38:39], v[54:55], v[38:39]
v_pk_mul_f32 v[40:41], v[56:57], v[40:41]
v_pk_mul_f32 v[42:43], v[58:59], v[42:43]
v_pk_mul_f32 v[44:45], v[60:61], v[44:45]
v_pk_mul_f32 v[46:47], v[62:63], v[46:47]
v_pk_fma_f32 v[114:115], v[32:33], v[32:33], v[114:115]
v_pk_fma_f32 v[48:49], v[16:17], v[16:17], s[60:61] neg_lo:[1,0,0] neg_hi:[1,0,0]
v_pk_fma_f32 v[114:115], v[34:35], v[34:35], v[114:115]
v_pk_fma_f32 v[50:51], v[18:19], v[18:19], s[60:61] neg_lo:[1,0,0] neg_hi:[1,0,0]
v_pk_fma_f32 v[114:115], v[36:37], v[36:37], v[114:115]
v_pk_fma_f32 v[52:53], v[20:21], v[20:21], s[60:61] neg_lo:[1,0,0] neg_hi:[1,0,0]
v_pk_fma_f32 v[114:115], v[38:39], v[38:39], v[114:115]
v_pk_fma_f32 v[54:55], v[22:23], v[22:23], s[60:61] neg_lo:[1,0,0] neg_hi:[1,0,0]
v_pk_fma_f32 v[114:115], v[40:41], v[40:41], v[114:115]
v_pk_fma_f32 v[56:57], v[24:25], v[24:25], s[60:61] neg_lo:[1,0,0] neg_hi:[1,0,0]
v_pk_fma_f32 v[114:115], v[42:43], v[42:43], v[114:115]
v_pk_fma_f32 v[58:59], v[26:27], v[26:27], s[60:61] neg_lo:[1,0,0] neg_hi:[1,0,0]
v_pk_fma_f32 v[114:115], v[44:45], v[44:45], v[114:115]
v_pk_fma_f32 v[60:61], v[28:29], v[28:29], s[60:61] neg_lo:[1,0,0] neg_hi:[1,0,0]
v_pk_fma_f32 v[114:115], v[46:47], v[46:47], v[114:115]
v_pk_fma_f32 v[62:63], v[30:31], v[30:31], s[60:61] neg_lo:[1,0,0] neg_hi:[1,0,0]
v_pk_mul_f32 v[48:49], v[48:49], v[16:17]
v_pk_mul_f32 v[50:51], v[50:51], v[18:19]
v_pk_mul_f32 v[52:53], v[52:53], v[20:21]
v_pk_mul_f32 v[54:55], v[54:55], v[22:23]
v_pk_mul_f32 v[56:57], v[56:57], v[24:25]
v_pk_mul_f32 v[58:59], v[58:59], v[26:27]
v_pk_mul_f32 v[60:61], v[60:61], v[28:29]
v_pk_mul_f32 v[62:63], v[62:63], v[30:31]
v_cvt_pk_bf16_f32 v184, v32, v33
v_cvt_pk_bf16_f32 v185, v34, v35
v_cvt_pk_bf16_f32 v186, v36, v37
v_cvt_pk_bf16_f32 v187, v38, v39
v_cvt_pk_bf16_f32 v188, v40, v41
v_cvt_pk_bf16_f32 v189, v42, v43
v_cvt_pk_bf16_f32 v190, v44, v45
v_cvt_pk_bf16_f32 v191, v46, v47
s_waitcnt lgkmcnt(0)
v_mfma_f32_32x32x16_bf16 v[32:47], v[64:67], v[88:91], 0
ds_read_b128 v[88:91], v1 offset:57856
ds_write_b64 v3, v[184:185] offset:0
v_exp_f32 v48, v48
v_exp_f32 v49, v49
v_exp_f32 v50, v50
v_mfma_f32_32x32x16_bf16 v[32:47], v[68:71], v[92:95], v[32:47]
ds_read_b128 v[92:95], v1 offset:59392
ds_write_b64 v3, v[186:187] offset:128
v_exp_f32 v51, v51
v_exp_f32 v52, v52
v_mfma_f32_32x32x16_bf16 v[32:47], v[72:75], v[96:99], v[32:47]
ds_read_b128 v[96:99], v1 offset:59904
ds_write_b64 v3, v[188:189] offset:1024
v_exp_f32 v53, v53
v_exp_f32 v54, v54
v_exp_f32 v55, v55
v_exp_f32 v56, v56
v_exp_f32 v57, v57
v_exp_f32 v58, v58
v_exp_f32 v59, v59
v_exp_f32 v60, v60
v_exp_f32 v61, v61
v_exp_f32 v62, v62
v_exp_f32_e64 v63, v63
v_pk_add_f32 v[48:49], v[48:49], 1.0 op_sel_hi:[1,0]
v_pk_add_f32 v[50:51], v[50:51], 1.0 op_sel_hi:[1,0]
v_pk_add_f32 v[52:53], v[52:53], 1.0 op_sel_hi:[1,0]
v_pk_add_f32 v[54:55], v[54:55], 1.0 op_sel_hi:[1,0]
v_pk_add_f32 v[56:57], v[56:57], 1.0 op_sel_hi:[1,0]
v_pk_add_f32 v[58:59], v[58:59], 1.0 op_sel_hi:[1,0]
v_pk_add_f32 v[60:61], v[60:61], 1.0 op_sel_hi:[1,0]
v_pk_add_f32 v[62:63], v[62:63], 1.0 op_sel_hi:[1,0]
s_waitcnt lgkmcnt(0)
v_mfma_f32_32x32x16_bf16 v[32:47], v[76:79], v[88:91], v[32:47]
ds_read_b128 v[88:91], v1 offset:61440
ds_write_b64 v3, v[190:191] offset:1152
v_rcp_f32 v48, v48
v_rcp_f32 v49, v49
v_rcp_f32 v50, v50
v_mfma_f32_32x32x16_bf16 v[32:47], v[80:83], v[92:95], v[32:47]
ds_read_b128 v[92:95], v1 offset:61952
ds_read_b64_tr_b16 v[184:185], v4 offset:0
ds_read_b64_tr_b16 v[186:187], v4 offset:512
v_rcp_f32 v51, v51
v_rcp_f32 v52, v52
v_mfma_f32_32x32x16_bf16 v[32:47], v[84:87], v[96:99], v[32:47]
ds_read_b128 v[96:99], v1 offset:63488
ds_read_b64_tr_b16 v[188:189], v4 offset:1024
ds_read_b64_tr_b16 v[190:191], v4 offset:1536
v_rcp_f32 v53, v53
v_rcp_f32 v54, v54
v_rcp_f32 v55, v55
v_rcp_f32 v56, v56
v_rcp_f32 v57, v57
v_rcp_f32 v58, v58
v_rcp_f32 v59, v59
v_rcp_f32 v60, v60
v_rcp_f32 v61, v61
v_rcp_f32 v62, v62
v_rcp_f32_e64 v63, v63
v_pk_mul_f32 v[16:17], v[48:49], v[16:17]
v_pk_mul_f32 v[18:19], v[50:51], v[18:19]
v_pk_mul_f32 v[20:21], v[52:53], v[20:21]
v_pk_mul_f32 v[22:23], v[54:55], v[22:23]
v_pk_mul_f32 v[24:25], v[56:57], v[24:25]
v_pk_mul_f32 v[26:27], v[58:59], v[26:27]
v_pk_mul_f32 v[28:29], v[60:61], v[28:29]
v_pk_mul_f32 v[30:31], v[62:63], v[30:31]
v_pk_fma_f32 v[116:117], v[16:17], v[16:17], v[116:117]
v_pk_fma_f32 v[48:49], v[32:33], v[32:33], s[60:61] neg_lo:[1,0,0] neg_hi:[1,0,0]
v_pk_fma_f32 v[116:117], v[18:19], v[18:19], v[116:117]
v_pk_fma_f32 v[50:51], v[34:35], v[34:35], s[60:61] neg_lo:[1,0,0] neg_hi:[1,0,0]
v_pk_fma_f32 v[116:117], v[20:21], v[20:21], v[116:117]
v_pk_fma_f32 v[52:53], v[36:37], v[36:37], s[60:61] neg_lo:[1,0,0] neg_hi:[1,0,0]
v_pk_fma_f32 v[116:117], v[22:23], v[22:23], v[116:117]
v_pk_fma_f32 v[54:55], v[38:39], v[38:39], s[60:61] neg_lo:[1,0,0] neg_hi:[1,0,0]
v_pk_fma_f32 v[116:117], v[24:25], v[24:25], v[116:117]
v_pk_fma_f32 v[56:57], v[40:41], v[40:41], s[60:61] neg_lo:[1,0,0] neg_hi:[1,0,0]
v_pk_fma_f32 v[116:117], v[26:27], v[26:27], v[116:117]
v_pk_fma_f32 v[58:59], v[42:43], v[42:43], s[60:61] neg_lo:[1,0,0] neg_hi:[1,0,0]
v_pk_fma_f32 v[116:117], v[28:29], v[28:29], v[116:117]
v_pk_fma_f32 v[60:61], v[44:45], v[44:45], s[60:61] neg_lo:[1,0,0] neg_hi:[1,0,0]
v_pk_fma_f32 v[116:117], v[30:31], v[30:31], v[116:117]
v_pk_fma_f32 v[62:63], v[46:47], v[46:47], s[60:61] neg_lo:[1,0,0] neg_hi:[1,0,0]
v_pk_mul_f32 v[48:49], v[48:49], v[32:33]
v_pk_mul_f32 v[50:51], v[50:51], v[34:35]
v_pk_mul_f32 v[52:53], v[52:53], v[36:37]
v_pk_mul_f32 v[54:55], v[54:55], v[38:39]
v_pk_mul_f32 v[56:57], v[56:57], v[40:41]
v_pk_mul_f32 v[58:59], v[58:59], v[42:43]
v_pk_mul_f32 v[60:61], v[60:61], v[44:45]
v_pk_mul_f32 v[62:63], v[62:63], v[46:47]
v_cvt_pk_bf16_f32 v192, v16, v17
v_cvt_pk_bf16_f32 v193, v18, v19
v_cvt_pk_bf16_f32 v194, v20, v21
v_cvt_pk_bf16_f32 v195, v22, v23
v_cvt_pk_bf16_f32 v196, v24, v25
v_cvt_pk_bf16_f32 v197, v26, v27
v_cvt_pk_bf16_f32 v198, v28, v29
v_cvt_pk_bf16_f32 v199, v30, v31
s_waitcnt lgkmcnt(0)
v_mfma_f32_32x32x16_bf16 v[16:31], v[64:67], v[88:91], 0
ds_read_b128 v[88:91], v1 offset:64000
ds_write_b64 v3, v[192:193] offset:0
v_exp_f32 v48, v48
v_exp_f32 v49, v49
v_exp_f32 v50, v50
v_mfma_f32_32x32x16_bf16 v[16:31], v[68:71], v[92:95], v[16:31]
ds_read_b128 v[92:95], v7 offset:0
ds_write_b64 v3, v[194:195] offset:128
v_exp_f32 v51, v51
v_exp_f32 v52, v52
v_mfma_f32_32x32x16_bf16 v[16:31], v[72:75], v[96:99], v[16:31]
ds_read_b128 v[96:99], v7 offset:512
ds_write_b64 v3, v[196:197] offset:1024
v_exp_f32 v53, v53
v_exp_f32 v54, v54
v_exp_f32 v55, v55
v_exp_f32 v56, v56
v_exp_f32 v57, v57
v_exp_f32 v58, v58
v_exp_f32 v59, v59
v_exp_f32 v60, v60
v_exp_f32 v61, v61
v_exp_f32 v62, v62
v_exp_f32 v63, v63
v_mov_b32_e64 v125, 0
v_pk_add_f32 v[48:49], v[48:49], 1.0 op_sel_hi:[1,0]
v_pk_add_f32 v[50:51], v[50:51], 1.0 op_sel_hi:[1,0]
v_pk_add_f32 v[52:53], v[52:53], 1.0 op_sel_hi:[1,0]
v_pk_add_f32 v[54:55], v[54:55], 1.0 op_sel_hi:[1,0]
v_pk_add_f32 v[56:57], v[56:57], 1.0 op_sel_hi:[1,0]
v_pk_add_f32 v[58:59], v[58:59], 1.0 op_sel_hi:[1,0]
v_pk_add_f32 v[60:61], v[60:61], 1.0 op_sel_hi:[1,0]
v_pk_add_f32 v[62:63], v[62:63], 1.0 op_sel_hi:[1,0]
s_waitcnt lgkmcnt(0)
v_mfma_f32_32x32x16_bf16 v[16:31], v[76:79], v[88:91], v[16:31]
ds_read_b128 v[88:91], v7 offset:2048
ds_write_b64 v3, v[198:199] offset:1152
v_rcp_f32 v48, v48
v_rcp_f32 v49, v49
v_rcp_f32_e64 v50, v50
v_mfma_f32_32x32x16_bf16 v[16:31], v[80:83], v[92:95], v[16:31]
ds_read_b128 v[92:95], v7 offset:2560
ds_read_b64_tr_b16 v[192:193], v4 offset:0
ds_read_b64_tr_b16 v[194:195], v4 offset:512
v_rcp_f32 v51, v51
v_rcp_f32 v52, v52
v_mfma_f32_32x32x16_bf16 v[16:31], v[84:87], v[96:99], v[16:31]
ds_read_b128 v[96:99], v7 offset:4096
ds_read_b64_tr_b16 v[196:197], v4 offset:1024
ds_read_b64_tr_b16 v[198:199], v4 offset:1536
buffer_load_dword v125, v125, s[44:47], 0 offen sc1
v_rcp_f32 v53, v53
v_rcp_f32 v54, v54
v_rcp_f32 v55, v55
v_rcp_f32 v56, v56
v_rcp_f32 v57, v57
v_rcp_f32 v58, v58
v_rcp_f32 v59, v59
v_rcp_f32 v60, v60
v_rcp_f32 v61, v61
v_rcp_f32 v62, v62
v_rcp_f32_e64 v63, v63
v_pk_mul_f32 v[32:33], v[48:49], v[32:33]
v_pk_mul_f32 v[34:35], v[50:51], v[34:35]
v_pk_mul_f32 v[36:37], v[52:53], v[36:37]
v_pk_mul_f32 v[38:39], v[54:55], v[38:39]
v_pk_mul_f32 v[40:41], v[56:57], v[40:41]
v_pk_mul_f32 v[42:43], v[58:59], v[42:43]
v_pk_mul_f32 v[44:45], v[60:61], v[44:45]
v_pk_mul_f32 v[46:47], v[62:63], v[46:47]
v_pk_fma_f32 v[118:119], v[32:33], v[32:33], v[118:119]
v_pk_fma_f32 v[48:49], v[16:17], v[16:17], s[60:61] neg_lo:[1,0,0] neg_hi:[1,0,0]
v_pk_fma_f32 v[118:119], v[34:35], v[34:35], v[118:119]
v_pk_fma_f32 v[50:51], v[18:19], v[18:19], s[60:61] neg_lo:[1,0,0] neg_hi:[1,0,0]
v_pk_fma_f32 v[118:119], v[36:37], v[36:37], v[118:119]
v_pk_fma_f32 v[52:53], v[20:21], v[20:21], s[60:61] neg_lo:[1,0,0] neg_hi:[1,0,0]
v_pk_fma_f32 v[118:119], v[38:39], v[38:39], v[118:119]
v_pk_fma_f32 v[54:55], v[22:23], v[22:23], s[60:61] neg_lo:[1,0,0] neg_hi:[1,0,0]
v_pk_fma_f32 v[118:119], v[40:41], v[40:41], v[118:119]
v_pk_fma_f32 v[56:57], v[24:25], v[24:25], s[60:61] neg_lo:[1,0,0] neg_hi:[1,0,0]
v_pk_fma_f32 v[118:119], v[42:43], v[42:43], v[118:119]
v_pk_fma_f32 v[58:59], v[26:27], v[26:27], s[60:61] neg_lo:[1,0,0] neg_hi:[1,0,0]
v_pk_fma_f32 v[118:119], v[44:45], v[44:45], v[118:119]
v_pk_fma_f32 v[60:61], v[28:29], v[28:29], s[60:61] neg_lo:[1,0,0] neg_hi:[1,0,0]
v_pk_fma_f32 v[118:119], v[46:47], v[46:47], v[118:119]
v_pk_fma_f32 v[62:63], v[30:31], v[30:31], s[60:61] neg_lo:[1,0,0] neg_hi:[1,0,0]
v_pk_mul_f32 v[48:49], v[48:49], v[16:17]
v_pk_mul_f32 v[50:51], v[50:51], v[18:19]
v_pk_mul_f32 v[52:53], v[52:53], v[20:21]
v_pk_mul_f32 v[54:55], v[54:55], v[22:23]
v_pk_mul_f32 v[56:57], v[56:57], v[24:25]
v_pk_mul_f32 v[58:59], v[58:59], v[26:27]
v_pk_mul_f32 v[60:61], v[60:61], v[28:29]
v_pk_mul_f32 v[62:63], v[62:63], v[30:31]
v_cvt_pk_bf16_f32 v200, v32, v33
v_cvt_pk_bf16_f32 v201, v34, v35
v_cvt_pk_bf16_f32 v202, v36, v37
v_cvt_pk_bf16_f32 v203, v38, v39
v_cvt_pk_bf16_f32 v204, v40, v41
v_cvt_pk_bf16_f32 v205, v42, v43
v_cvt_pk_bf16_f32 v206, v44, v45
v_cvt_pk_bf16_f32 v207, v46, v47
s_waitcnt lgkmcnt(0)
v_mfma_f32_32x32x16_bf16 v[32:47], v[64:67], v[88:91], 0
ds_read_b128 v[88:91], v7 offset:4608
ds_write_b64 v3, v[200:201] offset:0
v_exp_f32 v48, v48
v_exp_f32 v49, v49
v_exp_f32 v50, v50
v_mfma_f32_32x32x16_bf16 v[32:47], v[68:71], v[92:95], v[32:47]
ds_read_b128 v[92:95], v7 offset:6144
ds_write_b64 v3, v[202:203] offset:128
v_exp_f32 v51, v51
v_exp_f32 v52, v52
v_mfma_f32_32x32x16_bf16 v[32:47], v[72:75], v[96:99], v[32:47]
ds_read_b128 v[96:99], v7 offset:6656
ds_write_b64 v3, v[204:205] offset:1024
v_exp_f32 v53, v53
v_exp_f32 v54, v54
v_exp_f32 v55, v55
v_exp_f32 v56, v56
v_exp_f32 v57, v57
v_exp_f32 v58, v58
v_exp_f32 v59, v59
v_exp_f32 v60, v60
v_exp_f32 v61, v61
v_exp_f32 v62, v62
v_exp_f32_e64 v63, v63
v_pk_add_f32 v[48:49], v[48:49], 1.0 op_sel_hi:[1,0]
v_pk_add_f32 v[50:51], v[50:51], 1.0 op_sel_hi:[1,0]
v_pk_add_f32 v[52:53], v[52:53], 1.0 op_sel_hi:[1,0]
v_pk_add_f32 v[54:55], v[54:55], 1.0 op_sel_hi:[1,0]
v_pk_add_f32 v[56:57], v[56:57], 1.0 op_sel_hi:[1,0]
v_pk_add_f32 v[58:59], v[58:59], 1.0 op_sel_hi:[1,0]
v_pk_add_f32 v[60:61], v[60:61], 1.0 op_sel_hi:[1,0]
v_pk_add_f32 v[62:63], v[62:63], 1.0 op_sel_hi:[1,0]
s_waitcnt lgkmcnt(0)
v_mfma_f32_32x32x16_bf16 v[32:47], v[76:79], v[88:91], v[32:47]
ds_write_b64 v3, v[206:207] offset:1152
v_rcp_f32 v48, v48
v_rcp_f32 v49, v49
v_rcp_f32 v50, v50
v_mfma_f32_32x32x16_bf16 v[32:47], v[80:83], v[92:95], v[32:47]
ds_read_b64_tr_b16 v[200:201], v4 offset:0
ds_read_b64_tr_b16 v[202:203], v4 offset:512
v_rcp_f32 v51, v51
v_rcp_f32 v52, v52
v_rcp_f32_e64 v53, v53
v_mfma_f32_32x32x16_bf16 v[32:47], v[84:87], v[96:99], v[32:47]
ds_read_b64_tr_b16 v[204:205], v4 offset:1024
ds_read_b64_tr_b16 v[206:207], v4 offset:1536
v_rcp_f32 v54, v54
v_rcp_f32 v55, v55
v_rcp_f32 v56, v56
v_rcp_f32 v57, v57
v_rcp_f32 v58, v58
v_rcp_f32 v59, v59
v_rcp_f32 v60, v60
v_rcp_f32 v61, v61
v_rcp_f32 v62, v62
v_rcp_f32 v63, v63
v_pk_mul_f32 v[16:17], v[48:49], v[16:17]
v_pk_mul_f32 v[18:19], v[50:51], v[18:19]
v_pk_mul_f32 v[20:21], v[52:53], v[20:21]
v_pk_mul_f32 v[22:23], v[54:55], v[22:23]
v_pk_mul_f32 v[24:25], v[56:57], v[24:25]
v_pk_mul_f32 v[26:27], v[58:59], v[26:27]
v_pk_mul_f32 v[28:29], v[60:61], v[28:29]
v_pk_mul_f32 v[30:31], v[62:63], v[30:31]
v_pk_fma_f32 v[120:121], v[16:17], v[16:17], v[120:121]
v_pk_fma_f32 v[48:49], v[32:33], v[32:33], s[60:61] neg_lo:[1,0,0] neg_hi:[1,0,0]
v_pk_fma_f32 v[120:121], v[18:19], v[18:19], v[120:121]
v_pk_fma_f32 v[50:51], v[34:35], v[34:35], s[60:61] neg_lo:[1,0,0] neg_hi:[1,0,0]
v_pk_fma_f32 v[120:121], v[20:21], v[20:21], v[120:121]
v_pk_fma_f32 v[52:53], v[36:37], v[36:37], s[60:61] neg_lo:[1,0,0] neg_hi:[1,0,0]
v_pk_fma_f32 v[120:121], v[22:23], v[22:23], v[120:121]
v_pk_fma_f32 v[54:55], v[38:39], v[38:39], s[60:61] neg_lo:[1,0,0] neg_hi:[1,0,0]
v_pk_fma_f32 v[120:121], v[24:25], v[24:25], v[120:121]
v_pk_fma_f32 v[56:57], v[40:41], v[40:41], s[60:61] neg_lo:[1,0,0] neg_hi:[1,0,0]
v_pk_fma_f32 v[120:121], v[26:27], v[26:27], v[120:121]
v_pk_fma_f32 v[58:59], v[42:43], v[42:43], s[60:61] neg_lo:[1,0,0] neg_hi:[1,0,0]
v_pk_fma_f32 v[120:121], v[28:29], v[28:29], v[120:121]
v_pk_fma_f32 v[60:61], v[44:45], v[44:45], s[60:61] neg_lo:[1,0,0] neg_hi:[1,0,0]
v_pk_fma_f32 v[120:121], v[30:31], v[30:31], v[120:121]
v_pk_fma_f32 v[62:63], v[46:47], v[46:47], s[60:61] neg_lo:[1,0,0] neg_hi:[1,0,0]
v_pk_mul_f32 v[48:49], v[48:49], v[32:33]
v_pk_mul_f32 v[50:51], v[50:51], v[34:35]
v_pk_mul_f32 v[52:53], v[52:53], v[36:37]
v_pk_mul_f32 v[54:55], v[54:55], v[38:39]
v_pk_mul_f32 v[56:57], v[56:57], v[40:41]
v_pk_mul_f32 v[58:59], v[58:59], v[42:43]
v_pk_mul_f32 v[60:61], v[60:61], v[44:45]
v_pk_mul_f32 v[62:63], v[62:63], v[46:47]
v_cvt_pk_bf16_f32 v208, v16, v17
v_cvt_pk_bf16_f32 v209, v18, v19
v_cvt_pk_bf16_f32 v210, v20, v21
v_cvt_pk_bf16_f32 v211, v22, v23
v_cvt_pk_bf16_f32 v212, v24, v25
v_cvt_pk_bf16_f32 v213, v26, v27
v_cvt_pk_bf16_f32 v214, v28, v29
v_cvt_pk_bf16_f32 v215, v30, v31
ds_write_b64 v3, v[208:209] offset:0
ds_write_b64 v3, v[210:211] offset:128
ds_write_b64 v3, v[212:213] offset:1024
v_exp_f32 v48, v48
v_exp_f32 v49, v49
v_exp_f32 v50, v50
v_exp_f32 v51, v51
v_exp_f32 v52, v52
v_exp_f32 v53, v53
v_exp_f32 v54, v54
v_exp_f32 v55, v55
v_exp_f32 v56, v56
v_exp_f32 v57, v57
v_exp_f32 v58, v58
v_exp_f32 v59, v59
v_exp_f32 v60, v60
v_exp_f32 v61, v61
v_exp_f32 v62, v62
v_exp_f32 v63, v63
v_pk_add_f32 v[48:49], v[48:49], 1.0 op_sel_hi:[1,0]
v_pk_add_f32 v[50:51], v[50:51], 1.0 op_sel_hi:[1,0]
v_pk_add_f32 v[52:53], v[52:53], 1.0 op_sel_hi:[1,0]
v_pk_add_f32 v[54:55], v[54:55], 1.0 op_sel_hi:[1,0]
v_pk_add_f32 v[56:57], v[56:57], 1.0 op_sel_hi:[1,0]
v_pk_add_f32 v[58:59], v[58:59], 1.0 op_sel_hi:[1,0]
v_pk_add_f32 v[60:61], v[60:61], 1.0 op_sel_hi:[1,0]
v_pk_add_f32 v[62:63], v[62:63], 1.0 op_sel_hi:[1,0]
ds_write_b64 v3, v[214:215] offset:1152
ds_read_b64_tr_b16 v[208:209], v4 offset:0
ds_read_b64_tr_b16 v[210:211], v4 offset:512
ds_read_b64_tr_b16 v[212:213], v4 offset:1024
ds_read_b64_tr_b16 v[214:215], v4 offset:1536
v_rcp_f32 v48, v48
v_rcp_f32 v49, v49
v_rcp_f32 v50, v50
v_rcp_f32 v51, v51
v_rcp_f32 v52, v52
v_rcp_f32 v53, v53
v_rcp_f32 v54, v54
v_rcp_f32 v55, v55
v_rcp_f32 v56, v56
v_rcp_f32 v57, v57
v_rcp_f32 v58, v58
v_rcp_f32 v59, v59
v_rcp_f32 v60, v60
v_rcp_f32 v61, v61
v_rcp_f32 v62, v62
v_rcp_f32 v63, v63
v_pk_mul_f32 v[32:33], v[48:49], v[32:33]
v_pk_mul_f32 v[34:35], v[50:51], v[34:35]
v_pk_mul_f32 v[36:37], v[52:53], v[36:37]
v_pk_mul_f32 v[38:39], v[54:55], v[38:39]
v_pk_mul_f32 v[40:41], v[56:57], v[40:41]
v_pk_mul_f32 v[42:43], v[58:59], v[42:43]
v_pk_mul_f32 v[44:45], v[60:61], v[44:45]
v_pk_mul_f32 v[46:47], v[62:63], v[46:47]
v_pk_fma_f32 v[122:123], v[32:33], v[32:33], v[122:123]
v_pk_fma_f32 v[122:123], v[34:35], v[34:35], v[122:123]
v_pk_fma_f32 v[122:123], v[36:37], v[36:37], v[122:123]
v_pk_fma_f32 v[122:123], v[38:39], v[38:39], v[122:123]
v_pk_fma_f32 v[122:123], v[40:41], v[40:41], v[122:123]
v_pk_fma_f32 v[122:123], v[42:43], v[42:43], v[122:123]
v_pk_fma_f32 v[122:123], v[44:45], v[44:45], v[122:123]
v_pk_fma_f32 v[122:123], v[46:47], v[46:47], v[122:123]
L_sync:
v_cvt_pk_bf16_f32 v216, v32, v33
v_cvt_pk_bf16_f32 v217, v34, v35
v_cvt_pk_bf16_f32 v218, v36, v37
v_cvt_pk_bf16_f32 v219, v38, v39
v_cvt_pk_bf16_f32 v220, v40, v41
v_cvt_pk_bf16_f32 v221, v42, v43
v_cvt_pk_bf16_f32 v222, v44, v45
v_cvt_pk_bf16_f32 v223, v46, v47
ds_write_b64 v3, v[216:217] offset:0
ds_write_b64 v3, v[218:219] offset:128
ds_write_b64 v3, v[220:221] offset:1024
ds_write_b64 v3, v[222:223] offset:1152
ds_read_b64_tr_b16 v[216:217], v4 offset:0
ds_read_b64_tr_b16 v[218:219], v4 offset:512
ds_read_b64_tr_b16 v[220:221], v4 offset:1024
ds_read_b64_tr_b16 v[222:223], v4 offset:1536
s_waitcnt vmcnt(0)
v_readfirstlane_b32 s95, v125
v_add_f32 v100, v100, v101
v_add_f32 v102, v102, v103
v_add_f32 v104, v104, v105
v_add_f32 v106, v106, v107
v_add_f32 v108, v108, v109
v_add_f32 v110, v110, v111
v_add_f32 v112, v112, v113
v_add_f32 v114, v114, v115
v_add_f32 v116, v116, v117
v_add_f32 v118, v118, v119
v_add_f32 v120, v120, v121
v_add_f32 v122, v122, v123
v_permlane32_swap_b32 v100, v102
v_permlane32_swap_b32 v104, v106
v_permlane32_swap_b32 v108, v110
v_permlane32_swap_b32 v112, v114
v_permlane32_swap_b32 v116, v118
v_permlane32_swap_b32 v120, v122
v_add_f32 v100, v100, v102
v_add_f32 v104, v104, v106
v_add_f32 v108, v108, v110
v_add_f32 v112, v112, v114
v_add_f32 v116, v116, v118
v_add_f32 v120, v120, v122
v_lshrrev_b32 v16, 2, v0
s_lshl_b32 s67, s66, 11
s_add_u32 s67, s67, 147456
v_add_u32_e64 v17, s67, v16
ds_write_b32 v17, v100 offset:0
ds_write_b32 v17, v104 offset:256
ds_write_b32 v17, v108 offset:512
ds_write_b32 v17, v112 offset:768
ds_write_b32 v17, v116 offset:1024
ds_write_b32 v17, v120 offset:1280
s_waitcnt vmcnt(0) lgkmcnt(0)
s_barrier
s_lshl_b32 s67, s66, 10
v_add_u32 v18, s67, v0
v_add_u32 v19, 147456, v18
ds_read_b128 v[24:27], v19 offset:0
ds_read_b128 v[28:31], v19 offset:2048
ds_read_b128 v[32:35], v19 offset:4096
ds_read_b128 v[36:39], v19 offset:6144
v_mov_b32 v20, 1073741824
v_cmp_gt_u32 vcc, 1536, v18
v_lshlrev_b32 v18, 8, v18
s_nop 0
v_cndmask_b32_e64 v18, v20, v18, vcc
s_waitcnt lgkmcnt(2)
v_pk_add_f32 v[24:25], v[24:25], v[28:29]
s_waitcnt lgkmcnt(0)
v_pk_add_f32 v[32:33], v[32:33], v[36:37]
v_pk_add_f32 v[26:27], v[26:27], v[30:31]
v_pk_add_f32 v[34:35], v[34:35], v[38:39]
v_pk_add_f32 v[24:25], v[24:25], v[32:33]
v_pk_add_f32 v[26:27], v[26:27], v[34:35]
s_lshl_b32 s68, s2, 4
buffer_store_dwordx4 v[24:27], v18, s[40:43], s68 offen sc1
s_lshl_b32 s70, s2, 2
s_add_u32 s70, s70, s66
s_mul_i32 s70, s70, 6144
v_lshl_add_u32 v2, v0, 3, s70
v_lshrrev_b32 v8, 4, v0
v_bfe_u32 v9, v8, 1, 1
v_lshlrev_b32 v10, 4, v9
v_and_b32 v9, 12, v8
v_add_u32 v10, v10, v9
v_and_b32 v9, 1, v8
v_lshl_add_u32 v10, v9, 1, v10
v_lshrrev_b32 v9, 5, v8
v_sub_u32 v11, 4, v9
v_lshlrev_b32 v10, v11, v10
v_lshrrev_b32 v12, 1, v8
v_and_b32 v12, 8, v12
v_lshl_add_u32 v12, v9, 9, v12
v_add_u32 v10, v10, v12
s_lshl_b32 s67, s66, 1
v_add_u32 v10, s67, v10
v_lshlrev_b32 v12, 3, v9
v_sub_u32 v12, 16, v12
v_add_u32 v12, v10, v12
buffer_load_ushort v11, v10, s[56:59], 0 offen
buffer_load_ushort v12, v12, s[56:59], 0 offen
v_and_b32 v9, 12, v8
v_and_b32 v10, 3, v8
v_lshl_add_u32 v10, v9, 1, v10
v_lshlrev_b32 v10, 1, v10
buffer_load_ushort v88, v10, s[48:51], 0 offen offset:0
buffer_load_ushort v89, v10, s[48:51], 0 offen offset:8
buffer_load_ushort v90, v10, s[48:51], 0 offen offset:64
buffer_load_ushort v91, v10, s[48:51], 0 offen offset:72
buffer_load_ushort v92, v10, s[48:51], 0 offen offset:128
buffer_load_ushort v93, v10, s[48:51], 0 offen offset:136
s_add_u32 s74, s87, L_pair-L_pc
v_lshl_add_u32 v14, v0, 3, s74
v_min_u32 v14, L_pf1-L_pc-4, v14
v_mov_b32 v15, s89
v_add_co_u32 v14, vcc, s88, v14
s_nop 1
v_addc_co_u32 v15, vcc, 0, v15, vcc
global_load_dword v15, v[14:15], off
s_sub_u32 s87, s87, s70
s_lshr_b32 s20, s70, 4
s_cmp_eq_u32 s66, 3
s_cbranch_scc1 L_wave3
s_lshr_b32 s67, s66, 1
s_lshr_b32 s67, 1536, s67
v_bfe_u32 v13, v8, 2, 2
v_mul_u32_u24 v13, s67, v13
v_lshrrev_b32 v16, 4, v8
v_lshl_add_u32 v13, v16, 6, v13
v_and_b32 v16, 3, v8
v_lshl_add_u32 v13, v16, 4, v13
s_mul_i32 s67, s66, 24576
s_cmp_lt_u32 s66, 2
s_cbranch_scc0 L_dmaB
s_add_u32 s69, s67, 0
s_add_u32 s68, s67, 0
s_mov_b32 m0, s69
s_nop 0
buffer_load_dwordx4 v13, s[36:39], s68 offen lds
s_add_u32 s69, s67, 1024
s_add_u32 s68, s67, 256
s_mov_b32 m0, s69
s_nop 0
buffer_load_dwordx4 v13, s[36:39], s68 offen lds
s_add_u32 s69, s67, 2048
s_add_u32 s68, s67, 512
s_mov_b32 m0, s69
s_nop 0
buffer_load_dwordx4 v13, s[36:39], s68 offen lds
s_add_u32 s69, s67, 3072
s_add_u32 s68, s67, 768
s_mov_b32 m0, s69
s_nop 0
buffer_load_dwordx4 v13, s[36:39], s68 offen lds
s_add_u32 s69, s67, 4096
s_add_u32 s68, s67, 1024
s_mov_b32 m0, s69
s_nop 0
buffer_load_dwordx4 v13, s[36:39], s68 offen lds
s_add_u32 s69, s67, 5120
s_add_u32 s68, s67, 1280
s_mov_b32 m0, s69
s_nop 0
buffer_load_dwordx4 v13, s[36:39], s68 offen lds
s_add_u32 s69, s67, 6144
s_add_u32 s68, s67, 6144
s_mov_b32 m0, s69
s_nop 0
buffer_load_dwordx4 v13, s[36:39], s68 offen lds
s_add_u32 s69, s67, 7168
s_add_u32 s68, s67, 6400
s_mov_b32 m0, s69
s_nop 0
buffer_load_dwordx4 v13, s[36:39], s68 offen lds
s_add_u32 s69, s67, 8192
s_add_u32 s68, s67, 6656
s_mov_b32 m0, s69
s_nop 0
buffer_load_dwordx4 v13, s[36:39], s68 offen lds
s_add_u32 s69, s67, 9216
s_add_u32 s68, s67, 6912
s_mov_b32 m0, s69
s_nop 0
buffer_load_dwordx4 v13, s[36:39], s68 offen lds
s_add_u32 s69, s67, 10240
s_add_u32 s68, s67, 7168
s_mov_b32 m0, s69
s_nop 0
buffer_load_dwordx4 v13, s[36:39], s68 offen lds
s_add_u32 s69, s67, 11264
s_add_u32 s68, s67, 7424
s_mov_b32 m0, s69
s_nop 0
buffer_load_dwordx4 v13, s[36:39], s68 offen lds
s_add_u32 s69, s67, 12288
s_add_u32 s68, s67, 12288
s_mov_b32 m0, s69
s_nop 0
buffer_load_dwordx4 v13, s[36:39], s68 offen lds
s_add_u32 s69, s67, 13312
s_add_u32 s68, s67, 12544
s_mov_b32 m0, s69
s_nop 0
buffer_load_dwordx4 v13, s[36:39], s68 offen lds
s_add_u32 s69, s67, 14336
s_add_u32 s68, s67, 12800
s_mov_b32 m0, s69
s_nop 0
buffer_load_dwordx4 v13, s[36:39], s68 offen lds
s_add_u32 s69, s67, 15360
s_add_u32 s68, s67, 13056
s_mov_b32 m0, s69
s_nop 0
buffer_load_dwordx4 v13, s[36:39], s68 offen lds
s_add_u32 s69, s67, 16384
s_add_u32 s68, s67, 13312
s_mov_b32 m0, s69
s_nop 0
buffer_load_dwordx4 v13, s[36:39], s68 offen lds
s_add_u32 s69, s67, 17408
s_add_u32 s68, s67, 13568
s_mov_b32 m0, s69
s_nop 0
buffer_load_dwordx4 v13, s[36:39], s68 offen lds
s_add_u32 s69, s67, 18432
s_add_u32 s68, s67, 18432
s_mov_b32 m0, s69
s_nop 0
buffer_load_dwordx4 v13, s[36:39], s68 offen lds
s_add_u32 s69, s67, 19456
s_add_u32 s68, s67, 18688
s_mov_b32 m0, s69
s_nop 0
buffer_load_dwordx4 v13, s[36:39], s68 offen lds
s_add_u32 s69, s67, 20480
s_add_u32 s68, s67, 18944
s_mov_b32 m0, s69
s_nop 0
buffer_load_dwordx4 v13, s[36:39], s68 offen lds
s_add_u32 s69, s67, 21504
s_add_u32 s68, s67, 19200
s_mov_b32 m0, s69
s_nop 0
buffer_load_dwordx4 v13, s[36:39], s68 offen lds
s_add_u32 s69, s67, 22528
s_add_u32 s68, s67, 19456
s_mov_b32 m0, s69
s_nop 0
buffer_load_dwordx4 v13, s[36:39], s68 offen lds
s_add_u32 s69, s67, 23552
s_add_u32 s68, s67, 19712
s_mov_b32 m0, s69
s_nop 0
buffer_load_dwordx4 v13, s[36:39], s68 offen lds
s_waitcnt vmcnt(0)
s_branch L_nored
L_dmaB:
s_add_u32 s69, s67, 0
s_add_u32 s68, s67, 0
s_mov_b32 m0, s69
s_nop 0
buffer_load_dwordx4 v13, s[36:39], s68 offen lds
s_add_u32 s69, s67, 1024
s_add_u32 s68, s67, 256
s_mov_b32 m0, s69
s_nop 0
buffer_load_dwordx4 v13, s[36:39], s68 offen lds
s_add_u32 s69, s67, 2048
s_add_u32 s68, s67, 512
s_mov_b32 m0, s69
s_nop 0
buffer_load_dwordx4 v13, s[36:39], s68 offen lds
s_add_u32 s69, s67, 3072
s_add_u32 s68, s67, 3072
s_mov_b32 m0, s69
s_nop 0
buffer_load_dwordx4 v13, s[36:39], s68 offen lds
s_add_u32 s69, s67, 4096
s_add_u32 s68, s67, 3328
s_mov_b32 m0, s69
s_nop 0
buffer_load_dwordx4 v13, s[36:39], s68 offen lds
s_add_u32 s69, s67, 5120
s_add_u32 s68, s67, 3584
s_mov_b32 m0, s69
s_nop 0
buffer_load_dwordx4 v13, s[36:39], s68 offen lds
s_add_u32 s69, s67, 6144
s_add_u32 s68, s67, 6144
s_mov_b32 m0, s69
s_nop 0
buffer_load_dwordx4 v13, s[36:39], s68 offen lds
s_add_u32 s69, s67, 7168
s_add_u32 s68, s67, 6400
s_mov_b32 m0, s69
s_nop 0
buffer_load_dwordx4 v13, s[36:39], s68 offen lds
s_add_u32 s69, s67, 8192
s_add_u32 s68, s67, 6656
s_mov_b32 m0, s69
s_nop 0
buffer_load_dwordx4 v13, s[36:39], s68 offen lds
s_add_u32 s69, s67, 9216
s_add_u32 s68, s67, 9216
s_mov_b32 m0, s69
s_nop 0
buffer_load_dwordx4 v13, s[36:39], s68 offen lds
s_add_u32 s69, s67, 10240
s_add_u32 s68, s67, 9472
s_mov_b32 m0, s69
s_nop 0
buffer_load_dwordx4 v13, s[36:39], s68 offen lds
s_add_u32 s69, s67, 11264
s_add_u32 s68, s67, 9728
s_mov_b32 m0, s69
s_nop 0
buffer_load_dwordx4 v13, s[36:39], s68 offen lds
s_add_u32 s69, s67, 12288
s_add_u32 s68, s67, 12288
s_mov_b32 m0, s69
s_nop 0
buffer_load_dwordx4 v13, s[36:39], s68 offen lds
s_add_u32 s69, s67, 13312
s_add_u32 s68, s67, 12544
s_mov_b32 m0, s69
s_nop 0
buffer_load_dwordx4 v13, s[36:39], s68 offen lds
s_add_u32 s69, s67, 14336
s_add_u32 s68, s67, 12800
s_mov_b32 m0, s69
s_nop 0
buffer_load_dwordx4 v13, s[36:39], s68 offen lds
s_add_u32 s69, s67, 15360
s_add_u32 s68, s67, 15360
s_mov_b32 m0, s69
s_nop 0
buffer_load_dwordx4 v13, s[36:39], s68 offen lds
s_add_u32 s69, s67, 16384
s_add_u32 s68, s67, 15616
s_mov_b32 m0, s69
s_nop 0
buffer_load_dwordx4 v13, s[36:39], s68 offen lds
s_add_u32 s69, s67, 17408
s_add_u32 s68, s67, 15872
s_mov_b32 m0, s69
s_nop 0
buffer_load_dwordx4 v13, s[36:39], s68 offen lds
s_add_u32 s69, s67, 18432
s_add_u32 s68, s67, 18432
s_mov_b32 m0, s69
s_nop 0
buffer_load_dwordx4 v13, s[36:39], s68 offen lds
s_add_u32 s69, s67, 19456
s_add_u32 s68, s67, 18688
s_mov_b32 m0, s69
s_nop 0
buffer_load_dwordx4 v13, s[36:39], s68 offen lds
s_add_u32 s69, s67, 20480
s_add_u32 s68, s67, 18944
s_mov_b32 m0, s69
s_nop 0
buffer_load_dwordx4 v13, s[36:39], s68 offen lds
s_add_u32 s69, s67, 21504
s_add_u32 s68, s67, 21504
s_mov_b32 m0, s69
s_nop 0
buffer_load_dwordx4 v13, s[36:39], s68 offen lds
s_add_u32 s69, s67, 22528
s_add_u32 s68, s67, 21760
s_mov_b32 m0, s69
s_nop 0
buffer_load_dwordx4 v13, s[36:39], s68 offen lds
s_add_u32 s69, s67, 23552
s_add_u32 s68, s67, 22016
s_mov_b32 m0, s69
s_nop 0
buffer_load_dwordx4 v13, s[36:39], s68 offen lds
s_waitcnt vmcnt(0)
s_branch L_nored
L_wave3:
s_cmp_ge_u32 s2, 96
s_cbranch_scc1 L_nored
s_cmp_ge_u32 s95, 256
s_cbranch_scc1 L_clrda
s_mov_b32 s78, 131072
L_clra:
v_mov_b32 v21, 0
buffer_load_dword v21, v21, s[44:47], 0 offen sc1
s_waitcnt vmcnt(0)
v_cmp_gt_u32 vcc, 256, v21
s_nop 4
s_cbranch_vccz L_clrda
s_sub_u32 s78, s78, 1
s_cmp_lg_u32 s78, 0
s_cbranch_scc1 L_clra
L_clrda:
s_lshl_b32 s69, s2, 12
s_lshl_b32 s68, s2, 4
s_mov_b32 s78, 131072
L_red:
buffer_load_dwordx4 v[24:27], v0, s[40:43], s69 offen offset:0 sc1
buffer_load_dwordx4 v[28:31], v0, s[40:43], s69 offen offset:1024 sc1
buffer_load_dwordx4 v[32:35], v0, s[40:43], s69 offen offset:2048 sc1
buffer_load_dwordx4 v[36:39], v0, s[40:43], s69 offen offset:3072 sc1
s_waitcnt vmcnt(0)
v_max3_u32 v22, v24, v25, v26
v_max3_u32 v22, v22, v27, v28
v_max3_u32 v22, v22, v29, v30
v_max3_u32 v22, v22, v31, v32
v_max3_u32 v22, v22, v33, v34
v_max3_u32 v22, v22, v35, v36
v_max3_u32 v22, v22, v37, v38
v_max_u32 v22, v22, v39
v_cmp_eq_u32 vcc, -1, v22
s_nop 4
s_cbranch_vccz L_redd
s_sub_u32 s78, s78, 1
s_cmp_lg_u32 s78, 0
s_cbranch_scc1 L_red
L_redd:
v_pk_add_f32 v[24:25], v[24:25], v[28:29]
v_pk_add_f32 v[32:33], v[32:33], v[36:37]
v_pk_add_f32 v[26:27], v[26:27], v[30:31]
v_pk_add_f32 v[34:35], v[34:35], v[38:39]
v_pk_add_f32 v[24:25], v[24:25], v[32:33]
v_pk_add_f32 v[26:27], v[26:27], v[34:35]
s_nop 0
v_permlane32_swap_b32 v24, v25
v_permlane32_swap_b32 v26, v27
v_add_f32 v24, v24, v25
v_add_f32 v26, v26, v27
s_nop 1
v_permlane16_swap_b32 v24, v26
v_add_f32 v24, v24, v26
s_nop 1
v_add_f32_dpp v24, v24, v24 row_ror:8 row_mask:0xf bank_mask:0xf
s_nop 1
v_add_f32_dpp v24, v24, v24 row_ror:4 row_mask:0xf bank_mask:0xf
s_nop 1
v_add_f32_dpp v24, v24, v24 row_ror:2 row_mask:0xf bank_mask:0xf
s_nop 1
v_add_f32_dpp v24, v24, v24 row_ror:1 row_mask:0xf bank_mask:0xf
v_lshrrev_b32 v22, 4, v0
v_and_b32 v23, 15, v22
v_lshrrev_b32 v22, 4, v22
v_and_b32 v25, 1, v22
v_lshrrev_b32 v22, 1, v22
v_lshl_or_b32 v22, v25, 1, v22
v_lshlrev_b32 v22, 2, v22
v_lshl_add_u32 v22, v23, 11, v22
v_add_u32 v22, s68, v22
v_cmp_gt_u32 vcc, 4, v23
s_nop 1
v_cndmask_b32 v22, v20, v22, vcc
s_mov_b32 s69, 393216
buffer_store_dword v24, v22, s[40:43], s69 offen sc1
s_nop 1
L_nored:
s_barrier
v_lshrrev_b32 v13, 4, v8
v_mul_u32_u24 v13, 3072, v13
v_and_b32_e64 v10, 15, v8
v_lshl_add_u32 v14, v10, 4, v13
s_mul_i32 s68, s66, 768
v_add3_u32 v13, v13, v14, s68
s_add_u32 s68, s68, 49152
v_add_u32_e64 v14, s68, v14
ds_read_b64_tr_b16 v[16:17], v13 offset:0
ds_read_b64_tr_b16 v[18:19], v13 offset:24576
ds_read_b64_tr_b16 v[20:21], v13 offset:8
ds_read_b64_tr_b16 v[22:23], v13 offset:24584
ds_read_b64_tr_b16 v[24:25], v13 offset:256
ds_read_b64_tr_b16 v[26:27], v13 offset:24832
ds_read_b64_tr_b16 v[28:29], v13 offset:264
ds_read_b64_tr_b16 v[30:31], v13 offset:24840
ds_read_b64_tr_b16 v[32:33], v13 offset:512
ds_read_b64_tr_b16 v[34:35], v13 offset:25088
ds_read_b64_tr_b16 v[36:37], v13 offset:520
ds_read_b64_tr_b16 v[38:39], v13 offset:25096
ds_read_b64_tr_b16 v[40:41], v13 offset:3072
ds_read_b64_tr_b16 v[42:43], v13 offset:27648
ds_read_b64_tr_b16 v[44:45], v13 offset:3080
ds_read_b64_tr_b16 v[46:47], v13 offset:27656
ds_read_b64_tr_b16 v[48:49], v13 offset:3328
ds_read_b64_tr_b16 v[50:51], v13 offset:27904
ds_read_b64_tr_b16 v[52:53], v13 offset:3336
ds_read_b64_tr_b16 v[54:55], v13 offset:27912
ds_read_b64_tr_b16 v[56:57], v13 offset:3584
ds_read_b64_tr_b16 v[58:59], v13 offset:28160
ds_read_b64_tr_b16 v[60:61], v13 offset:3592
ds_read_b64_tr_b16 v[62:63], v13 offset:28168
ds_read_b64_tr_b16 v[64:65], v14 offset:0
ds_read_b64_tr_b16 v[66:67], v14 offset:12288
ds_read_b64_tr_b16 v[68:69], v14 offset:8
ds_read_b64_tr_b16 v[70:71], v14 offset:12296
ds_read_b64_tr_b16 v[72:73], v14 offset:256
ds_read_b64_tr_b16 v[74:75], v14 offset:12544
ds_read_b64_tr_b16 v[76:77], v14 offset:264
ds_read_b64_tr_b16 v[78:79], v14 offset:12552
ds_read_b64_tr_b16 v[80:81], v14 offset:512
ds_read_b64_tr_b16 v[82:83], v14 offset:12800
ds_read_b64_tr_b16 v[84:85], v14 offset:520
ds_read_b64_tr_b16 v[86:87], v14 offset:12808
s_waitcnt vmcnt(1)
v_lshl_or_b32 v11, v12, 16, v11
s_mul_i32 s69, s66, 192
s_add_u32 s69, s69, 157824
v_lshlrev_b32 v12, 2, v8
v_add_u32 v12, s69, v12
s_mov_b32 exec_hi, 65535
ds_write_b32 v12, v11
s_mov_b32 exec_hi, -1
v_and_b32 v12, 48, v8
v_add_u32 v12, s69, v12
ds_read_b128 v[112:115], v12 offset:0
ds_read_b128 v[116:119], v12 offset:64
ds_read_b128 v[120:123], v12 offset:128
v_lshrrev_b32 v9, 4, v8
v_bfe_u32 v10, v8, 2, 2
v_cmp_eq_u32 vcc, v9, v10
v_and_b32 v9, 15, v8
v_lshlrev_b32 v9, 4, v9
v_mov_b32 v10, 256
v_cndmask_b32 v5, v10, v9, vcc
v_add_u32 v5, 155648, v5
s_cmp_lg_u32 s66, 1
s_cbranch_scc1 L_notab
v_and_b32 v9, 1, v8
v_lshlrev_b32 v9, 4, v9
v_mov_b32 v10, 65535
v_lshlrev_b32 v9, v9, v10
v_cndmask_b32 v9, 0, v9, vcc
v_bfe_u32 v11, v8, 1, 1
v_sub_u32 v11, 0, v11
v_and_b32 v10, v11, v9
v_xor_b32 v10, v10, v9
v_and_b32 v11, v11, v9
v_mov_b32 v98, 0
v_mov_b32 v99, 0
v_mov_b32 v100, 0
v_mov_b32 v101, 0
v_cmp_ne_u32 s[90:91], 0, v9
s_nop 3
s_or_b32 s90, s90, 16
v_lshl_or_b32 v88, v88, 16, v88
v_and_b32 v96, v88, v10
v_and_b32 v97, v88, v11
s_mov_b64 exec, s[90:91]
ds_write_b128 v5, v[96:99] offset:0
s_mov_b64 exec, -1
v_lshl_or_b32 v89, v89, 16, v89
v_and_b32 v102, v89, v10
v_and_b32 v103, v89, v11
s_mov_b64 exec, s[90:91]
ds_write_b128 v5, v[100:103] offset:272
s_mov_b64 exec, -1
v_lshl_or_b32 v90, v90, 16, v90
v_and_b32 v96, v90, v10
v_and_b32 v97, v90, v11
s_mov_b64 exec, s[90:91]
ds_write_b128 v5, v[96:99] offset:544
s_mov_b64 exec, -1
v_lshl_or_b32 v91, v91, 16, v91
v_and_b32 v102, v91, v10
v_and_b32 v103, v91, v11
s_mov_b64 exec, s[90:91]
ds_write_b128 v5, v[100:103] offset:816
s_mov_b64 exec, -1
v_lshl_or_b32 v92, v92, 16, v92
v_and_b32 v96, v92, v10
v_and_b32 v97, v92, v11
s_mov_b64 exec, s[90:91]
ds_write_b128 v5, v[96:99] offset:1088
s_mov_b64 exec, -1
v_lshl_or_b32 v93, v93, 16, v93
v_and_b32 v102, v93, v10
v_and_b32 v103, v93, v11
s_mov_b64 exec, s[90:91]
ds_write_b128 v5, v[100:103] offset:1360
s_mov_b64 exec, -1
v_and_b32 v96, 1065369472, v10
v_and_b32 v97, 1065369472, v11
s_mov_b64 exec, s[90:91]
ds_write_b128 v5, v[96:99] offset:1632
s_mov_b64 exec, -1
v_and_b32 v102, 1065369472, v10
v_and_b32 v103, 1065369472, v11
s_mov_b64 exec, s[90:91]
ds_write_b128 v5, v[100:103] offset:1904
s_mov_b64 exec, -1
L_notab:
s_waitcnt lgkmcnt(0)
s_mul_i32 s69, s66, 384
s_add_u32 s69, s69, 158592
v_and_b32 v12, 48, v8
v_lshlrev_b32 v12, 1, v12
v_add_u32_e64 v12, s69, v12
v_mfma_f32_16x16x32_bf16 v[88:91], v[16:19], v[112:115], 0
v_mfma_f32_16x16x32_bf16 v[92:95], v[20:23], v[112:115], 0
v_mfma_f32_16x16x32_bf16 v[96:99], v[24:27], v[112:115], 0
v_mfma_f32_16x16x32_bf16 v[100:103], v[28:31], v[112:115], 0
v_mfma_f32_16x16x32_bf16 v[104:107], v[32:35], v[112:115], 0
v_mfma_f32_16x16x32_bf16 v[108:111], v[36:39], v[112:115], 0
v_mfma_f32_16x16x32_bf16 v[88:91], v[40:43], v[116:119], v[88:91]
v_mfma_f32_16x16x32_bf16 v[92:95], v[44:47], v[116:119], v[92:95]
v_mfma_f32_16x16x32_bf16 v[96:99], v[48:51], v[116:119], v[96:99]
v_mfma_f32_16x16x32_bf16 v[100:103], v[52:55], v[116:119], v[100:103]
v_mfma_f32_16x16x32_bf16 v[104:107], v[56:59], v[116:119], v[104:107]
v_mfma_f32_16x16x32_bf16 v[108:111], v[60:63], v[116:119], v[108:111]
v_mfma_f32_16x16x32_bf16 v[88:91], v[64:67], v[120:123], v[88:91]
v_mfma_f32_16x16x32_bf16 v[92:95], v[68:71], v[120:123], v[92:95]
v_mfma_f32_16x16x32_bf16 v[96:99], v[72:75], v[120:123], v[96:99]
v_mfma_f32_16x16x32_bf16 v[100:103], v[76:79], v[120:123], v[100:103]
v_mfma_f32_16x16x32_bf16 v[104:107], v[80:83], v[120:123], v[104:107]
v_mfma_f32_16x16x32_bf16 v[108:111], v[84:87], v[120:123], v[108:111]
s_mov_b32 exec_lo, 65537
s_mov_b32 exec_hi, 65537
s_nop 0
ds_write_b128 v12, v[88:91] offset:0
ds_write_b128 v12, v[92:95] offset:16
ds_write_b128 v12, v[96:99] offset:128
ds_write_b128 v12, v[100:103] offset:144
ds_write_b128 v12, v[104:107] offset:256
ds_write_b128 v12, v[108:111] offset:272
s_mov_b64 exec, -1
s_waitcnt vmcnt(0) lgkmcnt(0)
s_nop 7
v_and_b32 v9, 15, v8
v_lshlrev_b32 v6, 3, v9
v_lshrrev_b32 v12, 4, v8
v_lshlrev_b32 v0, 4, v9
v_lshl_add_u32 v0, v12, 9, v0
v_add_u32 v1, 65536, v0
v_add_u32 v7, 131072, v0
v_lshlrev_b32 v3, 5, v12
v_add_u32 v3, 160128, v3
v_mul_u32_u24 v4, 192, v9
v_lshlrev_b32 v12, 4, v12
s_lshl_b32 s68, s2, 2
s_add_u32 s68, s68, s66
s_mul_i32 s68, s68, 6144
v_add3_u32 v4, v4, v12, s68
s_mul_i32 s68, s66, 6144
v_add_u32 v15, s68, v0
s_lshl_b32 s67, s66, 7
s_add_u32 s67, s67, 160512
v_and_b32 v127, 48, v8
v_add_u32 v127, s67, v127
s_waitcnt lgkmcnt(0)
s_nop 1
s_cmp_lg_u32 s66, 0
s_cbranch_scc1 L_notot
v_and_b32 v9, 15, v8
v_lshrrev_b32 v10, 4, v8
v_lshlrev_b32_e64 v10, 1, v10
v_lshl_add_u32 v13, v9, 5, v10
v_lshl_add_u32 v14, v9, 4, v10
buffer_load_ushort v88, v13, s[52:55], 0 offen offset:0
buffer_load_ushort v89, v13, s[52:55], 0 offen offset:16
buffer_load_ushort v90, v13, s[52:55], 0 offen offset:8
buffer_load_ushort v91, v13, s[52:55], 0 offen offset:24
buffer_load_ushort v92, v14, s[52:55], 0 offen offset:512
buffer_load_ushort v93, v14, s[52:55], 0 offen offset:520
s_cmp_ge_u32 s95, 256
s_cbranch_scc1 L_clrdb
s_mov_b32 s78, 131072
L_clrb:
v_mov_b32 v11, 0
buffer_load_dword v11, v11, s[44:47], 0 offen sc1
s_waitcnt vmcnt(0)
v_cmp_gt_u32 vcc, 256, v11
s_nop 4
s_cbranch_vccz L_clrdb
s_sub_u32 s78, s78, 1
s_cmp_lg_u32 s78, 0
s_cbranch_scc1 L_clrb
L_clrdb:
s_and_b32 s68, s2, 3
s_lshl_b32 s68, s68, 11
s_add_u32 s68, s68, 393216
v_lshlrev_b32 v11, 3, v8
s_mov_b32 s78, 131072
L_tot:
buffer_load_dwordx2 v[96:97], v11, s[40:43], s68 offen offset:0 sc1
buffer_load_dwordx2 v[98:99], v11, s[40:43], s68 offen offset:512 sc1
buffer_load_dwordx2 v[100:101], v11, s[40:43], s68 offen offset:1024 sc1
s_waitcnt vmcnt(0)
v_max3_u32 v12, v96, v97, v98
v_max3_u32 v12, v12, v99, v100
v_max_u32 v12, v12, v101
v_cmp_eq_u32 vcc, -1, v12
s_nop 4
s_cbranch_vccz L_totd
s_sub_u32 s78, s78, 1
s_cmp_lg_u32 s78, 0
s_cbranch_scc1 L_tot
L_totd:
v_mul_f32 v96, 0x4091afa4, v96
v_mul_f32 v97, 0x4091afa4, v97
v_mul_f32 v98, 0x4091afa4, v98
v_mul_f32 v99, 0x4091afa4, v99
v_mul_f32 v100, 0x4091afa4, v100
v_mul_f32 v101, 0x4091afa4, v101
v_add_f32 v96, 0x358637bd, v96
v_add_f32 v97, 0x358637bd, v97
v_add_f32 v98, 0x358637bd, v98
v_add_f32 v99, 0x358637bd, v99
v_add_f32 v100, 0x358637bd, v100
v_add_f32 v101, 0x358637bd, v101
v_sqrt_f32 v96, v96
v_sqrt_f32 v97, v97
v_sqrt_f32 v98, v98
v_sqrt_f32 v99, v99
v_sqrt_f32 v100, v100
v_sqrt_f32 v101, v101
v_lshlrev_b32 v88, 16, v88
v_lshlrev_b32 v89, 16, v89
v_lshlrev_b32 v90, 16, v90
v_lshlrev_b32 v91, 16, v91
v_lshlrev_b32 v92, 16, v92
v_lshlrev_b32 v93, 16, v93
v_add_f32 v104, v96, v97
v_add_f32 v105, v98, v99
v_add_f32 v104, v104, v100
v_add_f32 v105, v105, v101
v_add_f32 v104, v104, v105
s_nop 1
v_add_f32_dpp v104, v104, v104 row_ror:8 row_mask:0xf bank_mask:0xf
s_nop 1
v_add_f32_dpp v104, v104, v104 row_ror:4 row_mask:0xf bank_mask:0xf
s_nop 1
v_add_f32_dpp v104, v104, v104 row_ror:2 row_mask:0xf bank_mask:0xf
s_nop 1
v_add_f32_dpp v104, v104, v104 row_ror:1 row_mask:0xf bank_mask:0xf
v_mov_b32 v105, v104
s_nop 1
v_permlane16_swap_b32 v104, v105
v_add_f32 v104, v104, v105
v_mov_b32 v105, v104
s_nop 1
v_permlane32_swap_b32 v104, v105
v_add_f32 v104, v104, v105
v_mul_f32 v104, 0x3b2aaaab, v104
v_add_f32 v104, 0x358637bd, v104
v_rcp_f32 v105, v104
s_nop 0
v_fma_f32 v106, -v104, v105, 1.0
v_fmac_f32 v105, v106, v105
v_mul_f32 v105, 0x40088e99, v105
v_mul_f32 v96, v96, v105
v_mul_f32 v97, v97, v105
v_mul_f32 v98, v98, v105
v_mul_f32 v99, v99, v105
v_mul_f32 v100, v100, v105
v_mul_f32_e64 v101, v101, v105
v_fmaak_f32 v96, v96, v88, 0x40088e99
v_fmaak_f32 v97, v97, v89, 0x40088e99
v_fmaak_f32 v98, v98, v90, 0x40088e99
v_fmaak_f32 v99, v99, v91, 0x40088e99
v_fmaak_f32 v100, v100, v92, 0x40088e99
v_fmaak_f32 v101, v101, v93, 0x40088e99
v_add_u32 v11, 160512, v11
ds_write_b64 v11, v[96:97] offset:0
ds_write_b64 v11, v[98:99] offset:512
ds_write_b64 v11, v[100:101] offset:1024
s_waitcnt vmcnt(0) lgkmcnt(0)
L_notot:
s_barrier
ds_read_b128 v[88:91], v127 offset:0
ds_read_b128 v[92:95], v127 offset:64
ds_read_b128 v[96:99], v127 offset:512
ds_read_b128 v[100:103], v127 offset:576
s_lshl_b32 s67, s66, 8
v_lshlrev_b32 v9, 2, v8
v_add_u32_e64 v9, s67, v9
v_min_u32 v9, 380, v9
v_add_u32 v9, 158592, v9
ds_read_b32 v120, v9 offset:0
ds_read_b32 v121, v9 offset:384
ds_read_b32 v122, v9 offset:768
ds_read_b32 v123, v9 offset:1152
s_waitcnt lgkmcnt(2)
v_add_f32 v120, v120, v121
s_waitcnt lgkmcnt(0)
v_add_f32 v122, v122, v123
v_add_f32 v120, v120, v122
ds_write_b32 v9, v120 offset:1536
v_lshlrev_b32 v104, 16, v16
v_and_b32 v105, 4294901760, v16
v_lshlrev_b32 v106, 16, v17
v_and_b32 v107, 4294901760, v17
v_lshlrev_b32 v108, 16, v18
v_and_b32 v109, 4294901760, v18
v_lshlrev_b32_e64 v110, 16, v19
v_and_b32 v111, 4294901760, v19
v_pk_mul_f32 v[104:105], v[104:105], v[88:89]
v_pk_mul_f32 v[106:107], v[106:107], v[90:91]
v_pk_mul_f32 v[108:109], v[108:109], v[92:93]
v_pk_mul_f32 v[110:111], v[110:111], v[94:95]
v_cvt_pk_bf16_f32 v16, v104, v105
v_cvt_pk_bf16_f32 v17, v106, v107
v_cvt_pk_bf16_f32 v18, v108, v109
v_cvt_pk_bf16_f32 v19, v110, v111
ds_write_b128 v15, v[16:19] offset:0
v_lshlrev_b32 v112, 16, v20
v_and_b32 v113, 4294901760, v20
v_lshlrev_b32 v114, 16, v21
v_and_b32 v115, 4294901760, v21
v_lshlrev_b32 v116, 16, v22
v_and_b32 v117, 4294901760, v22
v_lshlrev_b32 v118, 16, v23
v_and_b32 v119, 4294901760, v23
v_pk_mul_f32 v[112:113], v[112:113], v[88:89]
v_pk_mul_f32 v[114:115], v[114:115], v[90:91]
v_pk_mul_f32 v[116:117], v[116:117], v[92:93]
v_pk_mul_f32 v[118:119], v[118:119], v[94:95]
v_cvt_pk_bf16_f32 v20, v112, v113
v_cvt_pk_bf16_f32 v21, v114, v115
v_cvt_pk_bf16_f32 v22, v116, v117
v_cvt_pk_bf16_f32 v23, v118, v119
ds_write_b128 v15, v[20:23] offset:256
v_lshlrev_b32 v104, 16, v24
v_and_b32 v105, 4294901760, v24
v_lshlrev_b32 v106, 16, v25
v_and_b32 v107, 4294901760, v25
v_lshlrev_b32 v108, 16, v26
v_and_b32 v109, 4294901760, v26
v_lshlrev_b32 v110, 16, v27
v_and_b32 v111, 4294901760, v27
v_pk_mul_f32 v[104:105], v[104:105], v[88:89]
v_pk_mul_f32 v[106:107], v[106:107], v[90:91]
v_pk_mul_f32 v[108:109], v[108:109], v[92:93]
v_pk_mul_f32 v[110:111], v[110:111], v[94:95]
v_cvt_pk_bf16_f32 v24, v104, v105
v_cvt_pk_bf16_f32 v25, v106, v107
v_cvt_pk_bf16_f32 v26, v108, v109
v_cvt_pk_bf16_f32 v27, v110, v111
ds_write_b128 v15, v[24:27] offset:2048
v_lshlrev_b32 v112, 16, v28
v_and_b32 v113, 4294901760, v28
v_lshlrev_b32 v114, 16, v29
v_and_b32 v115, 4294901760, v29
v_lshlrev_b32 v116, 16, v30
v_and_b32 v117, 4294901760, v30
v_lshlrev_b32 v118, 16, v31
v_and_b32 v119, 4294901760, v31
v_pk_mul_f32 v[112:113], v[112:113], v[88:89]
v_pk_mul_f32 v[114:115], v[114:115], v[90:91]
v_pk_mul_f32 v[116:117], v[116:117], v[92:93]
v_pk_mul_f32 v[118:119], v[118:119], v[94:95]
v_cvt_pk_bf16_f32 v28, v112, v113
v_cvt_pk_bf16_f32 v29, v114, v115
v_cvt_pk_bf16_f32 v30, v116, v117
v_cvt_pk_bf16_f32 v31, v118, v119
ds_write_b128 v15, v[28:31] offset:2304
v_lshlrev_b32 v104, 16, v32
v_and_b32 v105, 4294901760, v32
v_lshlrev_b32 v106, 16, v33
v_and_b32 v107, 4294901760, v33
v_lshlrev_b32 v108, 16, v34
v_and_b32 v109, 4294901760, v34
v_lshlrev_b32 v110, 16, v35
v_and_b32 v111, 4294901760, v35
v_pk_mul_f32 v[104:105], v[104:105], v[88:89]
v_pk_mul_f32 v[106:107], v[106:107], v[90:91]
v_pk_mul_f32 v[108:109], v[108:109], v[92:93]
v_pk_mul_f32 v[110:111], v[110:111], v[94:95]
v_cvt_pk_bf16_f32 v32, v104, v105
v_cvt_pk_bf16_f32 v33, v106, v107
v_cvt_pk_bf16_f32 v34, v108, v109
v_cvt_pk_bf16_f32 v35, v110, v111
ds_write_b128 v15, v[32:35] offset:4096
v_lshlrev_b32 v112, 16, v36
v_and_b32 v113, 4294901760, v36
v_lshlrev_b32 v114, 16, v37
v_and_b32 v115, 4294901760, v37
v_lshlrev_b32 v116, 16, v38
v_and_b32 v117, 4294901760, v38
v_lshlrev_b32 v118, 16, v39
v_and_b32 v119, 4294901760, v39
v_pk_mul_f32 v[112:113], v[112:113], v[88:89]
v_pk_mul_f32 v[114:115], v[114:115], v[90:91]
v_pk_mul_f32 v[116:117], v[116:117], v[92:93]
v_pk_mul_f32 v[118:119], v[118:119], v[94:95]
v_cvt_pk_bf16_f32 v36, v112, v113
v_cvt_pk_bf16_f32 v37, v114, v115
v_cvt_pk_bf16_f32 v38, v116, v117
v_cvt_pk_bf16_f32 v39, v118, v119
ds_write_b128 v15, v[36:39] offset:4352
ds_read_b128 v[88:91], v127 offset:1024
ds_read_b128 v[92:95], v127 offset:1088
v_lshlrev_b32 v104, 16, v40
v_and_b32 v105, 4294901760, v40
v_lshlrev_b32 v106, 16, v41
v_and_b32 v107, 4294901760, v41
v_lshlrev_b32 v108, 16, v42
v_and_b32 v109, 4294901760, v42
v_lshlrev_b32 v110, 16, v43
v_and_b32 v111, 4294901760, v43
v_pk_mul_f32 v[104:105], v[104:105], v[96:97]
v_pk_mul_f32 v[106:107], v[106:107], v[98:99]
v_pk_mul_f32 v[108:109], v[108:109], v[100:101]
v_pk_mul_f32 v[110:111], v[110:111], v[102:103]
v_cvt_pk_bf16_f32 v40, v104, v105
v_cvt_pk_bf16_f32 v41, v106, v107
v_cvt_pk_bf16_f32 v42, v108, v109
v_cvt_pk_bf16_f32 v43, v110, v111
ds_write_b128 v15, v[40:43] offset:24576
v_lshlrev_b32 v112, 16, v44
v_and_b32 v113, 4294901760, v44
v_lshlrev_b32 v114, 16, v45
v_and_b32 v115, 4294901760, v45
v_lshlrev_b32 v116, 16, v46
v_and_b32 v117, 4294901760, v46
v_lshlrev_b32 v118, 16, v47
v_and_b32 v119, 4294901760, v47
v_pk_mul_f32 v[112:113], v[112:113], v[96:97]
v_pk_mul_f32 v[114:115], v[114:115], v[98:99]
v_pk_mul_f32 v[116:117], v[116:117], v[100:101]
v_pk_mul_f32 v[118:119], v[118:119], v[102:103]
v_cvt_pk_bf16_f32 v44, v112, v113
v_cvt_pk_bf16_f32 v45, v114, v115
v_cvt_pk_bf16_f32 v46, v116, v117
v_cvt_pk_bf16_f32 v47, v118, v119
ds_write_b128 v15, v[44:47] offset:24832
v_lshlrev_b32 v104, 16, v48
v_and_b32 v105, 4294901760, v48
v_lshlrev_b32 v106, 16, v49
v_and_b32 v107, 4294901760, v49
v_lshlrev_b32 v108, 16, v50
v_and_b32 v109, 4294901760, v50
v_lshlrev_b32 v110, 16, v51
v_and_b32 v111, 4294901760, v51
v_pk_mul_f32 v[104:105], v[104:105], v[96:97]
v_pk_mul_f32 v[106:107], v[106:107], v[98:99]
v_pk_mul_f32 v[108:109], v[108:109], v[100:101]
v_pk_mul_f32 v[110:111], v[110:111], v[102:103]
v_cvt_pk_bf16_f32 v48, v104, v105
v_cvt_pk_bf16_f32 v49, v106, v107
v_cvt_pk_bf16_f32 v50, v108, v109
v_cvt_pk_bf16_f32 v51, v110, v111
ds_write_b128 v15, v[48:51] offset:26624
v_lshlrev_b32 v112, 16, v52
v_and_b32 v113, 4294901760, v52
v_lshlrev_b32 v114, 16, v53
v_and_b32 v115, 4294901760, v53
v_lshlrev_b32 v116, 16, v54
v_and_b32 v117, 4294901760, v54
v_lshlrev_b32 v118, 16, v55
v_and_b32 v119, 4294901760, v55
v_pk_mul_f32 v[112:113], v[112:113], v[96:97]
v_pk_mul_f32 v[114:115], v[114:115], v[98:99]
v_pk_mul_f32 v[116:117], v[116:117], v[100:101]
v_pk_mul_f32 v[118:119], v[118:119], v[102:103]
v_cvt_pk_bf16_f32 v52, v112, v113
v_cvt_pk_bf16_f32 v53, v114, v115
v_cvt_pk_bf16_f32 v54, v116, v117
v_cvt_pk_bf16_f32 v55, v118, v119
ds_write_b128 v15, v[52:55] offset:26880
v_lshlrev_b32 v104, 16, v56
v_and_b32 v105, 4294901760, v56
v_lshlrev_b32 v106, 16, v57
v_and_b32 v107, 4294901760, v57
v_lshlrev_b32 v108, 16, v58
v_and_b32 v109, 4294901760, v58
v_lshlrev_b32 v110, 16, v59
v_and_b32 v111, 4294901760, v59
v_pk_mul_f32 v[104:105], v[104:105], v[96:97]
v_pk_mul_f32 v[106:107], v[106:107], v[98:99]
v_pk_mul_f32 v[108:109], v[108:109], v[100:101]
v_pk_mul_f32 v[110:111], v[110:111], v[102:103]
v_cvt_pk_bf16_f32 v56, v104, v105
v_cvt_pk_bf16_f32 v57, v106, v107
v_cvt_pk_bf16_f32 v58, v108, v109
v_cvt_pk_bf16_f32 v59, v110, v111
ds_write_b128 v15, v[56:59] offset:28672
v_lshlrev_b32 v112, 16, v60
v_and_b32 v113, 4294901760, v60
v_lshlrev_b32 v114, 16, v61
v_and_b32 v115, 4294901760, v61
v_lshlrev_b32 v116, 16, v62
v_and_b32 v117, 4294901760, v62
v_lshlrev_b32 v118, 16, v63
v_and_b32 v119, 4294901760, v63
v_pk_mul_f32 v[112:113], v[112:113], v[96:97]
v_pk_mul_f32 v[114:115], v[114:115], v[98:99]
v_pk_mul_f32 v[116:117], v[116:117], v[100:101]
v_pk_mul_f32 v[118:119], v[118:119], v[102:103]
v_cvt_pk_bf16_f32 v60, v112, v113
v_cvt_pk_bf16_f32 v61, v114, v115
v_cvt_pk_bf16_f32 v62, v116, v117
v_cvt_pk_bf16_f32 v63, v118, v119
ds_write_b128 v15, v[60:63] offset:28928
v_lshlrev_b32 v104, 16, v64
v_and_b32 v105, 4294901760, v64
v_lshlrev_b32 v106, 16, v65
v_and_b32 v107, 4294901760, v65
v_lshlrev_b32 v108, 16, v66
v_and_b32 v109, 4294901760, v66
v_lshlrev_b32_e64 v110, 16, v67
v_and_b32 v111, 4294901760, v67
s_waitcnt lgkmcnt(1)
v_pk_mul_f32 v[104:105], v[104:105], v[88:89]
v_pk_mul_f32 v[106:107], v[106:107], v[90:91]
v_pk_mul_f32 v[108:109], v[108:109], v[92:93]
v_pk_mul_f32 v[110:111], v[110:111], v[94:95]
v_cvt_pk_bf16_f32 v64, v104, v105
v_cvt_pk_bf16_f32 v65, v106, v107
v_cvt_pk_bf16_f32 v66, v108, v109
v_cvt_pk_bf16_f32 v67, v110, v111
ds_write_b128 v15, v[64:67] offset:49152
v_lshlrev_b32 v112, 16, v68
v_and_b32 v113, 4294901760, v68
v_lshlrev_b32 v114, 16, v69
v_and_b32 v115, 4294901760, v69
v_lshlrev_b32 v116, 16, v70
v_and_b32 v117, 4294901760, v70
v_lshlrev_b32 v118, 16, v71
v_and_b32 v119, 4294901760, v71
v_pk_mul_f32 v[112:113], v[112:113], v[88:89]
v_pk_mul_f32 v[114:115], v[114:115], v[90:91]
v_pk_mul_f32 v[116:117], v[116:117], v[92:93]
v_pk_mul_f32 v[118:119], v[118:119], v[94:95]
v_cvt_pk_bf16_f32 v68, v112, v113
v_cvt_pk_bf16_f32 v69, v114, v115
v_cvt_pk_bf16_f32 v70, v116, v117
v_cvt_pk_bf16_f32 v71, v118, v119
ds_write_b128 v15, v[68:71] offset:49408
v_lshlrev_b32 v104, 16, v72
v_and_b32 v105, 4294901760, v72
v_lshlrev_b32 v106, 16, v73
v_and_b32 v107, 4294901760, v73
v_lshlrev_b32 v108, 16, v74
v_and_b32 v109, 4294901760, v74
v_lshlrev_b32 v110, 16, v75
v_and_b32 v111, 4294901760, v75
v_pk_mul_f32 v[104:105], v[104:105], v[88:89]
v_pk_mul_f32 v[106:107], v[106:107], v[90:91]
v_pk_mul_f32 v[108:109], v[108:109], v[92:93]
v_pk_mul_f32 v[110:111], v[110:111], v[94:95]
v_cvt_pk_bf16_f32 v72, v104, v105
v_cvt_pk_bf16_f32 v73, v106, v107
v_cvt_pk_bf16_f32 v74, v108, v109
v_cvt_pk_bf16_f32 v75, v110, v111
ds_write_b128 v15, v[72:75] offset:51200
v_lshlrev_b32 v112, 16, v76
v_and_b32 v113, 4294901760, v76
v_lshlrev_b32 v114, 16, v77
v_and_b32 v115, 4294901760, v77
v_lshlrev_b32 v116, 16, v78
v_and_b32 v117, 4294901760, v78
v_lshlrev_b32 v118, 16, v79
v_and_b32 v119, 4294901760, v79
v_pk_mul_f32 v[112:113], v[112:113], v[88:89]
v_pk_mul_f32 v[114:115], v[114:115], v[90:91]
v_pk_mul_f32 v[116:117], v[116:117], v[92:93]
v_pk_mul_f32 v[118:119], v[118:119], v[94:95]
v_cvt_pk_bf16_f32 v76, v112, v113
v_cvt_pk_bf16_f32 v77, v114, v115
v_cvt_pk_bf16_f32 v78, v116, v117
v_cvt_pk_bf16_f32 v79, v118, v119
ds_write_b128 v15, v[76:79] offset:51456
v_lshlrev_b32 v104, 16, v80
v_and_b32 v105, 4294901760, v80
v_lshlrev_b32 v106, 16, v81
v_and_b32 v107, 4294901760, v81
v_lshlrev_b32 v108, 16, v82
v_and_b32 v109, 4294901760, v82
v_lshlrev_b32 v110, 16, v83
v_and_b32 v111, 4294901760, v83
v_pk_mul_f32 v[104:105], v[104:105], v[88:89]
v_pk_mul_f32 v[106:107], v[106:107], v[90:91]
v_pk_mul_f32 v[108:109], v[108:109], v[92:93]
v_pk_mul_f32 v[110:111], v[110:111], v[94:95]
v_cvt_pk_bf16_f32 v80, v104, v105
v_cvt_pk_bf16_f32 v81, v106, v107
v_cvt_pk_bf16_f32 v82, v108, v109
v_cvt_pk_bf16_f32 v83, v110, v111
ds_write_b128 v15, v[80:83] offset:53248
v_lshlrev_b32 v112, 16, v84
v_and_b32 v113, 4294901760, v84
v_lshlrev_b32 v114, 16, v85
v_and_b32 v115, 4294901760, v85
v_lshlrev_b32 v116, 16, v86
v_and_b32 v117, 4294901760, v86
v_lshlrev_b32 v118, 16, v87
v_and_b32 v119, 4294901760, v87
v_pk_mul_f32 v[112:113], v[112:113], v[88:89]
v_pk_mul_f32 v[114:115], v[114:115], v[90:91]
v_pk_mul_f32 v[116:117], v[116:117], v[92:93]
v_pk_mul_f32 v[118:119], v[118:119], v[94:95]
v_cvt_pk_bf16_f32 v84, v112, v113
v_cvt_pk_bf16_f32 v85, v114, v115
v_cvt_pk_bf16_f32 v86, v116, v117
v_cvt_pk_bf16_f32 v87, v118, v119
ds_write_b128 v15, v[84:87] offset:53504
s_waitcnt lgkmcnt(0)
s_barrier
L_pair:
ds_read_b128 v[112:115], v0 offset:0
ds_read_b128 v[116:119], v0 offset:256
ds_read_b128 v[120:123], v0 offset:2048
ds_read_b128 v[16:19], v3 offset:0
ds_read_b128 v[20:23], v3 offset:16
ds_read_b128 v[24:27], v3 offset:128
ds_read_b128 v[28:31], v3 offset:144
ds_read_b128 v[32:35], v3 offset:256
ds_read_b128 v[36:39], v3 offset:272
s_waitcnt lgkmcnt(5)
v_mfma_f32_16x16x32_bf16 v[88:91], v[112:115], v[132:135], v[16:19]
ds_read_b128 v[124:127], v0 offset:2304
v_mfma_f32_16x16x32_bf16 v[64:67], v[112:115], v[128:131], v[16:19]
v_mfma_f32_16x16x32_bf16 v[40:43], v[112:115], a[196:199], v[16:19]
v_mfma_f32_16x16x32_bf16 v[16:19], v[112:115], a[192:195], v[16:19]
s_waitcnt lgkmcnt(5)
v_mfma_f32_16x16x32_bf16 v[92:95], v[116:119], v[132:135], v[20:23]
ds_read_b128 v[112:115], v0 offset:4096
v_mfma_f32_16x16x32_bf16 v[68:71], v[116:119], v[128:131], v[20:23]
v_mfma_f32_16x16x32_bf16 v[44:47], v[116:119], a[196:199], v[20:23]
v_mfma_f32_16x16x32_bf16 v[20:23], v[116:119], a[192:195], v[20:23]
s_waitcnt lgkmcnt(1)
v_mfma_f32_16x16x32_bf16 v[96:99], v[120:123], v[132:135], v[24:27]
ds_read_b128 v[116:119], v0 offset:4352
v_mfma_f32_16x16x32_bf16 v[72:75], v[120:123], v[128:131], v[24:27]
v_mfma_f32_16x16x32_bf16 v[48:51], v[120:123], a[196:199], v[24:27]
v_mfma_f32_16x16x32_bf16 v[24:27], v[120:123], a[192:195], v[24:27]
v_mfma_f32_16x16x32_bf16 v[100:103], v[124:127], v[132:135], v[28:31]
ds_read_b128 v[120:123], v0 offset:6144
v_mfma_f32_16x16x32_bf16 v[76:79], v[124:127], v[128:131], v[28:31]
v_mfma_f32_16x16x32_bf16 v[52:55], v[124:127], a[196:199], v[28:31]
v_mfma_f32_16x16x32_bf16 v[28:31], v[124:127], a[192:195], v[28:31]
s_waitcnt lgkmcnt(1)
v_mfma_f32_16x16x32_bf16 v[104:107], v[112:115], v[132:135], v[32:35]
ds_read_b128 v[124:127], v0 offset:6400
v_mfma_f32_16x16x32_bf16 v[80:83], v[112:115], v[128:131], v[32:35]
v_mfma_f32_16x16x32_bf16 v[56:59], v[112:115], a[196:199], v[32:35]
v_mfma_f32_16x16x32_bf16 v[32:35], v[112:115], a[192:195], v[32:35]
v_mfma_f32_16x16x32_bf16 v[108:111], v[116:119], v[132:135], v[36:39]
ds_read_b128 v[112:115], v0 offset:8192
v_mfma_f32_16x16x32_bf16 v[84:87], v[116:119], v[128:131], v[36:39]
v_mfma_f32_16x16x32_bf16 v[60:63], v[116:119], a[196:199], v[36:39]
v_mfma_f32_16x16x32_bf16 v[36:39], v[116:119], a[192:195], v[36:39]
s_waitcnt lgkmcnt(1)
v_mfma_f32_16x16x32_bf16 v[88:91], v[120:123], v[140:143], v[88:91]
ds_read_b128 v[116:119], v0 offset:8448
v_mfma_f32_16x16x32_bf16 v[64:67], v[120:123], v[136:139], v[64:67]
v_mfma_f32_16x16x32_bf16 v[40:43], v[120:123], a[204:207], v[40:43]
v_mfma_f32_16x16x32_bf16 v[16:19], v[120:123], a[200:203], v[16:19]
v_mfma_f32_16x16x32_bf16 v[92:95], v[124:127], v[140:143], v[92:95]
ds_read_b128 v[120:123], v0 offset:10240
v_mfma_f32_16x16x32_bf16 v[68:71], v[124:127], v[136:139], v[68:71]
v_mfma_f32_16x16x32_bf16 v[44:47], v[124:127], a[204:207], v[44:47]
v_mfma_f32_16x16x32_bf16 v[20:23], v[124:127], a[200:203], v[20:23]
s_waitcnt lgkmcnt(1)
v_mfma_f32_16x16x32_bf16 v[96:99], v[112:115], v[140:143], v[96:99]
ds_read_b128 v[124:127], v0 offset:10496
v_mfma_f32_16x16x32_bf16 v[72:75], v[112:115], v[136:139], v[72:75]
v_mfma_f32_16x16x32_bf16 v[48:51], v[112:115], a[204:207], v[48:51]
v_mfma_f32_16x16x32_bf16 v[24:27], v[112:115], a[200:203], v[24:27]
v_mfma_f32_16x16x32_bf16 v[100:103], v[116:119], v[140:143], v[100:103]
ds_read_b128 v[112:115], v0 offset:12288
v_mfma_f32_16x16x32_bf16 v[76:79], v[116:119], v[136:139], v[76:79]
v_mfma_f32_16x16x32_bf16 v[52:55], v[116:119], a[204:207], v[52:55]
v_mfma_f32_16x16x32_bf16 v[28:31], v[116:119], a[200:203], v[28:31]
s_waitcnt lgkmcnt(1)
v_mfma_f32_16x16x32_bf16 v[104:107], v[120:123], v[140:143], v[104:107]
ds_read_b128 v[116:119], v0 offset:12544
v_mfma_f32_16x16x32_bf16 v[80:83], v[120:123], v[136:139], v[80:83]
v_mfma_f32_16x16x32_bf16 v[56:59], v[120:123], a[204:207], v[56:59]
v_mfma_f32_16x16x32_bf16 v[32:35], v[120:123], a[200:203], v[32:35]
v_mfma_f32_16x16x32_bf16 v[108:111], v[124:127], v[140:143], v[108:111]
ds_read_b128 v[120:123], v0 offset:14336
v_mfma_f32_16x16x32_bf16 v[84:87], v[124:127], v[136:139], v[84:87]
v_mfma_f32_16x16x32_bf16 v[60:63], v[124:127], a[204:207], v[60:63]
v_mfma_f32_16x16x32_bf16 v[36:39], v[124:127], a[200:203], v[36:39]
s_waitcnt lgkmcnt(1)
v_mfma_f32_16x16x32_bf16 v[88:91], v[112:115], v[148:151], v[88:91]
ds_read_b128 v[124:127], v0 offset:14592
v_mfma_f32_16x16x32_bf16 v[64:67], v[112:115], v[144:147], v[64:67]
v_mfma_f32_16x16x32_bf16 v[40:43], v[112:115], a[212:215], v[40:43]
v_mfma_f32_16x16x32_bf16 v[16:19], v[112:115], a[208:211], v[16:19]
v_mfma_f32_16x16x32_bf16 v[92:95], v[116:119], v[148:151], v[92:95]
ds_read_b128 v[112:115], v0 offset:16384
v_mfma_f32_16x16x32_bf16 v[68:71], v[116:119], v[144:147], v[68:71]
v_mfma_f32_16x16x32_bf16 v[44:47], v[116:119], a[212:215], v[44:47]
v_mfma_f32_16x16x32_bf16 v[20:23], v[116:119], a[208:211], v[20:23]
s_waitcnt lgkmcnt(1)
v_mfma_f32_16x16x32_bf16 v[96:99], v[120:123], v[148:151], v[96:99]
ds_read_b128 v[116:119], v0 offset:16640
v_mfma_f32_16x16x32_bf16 v[72:75], v[120:123], v[144:147], v[72:75]
v_mfma_f32_16x16x32_bf16 v[48:51], v[120:123], a[212:215], v[48:51]
v_mfma_f32_16x16x32_bf16 v[24:27], v[120:123], a[208:211], v[24:27]
v_mfma_f32_16x16x32_bf16 v[100:103], v[124:127], v[148:151], v[100:103]
ds_read_b128 v[120:123], v0 offset:18432
v_mfma_f32_16x16x32_bf16 v[76:79], v[124:127], v[144:147], v[76:79]
v_mfma_f32_16x16x32_bf16 v[52:55], v[124:127], a[212:215], v[52:55]
v_mfma_f32_16x16x32_bf16 v[28:31], v[124:127], a[208:211], v[28:31]
s_waitcnt lgkmcnt(1)
v_mfma_f32_16x16x32_bf16 v[104:107], v[112:115], v[148:151], v[104:107]
ds_read_b128 v[124:127], v0 offset:18688
v_mfma_f32_16x16x32_bf16 v[80:83], v[112:115], v[144:147], v[80:83]
v_mfma_f32_16x16x32_bf16 v[56:59], v[112:115], a[212:215], v[56:59]
v_mfma_f32_16x16x32_bf16 v[32:35], v[112:115], a[208:211], v[32:35]
v_mfma_f32_16x16x32_bf16 v[108:111], v[116:119], v[148:151], v[108:111]
ds_read_b128 v[112:115], v0 offset:20480
v_mfma_f32_16x16x32_bf16 v[84:87], v[116:119], v[144:147], v[84:87]
v_mfma_f32_16x16x32_bf16 v[60:63], v[116:119], a[212:215], v[60:63]
v_mfma_f32_16x16x32_bf16 v[36:39], v[116:119], a[208:211], v[36:39]
s_waitcnt lgkmcnt(1)
v_mfma_f32_16x16x32_bf16 v[88:91], v[120:123], v[156:159], v[88:91]
ds_read_b128 v[116:119], v0 offset:20736
v_mfma_f32_16x16x32_bf16 v[64:67], v[120:123], v[152:155], v[64:67]
s_mov_b32 s64, 37748736
buffer_load_dwordx4 a[192:195], v4, s[24:27], s64 offen offset:0
v_mfma_f32_16x16x32_bf16 v[40:43], v[120:123], a[220:223], v[40:43]
v_mfma_f32_16x16x32_bf16 v[16:19], v[120:123], a[216:219], v[16:19]
v_mfma_f32_16x16x32_bf16 v[92:95], v[124:127], v[156:159], v[92:95]
ds_read_b128 v[120:123], v0 offset:22528
v_mfma_f32_16x16x32_bf16 v[68:71], v[124:127], v[152:155], v[68:71]
v_mfma_f32_16x16x32_bf16 v[44:47], v[124:127], a[220:223], v[44:47]
v_mfma_f32_16x16x32_bf16 v[20:23], v[124:127], a[216:219], v[20:23]
s_waitcnt lgkmcnt(1)
v_mfma_f32_16x16x32_bf16 v[96:99], v[112:115], v[156:159], v[96:99]
ds_read_b128 v[124:127], v0 offset:22784
v_mfma_f32_16x16x32_bf16 v[72:75], v[112:115], v[152:155], v[72:75]
v_mfma_f32_16x16x32_bf16 v[48:51], v[112:115], a[220:223], v[48:51]
v_mfma_f32_16x16x32_bf16 v[24:27], v[112:115], a[216:219], v[24:27]
v_mfma_f32_16x16x32_bf16 v[100:103], v[116:119], v[156:159], v[100:103]
ds_read_b128 v[112:115], v0 offset:24576
v_mfma_f32_16x16x32_bf16 v[76:79], v[116:119], v[152:155], v[76:79]
buffer_load_dwordx4 a[196:199], v4, s[24:27], s64 offen offset:64
v_mfma_f32_16x16x32_bf16 v[52:55], v[116:119], a[220:223], v[52:55]
v_mfma_f32_16x16x32_bf16 v[28:31], v[116:119], a[216:219], v[28:31]
s_waitcnt lgkmcnt(1)
v_mfma_f32_16x16x32_bf16 v[104:107], v[120:123], v[156:159], v[104:107]
ds_read_b128 v[116:119], v0 offset:24832
v_mfma_f32_16x16x32_bf16 v[80:83], v[120:123], v[152:155], v[80:83]
v_mfma_f32_16x16x32_bf16 v[56:59], v[120:123], a[220:223], v[56:59]
v_mfma_f32_16x16x32_bf16 v[32:35], v[120:123], a[216:219], v[32:35]
v_mfma_f32_16x16x32_bf16 v[108:111], v[124:127], v[156:159], v[108:111]
ds_read_b128 v[120:123], v0 offset:26624
v_mfma_f32_16x16x32_bf16 v[84:87], v[124:127], v[152:155], v[84:87]
v_mfma_f32_16x16x32_bf16 v[60:63], v[124:127], a[220:223], v[60:63]
v_mfma_f32_16x16x32_bf16 v[36:39], v[124:127], a[216:219], v[36:39]
s_waitcnt lgkmcnt(1)
v_mfma_f32_16x16x32_bf16 v[88:91], v[112:115], v[164:167], v[88:91]
ds_read_b128 v[124:127], v0 offset:26880
v_mfma_f32_16x16x32_bf16 v[64:67], v[112:115], v[160:163], v[64:67]
buffer_load_dwordx4 a[200:203], v4, s[24:27], s64 offen offset:128
v_mfma_f32_16x16x32_bf16 v[40:43], v[112:115], a[228:231], v[40:43]
v_mfma_f32_16x16x32_bf16 v[16:19], v[112:115], a[224:227], v[16:19]
v_mfma_f32_16x16x32_bf16 v[92:95], v[116:119], v[164:167], v[92:95]
ds_read_b128 v[112:115], v0 offset:28672
v_lshrrev_b32 v155, 4, v2
v_subrev_u32 v155, s20, v155
v_mfma_f32_16x16x32_bf16 v[68:71], v[116:119], v[160:163], v[68:71]
v_lshrrev_b32 v155, 3, v155
v_bfe_u32 v154, v155, 2, 3
v_mfma_f32_16x16x32_bf16 v[44:47], v[116:119], a[228:231], v[44:47]
v_lshlrev_b32 v152, 3, v154
v_lshrrev_b32 v154, 5, v155
v_mfma_f32_16x16x32_bf16 v[20:23], v[116:119], a[224:227], v[20:23]
v_lshl_add_u32 v152, v154, 8, v152
v_xor_b32 v154, v155, v154
s_waitcnt lgkmcnt(0)
v_mfma_f32_16x16x32_bf16 v[96:99], v[120:123], v[164:167], v[96:99]
ds_read_b128 v[116:119], v0 offset:28928
v_and_b32 v154, 1, v154
v_lshl_add_u32 v152, v154, 6, v152
v_mfma_f32_16x16x32_bf16 v[72:75], v[120:123], v[160:163], v[72:75]
v_bfe_u32 v154, v155, 1, 1
v_lshl_add_u32 v152, v154, 7, v152
v_mfma_f32_16x16x32_bf16 v[48:51], v[120:123], a[228:231], v[48:51]
s_mul_i32 s67, s66, 18432
s_add_u32 s67, s67, 73728
v_mfma_f32_16x16x32_bf16 v[24:27], v[120:123], a[224:227], v[24:27]
v_add_u32_e64 v152, s67, v152
v_mfma_f32_16x16x32_bf16 v[100:103], v[124:127], v[164:167], v[100:103]
ds_read_b128 v[120:123], v0 offset:30720
v_mfma_f32_16x16x32_bf16 v[76:79], v[124:127], v[160:163], v[76:79]
buffer_load_dwordx4 a[204:207], v4, s[24:27], s64 offen offset:3072
v_mfma_f32_16x16x32_bf16 v[52:55], v[124:127], a[228:231], v[52:55]
v_mfma_f32_16x16x32_bf16 v[28:31], v[124:127], a[224:227], v[28:31]
v_mfma_f32_16x16x32_bf16 v[104:107], v[112:115], v[164:167], v[104:107]
ds_read_b128 v[124:127], v0 offset:30976
v_mfma_f32_16x16x32_bf16 v[80:83], v[112:115], v[160:163], v[80:83]
v_mfma_f32_16x16x32_bf16 v[56:59], v[112:115], a[228:231], v[56:59]
v_mfma_f32_16x16x32_bf16 v[32:35], v[112:115], a[224:227], v[32:35]
s_waitcnt lgkmcnt(1)
v_mfma_f32_16x16x32_bf16 v[108:111], v[116:119], v[164:167], v[108:111]
ds_read_b128 v[112:115], v0 offset:32768
v_mfma_f32_16x16x32_bf16 v[84:87], v[116:119], v[160:163], v[84:87]
v_mfma_f32_16x16x32_bf16 v[60:63], v[116:119], a[228:231], v[60:63]
v_mfma_f32_16x16x32_bf16 v[36:39], v[116:119], a[224:227], v[36:39]
v_mfma_f32_16x16x32_bf16 v[88:91], v[120:123], v[172:175], v[88:91]
ds_read_b128 v[116:119], v0 offset:33024
v_mfma_f32_16x16x32_bf16 v[64:67], v[120:123], v[168:171], v[64:67]
buffer_load_dwordx4 a[208:211], v4, s[24:27], s64 offen offset:3136
v_mfma_f32_16x16x32_bf16 v[40:43], v[120:123], a[236:239], v[40:43]
v_mfma_f32_16x16x32_bf16 v[16:19], v[120:123], a[232:235], v[16:19]
s_waitcnt lgkmcnt(1)
v_mfma_f32_16x16x32_bf16 v[92:95], v[124:127], v[172:175], v[92:95]
ds_read_b128 v[120:123], v0 offset:34816
v_mfma_f32_16x16x32_bf16 v[68:71], v[124:127], v[168:171], v[68:71]
v_mfma_f32_16x16x32_bf16 v[44:47], v[124:127], a[236:239], v[44:47]
v_mfma_f32_16x16x32_bf16 v[20:23], v[124:127], a[232:235], v[20:23]
v_mfma_f32_16x16x32_bf16 v[96:99], v[112:115], v[172:175], v[96:99]
ds_read_b128 v[124:127], v0 offset:35072
v_mfma_f32_16x16x32_bf16 v[72:75], v[112:115], v[168:171], v[72:75]
v_mfma_f32_16x16x32_bf16 v[48:51], v[112:115], a[236:239], v[48:51]
v_mfma_f32_16x16x32_bf16 v[24:27], v[112:115], a[232:235], v[24:27]
s_waitcnt lgkmcnt(1)
v_mfma_f32_16x16x32_bf16 v[100:103], v[116:119], v[172:175], v[100:103]
ds_read_b128 v[112:115], v0 offset:36864
v_mfma_f32_16x16x32_bf16 v[76:79], v[116:119], v[168:171], v[76:79]
buffer_load_dwordx4 a[212:215], v4, s[24:27], s64 offen offset:3200
v_mfma_f32_16x16x32_bf16 v[52:55], v[116:119], a[236:239], v[52:55]
v_mfma_f32_16x16x32_bf16 v[28:31], v[116:119], a[232:235], v[28:31]
v_mfma_f32_16x16x32_bf16 v[104:107], v[120:123], v[172:175], v[104:107]
ds_read_b128 v[116:119], v0 offset:37120
v_mfma_f32_16x16x32_bf16 v[80:83], v[120:123], v[168:171], v[80:83]
v_mfma_f32_16x16x32_bf16 v[56:59], v[120:123], a[236:239], v[56:59]
v_mfma_f32_16x16x32_bf16 v[32:35], v[120:123], a[232:235], v[32:35]
s_waitcnt lgkmcnt(1)
v_mfma_f32_16x16x32_bf16 v[108:111], v[124:127], v[172:175], v[108:111]
ds_read_b128 v[120:123], v0 offset:38912
v_mfma_f32_16x16x32_bf16 v[84:87], v[124:127], v[168:171], v[84:87]
v_mfma_f32_16x16x32_bf16 v[60:63], v[124:127], a[236:239], v[60:63]
v_mfma_f32_16x16x32_bf16 v[36:39], v[124:127], a[232:235], v[36:39]
v_mfma_f32_16x16x32_bf16 v[88:91], v[112:115], v[180:183], v[88:91]
ds_read_b128 v[124:127], v0 offset:39168
v_mfma_f32_16x16x32_bf16 v[64:67], v[112:115], v[176:179], v[64:67]
s_mov_b32 s64, 44040192
buffer_load_dwordx4 a[216:219], v4, s[24:27], s64 offen offset:0
v_mfma_f32_16x16x32_bf16 v[40:43], v[112:115], a[244:247], v[40:43]
v_mfma_f32_16x16x32_bf16 v[16:19], v[112:115], a[240:243], v[16:19]
s_waitcnt lgkmcnt(1)
v_mfma_f32_16x16x32_bf16 v[92:95], v[116:119], v[180:183], v[92:95]
ds_read_b128 v[112:115], v0 offset:40960
v_mfma_f32_16x16x32_bf16 v[68:71], v[116:119], v[176:179], v[68:71]
v_mfma_f32_16x16x32_bf16 v[44:47], v[116:119], a[244:247], v[44:47]
v_lshrrev_b32 v153, 9, v0
v_lshlrev_b32_e64 v153, 8, v153
v_mfma_f32_16x16x32_bf16 v[20:23], v[116:119], a[240:243], v[20:23]
ds_read_b64_tr_b16 v[128:129], v152 offset:0
v_and_b32 v154, 240, v0
v_or_b32_e64 v153, v153, v154
v_mfma_f32_16x16x32_bf16 v[96:99], v[120:123], v[180:183], v[96:99]
ds_read_b128 v[116:119], v0 offset:41216
v_mfma_f32_16x16x32_bf16 v[72:75], v[120:123], v[176:179], v[72:75]
v_mfma_f32_16x16x32_bf16 v[48:51], v[120:123], a[244:247], v[48:51]
ds_read_b64_tr_b16 v[130:131], v152 offset:512
v_mfma_f32_16x16x32_bf16 v[24:27], v[120:123], a[240:243], v[24:27]
s_waitcnt lgkmcnt(3)
v_mfma_f32_16x16x32_bf16 v[100:103], v[124:127], v[180:183], v[100:103]
ds_read_b128 v[120:123], v0 offset:43008
v_mfma_f32_16x16x32_bf16 v[76:79], v[124:127], v[176:179], v[76:79]
buffer_load_dwordx4 a[220:223], v4, s[24:27], s64 offen offset:64
ds_read_b64_tr_b16 v[132:133], v152 offset:1024
v_mfma_f32_16x16x32_bf16 v[52:55], v[124:127], a[244:247], v[52:55]
v_mfma_f32_16x16x32_bf16 v[28:31], v[124:127], a[240:243], v[28:31]
v_mfma_f32_16x16x32_bf16 v[104:107], v[112:115], v[180:183], v[104:107]
ds_read_b128 v[124:127], v0 offset:43264
ds_read_b64_tr_b16 v[134:135], v152 offset:1536
v_mfma_f32_16x16x32_bf16 v[80:83], v[112:115], v[176:179], v[80:83]
v_mfma_f32_16x16x32_bf16 v[56:59], v[112:115], a[244:247], v[56:59]
v_mfma_f32_16x16x32_bf16 v[32:35], v[112:115], a[240:243], v[32:35]
s_waitcnt lgkmcnt(2)
v_mfma_f32_16x16x32_bf16 v[108:111], v[116:119], v[180:183], v[108:111]
ds_read_b128 v[112:115], v0 offset:45056
v_mfma_f32_16x16x32_bf16 v[84:87], v[116:119], v[176:179], v[84:87]
v_mfma_f32_16x16x32_bf16 v[60:63], v[116:119], a[244:247], v[60:63]
v_mfma_f32_16x16x32_bf16 v[36:39], v[116:119], a[240:243], v[36:39]
v_mfma_f32_16x16x32_bf16 v[88:91], v[120:123], v[188:191], v[88:91]
ds_read_b128 v[116:119], v0 offset:45312
v_mfma_f32_16x16x32_bf16 v[64:67], v[120:123], v[184:187], v[64:67]
buffer_load_dwordx4 a[224:227], v4, s[24:27], s64 offen offset:128
v_mfma_f32_16x16x32_bf16 v[40:43], v[120:123], a[252:255], v[40:43]
v_mfma_f32_16x16x32_bf16 v[16:19], v[120:123], a[248:251], v[16:19]
s_waitcnt lgkmcnt(1)
v_mfma_f32_16x16x32_bf16 v[92:95], v[124:127], v[188:191], v[92:95]
ds_read_b128 v[120:123], v0 offset:47104
v_mfma_f32_16x16x32_bf16 v[68:71], v[124:127], v[184:187], v[68:71]
v_mfma_f32_16x16x32_bf16 v[44:47], v[124:127], a[252:255], v[44:47]
v_mfma_f32_16x16x32_bf16 v[20:23], v[124:127], a[248:251], v[20:23]
ds_read_b64_tr_b16 v[136:137], v152 offset:2048
v_mfma_f32_16x16x32_bf16 v[96:99], v[112:115], v[188:191], v[96:99]
ds_read_b128 v[124:127], v0 offset:47360
v_mfma_f32_16x16x32_bf16 v[72:75], v[112:115], v[184:187], v[72:75]
v_mfma_f32_16x16x32_bf16 v[48:51], v[112:115], a[252:255], v[48:51]
ds_read_b64_tr_b16 v[138:139], v152 offset:2560
v_mfma_f32_16x16x32_bf16 v[24:27], v[112:115], a[248:251], v[24:27]
s_waitcnt lgkmcnt(3)
v_mfma_f32_16x16x32_bf16 v[100:103], v[116:119], v[188:191], v[100:103]
ds_read_b128 v[112:115], v0 offset:49152
ds_read_b128 v[8:11], v5 offset:1632
v_mfma_f32_16x16x32_bf16 v[76:79], v[116:119], v[184:187], v[76:79]
buffer_load_dwordx4 a[228:231], v4, s[24:27], s64 offen offset:3072
ds_read_b64_tr_b16 v[140:141], v152 offset:3072
v_mfma_f32_16x16x32_bf16 v[52:55], v[116:119], a[252:255], v[52:55]
ds_read_b128 v[12:15], v5 offset:1904
v_mfma_f32_16x16x32_bf16 v[28:31], v[116:119], a[248:251], v[28:31]
v_mfma_f32_16x16x32_bf16 v[104:107], v[120:123], v[188:191], v[104:107]
ds_read_b128 v[116:119], v0 offset:49408
ds_read_b64_tr_b16 v[142:143], v152 offset:3584
v_mfma_f32_16x16x32_bf16 v[80:83], v[120:123], v[184:187], v[80:83]
v_mfma_f32_16x16x32_bf16 v[56:59], v[120:123], a[252:255], v[56:59]
v_mfma_f32_16x16x32_bf16 v[32:35], v[120:123], a[248:251], v[32:35]
s_waitcnt lgkmcnt(3)
v_mfma_f32_16x16x32_bf16 v[108:111], v[124:127], v[188:191], v[108:111]
ds_read_b128 v[120:123], v0 offset:51200
v_mfma_f32_16x16x32_bf16 v[84:87], v[124:127], v[184:187], v[84:87]
v_mfma_f32_16x16x32_bf16 v[60:63], v[124:127], a[252:255], v[60:63]
v_mfma_f32_16x16x32_bf16 v[36:39], v[124:127], a[248:251], v[36:39]
v_mfma_f32_16x16x32_bf16 v[88:91], v[112:115], v[196:199], v[88:91]
ds_read_b128 v[124:127], v0 offset:51456
v_mfma_f32_16x16x32_bf16 v[64:67], v[112:115], v[192:195], v[64:67]
buffer_load_dwordx4 a[232:235], v4, s[24:27], s64 offen offset:3136
v_mfma_f32_16x16x32_bf16 v[40:43], v[112:115], v[228:231], v[40:43]
v_mfma_f32_16x16x32_bf16 v[16:19], v[112:115], v[224:227], v[16:19]
s_waitcnt lgkmcnt(1)
v_mfma_f32_16x16x32_bf16 v[92:95], v[116:119], v[196:199], v[92:95]
ds_read_b128 v[112:115], v0 offset:53248
s_waitcnt vmcnt(7)
v_mfma_f32_16x16x32_bf16 v[40:43], v[8:11], a[204:207], v[40:43]
v_mfma_f32_16x16x32_bf16 v[68:71], v[116:119], v[192:195], v[68:71]
v_mfma_f32_16x16x32_bf16 v[16:19], v[8:11], a[192:195], v[16:19]
v_mfma_f32_16x16x32_bf16 v[44:47], v[116:119], v[228:231], v[44:47]
v_mfma_f32_16x16x32_bf16 v[44:47], v[12:15], a[204:207], v[44:47]
v_mfma_f32_16x16x32_bf16 v[20:23], v[116:119], v[224:227], v[20:23]
ds_read_b64_tr_b16 v[144:145], v152 offset:4096
v_mfma_f32_16x16x32_bf16 v[20:23], v[12:15], a[192:195], v[20:23]
v_mfma_f32_16x16x32_bf16 v[96:99], v[120:123], v[196:199], v[96:99]
ds_read_b128 v[116:119], v0 offset:53504
s_waitcnt vmcnt(6)
v_mfma_f32_16x16x32_bf16 v[48:51], v[8:11], a[208:211], v[48:51]
v_mfma_f32_16x16x32_bf16 v[72:75], v[120:123], v[192:195], v[72:75]
v_mfma_f32_16x16x32_bf16 v[24:27], v[8:11], a[196:199], v[24:27]
v_mfma_f32_16x16x32_bf16 v[48:51], v[120:123], v[228:231], v[48:51]
ds_read_b64_tr_b16 v[146:147], v152 offset:4608
v_mfma_f32_16x16x32_bf16 v[52:55], v[12:15], a[208:211], v[52:55]
v_mfma_f32_16x16x32_bf16 v[24:27], v[120:123], v[224:227], v[24:27]
v_mfma_f32_16x16x32_bf16 v[28:31], v[12:15], a[196:199], v[28:31]
s_waitcnt lgkmcnt(1)
v_mfma_f32_16x16x32_bf16 v[100:103], v[124:127], v[196:199], v[100:103]
ds_read_b128 v[120:123], v0 offset:55296
s_waitcnt vmcnt(5)
v_mfma_f32_16x16x32_bf16 v[56:59], v[8:11], a[212:215], v[56:59]
v_mfma_f32_16x16x32_bf16 v[76:79], v[124:127], v[192:195], v[76:79]
buffer_load_dwordx4 a[236:239], v4, s[24:27], s64 offen offset:3200
ds_read_b64_tr_b16 v[148:149], v152 offset:5120
v_mfma_f32_16x16x32_bf16 v[32:35], v[8:11], a[200:203], v[32:35]
v_mfma_f32_16x16x32_bf16 v[52:55], v[124:127], v[228:231], v[52:55]
v_mfma_f32_16x16x32_bf16 v[60:63], v[12:15], a[212:215], v[60:63]
v_mfma_f32_16x16x32_bf16 v[28:31], v[124:127], v[224:227], v[28:31]
v_mfma_f32_16x16x32_bf16 v[36:39], v[12:15], a[200:203], v[36:39]
v_mfma_f32_16x16x32_bf16 v[104:107], v[112:115], v[196:199], v[104:107]
ds_read_b128 v[124:127], v0 offset:55552
ds_read_b64_tr_b16 v[150:151], v152 offset:5632
v_mfma_f32_16x16x32_bf16 v[80:83], v[112:115], v[192:195], v[80:83]
v_mfma_f32_16x16x32_bf16 v[56:59], v[112:115], v[228:231], v[56:59]
v_mfma_f32_16x16x32_bf16 v[32:35], v[112:115], v[224:227], v[32:35]
v_mfma_f32_16x16x32_bf16 v[108:111], v[116:119], v[196:199], v[108:111]
ds_read_b128 v[112:115], v0 offset:57344
s_mov_b32 s85, 12582912
buffer_load_dwordx4 a[192:195], v4, s[24:27], s85 offen offset:0
v_mfma_f32_16x16x32_bf16 v[84:87], v[116:119], v[192:195], v[84:87]
v_mfma_f32_16x16x32_bf16 v[60:63], v[116:119], v[228:231], v[60:63]
v_mfma_f32_16x16x32_bf16 v[36:39], v[116:119], v[224:227], v[36:39]
s_waitcnt lgkmcnt(1)
v_mfma_f32_16x16x32_bf16 v[88:91], v[120:123], v[204:207], v[88:91]
ds_read_b128 v[116:119], v0 offset:57600
v_mfma_f32_16x16x32_bf16 v[64:67], v[120:123], v[200:203], v[64:67]
v_mfma_f32_16x16x32_bf16 v[40:43], v[120:123], v[236:239], v[40:43]
s_add_u32 s81, s80, 0
buffer_load_dwordx4 v[224:227], v153, s[40:43], s81 offen offset:0 sc1
v_mfma_f32_16x16x32_bf16 v[16:19], v[120:123], v[232:235], v[16:19]
v_mfma_f32_16x16x32_bf16 v[92:95], v[124:127], v[204:207], v[92:95]
ds_read_b128 v[120:123], v0 offset:59392
ds_read_b128 v[176:179], v3 offset:0
v_mfma_f32_16x16x32_bf16 v[68:71], v[124:127], v[200:203], v[68:71]
v_mfma_f32_16x16x32_bf16 v[44:47], v[124:127], v[236:239], v[44:47]
v_mfma_f32_16x16x32_bf16 v[20:23], v[124:127], v[232:235], v[20:23]
s_waitcnt lgkmcnt(2)
v_mfma_f32_16x16x32_bf16 v[96:99], v[112:115], v[204:207], v[96:99]
ds_read_b128 v[124:127], v0 offset:59648
ds_read_b128 v[180:183], v3 offset:16
v_mfma_f32_16x16x32_bf16 v[72:75], v[112:115], v[200:203], v[72:75]
v_mfma_f32_16x16x32_bf16 v[48:51], v[112:115], v[236:239], v[48:51]
v_mfma_f32_16x16x32_bf16 v[24:27], v[112:115], v[232:235], v[24:27]
buffer_load_dwordx4 a[196:199], v4, s[24:27], s85 offen offset:64
v_mfma_f32_16x16x32_bf16 v[100:103], v[116:119], v[204:207], v[100:103]
ds_read_b128 v[112:115], v0 offset:61440
ds_read_b128 v[184:187], v3 offset:128
v_mfma_f32_16x16x32_bf16 v[76:79], v[116:119], v[200:203], v[76:79]
v_mfma_f32_16x16x32_bf16 v[52:55], v[116:119], v[236:239], v[52:55]
buffer_load_dwordx4 v[228:231], v153, s[40:43], s81 offen offset:1024 sc1
v_mfma_f32_16x16x32_bf16 v[28:31], v[116:119], v[232:235], v[28:31]
s_waitcnt lgkmcnt(2)
v_mfma_f32_16x16x32_bf16 v[104:107], v[120:123], v[204:207], v[104:107]
ds_read_b128 v[116:119], v0 offset:61696
ds_read_b128 v[188:191], v3 offset:144
v_mfma_f32_16x16x32_bf16 v[80:83], v[120:123], v[200:203], v[80:83]
v_mfma_f32_16x16x32_bf16 v[56:59], v[120:123], v[236:239], v[56:59]
v_mfma_f32_16x16x32_bf16 v[32:35], v[120:123], v[232:235], v[32:35]
v_mfma_f32_16x16x32_bf16 v[108:111], v[124:127], v[204:207], v[108:111]
ds_read_b128 v[120:123], v0 offset:63488
ds_read_b128 v[192:195], v3 offset:256
v_mfma_f32_16x16x32_bf16 v[84:87], v[124:127], v[200:203], v[84:87]
v_mfma_f32_16x16x32_bf16 v[60:63], v[124:127], v[236:239], v[60:63]
v_mfma_f32_16x16x32_bf16 v[36:39], v[124:127], v[232:235], v[36:39]
s_waitcnt lgkmcnt(2)
v_mfma_f32_16x16x32_bf16 v[88:91], v[112:115], v[212:215], v[88:91]
ds_read_b128 v[124:127], v0 offset:63744
ds_read_b128 v[196:199], v3 offset:272
v_mfma_f32_16x16x32_bf16 v[64:67], v[112:115], v[208:211], v[64:67]
v_mfma_f32_16x16x32_bf16 v[40:43], v[112:115], v[244:247], v[40:43]
s_add_u32 s81, s80, 2048
buffer_load_dwordx4 v[232:235], v153, s[40:43], s81 offen offset:0 sc1
buffer_load_dwordx4 a[200:203], v4, s[24:27], s85 offen offset:128
v_mfma_f32_16x16x32_bf16 v[16:19], v[112:115], v[240:243], v[16:19]
v_mfma_f32_16x16x32_bf16 v[92:95], v[116:119], v[212:215], v[92:95]
ds_read_b128 v[112:115], v1 offset:0
v_mfma_f32_16x16x32_bf16 v[68:71], v[116:119], v[208:211], v[68:71]
v_mfma_f32_16x16x32_bf16 v[44:47], v[116:119], v[244:247], v[44:47]
v_mfma_f32_16x16x32_bf16 v[20:23], v[116:119], v[240:243], v[20:23]
s_waitcnt lgkmcnt(1)
v_mfma_f32_16x16x32_bf16 v[96:99], v[120:123], v[212:215], v[96:99]
ds_read_b128 v[116:119], v1 offset:256
v_mfma_f32_16x16x32_bf16 v[72:75], v[120:123], v[208:211], v[72:75]
v_mfma_f32_16x16x32_bf16 v[48:51], v[120:123], v[244:247], v[48:51]
v_mfma_f32_16x16x32_bf16 v[24:27], v[120:123], v[240:243], v[24:27]
v_mfma_f32_16x16x32_bf16 v[100:103], v[124:127], v[212:215], v[100:103]
ds_read_b128 v[120:123], v1 offset:2048
v_mfma_f32_16x16x32_bf16 v[76:79], v[124:127], v[208:211], v[76:79]
v_mfma_f32_16x16x32_bf16 v[52:55], v[124:127], v[244:247], v[52:55]
buffer_load_dwordx4 v[236:239], v153, s[40:43], s81 offen offset:1024 sc1
v_mfma_f32_16x16x32_bf16 v[28:31], v[124:127], v[240:243], v[28:31]
s_waitcnt lgkmcnt(1)
v_mfma_f32_16x16x32_bf16 v[104:107], v[112:115], v[212:215], v[104:107]
ds_read_b128 v[124:127], v1 offset:2304
v_mfma_f32_16x16x32_bf16 v[80:83], v[112:115], v[208:211], v[80:83]
buffer_load_dwordx4 a[204:207], v4, s[24:27], s85 offen offset:3072
v_mfma_f32_16x16x32_bf16 v[56:59], v[112:115], v[244:247], v[56:59]
v_mfma_f32_16x16x32_bf16 v[32:35], v[112:115], v[240:243], v[32:35]
v_mfma_f32_16x16x32_bf16 v[108:111], v[116:119], v[212:215], v[108:111]
ds_read_b128 v[112:115], v1 offset:4096
v_mfma_f32_16x16x32_bf16 v[84:87], v[116:119], v[208:211], v[84:87]
v_mfma_f32_16x16x32_bf16 v[60:63], v[116:119], v[244:247], v[60:63]
v_mfma_f32_16x16x32_bf16 v[36:39], v[116:119], v[240:243], v[36:39]
s_waitcnt lgkmcnt(1)
v_mfma_f32_16x16x32_bf16 v[88:91], v[120:123], v[220:223], v[88:91]
ds_read_b128 v[116:119], v1 offset:4352
v_mfma_f32_16x16x32_bf16 v[64:67], v[120:123], v[216:219], v[64:67]
v_mfma_f32_16x16x32_bf16 v[40:43], v[120:123], v[252:255], v[40:43]
s_add_u32 s81, s80, 4096
buffer_load_dwordx4 v[240:243], v153, s[40:43], s81 offen offset:0 sc1
v_mfma_f32_16x16x32_bf16 v[16:19], v[120:123], v[248:251], v[16:19]
v_mfma_f32_16x16x32_bf16 v[92:95], v[124:127], v[220:223], v[92:95]
ds_read_b128 v[120:123], v1 offset:6144
v_mfma_f32_16x16x32_bf16 v[68:71], v[124:127], v[216:219], v[68:71]
v_mfma_f32_16x16x32_bf16 v[44:47], v[124:127], v[252:255], v[44:47]
v_mfma_f32_16x16x32_bf16 v[20:23], v[124:127], v[248:251], v[20:23]
s_waitcnt lgkmcnt(1)
v_mfma_f32_16x16x32_bf16 v[96:99], v[112:115], v[220:223], v[96:99]
ds_read_b128 v[124:127], v1 offset:6400
buffer_load_dwordx4 a[208:211], v4, s[24:27], s85 offen offset:3136
v_mfma_f32_16x16x32_bf16 v[72:75], v[112:115], v[216:219], v[72:75]
v_mfma_f32_16x16x32_bf16 v[48:51], v[112:115], v[252:255], v[48:51]
v_mfma_f32_16x16x32_bf16 v[24:27], v[112:115], v[248:251], v[24:27]
v_mfma_f32_16x16x32_bf16 v[100:103], v[116:119], v[220:223], v[100:103]
v_mfma_f32_16x16x32_bf16 v[76:79], v[116:119], v[216:219], v[76:79]
v_mfma_f32_16x16x32_bf16 v[52:55], v[116:119], v[252:255], v[52:55]
buffer_load_dwordx4 v[244:247], v153, s[40:43], s81 offen offset:1024 sc1
v_mfma_f32_16x16x32_bf16 v[28:31], v[116:119], v[248:251], v[28:31]
s_waitcnt lgkmcnt(0)
v_mfma_f32_16x16x32_bf16 v[104:107], v[120:123], v[220:223], v[104:107]
v_mfma_f32_16x16x32_bf16 v[80:83], v[120:123], v[216:219], v[80:83]
v_mfma_f32_16x16x32_bf16 v[56:59], v[120:123], v[252:255], v[56:59]
v_mfma_f32_16x16x32_bf16 v[32:35], v[120:123], v[248:251], v[32:35]
v_mfma_f32_16x16x32_bf16 v[108:111], v[124:127], v[220:223], v[108:111]
v_mfma_f32_16x16x32_bf16 v[84:87], v[124:127], v[216:219], v[84:87]
v_mfma_f32_16x16x32_bf16 v[60:63], v[124:127], v[252:255], v[60:63]
v_mfma_f32_16x16x32_bf16 v[36:39], v[124:127], v[248:251], v[36:39]
buffer_load_dwordx4 a[212:215], v4, s[24:27], s85 offen offset:3200
s_waitcnt vmcnt(14)
v_mfma_f32_16x16x32_bf16 v[88:91], v[8:11], a[228:231], v[88:91]
ds_read_b128 v[112:115], v0 offset:0
v_mfma_f32_16x16x32_bf16 v[64:67], v[8:11], a[216:219], v[64:67]
ds_read_b128 v[116:119], v0 offset:256
v_mfma_f32_16x16x32_bf16 v[92:95], v[12:15], a[228:231], v[92:95]
ds_read_b128 v[120:123], v0 offset:2048
v_mfma_f32_16x16x32_bf16 v[68:71], v[12:15], a[216:219], v[68:71]
ds_read_b128 v[124:127], v0 offset:2304
s_waitcnt vmcnt(13)
v_mfma_f32_16x16x32_bf16 v[96:99], v[8:11], a[232:235], v[96:99]
ds_read_b128 v[160:163], v0 offset:4096
v_mfma_f32_16x16x32_bf16 v[72:75], v[8:11], a[220:223], v[72:75]
ds_read_b128 v[164:167], v0 offset:4352
v_mfma_f32_16x16x32_bf16 v[100:103], v[12:15], a[232:235], v[100:103]
v_mfma_f32_16x16x32_bf16 v[76:79], v[12:15], a[220:223], v[76:79]
s_waitcnt vmcnt(12)
v_mfma_f32_16x16x32_bf16 v[104:107], v[8:11], a[236:239], v[104:107]
v_mfma_f32_16x16x32_bf16 v[80:83], v[8:11], a[224:227], v[80:83]
v_mfma_f32_16x16x32_bf16 v[108:111], v[12:15], a[236:239], v[108:111]
v_mfma_f32_16x16x32_bf16 v[84:87], v[12:15], a[224:227], v[84:87]
s_waitcnt lgkmcnt(1)
v_mfma_f32_16x16x32_bf16 v[200:203], v[112:115], v[132:135], v[176:179]
ds_read_b128 v[168:171], v0 offset:6144
v_mov_b32_e64 v253, v153
v_mfma_f32_16x16x32_bf16 v[176:179], v[112:115], v[128:131], v[176:179]
v_mfma_f32_16x16x32_bf16 v[204:207], v[116:119], v[132:135], v[180:183]
ds_read_b128 v[172:175], v0 offset:6400
v_cvt_pk_bf16_f32 v16, v16, v17
v_mfma_f32_16x16x32_bf16 v[180:183], v[116:119], v[128:131], v[180:183]
v_cvt_pk_bf16_f32 v17, v18, v19
v_mfma_f32_16x16x32_bf16 v[208:211], v[120:123], v[132:135], v[184:187]
ds_read_b128 v[112:115], v0 offset:8192
v_cvt_pk_bf16_f32 v18, v20, v21
v_mfma_f32_16x16x32_bf16 v[184:187], v[120:123], v[128:131], v[184:187]
s_mov_b32 s64, 0
buffer_load_dwordx4 a[240:243], v4, s[24:27], s64 offen offset:0
v_cvt_pk_bf16_f32 v19, v22, v23
v_mfma_f32_16x16x32_bf16 v[212:215], v[124:127], v[132:135], v[188:191]
ds_read_b128 v[116:119], v0 offset:8448
v_cvt_pk_bf16_f32 v20, v24, v25
v_mfma_f32_16x16x32_bf16 v[188:191], v[124:127], v[128:131], v[188:191]
v_cvt_pk_bf16_f32 v21, v26, v27
v_mfma_f32_16x16x32_bf16 v[216:219], v[160:163], v[132:135], v[192:195]
ds_read_b128 v[120:123], v0 offset:10240
v_cvt_pk_bf16_f32 v22, v28, v29
v_mfma_f32_16x16x32_bf16 v[192:195], v[160:163], v[128:131], v[192:195]
v_cvt_pk_bf16_f32 v23, v30, v31
s_waitcnt lgkmcnt(2)
v_mfma_f32_16x16x32_bf16 v[220:223], v[164:167], v[132:135], v[196:199]
ds_read_b128 v[124:127], v0 offset:10496
v_cvt_pk_bf16_f32 v24, v32, v33
v_mfma_f32_16x16x32_bf16 v[196:199], v[164:167], v[128:131], v[196:199]
v_cvt_pk_bf16_f32 v25, v34, v35
v_mfma_f32_16x16x32_bf16 v[200:203], v[168:171], v[140:143], v[200:203]
ds_read_b128 v[160:163], v0 offset:12288
v_cvt_pk_bf16_f32 v26, v36, v37
v_mfma_f32_16x16x32_bf16 v[176:179], v[168:171], v[136:139], v[176:179]
ds_read_b64_tr_b16 v[128:129], v152 offset:6144
v_cvt_pk_bf16_f32 v27, v38, v39
v_mfma_f32_16x16x32_bf16 v[204:207], v[172:175], v[140:143], v[204:207]
ds_read_b128 v[164:167], v0 offset:12544
v_cvt_pk_bf16_f32 v28, v40, v41
v_mfma_f32_16x16x32_bf16 v[180:183], v[172:175], v[136:139], v[180:183]
ds_read_b64_tr_b16 v[130:131], v152 offset:6656
v_cvt_pk_bf16_f32 v29, v42, v43
v_mfma_f32_16x16x32_bf16 v[208:211], v[112:115], v[140:143], v[208:211]
ds_read_b128 v[168:171], v0 offset:14336
v_cvt_pk_bf16_f32 v30, v44, v45
v_mfma_f32_16x16x32_bf16 v[184:187], v[112:115], v[136:139], v[184:187]
ds_read_b64_tr_b16 v[132:133], v152 offset:7168
v_cvt_pk_bf16_f32 v31, v46, v47
s_waitcnt lgkmcnt(4)
v_mfma_f32_16x16x32_bf16 v[212:215], v[116:119], v[140:143], v[212:215]
ds_read_b128 v[172:175], v0 offset:14592
v_cvt_pk_bf16_f32 v32, v48, v49
v_mfma_f32_16x16x32_bf16 v[188:191], v[116:119], v[136:139], v[188:191]
buffer_load_dwordx4 a[244:247], v4, s[24:27], s64 offen offset:64
ds_read_b64_tr_b16 v[134:135], v152 offset:7680
v_cvt_pk_bf16_f32 v33, v50, v51
v_mfma_f32_16x16x32_bf16 v[216:219], v[120:123], v[140:143], v[216:219]
ds_read_b128 v[112:115], v0 offset:16384
v_cvt_pk_bf16_f32 v34, v52, v53
v_mfma_f32_16x16x32_bf16 v[192:195], v[120:123], v[136:139], v[192:195]
v_cvt_pk_bf16_f32 v35, v54, v55
v_mfma_f32_16x16x32_bf16 v[220:223], v[124:127], v[140:143], v[220:223]
ds_read_b128 v[116:119], v0 offset:16640
v_cvt_pk_bf16_f32 v36, v56, v57
v_mfma_f32_16x16x32_bf16 v[196:199], v[124:127], v[136:139], v[196:199]
v_cvt_pk_bf16_f32 v37, v58, v59
v_mfma_f32_16x16x32_bf16 v[200:203], v[160:163], v[148:151], v[200:203]
ds_read_b128 v[120:123], v0 offset:18432
v_cvt_pk_bf16_f32 v38, v60, v61
v_mfma_f32_16x16x32_bf16 v[176:179], v[160:163], v[144:147], v[176:179]
ds_read_b64_tr_b16 v[136:137], v152 offset:8192
v_cvt_pk_bf16_f32 v39, v62, v63
s_waitcnt lgkmcnt(3)
v_mfma_f32_16x16x32_bf16 v[204:207], v[164:167], v[148:151], v[204:207]
ds_read_b128 v[124:127], v0 offset:18688
v_cvt_pk_bf16_f32 v64, v64, v65
v_mfma_f32_16x16x32_bf16 v[180:183], v[164:167], v[144:147], v[180:183]
ds_read_b64_tr_b16 v[138:139], v152 offset:8704
v_cvt_pk_bf16_f32 v65, v66, v67
v_mfma_f32_16x16x32_bf16 v[208:211], v[168:171], v[148:151], v[208:211]
ds_read_b128 v[160:163], v0 offset:20480
v_cvt_pk_bf16_f32 v66, v68, v69
v_mfma_f32_16x16x32_bf16 v[184:187], v[168:171], v[144:147], v[184:187]
ds_read_b64_tr_b16 v[140:141], v152 offset:9216
v_cvt_pk_bf16_f32 v67, v70, v71
v_mfma_f32_16x16x32_bf16 v[212:215], v[172:175], v[148:151], v[212:215]
ds_read_b128 v[164:167], v0 offset:20736
v_cvt_pk_bf16_f32 v68, v72, v73
v_mfma_f32_16x16x32_bf16 v[188:191], v[172:175], v[144:147], v[188:191]
ds_read_b64_tr_b16 v[142:143], v152 offset:9728
v_cvt_pk_bf16_f32 v69, v74, v75
v_mfma_f32_16x16x32_bf16 v[216:219], v[112:115], v[148:151], v[216:219]
ds_read_b128 v[168:171], v0 offset:22528
v_cvt_pk_bf16_f32 v70, v76, v77
v_mfma_f32_16x16x32_bf16 v[192:195], v[112:115], v[144:147], v[192:195]
buffer_load_dwordx4 a[248:251], v4, s[24:27], s64 offen offset:128
v_cvt_pk_bf16_f32 v71, v78, v79
s_waitcnt lgkmcnt(3)
v_mfma_f32_16x16x32_bf16 v[220:223], v[116:119], v[148:151], v[220:223]
ds_read_b128 v[172:175], v0 offset:22784
v_cvt_pk_bf16_f32 v72, v80, v81
v_mfma_f32_16x16x32_bf16 v[196:199], v[116:119], v[144:147], v[196:199]
v_cvt_pk_bf16_f32 v73, v82, v83
v_mfma_f32_16x16x32_bf16 v[200:203], v[120:123], v[132:135], v[200:203]
ds_read_b128 v[112:115], v0 offset:24576
v_cvt_pk_bf16_f32 v74, v84, v85
v_mfma_f32_16x16x32_bf16 v[176:179], v[120:123], v[128:131], v[176:179]
ds_read_b64_tr_b16 v[144:145], v152 offset:10240
v_cvt_pk_bf16_f32 v75, v86, v87
v_mfma_f32_16x16x32_bf16 v[204:207], v[124:127], v[132:135], v[204:207]
ds_read_b128 v[116:119], v0 offset:24832
v_cvt_pk_bf16_f32 v76, v88, v89
v_mfma_f32_16x16x32_bf16 v[180:183], v[124:127], v[128:131], v[180:183]
ds_read_b64_tr_b16 v[146:147], v152 offset:10752
v_cvt_pk_bf16_f32 v77, v90, v91
v_mfma_f32_16x16x32_bf16 v[208:211], v[160:163], v[132:135], v[208:211]
ds_read_b128 v[120:123], v0 offset:26624
v_cvt_pk_bf16_f32 v78, v92, v93
v_mfma_f32_16x16x32_bf16 v[184:187], v[160:163], v[128:131], v[184:187]
ds_read_b64_tr_b16 v[148:149], v152 offset:11264
v_cvt_pk_bf16_f32 v79, v94, v95
s_waitcnt lgkmcnt(4)
v_mfma_f32_16x16x32_bf16 v[212:215], v[164:167], v[132:135], v[212:215]
ds_read_b128 v[124:127], v0 offset:26880
v_cvt_pk_bf16_f32 v80, v96, v97
v_mfma_f32_16x16x32_bf16 v[188:191], v[164:167], v[128:131], v[188:191]
ds_read_b64_tr_b16 v[150:151], v152 offset:11776
v_cvt_pk_bf16_f32 v81, v98, v99
v_mfma_f32_16x16x32_bf16 v[216:219], v[168:171], v[132:135], v[216:219]
ds_read_b128 v[160:163], v0 offset:28672
v_cvt_pk_bf16_f32 v82, v100, v101
v_mfma_f32_16x16x32_bf16 v[192:195], v[168:171], v[128:131], v[192:195]
v_cvt_pk_bf16_f32 v83, v102, v103
v_mfma_f32_16x16x32_bf16 v[220:223], v[172:175], v[132:135], v[220:223]
ds_read_b128 v[164:167], v0 offset:28928
v_cvt_pk_bf16_f32 v84, v104, v105
v_mfma_f32_16x16x32_bf16 v[196:199], v[172:175], v[128:131], v[196:199]
buffer_load_dwordx4 a[252:255], v4, s[24:27], s64 offen offset:3072
v_cvt_pk_bf16_f32 v85, v106, v107
v_mfma_f32_16x16x32_bf16 v[200:203], v[112:115], v[140:143], v[200:203]
ds_read_b128 v[168:171], v0 offset:30720
v_cvt_pk_bf16_f32 v86, v108, v109
v_mfma_f32_16x16x32_bf16 v[176:179], v[112:115], v[136:139], v[176:179]
ds_read_b64_tr_b16 v[128:129], v152 offset:12288
v_cvt_pk_bf16_f32 v87, v110, v111
s_waitcnt lgkmcnt(3)
v_mfma_f32_16x16x32_bf16 v[204:207], v[116:119], v[140:143], v[204:207]
ds_read_b128 v[172:175], v0 offset:30976
v_mfma_f32_16x16x32_bf16 v[180:183], v[116:119], v[136:139], v[180:183]
ds_read_b64_tr_b16 v[130:131], v152 offset:12800
v_mfma_f32_16x16x32_bf16 v[208:211], v[120:123], v[140:143], v[208:211]
ds_read_b128 v[112:115], v0 offset:32768
v_mfma_f32_16x16x32_bf16 v[184:187], v[120:123], v[136:139], v[184:187]
ds_read_b64_tr_b16 v[132:133], v152 offset:13312
v_mfma_f32_16x16x32_bf16 v[212:215], v[124:127], v[140:143], v[212:215]
ds_read_b128 v[116:119], v0 offset:33024
v_mfma_f32_16x16x32_bf16 v[188:191], v[124:127], v[136:139], v[188:191]
ds_read_b64_tr_b16 v[134:135], v152 offset:13824
v_mfma_f32_16x16x32_bf16 v[216:219], v[160:163], v[140:143], v[216:219]
ds_read_b128 v[120:123], v0 offset:34816
v_mfma_f32_16x16x32_bf16 v[192:195], v[160:163], v[136:139], v[192:195]
s_waitcnt lgkmcnt(4)
v_mfma_f32_16x16x32_bf16 v[220:223], v[164:167], v[140:143], v[220:223]
ds_read_b128 v[124:127], v0 offset:35072
v_mfma_f32_16x16x32_bf16 v[196:199], v[164:167], v[136:139], v[196:199]
v_mfma_f32_16x16x32_bf16 v[200:203], v[168:171], v[148:151], v[200:203]
ds_read_b128 v[160:163], v0 offset:36864
v_mfma_f32_16x16x32_bf16 v[176:179], v[168:171], v[144:147], v[176:179]
buffer_load_dwordx4 a[216:219], v4, s[24:27], s64 offen offset:3136
ds_read_b64_tr_b16 v[136:137], v152 offset:14336
v_mfma_f32_16x16x32_bf16 v[204:207], v[172:175], v[148:151], v[204:207]
ds_read_b128 v[164:167], v0 offset:37120
v_mfma_f32_16x16x32_bf16 v[180:183], v[172:175], v[144:147], v[180:183]
ds_read_b64_tr_b16 v[138:139], v152 offset:14848
v_mfma_f32_16x16x32_bf16 v[208:211], v[112:115], v[148:151], v[208:211]
ds_read_b128 v[168:171], v0 offset:38912
v_mfma_f32_16x16x32_bf16 v[184:187], v[112:115], v[144:147], v[184:187]
ds_read_b64_tr_b16 v[140:141], v152 offset:15360
s_waitcnt lgkmcnt(5)
v_mfma_f32_16x16x32_bf16 v[212:215], v[116:119], v[148:151], v[212:215]
ds_read_b128 v[172:175], v0 offset:39168
v_mfma_f32_16x16x32_bf16 v[188:191], v[116:119], v[144:147], v[188:191]
ds_read_b64_tr_b16 v[142:143], v152 offset:15872
v_mfma_f32_16x16x32_bf16 v[216:219], v[120:123], v[148:151], v[216:219]
ds_read_b128 v[112:115], v0 offset:40960
v_mfma_f32_16x16x32_bf16 v[192:195], v[120:123], v[144:147], v[192:195]
v_mfma_f32_16x16x32_bf16 v[220:223], v[124:127], v[148:151], v[220:223]
ds_read_b128 v[116:119], v0 offset:41216
v_mfma_f32_16x16x32_bf16 v[196:199], v[124:127], v[144:147], v[196:199]
v_mfma_f32_16x16x32_bf16 v[200:203], v[160:163], v[132:135], v[200:203]
ds_read_b128 v[120:123], v0 offset:43008
v_mfma_f32_16x16x32_bf16 v[176:179], v[160:163], v[128:131], v[176:179]
ds_read_b64_tr_b16 v[144:145], v152 offset:16384
s_waitcnt lgkmcnt(4)
v_mfma_f32_16x16x32_bf16 v[204:207], v[164:167], v[132:135], v[204:207]
ds_read_b128 v[124:127], v0 offset:43264
v_mfma_f32_16x16x32_bf16 v[180:183], v[164:167], v[128:131], v[180:183]
buffer_load_dwordx4 a[220:223], v4, s[24:27], s64 offen offset:3200
ds_read_b64_tr_b16 v[146:147], v152 offset:16896
v_mfma_f32_16x16x32_bf16 v[208:211], v[168:171], v[132:135], v[208:211]
ds_read_b128 v[160:163], v0 offset:45056
v_mfma_f32_16x16x32_bf16 v[184:187], v[168:171], v[128:131], v[184:187]
ds_read_b64_tr_b16 v[148:149], v152 offset:17408
v_mfma_f32_16x16x32_bf16 v[212:215], v[172:175], v[132:135], v[212:215]
ds_read_b128 v[164:167], v0 offset:45312
v_mfma_f32_16x16x32_bf16 v[188:191], v[172:175], v[128:131], v[188:191]
ds_read_b64_tr_b16 v[150:151], v152 offset:17920
s_waitcnt lgkmcnt(5)
v_mfma_f32_16x16x32_bf16 v[216:219], v[112:115], v[132:135], v[216:219]
ds_read_b128 v[168:171], v0 offset:47104
v_mfma_f32_16x16x32_bf16 v[192:195], v[112:115], v[128:131], v[192:195]
v_mfma_f32_16x16x32_bf16 v[220:223], v[116:119], v[132:135], v[220:223]
ds_read_b128 v[172:175], v0 offset:47360
v_mfma_f32_16x16x32_bf16 v[196:199], v[116:119], v[128:131], v[196:199]
v_mfma_f32_16x16x32_bf16 v[200:203], v[120:123], v[140:143], v[200:203]
ds_read_b128 v[112:115], v0 offset:49152
v_mfma_f32_16x16x32_bf16 v[176:179], v[120:123], v[136:139], v[176:179]
v_mfma_f32_16x16x32_bf16 v[204:207], v[124:127], v[140:143], v[204:207]
ds_read_b128 v[116:119], v0 offset:49408
v_mfma_f32_16x16x32_bf16 v[180:183], v[124:127], v[136:139], v[180:183]
s_waitcnt lgkmcnt(3)
v_mfma_f32_16x16x32_bf16 v[208:211], v[160:163], v[140:143], v[208:211]
ds_read_b128 v[120:123], v0 offset:51200
v_mfma_f32_16x16x32_bf16 v[184:187], v[160:163], v[136:139], v[184:187]
v_mfma_f32_16x16x32_bf16 v[212:215], v[164:167], v[140:143], v[212:215]
ds_read_b128 v[124:127], v0 offset:51456
v_mfma_f32_16x16x32_bf16 v[188:191], v[164:167], v[136:139], v[188:191]
v_mfma_f32_16x16x32_bf16 v[216:219], v[168:171], v[140:143], v[216:219]
ds_read_b128 v[160:163], v0 offset:53248
v_mfma_f32_16x16x32_bf16 v[192:195], v[168:171], v[136:139], v[192:195]
s_waitcnt lgkmcnt(3)
v_mfma_f32_16x16x32_bf16 v[220:223], v[172:175], v[140:143], v[220:223]
ds_read_b128 v[164:167], v0 offset:53504
v_mfma_f32_16x16x32_bf16 v[196:199], v[172:175], v[136:139], v[196:199]
v_mfma_f32_16x16x32_bf16 v[200:203], v[112:115], v[148:151], v[200:203]
ds_read_b128 v[168:171], v0 offset:55296
v_mfma_f32_16x16x32_bf16 v[176:179], v[112:115], v[144:147], v[176:179]
v_mfma_f32_16x16x32_bf16 v[204:207], v[116:119], v[148:151], v[204:207]
ds_read_b128 v[172:175], v0 offset:55552
s_mul_i32 s67, s66, 18432
s_add_u32 s68, s67, 1835008
s_add_u32 s69, s67, 73728
s_mov_b32 m0, s69
v_mfma_f32_16x16x32_bf16 v[180:183], v[116:119], v[144:147], v[180:183]
s_waitcnt lgkmcnt(2)
v_mfma_f32_16x16x32_bf16 v[208:211], v[120:123], v[148:151], v[208:211]
ds_read_b128 v[112:115], v0 offset:57344
v_mfma_f32_16x16x32_bf16 v[184:187], v[120:123], v[144:147], v[184:187]
v_mfma_f32_16x16x32_bf16 v[212:215], v[124:127], v[148:151], v[212:215]
ds_read_b128 v[116:119], v0 offset:57600
v_mfma_f32_16x16x32_bf16 v[188:191], v[124:127], v[144:147], v[188:191]
buffer_load_dwordx4 v253, s[40:43], s68 offen offset:0 sc1 lds
v_mfma_f32_16x16x32_bf16 v[216:219], v[160:163], v[148:151], v[216:219]
ds_read_b128 v[120:123], v0 offset:59392
v_mfma_f32_16x16x32_bf16 v[192:195], v[160:163], v[144:147], v[192:195]
v_mfma_f32_16x16x32_bf16 v[220:223], v[164:167], v[148:151], v[220:223]
ds_read_b128 v[124:127], v0 offset:59648
v_mfma_f32_16x16x32_bf16 v[196:199], v[164:167], v[144:147], v[196:199]
s_waitcnt vmcnt(15) lgkmcnt(3)
v_mfma_f32_16x16x32_bf16 v[200:203], v[168:171], v[228:231], v[200:203]
ds_read_b128 v[160:163], v0 offset:61440
buffer_load_dwordx4 v253, s[40:43], s68 offen offset:1024 sc1 lds
v_mfma_f32_16x16x32_bf16 v[176:179], v[168:171], v[224:227], v[176:179]
v_mfma_f32_16x16x32_bf16 v[204:207], v[172:175], v[228:231], v[204:207]
ds_read_b128 v[164:167], v0 offset:61696
v_mfma_f32_16x16x32_bf16 v[180:183], v[172:175], v[224:227], v[180:183]
ds_read_b128 v[128:131], v3 offset:0
v_mfma_f32_16x16x32_bf16 v[208:211], v[112:115], v[228:231], v[208:211]
ds_read_b128 v[168:171], v0 offset:63488
v_mfma_f32_16x16x32_bf16 v[184:187], v[112:115], v[224:227], v[184:187]
buffer_load_dwordx4 v253, s[40:43], s68 offen offset:2048 sc1 lds
ds_read_b128 v[132:135], v3 offset:16
s_waitcnt lgkmcnt(4)
v_mfma_f32_16x16x32_bf16 v[212:215], v[116:119], v[228:231], v[212:215]
ds_read_b128 v[172:175], v0 offset:63744
v_mfma_f32_16x16x32_bf16 v[188:191], v[116:119], v[224:227], v[188:191]
ds_read_b128 v[136:139], v3 offset:128
v_mfma_f32_16x16x32_bf16 v[216:219], v[120:123], v[228:231], v[216:219]
ds_read_b128 v[112:115], v1 offset:0
v_mfma_f32_16x16x32_bf16 v[192:195], v[120:123], v[224:227], v[192:195]
ds_read_b128 v[140:143], v3 offset:144
v_mfma_f32_16x16x32_bf16 v[220:223], v[124:127], v[228:231], v[220:223]
ds_read_b128 v[116:119], v1 offset:256
buffer_load_dwordx4 v253, s[40:43], s68 offen offset:3072 sc1 lds
v_mfma_f32_16x16x32_bf16 v[196:199], v[124:127], v[224:227], v[196:199]
ds_read_b128 v[144:147], v3 offset:256
s_waitcnt vmcnt(15)
v_mfma_f32_16x16x32_bf16 v[200:203], v[160:163], v[236:239], v[200:203]
ds_read_b128 v[120:123], v1 offset:2048
v_mfma_f32_16x16x32_bf16 v[176:179], v[160:163], v[232:235], v[176:179]
ds_read_b128 v[148:151], v3 offset:272
s_waitcnt lgkmcnt(4)
v_mfma_f32_16x16x32_bf16 v[204:207], v[164:167], v[236:239], v[204:207]
ds_read_b128 v[124:127], v1 offset:2304
v_mfma_f32_16x16x32_bf16 v[180:183], v[164:167], v[232:235], v[180:183]
s_add_u32 s68, s67, 1839104
s_add_u32 s69, s67, 77824
s_mov_b32 m0, s69
v_mfma_f32_16x16x32_bf16 v[208:211], v[168:171], v[236:239], v[208:211]
ds_read_b128 v[160:163], v1 offset:4096
v_mfma_f32_16x16x32_bf16 v[184:187], v[168:171], v[232:235], v[184:187]
v_mfma_f32_16x16x32_bf16 v[212:215], v[172:175], v[236:239], v[212:215]
ds_read_b128 v[164:167], v1 offset:4352
v_mfma_f32_16x16x32_bf16 v[188:191], v[172:175], v[232:235], v[188:191]
v_mfma_f32_16x16x32_bf16 v[216:219], v[112:115], v[236:239], v[216:219]
ds_read_b128 v[168:171], v1 offset:6144
buffer_load_dwordx4 v253, s[40:43], s68 offen offset:0 sc1 lds
v_mfma_f32_16x16x32_bf16 v[192:195], v[112:115], v[232:235], v[192:195]
s_waitcnt lgkmcnt(3)
v_mfma_f32_16x16x32_bf16 v[220:223], v[116:119], v[236:239], v[220:223]
ds_read_b128 v[172:175], v1 offset:6400
v_mfma_f32_16x16x32_bf16 v[196:199], v[116:119], v[232:235], v[196:199]
s_waitcnt vmcnt(12)
v_mfma_f32_16x16x32_bf16 v[200:203], v[120:123], v[244:247], v[200:203]
v_mfma_f32_16x16x32_bf16 v[176:179], v[120:123], v[240:243], v[176:179]
buffer_load_dwordx4 v253, s[40:43], s68 offen offset:1024 sc1 lds
v_mfma_f32_16x16x32_bf16 v[204:207], v[124:127], v[244:247], v[204:207]
v_mfma_f32_16x16x32_bf16 v[180:183], v[124:127], v[240:243], v[180:183]
s_waitcnt lgkmcnt(1)
v_mfma_f32_16x16x32_bf16 v[208:211], v[160:163], v[244:247], v[208:211]
v_mfma_f32_16x16x32_bf16 v[184:187], v[160:163], v[240:243], v[184:187]
v_mfma_f32_16x16x32_bf16 v[212:215], v[164:167], v[244:247], v[212:215]
buffer_load_dwordx4 v253, s[40:43], s68 offen offset:2048 sc1 lds
v_mfma_f32_16x16x32_bf16 v[188:191], v[164:167], v[240:243], v[188:191]
v_mfma_f32_16x16x32_bf16 v[216:219], v[168:171], v[244:247], v[216:219]
v_mfma_f32_16x16x32_bf16 v[192:195], v[168:171], v[240:243], v[192:195]
s_waitcnt lgkmcnt(0)
v_mfma_f32_16x16x32_bf16 v[220:223], v[172:175], v[244:247], v[220:223]
v_mfma_f32_16x16x32_bf16 v[196:199], v[172:175], v[240:243], v[196:199]
v_mfma_f32_16x16x32_bf16 v[200:203], v[8:11], a[204:207], v[200:203]
ds_read_b128 v[112:115], v0 offset:0
v_mfma_f32_16x16x32_bf16 v[176:179], v[8:11], a[192:195], v[176:179]
ds_read_b128 v[116:119], v0 offset:256
v_mfma_f32_16x16x32_bf16 v[204:207], v[12:15], a[204:207], v[204:207]
ds_read_b128 v[120:123], v0 offset:2048
v_mfma_f32_16x16x32_bf16 v[180:183], v[12:15], a[192:195], v[180:183]
v_mfma_f32_16x16x32_bf16 v[208:211], v[8:11], a[208:211], v[208:211]
v_mfma_f32_16x16x32_bf16 v[184:187], v[8:11], a[196:199], v[184:187]
v_mfma_f32_16x16x32_bf16 v[212:215], v[12:15], a[208:211], v[212:215]
v_mfma_f32_16x16x32_bf16 v[188:191], v[12:15], a[196:199], v[188:191]
s_waitcnt vmcnt(13)
v_mfma_f32_16x16x32_bf16 v[216:219], v[8:11], a[212:215], v[216:219]
v_mfma_f32_16x16x32_bf16 v[192:195], v[8:11], a[200:203], v[192:195]
v_mfma_f32_16x16x32_bf16 v[220:223], v[12:15], a[212:215], v[220:223]
v_mfma_f32_16x16x32_bf16 v[196:199], v[12:15], a[200:203], v[196:199]
v_cvt_pk_bf16_f32 v224, v176, v177
v_cvt_pk_bf16_f32 v225, v178, v179
v_cvt_pk_bf16_f32 v226, v180, v181
v_cvt_pk_bf16_f32 v227, v182, v183
v_cvt_pk_bf16_f32 v228, v184, v185
v_cvt_pk_bf16_f32 v229, v186, v187
v_cvt_pk_bf16_f32 v230, v188, v189
v_cvt_pk_bf16_f32 v231, v190, v191
v_cvt_pk_bf16_f32 v232, v192, v193
v_cvt_pk_bf16_f32 v233, v194, v195
v_cvt_pk_bf16_f32 v234, v196, v197
v_cvt_pk_bf16_f32 v235, v198, v199
v_cvt_pk_bf16_f32 v236, v200, v201
v_cvt_pk_bf16_f32 v237, v202, v203
v_cvt_pk_bf16_f32 v238, v204, v205
v_cvt_pk_bf16_f32 v239, v206, v207
v_cvt_pk_bf16_f32 v240, v208, v209
v_cvt_pk_bf16_f32 v241, v210, v211
v_cvt_pk_bf16_f32 v242, v212, v213
v_cvt_pk_bf16_f32 v243, v214, v215
v_cvt_pk_bf16_f32 v244, v216, v217
v_cvt_pk_bf16_f32 v245, v218, v219
v_cvt_pk_bf16_f32 v246, v220, v221
v_cvt_pk_bf16_f32 v247, v222, v223
s_waitcnt lgkmcnt(0)
v_mfma_f32_16x16x32_bf16 v[200:203], v[112:115], a[100:103], v[128:131]
ds_read_b128 v[124:127], v0 offset:2304
v_mfma_f32_16x16x32_bf16 v[176:179], v[112:115], a[96:99], v[128:131]
v_mfma_f32_16x16x32_bf16 v[152:155], v[112:115], a[4:7], v[128:131]
buffer_load_dwordx4 v253, s[40:43], s68 offen offset:3072 sc1 lds
v_mfma_f32_16x16x32_bf16 v[128:131], v[112:115], a[0:3], v[128:131]
buffer_load_dwordx2 v[248:249], v6, s[40:43], s79 offen offset:0 sc1
v_mfma_f32_16x16x32_bf16 v[204:207], v[116:119], a[100:103], v[132:135]
ds_read_b128 v[112:115], v0 offset:4096
v_mfma_f32_16x16x32_bf16 v[180:183], v[116:119], a[96:99], v[132:135]
buffer_load_dwordx2 v[250:251], v6, s[40:43], s79 offen offset:128 sc1
v_mfma_f32_16x16x32_bf16 v[156:159], v[116:119], a[4:7], v[132:135]
v_mfma_f32_16x16x32_bf16 v[132:135], v[116:119], a[0:3], v[132:135]
s_mov_b32 s85, 31457280
buffer_load_dwordx4 a[192:195], v4, s[24:27], s85 offen offset:0
v_mfma_f32_16x16x32_bf16 v[208:211], v[120:123], a[100:103], v[136:139]
ds_read_b128 v[116:119], v0 offset:4352
v_mfma_f32_16x16x32_bf16 v[184:187], v[120:123], a[96:99], v[136:139]
v_mfma_f32_16x16x32_bf16 v[160:163], v[120:123], a[4:7], v[136:139]
s_add_u32 s68, s67, 1843200
s_add_u32 s69, s67, 81920
s_mov_b32 m0, s69
v_mfma_f32_16x16x32_bf16 v[136:139], v[120:123], a[0:3], v[136:139]
s_waitcnt lgkmcnt(1)
v_mfma_f32_16x16x32_bf16 v[212:215], v[124:127], a[100:103], v[140:143]
ds_read_b128 v[120:123], v0 offset:6144
v_mfma_f32_16x16x32_bf16 v[188:191], v[124:127], a[96:99], v[140:143]
v_mfma_f32_16x16x32_bf16 v[164:167], v[124:127], a[4:7], v[140:143]
v_mfma_f32_16x16x32_bf16 v[140:143], v[124:127], a[0:3], v[140:143]
v_mfma_f32_16x16x32_bf16 v[216:219], v[112:115], a[100:103], v[144:147]
ds_read_b128 v[124:127], v0 offset:6400
v_mfma_f32_16x16x32_bf16 v[192:195], v[112:115], a[96:99], v[144:147]
v_mfma_f32_16x16x32_bf16 v[168:171], v[112:115], a[4:7], v[144:147]
buffer_load_dwordx4 v253, s[40:43], s68 offen offset:0 sc1 lds
v_mfma_f32_16x16x32_bf16 v[144:147], v[112:115], a[0:3], v[144:147]
s_waitcnt lgkmcnt(1)
v_mfma_f32_16x16x32_bf16 v[220:223], v[116:119], a[100:103], v[148:151]
ds_read_b128 v[112:115], v0 offset:8192
v_mfma_f32_16x16x32_bf16 v[196:199], v[116:119], a[96:99], v[148:151]
v_mfma_f32_16x16x32_bf16 v[172:175], v[116:119], a[4:7], v[148:151]
v_mfma_f32_16x16x32_bf16 v[148:151], v[116:119], a[0:3], v[148:151]
v_mfma_f32_16x16x32_bf16 v[200:203], v[120:123], a[108:111], v[200:203]
ds_read_b128 v[116:119], v0 offset:8448
v_mfma_f32_16x16x32_bf16 v[176:179], v[120:123], a[104:107], v[176:179]
v_mfma_f32_16x16x32_bf16 v[152:155], v[120:123], a[12:15], v[152:155]
buffer_load_dwordx4 v253, s[40:43], s68 offen offset:1024 sc1 lds
v_mfma_f32_16x16x32_bf16 v[128:131], v[120:123], a[8:11], v[128:131]
s_waitcnt lgkmcnt(1)
v_mfma_f32_16x16x32_bf16 v[204:207], v[124:127], a[108:111], v[204:207]
ds_read_b128 v[120:123], v0 offset:10240
v_mfma_f32_16x16x32_bf16 v[180:183], v[124:127], a[104:107], v[180:183]
v_mfma_f32_16x16x32_bf16 v[156:159], v[124:127], a[12:15], v[156:159]
s_add_u32 s74, s87, L_b2_0-L_pc
v_add_u32_e64 v254, s74, v2
v_mfma_f32_16x16x32_bf16 v[132:135], v[124:127], a[8:11], v[132:135]
buffer_load_dwordx4 a[196:199], v4, s[24:27], s85 offen offset:64
v_min_u32 v254, L_pf1-L_pc-4, v254
v_mov_b32 v255, s89
v_mfma_f32_16x16x32_bf16 v[208:211], v[112:115], a[108:111], v[208:211]
ds_read_b128 v[124:127], v0 offset:10496
v_add_co_u32 v254, vcc, s88, v254
s_nop 1
v_addc_co_u32_e64 v255, vcc, 0, v255, vcc
v_mfma_f32_16x16x32_bf16 v[184:187], v[112:115], a[104:107], v[184:187]
v_mfma_f32_16x16x32_bf16 v[160:163], v[112:115], a[12:15], v[160:163]
buffer_load_dwordx4 v253, s[40:43], s68 offen offset:2048 sc1 lds
v_mfma_f32_16x16x32_bf16 v[136:139], v[112:115], a[8:11], v[136:139]
s_waitcnt lgkmcnt(1)
v_mfma_f32_16x16x32_bf16 v[212:215], v[116:119], a[108:111], v[212:215]
ds_read_b128 v[112:115], v0 offset:12288
v_mfma_f32_16x16x32_bf16 v[188:191], v[116:119], a[104:107], v[188:191]
v_mfma_f32_16x16x32_bf16 v[164:167], v[116:119], a[12:15], v[164:167]
global_load_dword v255, v[254:255], off
v_mfma_f32_16x16x32_bf16 v[140:143], v[116:119], a[8:11], v[140:143]
v_mfma_f32_16x16x32_bf16 v[216:219], v[120:123], a[108:111], v[216:219]
ds_read_b128 v[116:119], v0 offset:12544
v_mfma_f32_16x16x32_bf16 v[192:195], v[120:123], a[104:107], v[192:195]
v_mfma_f32_16x16x32_bf16 v[168:171], v[120:123], a[12:15], v[168:171]
buffer_load_dwordx4 v253, s[40:43], s68 offen offset:3072 sc1 lds
v_mfma_f32_16x16x32_bf16 v[144:147], v[120:123], a[8:11], v[144:147]
s_waitcnt lgkmcnt(1)
v_mfma_f32_16x16x32_bf16 v[220:223], v[124:127], a[108:111], v[220:223]
ds_read_b128 v[120:123], v0 offset:14336
v_mfma_f32_16x16x32_bf16 v[196:199], v[124:127], a[104:107], v[196:199]
v_mfma_f32_16x16x32_bf16 v[172:175], v[124:127], a[12:15], v[172:175]
v_mfma_f32_16x16x32_bf16 v[148:151], v[124:127], a[8:11], v[148:151]
v_mfma_f32_16x16x32_bf16 v[200:203], v[112:115], a[116:119], v[200:203]
ds_read_b128 v[124:127], v0 offset:14592
v_mfma_f32_16x16x32_bf16 v[176:179], v[112:115], a[112:115], v[176:179]
v_mfma_f32_16x16x32_bf16 v[152:155], v[112:115], a[20:23], v[152:155]
s_add_u32 s68, s67, 1847296
s_add_u32 s69, s67, 86016
s_mov_b32 m0, s69
v_mfma_f32_16x16x32_bf16 v[128:131], v[112:115], a[16:19], v[128:131]
s_waitcnt lgkmcnt(1)
v_mfma_f32_16x16x32_bf16 v[204:207], v[116:119], a[116:119], v[204:207]
ds_read_b128 v[112:115], v0 offset:16384
v_mfma_f32_16x16x32_bf16 v[180:183], v[116:119], a[112:115], v[180:183]
v_mfma_f32_16x16x32_bf16 v[156:159], v[116:119], a[20:23], v[156:159]
v_mfma_f32_16x16x32_bf16 v[132:135], v[116:119], a[16:19], v[132:135]
buffer_load_dwordx4 a[200:203], v4, s[24:27], s85 offen offset:128
v_mfma_f32_16x16x32_bf16 v[208:211], v[120:123], a[116:119], v[208:211]
ds_read_b128 v[116:119], v0 offset:16640
v_mfma_f32_16x16x32_bf16 v[184:187], v[120:123], a[112:115], v[184:187]
v_mfma_f32_16x16x32_bf16 v[160:163], v[120:123], a[20:23], v[160:163]
buffer_load_dwordx4 v253, s[40:43], s68 offen offset:0 sc1 lds
v_mfma_f32_16x16x32_bf16 v[136:139], v[120:123], a[16:19], v[136:139]
s_waitcnt lgkmcnt(1)
v_mfma_f32_16x16x32_bf16 v[212:215], v[124:127], a[116:119], v[212:215]
ds_read_b128 v[120:123], v0 offset:18432
v_mfma_f32_16x16x32_bf16 v[188:191], v[124:127], a[112:115], v[188:191]
v_mfma_f32_16x16x32_bf16 v[164:167], v[124:127], a[20:23], v[164:167]
v_mfma_f32_16x16x32_bf16 v[140:143], v[124:127], a[16:19], v[140:143]
v_mfma_f32_16x16x32_bf16 v[216:219], v[112:115], a[116:119], v[216:219]
ds_read_b128 v[124:127], v0 offset:18688
v_mfma_f32_16x16x32_bf16 v[192:195], v[112:115], a[112:115], v[192:195]
v_mfma_f32_16x16x32_bf16 v[168:171], v[112:115], a[20:23], v[168:171]
buffer_load_dwordx4 v253, s[40:43], s68 offen offset:1024 sc1 lds
v_mfma_f32_16x16x32_bf16 v[144:147], v[112:115], a[16:19], v[144:147]
s_waitcnt lgkmcnt(1)
v_mfma_f32_16x16x32_bf16 v[220:223], v[116:119], a[116:119], v[220:223]
ds_read_b128 v[112:115], v0 offset:20480
v_mfma_f32_16x16x32_bf16 v[196:199], v[116:119], a[112:115], v[196:199]
v_mfma_f32_16x16x32_bf16 v[172:175], v[116:119], a[20:23], v[172:175]
v_mfma_f32_16x16x32_bf16 v[148:151], v[116:119], a[16:19], v[148:151]
v_mfma_f32_16x16x32_bf16 v[200:203], v[120:123], a[124:127], v[200:203]
ds_read_b128 v[116:119], v0 offset:20736
v_mfma_f32_16x16x32_bf16 v[176:179], v[120:123], a[120:123], v[176:179]
v_accvgpr_write_b32 a96, v16
v_accvgpr_write_b32 a97, v17
v_mfma_f32_16x16x32_bf16 v[152:155], v[120:123], a[28:31], v[152:155]
buffer_load_dwordx4 v253, s[40:43], s68 offen offset:2048 sc1 lds
v_accvgpr_write_b32 a98, v18
v_accvgpr_write_b32 a99, v19
v_mfma_f32_16x16x32_bf16 v[128:131], v[120:123], a[24:27], v[128:131]
v_accvgpr_write_b32 a100, v20
v_accvgpr_write_b32 a101, v21
s_waitcnt lgkmcnt(1)
v_mfma_f32_16x16x32_bf16 v[204:207], v[124:127], a[124:127], v[204:207]
ds_read_b128 v[120:123], v0 offset:22528
v_accvgpr_write_b32 a102, v22
v_accvgpr_write_b32 a103, v23
v_mfma_f32_16x16x32_bf16 v[180:183], v[124:127], a[120:123], v[180:183]
v_accvgpr_write_b32 a104, v24
v_accvgpr_write_b32 a105, v25
v_mfma_f32_16x16x32_bf16 v[156:159], v[124:127], a[28:31], v[156:159]
v_accvgpr_write_b32 a106, v26
v_accvgpr_write_b32 a107, v27
v_mfma_f32_16x16x32_bf16 v[132:135], v[124:127], a[24:27], v[132:135]
s_mov_b32 s64, 25165824
buffer_load_dwordx4 a[0:3], v4, s[24:27], s64 offen offset:0
buffer_load_dwordx4 a[204:207], v4, s[24:27], s85 offen offset:3072
v_accvgpr_write_b32 a108, v28
v_accvgpr_write_b32 a109, v29
v_mfma_f32_16x16x32_bf16 v[208:211], v[112:115], a[124:127], v[208:211]
ds_read_b128 v[124:127], v0 offset:22784
v_accvgpr_write_b32 a110, v30
v_accvgpr_write_b32 a111, v31
v_mfma_f32_16x16x32_bf16 v[184:187], v[112:115], a[120:123], v[184:187]
v_accvgpr_write_b32 a112, v32
v_accvgpr_write_b32 a113, v33
v_mfma_f32_16x16x32_bf16 v[160:163], v[112:115], a[28:31], v[160:163]
buffer_load_dwordx4 v253, s[40:43], s68 offen offset:3072 sc1 lds
v_accvgpr_write_b32 a114, v34
v_accvgpr_write_b32 a115, v35
v_mfma_f32_16x16x32_bf16 v[136:139], v[112:115], a[24:27], v[136:139]
v_accvgpr_write_b32 a116, v36
v_accvgpr_write_b32 a117, v37
s_waitcnt lgkmcnt(0)
v_mfma_f32_16x16x32_bf16 v[212:215], v[116:119], a[124:127], v[212:215]
ds_read_b128 v[112:115], v0 offset:24576
v_accvgpr_write_b32 a118, v38
v_accvgpr_write_b32 a119, v39
v_mfma_f32_16x16x32_bf16 v[188:191], v[116:119], a[120:123], v[188:191]
v_mfma_f32_16x16x32_bf16 v[164:167], v[116:119], a[28:31], v[164:167]
v_mfma_f32_16x16x32_bf16 v[140:143], v[116:119], a[24:27], v[140:143]
v_mfma_f32_16x16x32_bf16 v[216:219], v[120:123], a[124:127], v[216:219]
ds_read_b128 v[116:119], v0 offset:24832
v_mfma_f32_16x16x32_bf16 v[192:195], v[120:123], a[120:123], v[192:195]
v_mfma_f32_16x16x32_bf16 v[168:171], v[120:123], a[28:31], v[168:171]
s_add_u32 s68, s67, 1851392
s_add_u32 s69, s67, 90112
s_mov_b32 m0, s69
v_mfma_f32_16x16x32_bf16 v[144:147], v[120:123], a[24:27], v[144:147]
v_mfma_f32_16x16x32_bf16 v[220:223], v[124:127], a[124:127], v[220:223]
ds_read_b128 v[120:123], v0 offset:26624
v_mfma_f32_16x16x32_bf16 v[196:199], v[124:127], a[120:123], v[196:199]
v_mfma_f32_16x16x32_bf16 v[172:175], v[124:127], a[28:31], v[172:175]
v_mfma_f32_16x16x32_bf16 v[148:151], v[124:127], a[24:27], v[148:151]
s_waitcnt lgkmcnt(1)
v_mfma_f32_16x16x32_bf16 v[200:203], v[112:115], a[132:135], v[200:203]
ds_read_b128 v[124:127], v0 offset:26880
v_mfma_f32_16x16x32_bf16 v[176:179], v[112:115], a[128:131], v[176:179]
v_mfma_f32_16x16x32_bf16 v[152:155], v[112:115], a[36:39], v[152:155]
buffer_load_dwordx4 v253, s[40:43], s68 offen offset:0 sc1 lds
v_mfma_f32_16x16x32_bf16 v[128:131], v[112:115], a[32:35], v[128:131]
v_mfma_f32_16x16x32_bf16 v[204:207], v[116:119], a[132:135], v[204:207]
ds_read_b128 v[112:115], v0 offset:28672
v_mfma_f32_16x16x32_bf16 v[180:183], v[116:119], a[128:131], v[180:183]
v_mfma_f32_16x16x32_bf16 v[156:159], v[116:119], a[36:39], v[156:159]
v_mfma_f32_16x16x32_bf16 v[132:135], v[116:119], a[32:35], v[132:135]
buffer_load_dwordx4 a[4:7], v4, s[24:27], s64 offen offset:64
buffer_load_dwordx4 a[208:211], v4, s[24:27], s85 offen offset:3136
s_waitcnt lgkmcnt(1)
v_mfma_f32_16x16x32_bf16 v[208:211], v[120:123], a[132:135], v[208:211]
ds_read_b128 v[116:119], v0 offset:28928
v_mfma_f32_16x16x32_bf16 v[184:187], v[120:123], a[128:131], v[184:187]
v_mfma_f32_16x16x32_bf16 v[160:163], v[120:123], a[36:39], v[160:163]
buffer_load_dwordx4 v253, s[40:43], s68 offen offset:1024 sc1 lds
v_mfma_f32_16x16x32_bf16 v[136:139], v[120:123], a[32:35], v[136:139]
v_mfma_f32_16x16x32_bf16 v[212:215], v[124:127], a[132:135], v[212:215]
ds_read_b128 v[120:123], v0 offset:30720
v_mfma_f32_16x16x32_bf16 v[188:191], v[124:127], a[128:131], v[188:191]
v_mfma_f32_16x16x32_bf16 v[164:167], v[124:127], a[36:39], v[164:167]
v_mfma_f32_16x16x32_bf16 v[140:143], v[124:127], a[32:35], v[140:143]
s_waitcnt lgkmcnt(1)
v_mfma_f32_16x16x32_bf16 v[216:219], v[112:115], a[132:135], v[216:219]
ds_read_b128 v[124:127], v0 offset:30976
v_mfma_f32_16x16x32_bf16 v[192:195], v[112:115], a[128:131], v[192:195]
v_mfma_f32_16x16x32_bf16 v[168:171], v[112:115], a[36:39], v[168:171]
v_mfma_f32_16x16x32_bf16 v[144:147], v[112:115], a[32:35], v[144:147]
v_mfma_f32_16x16x32_bf16 v[220:223], v[116:119], a[132:135], v[220:223]
ds_read_b128 v[112:115], v0 offset:32768
v_mfma_f32_16x16x32_bf16 v[196:199], v[116:119], a[128:131], v[196:199]
v_mfma_f32_16x16x32_bf16 v[172:175], v[116:119], a[36:39], v[172:175]
v_mfma_f32_16x16x32_bf16 v[148:151], v[116:119], a[32:35], v[148:151]
s_waitcnt lgkmcnt(1)
v_mfma_f32_16x16x32_bf16 v[200:203], v[120:123], a[140:143], v[200:203]
ds_read_b128 v[116:119], v0 offset:33024
v_mfma_f32_16x16x32_bf16 v[176:179], v[120:123], a[136:139], v[176:179]
v_mfma_f32_16x16x32_bf16 v[152:155], v[120:123], a[44:47], v[152:155]
v_mfma_f32_16x16x32_bf16 v[128:131], v[120:123], a[40:43], v[128:131]
v_mfma_f32_16x16x32_bf16 v[204:207], v[124:127], a[140:143], v[204:207]
ds_read_b128 v[120:123], v0 offset:34816
v_mfma_f32_16x16x32_bf16 v[180:183], v[124:127], a[136:139], v[180:183]
v_mfma_f32_16x16x32_bf16 v[156:159], v[124:127], a[44:47], v[156:159]
v_mfma_f32_16x16x32_bf16 v[132:135], v[124:127], a[40:43], v[132:135]
buffer_load_dwordx4 a[8:11], v4, s[24:27], s64 offen offset:128
buffer_load_dwordx4 a[212:215], v4, s[24:27], s85 offen offset:3200
s_waitcnt lgkmcnt(1)
v_mfma_f32_16x16x32_bf16 v[208:211], v[112:115], a[140:143], v[208:211]
ds_read_b128 v[124:127], v0 offset:35072
v_mfma_f32_16x16x32_bf16 v[184:187], v[112:115], a[136:139], v[184:187]
v_mfma_f32_16x16x32_bf16 v[160:163], v[112:115], a[44:47], v[160:163]
v_mfma_f32_16x16x32_bf16 v[136:139], v[112:115], a[40:43], v[136:139]
v_mfma_f32_16x16x32_bf16 v[212:215], v[116:119], a[140:143], v[212:215]
ds_read_b128 v[112:115], v0 offset:36864
v_mfma_f32_16x16x32_bf16 v[188:191], v[116:119], a[136:139], v[188:191]
v_mfma_f32_16x16x32_bf16 v[164:167], v[116:119], a[44:47], v[164:167]
v_mfma_f32_16x16x32_bf16 v[140:143], v[116:119], a[40:43], v[140:143]
s_waitcnt lgkmcnt(1)
v_mfma_f32_16x16x32_bf16 v[216:219], v[120:123], a[140:143], v[216:219]
ds_read_b128 v[116:119], v0 offset:37120
v_mfma_f32_16x16x32_bf16 v[192:195], v[120:123], a[136:139], v[192:195]
v_mfma_f32_16x16x32_bf16 v[168:171], v[120:123], a[44:47], v[168:171]
v_mfma_f32_16x16x32_bf16 v[144:147], v[120:123], a[40:43], v[144:147]
v_mfma_f32_16x16x32_bf16 v[220:223], v[124:127], a[140:143], v[220:223]
ds_read_b128 v[120:123], v0 offset:38912
v_mfma_f32_16x16x32_bf16 v[196:199], v[124:127], a[136:139], v[196:199]
v_mfma_f32_16x16x32_bf16 v[172:175], v[124:127], a[44:47], v[172:175]
v_mfma_f32_16x16x32_bf16 v[148:151], v[124:127], a[40:43], v[148:151]
s_waitcnt lgkmcnt(1)
v_mfma_f32_16x16x32_bf16 v[200:203], v[112:115], a[148:151], v[200:203]
ds_read_b128 v[124:127], v0 offset:39168
v_mfma_f32_16x16x32_bf16 v[176:179], v[112:115], a[144:147], v[176:179]
s_mov_b32 s84, 12582912
buffer_store_dwordx4 v[224:227], v4, s[28:31], s84 offen offset:0 sc1
v_accvgpr_write_b32 a120, v64
v_accvgpr_write_b32 a121, v65
v_mfma_f32_16x16x32_bf16 v[152:155], v[112:115], a[52:55], v[152:155]
ds_read_b128 a[24:27], v5 offset:0
v_accvgpr_write_b32 a122, v66
v_accvgpr_write_b32 a123, v67
v_mfma_f32_16x16x32_bf16 v[128:131], v[112:115], a[48:51], v[128:131]
v_accvgpr_write_b32 a124, v68
v_accvgpr_write_b32 a125, v69
v_mfma_f32_16x16x32_bf16 v[204:207], v[116:119], a[148:151], v[204:207]
ds_read_b128 v[112:115], v0 offset:40960
ds_read_b128 a[28:31], v5 offset:272
v_accvgpr_write_b32 a126, v70
v_accvgpr_write_b32 a127, v71
v_mfma_f32_16x16x32_bf16 v[180:183], v[116:119], a[144:147], v[180:183]
v_accvgpr_write_b32 a128, v72
v_accvgpr_write_b32 a129, v73
v_mfma_f32_16x16x32_bf16 v[156:159], v[116:119], a[52:55], v[156:159]
ds_read_b128 a[32:35], v5 offset:544
v_accvgpr_write_b32 a130, v74
v_accvgpr_write_b32 a131, v75
v_mfma_f32_16x16x32_bf16 v[132:135], v[116:119], a[48:51], v[132:135]
buffer_load_dwordx4 a[12:15], v4, s[24:27], s64 offen offset:3072
v_accvgpr_write_b32 a132, v76
v_accvgpr_write_b32 a133, v77
s_waitcnt lgkmcnt(1)
v_mfma_f32_16x16x32_bf16 v[208:211], v[120:123], a[148:151], v[208:211]
ds_read_b128 v[116:119], v0 offset:41216
ds_read_b128 a[36:39], v5 offset:816
v_accvgpr_write_b32 a134, v78
v_accvgpr_write_b32 a135, v79
v_mfma_f32_16x16x32_bf16 v[184:187], v[120:123], a[144:147], v[184:187]
v_accvgpr_write_b32 a136, v80
v_accvgpr_write_b32 a137, v81
v_mfma_f32_16x16x32_bf16 v[160:163], v[120:123], a[52:55], v[160:163]
ds_read_b128 a[40:43], v5 offset:1088
v_accvgpr_write_b32 a138, v82
v_accvgpr_write_b32 a139, v83
v_mfma_f32_16x16x32_bf16 v[136:139], v[120:123], a[48:51], v[136:139]
v_accvgpr_write_b32 a140, v84
v_accvgpr_write_b32 a141, v85
v_mfma_f32_16x16x32_bf16 v[212:215], v[124:127], a[148:151], v[212:215]
ds_read_b128 v[120:123], v0 offset:43008
ds_read_b128 a[44:47], v5 offset:1360
v_accvgpr_write_b32 a142, v86
v_accvgpr_write_b32 a143, v87
v_mfma_f32_16x16x32_bf16 v[188:191], v[124:127], a[144:147], v[188:191]
v_mfma_f32_16x16x32_bf16 v[164:167], v[124:127], a[52:55], v[164:167]
v_mfma_f32_16x16x32_bf16 v[140:143], v[124:127], a[48:51], v[140:143]
v_mfma_f32_16x16x32_bf16 v[216:219], v[112:115], a[148:151], v[216:219]
ds_read_b128 v[124:127], v0 offset:43264
v_mfma_f32_16x16x32_bf16 v[192:195], v[112:115], a[144:147], v[192:195]
v_mfma_f32_16x16x32_bf16 v[168:171], v[112:115], a[52:55], v[168:171]
v_mfma_f32_16x16x32_bf16 v[144:147], v[112:115], a[48:51], v[144:147]
s_waitcnt lgkmcnt(1)
v_mfma_f32_16x16x32_bf16 v[220:223], v[116:119], a[148:151], v[220:223]
ds_read_b128 v[112:115], v0 offset:45056
v_mfma_f32_16x16x32_bf16 v[196:199], v[116:119], a[144:147], v[196:199]
v_mfma_f32_16x16x32_bf16 v[172:175], v[116:119], a[52:55], v[172:175]
v_mfma_f32_16x16x32_bf16 v[148:151], v[116:119], a[48:51], v[148:151]
v_mfma_f32_16x16x32_bf16 v[200:203], v[120:123], a[156:159], v[200:203]
ds_read_b128 v[116:119], v0 offset:45312
v_mfma_f32_16x16x32_bf16 v[176:179], v[120:123], a[152:155], v[176:179]
v_mfma_f32_16x16x32_bf16 v[152:155], v[120:123], a[60:63], v[152:155]
v_mfma_f32_16x16x32_bf16 v[128:131], v[120:123], a[56:59], v[128:131]
s_waitcnt lgkmcnt(1)
v_mfma_f32_16x16x32_bf16 v[204:207], v[124:127], a[156:159], v[204:207]
ds_read_b128 v[120:123], v0 offset:47104
s_waitcnt vmcnt(35)
v_mfma_f32_16x16x32_bf16 v[16:19], a[24:27], a[240:243], 0
v_mfma_f32_16x16x32_bf16 v[180:183], v[124:127], a[152:155], v[180:183]
buffer_store_dwordx4 v[228:231], v4, s[28:31], s84 offen offset:64 sc1
v_mfma_f32_16x16x32_bf16 v[156:159], v[124:127], a[60:63], v[156:159]
v_mfma_f32_16x16x32_bf16 v[20:23], a[28:31], a[240:243], 0
v_mfma_f32_16x16x32_bf16 v[132:135], v[124:127], a[56:59], v[132:135]
buffer_load_dwordx4 a[16:19], v4, s[24:27], s64 offen offset:3136
v_mfma_f32_16x16x32_bf16 v[208:211], v[112:115], a[156:159], v[208:211]
ds_read_b128 v[124:127], v0 offset:47360
v_mfma_f32_16x16x32_bf16 v[24:27], a[32:35], a[244:247], 0
v_mfma_f32_16x16x32_bf16 v[184:187], v[112:115], a[152:155], v[184:187]
v_mfma_f32_16x16x32_bf16 v[160:163], v[112:115], a[60:63], v[160:163]
v_mfma_f32_16x16x32_bf16 v[28:31], a[36:39], a[244:247], 0
v_mfma_f32_16x16x32_bf16 v[136:139], v[112:115], a[56:59], v[136:139]
s_waitcnt lgkmcnt(1)
v_mfma_f32_16x16x32_bf16 v[212:215], v[116:119], a[156:159], v[212:215]
ds_read_b128 v[112:115], v0 offset:49152
v_mfma_f32_16x16x32_bf16 v[32:35], a[40:43], a[248:251], 0
v_mfma_f32_16x16x32_bf16 v[188:191], v[116:119], a[152:155], v[188:191]
v_mfma_f32_16x16x32_bf16 v[164:167], v[116:119], a[60:63], v[164:167]
v_mfma_f32_16x16x32_bf16 v[36:39], a[44:47], a[248:251], 0
v_mfma_f32_16x16x32_bf16 v[140:143], v[116:119], a[56:59], v[140:143]
v_mfma_f32_16x16x32_bf16 v[216:219], v[120:123], a[156:159], v[216:219]
ds_read_b128 v[116:119], v0 offset:49408
s_waitcnt vmcnt(36)
v_mfma_f32_16x16x32_bf16 v[40:43], a[24:27], a[252:255], 0
v_mfma_f32_16x16x32_bf16 v[192:195], v[120:123], a[152:155], v[192:195]
v_mfma_f32_16x16x32_bf16 v[168:171], v[120:123], a[60:63], v[168:171]
v_mfma_f32_16x16x32_bf16 v[44:47], a[28:31], a[252:255], 0
v_mfma_f32_16x16x32_bf16 v[144:147], v[120:123], a[56:59], v[144:147]
s_waitcnt lgkmcnt(1)
v_mfma_f32_16x16x32_bf16 v[220:223], v[124:127], a[156:159], v[220:223]
ds_read_b128 v[120:123], v0 offset:51200
s_waitcnt vmcnt(35)
v_mfma_f32_16x16x32_bf16 v[48:51], a[32:35], a[216:219], 0
v_mfma_f32_16x16x32_bf16 v[196:199], v[124:127], a[152:155], v[196:199]
v_mfma_f32_16x16x32_bf16 v[172:175], v[124:127], a[60:63], v[172:175]
v_mfma_f32_16x16x32_bf16 v[52:55], a[36:39], a[216:219], 0
v_mfma_f32_16x16x32_bf16 v[148:151], v[124:127], a[56:59], v[148:151]
v_mfma_f32_16x16x32_bf16 v[200:203], v[112:115], a[164:167], v[200:203]
ds_read_b128 v[124:127], v0 offset:51456
s_waitcnt vmcnt(34)
v_mfma_f32_16x16x32_bf16 v[56:59], a[40:43], a[220:223], 0
v_mfma_f32_16x16x32_bf16 v[176:179], v[112:115], a[160:163], v[176:179]
v_mfma_f32_16x16x32_bf16 v[152:155], v[112:115], a[68:71], v[152:155]
v_mfma_f32_16x16x32_bf16 v[60:63], a[44:47], a[220:223], 0
v_mfma_f32_16x16x32_bf16 v[128:131], v[112:115], a[64:67], v[128:131]
s_waitcnt lgkmcnt(1)
v_mfma_f32_16x16x32_bf16 v[204:207], v[116:119], a[164:167], v[204:207]
ds_read_b128 v[112:115], v0 offset:53248
v_mfma_f32_16x16x32_bf16 v[180:183], v[116:119], a[160:163], v[180:183]
v_mfma_f32_16x16x32_bf16 v[156:159], v[116:119], a[68:71], v[156:159]
v_mfma_f32_16x16x32_bf16 v[132:135], v[116:119], a[64:67], v[132:135]
buffer_load_dwordx4 a[20:23], v4, s[24:27], s64 offen offset:3200
v_mfma_f32_16x16x32_bf16 v[208:211], v[120:123], a[164:167], v[208:211]
ds_read_b128 v[116:119], v0 offset:53504
s_waitcnt vmcnt(26)
v_fma_f32 v16, v16, v248, -v249
v_fma_f32 v17, v17, v248, -v249
v_mfma_f32_16x16x32_bf16 v[184:187], v[120:123], a[160:163], v[184:187]
buffer_store_dwordx4 v[232:235], v4, s[28:31], s84 offen offset:128 sc1
v_fma_f32 v18, v18, v248, -v249
v_fma_f32 v19, v19, v248, -v249
v_mfma_f32_16x16x32_bf16 v[160:163], v[120:123], a[68:71], v[160:163]
v_fma_f32 v20, v20, v248, -v249
v_fma_f32 v21, v21, v248, -v249
v_mfma_f32_16x16x32_bf16 v[136:139], v[120:123], a[64:67], v[136:139]
v_fma_f32 v22, v22, v248, -v249
v_fma_f32 v23, v23, v248, -v249
s_waitcnt lgkmcnt(0)
v_mfma_f32_16x16x32_bf16 v[212:215], v[124:127], a[164:167], v[212:215]
ds_read_b128 v[120:123], v0 offset:55296
v_fma_f32 v24, v24, v248, -v249
v_fma_f32 v25, v25, v248, -v249
v_mfma_f32_16x16x32_bf16 v[188:191], v[124:127], a[160:163], v[188:191]
v_fma_f32 v26, v26, v248, -v249
v_fma_f32 v27, v27, v248, -v249
v_mfma_f32_16x16x32_bf16 v[164:167], v[124:127], a[68:71], v[164:167]
v_fma_f32 v28, v28, v248, -v249
v_fma_f32 v29, v29, v248, -v249
v_mfma_f32_16x16x32_bf16 v[140:143], v[124:127], a[64:67], v[140:143]
v_fma_f32 v30, v30, v248, -v249
v_fma_f32 v31, v31, v248, -v249
v_mfma_f32_16x16x32_bf16 v[216:219], v[112:115], a[164:167], v[216:219]
ds_read_b128 v[124:127], v0 offset:55552
v_fma_f32 v32, v32, v248, -v249
v_fma_f32 v33, v33, v248, -v249
v_mfma_f32_16x16x32_bf16 v[192:195], v[112:115], a[160:163], v[192:195]
v_fma_f32 v34, v34, v248, -v249
v_fma_f32 v35, v35, v248, -v249
v_mfma_f32_16x16x32_bf16 v[168:171], v[112:115], a[68:71], v[168:171]
s_waitcnt vmcnt(8)
s_barrier
v_fma_f32 v36, v36, v248, -v249
v_fma_f32 v37, v37, v248, -v249
v_mfma_f32_16x16x32_bf16 v[144:147], v[112:115], a[64:67], v[144:147]
v_fma_f32 v38, v38, v248, -v249
v_fma_f32 v39, v39, v248, -v249
v_mfma_f32_16x16x32_bf16 v[220:223], v[116:119], a[164:167], v[220:223]
ds_read_b128 v[112:115], v0 offset:57344
v_fma_f32 v40, v40, v250, -v251
v_fma_f32 v41, v41, v250, -v251
v_mfma_f32_16x16x32_bf16 v[196:199], v[116:119], a[160:163], v[196:199]
v_fma_f32 v42, v42, v250, -v251
v_fma_f32 v43, v43, v250, -v251
v_mfma_f32_16x16x32_bf16 v[172:175], v[116:119], a[68:71], v[172:175]
v_fma_f32 v44, v44, v250, -v251
v_fma_f32 v45, v45, v250, -v251
v_mfma_f32_16x16x32_bf16 v[148:151], v[116:119], a[64:67], v[148:151]
v_fma_f32 v46, v46, v250, -v251
v_fma_f32 v47, v47, v250, -v251
s_waitcnt lgkmcnt(0)
v_mfma_f32_16x16x32_bf16 v[200:203], v[120:123], a[172:175], v[200:203]
ds_read_b128 v[116:119], v0 offset:57600
v_fma_f32 v48, v48, v250, -v251
v_fma_f32 v49, v49, v250, -v251
v_mfma_f32_16x16x32_bf16 v[176:179], v[120:123], a[168:171], v[176:179]
v_fma_f32 v50, v50, v250, -v251
v_fma_f32 v51, v51, v250, -v251
v_mfma_f32_16x16x32_bf16 v[152:155], v[120:123], a[76:79], v[152:155]
v_fma_f32 v52, v52, v250, -v251
v_fma_f32 v53, v53, v250, -v251
v_mfma_f32_16x16x32_bf16 v[128:131], v[120:123], a[72:75], v[128:131]
v_fma_f32 v54, v54, v250, -v251
v_fma_f32 v55, v55, v250, -v251
v_mfma_f32_16x16x32_bf16 v[204:207], v[124:127], a[172:175], v[204:207]
ds_read_b128 v[120:123], v0 offset:59392
ds_read_b128 a[48:51], v1 offset:8192
v_fma_f32 v56, v56, v250, -v251
v_fma_f32 v57, v57, v250, -v251
v_mfma_f32_16x16x32_bf16 v[180:183], v[124:127], a[168:171], v[180:183]
v_fma_f32 v58, v58, v250, -v251
v_fma_f32 v59, v59, v250, -v251
v_mfma_f32_16x16x32_bf16 v[156:159], v[124:127], a[76:79], v[156:159]
ds_read_b128 a[52:55], v1 offset:10240
v_fma_f32 v60, v60, v250, -v251
v_fma_f32 v61, v61, v250, -v251
v_mfma_f32_16x16x32_bf16 v[132:135], v[124:127], a[72:75], v[132:135]
v_fma_f32 v62, v62, v250, -v251
v_fma_f32 v63, v63, v250, -v251
v_mfma_f32_16x16x32_bf16 v[208:211], v[112:115], a[172:175], v[208:211]
ds_read_b128 v[124:127], v0 offset:59648
ds_read_b128 a[56:59], v1 offset:12288
v_cvt_pk_bf16_f32 v64, v16, v17
v_cvt_pk_bf16_f32 v65, v18, v19
v_mfma_f32_16x16x32_bf16 v[184:187], v[112:115], a[168:171], v[184:187]
v_cvt_pk_bf16_f32 v66, v20, v21
v_cvt_pk_bf16_f32 v67, v22, v23
v_mfma_f32_16x16x32_bf16 v[160:163], v[112:115], a[76:79], v[160:163]
ds_read_b128 a[60:63], v1 offset:8448
v_cvt_pk_bf16_f32 v68, v24, v25
v_cvt_pk_bf16_f32 v69, v26, v27
v_mfma_f32_16x16x32_bf16 v[136:139], v[112:115], a[72:75], v[136:139]
v_cvt_pk_bf16_f32 v70, v28, v29
v_cvt_pk_bf16_f32 v71, v30, v31
s_waitcnt lgkmcnt(1)
v_mfma_f32_16x16x32_bf16 v[212:215], v[116:119], a[172:175], v[212:215]
ds_read_b128 v[112:115], v0 offset:61440
ds_read_b128 a[64:67], v1 offset:10496
v_cvt_pk_bf16_f32 v72, v32, v33
v_cvt_pk_bf16_f32 v73, v34, v35
v_mfma_f32_16x16x32_bf16 v[188:191], v[116:119], a[168:171], v[188:191]
buffer_store_dwordx4 v[236:239], v4, s[28:31], s84 offen offset:3072 sc1
v_cvt_pk_bf16_f32 v74, v36, v37
v_cvt_pk_bf16_f32 v75, v38, v39
v_mfma_f32_16x16x32_bf16 v[164:167], v[116:119], a[76:79], v[164:167]
ds_read_b128 a[68:71], v1 offset:12544
v_cvt_pk_bf16_f32 v76, v40, v41
v_cvt_pk_bf16_f32 v77, v42, v43
v_mfma_f32_16x16x32_bf16 v[140:143], v[116:119], a[72:75], v[140:143]
v_cvt_pk_bf16_f32 v78, v44, v45
v_cvt_pk_bf16_f32 v79, v46, v47
v_mfma_f32_16x16x32_bf16 v[216:219], v[120:123], a[172:175], v[216:219]
ds_read_b128 v[116:119], v0 offset:61696
v_cvt_pk_bf16_f32 v80, v48, v49
v_cvt_pk_bf16_f32 v81, v50, v51
v_mfma_f32_16x16x32_bf16 v[192:195], v[120:123], a[168:171], v[192:195]
v_cvt_pk_bf16_f32 v82, v52, v53
v_cvt_pk_bf16_f32 v83, v54, v55
v_mfma_f32_16x16x32_bf16 v[168:171], v[120:123], a[76:79], v[168:171]
v_cvt_pk_bf16_f32 v84, v56, v57
v_cvt_pk_bf16_f32 v85, v58, v59
v_mfma_f32_16x16x32_bf16 v[144:147], v[120:123], a[72:75], v[144:147]
v_cvt_pk_bf16_f32 v86, v60, v61
v_cvt_pk_bf16_f32 v87, v62, v63
v_mfma_f32_16x16x32_bf16 v[220:223], v[124:127], a[172:175], v[220:223]
ds_read_b128 v[120:123], v0 offset:63488
v_mfma_f32_16x16x32_bf16 v[196:199], v[124:127], a[168:171], v[196:199]
v_mfma_f32_16x16x32_bf16 v[172:175], v[124:127], a[76:79], v[172:175]
v_mfma_f32_16x16x32_bf16 v[148:151], v[124:127], a[72:75], v[148:151]
s_waitcnt lgkmcnt(1)
v_mfma_f32_16x16x32_bf16 v[200:203], v[112:115], a[180:183], v[200:203]
ds_read_b128 v[124:127], v0 offset:63744
v_mfma_f32_16x16x32_bf16 v[176:179], v[112:115], a[176:179], v[176:179]
v_mfma_f32_16x16x32_bf16 v[152:155], v[112:115], a[84:87], v[152:155]
v_mfma_f32_16x16x32_bf16 v[128:131], v[112:115], a[80:83], v[128:131]
v_mfma_f32_16x16x32_bf16 v[204:207], v[116:119], a[180:183], v[204:207]
ds_read_b128 v[112:115], v1 offset:0
v_mfma_f32_16x16x32_bf16 v[180:183], v[116:119], a[176:179], v[180:183]
v_mfma_f32_16x16x32_bf16 v[156:159], v[116:119], a[84:87], v[156:159]
v_mfma_f32_16x16x32_bf16 v[132:135], v[116:119], a[80:83], v[132:135]
s_waitcnt lgkmcnt(1)
v_mfma_f32_16x16x32_bf16 v[208:211], v[120:123], a[180:183], v[208:211]
ds_read_b128 v[116:119], v1 offset:256
v_mfma_f32_16x16x32_bf16 v[184:187], v[120:123], a[176:179], v[184:187]
v_mfma_f32_16x16x32_bf16 v[160:163], v[120:123], a[84:87], v[160:163]
v_mfma_f32_16x16x32_bf16 v[136:139], v[120:123], a[80:83], v[136:139]
v_mfma_f32_16x16x32_bf16 v[212:215], v[124:127], a[180:183], v[212:215]
ds_read_b128 v[120:123], v1 offset:2048
v_mfma_f32_16x16x32_bf16 v[188:191], v[124:127], a[176:179], v[188:191]
v_mfma_f32_16x16x32_bf16 v[164:167], v[124:127], a[84:87], v[164:167]
v_mfma_f32_16x16x32_bf16 v[140:143], v[124:127], a[80:83], v[140:143]
s_waitcnt lgkmcnt(1)
v_mfma_f32_16x16x32_bf16 v[216:219], v[112:115], a[180:183], v[216:219]
ds_read_b128 v[124:127], v1 offset:2304
v_mfma_f32_16x16x32_bf16 v[192:195], v[112:115], a[176:179], v[192:195]
buffer_store_dwordx4 v[240:243], v4, s[28:31], s84 offen offset:3136 sc1
v_mfma_f32_16x16x32_bf16 v[168:171], v[112:115], a[84:87], v[168:171]
v_mfma_f32_16x16x32_bf16 v[144:147], v[112:115], a[80:83], v[144:147]
v_mfma_f32_16x16x32_bf16 v[220:223], v[116:119], a[180:183], v[220:223]
ds_read_b128 v[112:115], v1 offset:4096
v_mfma_f32_16x16x32_bf16 v[196:199], v[116:119], a[176:179], v[196:199]
v_mfma_f32_16x16x32_bf16 v[172:175], v[116:119], a[84:87], v[172:175]
v_mfma_f32_16x16x32_bf16 v[148:151], v[116:119], a[80:83], v[148:151]
s_waitcnt lgkmcnt(1)
v_mfma_f32_16x16x32_bf16 v[200:203], v[120:123], a[188:191], v[200:203]
ds_read_b128 v[116:119], v1 offset:4352
v_mfma_f32_16x16x32_bf16 v[176:179], v[120:123], a[184:187], v[176:179]
v_mfma_f32_16x16x32_bf16 v[152:155], v[120:123], a[92:95], v[152:155]
v_mfma_f32_16x16x32_bf16 v[128:131], v[120:123], a[88:91], v[128:131]
v_mfma_f32_16x16x32_bf16 v[204:207], v[124:127], a[188:191], v[204:207]
ds_read_b128 v[120:123], v1 offset:6144
v_mfma_f32_16x16x32_bf16 v[180:183], v[124:127], a[184:187], v[180:183]
v_mfma_f32_16x16x32_bf16 v[156:159], v[124:127], a[92:95], v[156:159]
v_mfma_f32_16x16x32_bf16 v[132:135], v[124:127], a[88:91], v[132:135]
s_waitcnt lgkmcnt(1)
v_mfma_f32_16x16x32_bf16 v[208:211], v[112:115], a[188:191], v[208:211]
ds_read_b128 v[124:127], v1 offset:6400
v_mfma_f32_16x16x32_bf16 v[184:187], v[112:115], a[184:187], v[184:187]
v_mfma_f32_16x16x32_bf16 v[160:163], v[112:115], a[92:95], v[160:163]
v_mfma_f32_16x16x32_bf16 v[136:139], v[112:115], a[88:91], v[136:139]
v_mfma_f32_16x16x32_bf16 v[212:215], v[116:119], a[188:191], v[212:215]
v_mfma_f32_16x16x32_bf16 v[188:191], v[116:119], a[184:187], v[188:191]
v_mfma_f32_16x16x32_bf16 v[164:167], v[116:119], a[92:95], v[164:167]
v_mfma_f32_16x16x32_bf16 v[140:143], v[116:119], a[88:91], v[140:143]
s_waitcnt lgkmcnt(0)
v_mfma_f32_16x16x32_bf16 v[216:219], v[120:123], a[188:191], v[216:219]
v_mfma_f32_16x16x32_bf16 v[192:195], v[120:123], a[184:187], v[192:195]
v_mfma_f32_16x16x32_bf16 v[168:171], v[120:123], a[92:95], v[168:171]
v_mfma_f32_16x16x32_bf16 v[144:147], v[120:123], a[88:91], v[144:147]
v_mfma_f32_16x16x32_bf16 v[220:223], v[124:127], a[188:191], v[220:223]
v_mfma_f32_16x16x32_bf16 v[196:199], v[124:127], a[184:187], v[196:199]
buffer_store_dwordx4 v[244:247], v4, s[28:31], s84 offen offset:3200 sc1
v_mfma_f32_16x16x32_bf16 v[172:175], v[124:127], a[92:95], v[172:175]
v_mfma_f32_16x16x32_bf16 v[148:151], v[124:127], a[88:91], v[148:151]
s_waitcnt vmcnt(7)
v_mfma_f32_16x16x32_bf16 v[152:155], v[8:11], a[12:15], v[152:155]
v_mfma_f32_16x16x32_bf16 v[128:131], v[8:11], a[0:3], v[128:131]
v_mfma_f32_16x16x32_bf16 v[156:159], v[12:15], a[12:15], v[156:159]
v_mfma_f32_16x16x32_bf16 v[132:135], v[12:15], a[0:3], v[132:135]
s_waitcnt vmcnt(5)
v_mfma_f32_16x16x32_bf16 v[160:163], v[8:11], a[16:19], v[160:163]
v_mfma_f32_16x16x32_bf16 v[136:139], v[8:11], a[4:7], v[136:139]
v_mfma_f32_16x16x32_bf16 v[164:167], v[12:15], a[16:19], v[164:167]
v_mfma_f32_16x16x32_bf16 v[140:143], v[12:15], a[4:7], v[140:143]
s_waitcnt vmcnt(4)
v_mfma_f32_16x16x32_bf16 v[168:171], v[8:11], a[20:23], v[168:171]
v_mfma_f32_16x16x32_bf16 v[144:147], v[8:11], a[8:11], v[144:147]
v_mfma_f32_16x16x32_bf16 v[172:175], v[12:15], a[20:23], v[172:175]
v_mfma_f32_16x16x32_bf16 v[148:151], v[12:15], a[8:11], v[148:151]
v_mfma_f32_16x16x32_bf16 v[200:203], v[8:11], a[204:207], v[200:203]
v_mfma_f32_16x16x32_bf16 v[176:179], v[8:11], a[192:195], v[176:179]
v_mfma_f32_16x16x32_bf16 v[204:207], v[12:15], a[204:207], v[204:207]
v_mfma_f32_16x16x32_bf16 v[180:183], v[12:15], a[192:195], v[180:183]
v_mfma_f32_16x16x32_bf16 v[208:211], v[8:11], a[208:211], v[208:211]
v_cvt_pk_bf16_f32 v96, v128, v129
v_mfma_f32_16x16x32_bf16 v[184:187], v[8:11], a[196:199], v[184:187]
v_cvt_pk_bf16_f32 v97, v130, v131
v_cvt_pk_bf16_f32 v98, v132, v133
v_mfma_f32_16x16x32_bf16 v[212:215], v[12:15], a[208:211], v[212:215]
v_cvt_pk_bf16_f32 v99, v134, v135
v_mfma_f32_16x16x32_bf16 v[188:191], v[12:15], a[196:199], v[188:191]
v_cvt_pk_bf16_f32 v100, v136, v137
v_mfma_f32_16x16x32_bf16 v[216:219], v[8:11], a[212:215], v[216:219]
v_cvt_pk_bf16_f32 v101, v138, v139
v_mfma_f32_16x16x32_bf16 v[192:195], v[8:11], a[200:203], v[192:195]
v_cvt_pk_bf16_f32 v102, v140, v141
v_cvt_pk_bf16_f32 v103, v142, v143
v_mfma_f32_16x16x32_bf16 v[220:223], v[12:15], a[212:215], v[220:223]
v_cvt_pk_bf16_f32 v104, v144, v145
v_mfma_f32_16x16x32_bf16 v[196:199], v[12:15], a[200:203], v[196:199]
v_cvt_pk_bf16_f32 v105, v146, v147
v_mfma_f32_16x16x32_bf16 v[16:19], a[48:51], v[64:67], 0
v_cvt_pk_bf16_f32 v106, v148, v149
v_mfma_f32_16x16x32_bf16 v[24:27], a[48:51], v[76:79], 0
ds_read_b128 a[48:51], v1 offset:14336
v_cvt_pk_bf16_f32 v107, v150, v151
v_cvt_pk_bf16_f32 v108, v152, v153
v_mfma_f32_16x16x32_bf16 v[16:19], a[52:55], v[68:71], v[16:19]
v_cvt_pk_bf16_f32 v109, v154, v155
v_mfma_f32_16x16x32_bf16 v[24:27], a[52:55], v[80:83], v[24:27]
ds_read_b128 a[52:55], v1 offset:16384
v_cvt_pk_bf16_f32 v110, v156, v157
v_mfma_f32_16x16x32_bf16 v[16:19], a[56:59], v[72:75], v[16:19]
v_cvt_pk_bf16_f32 v111, v158, v159
v_mfma_f32_16x16x32_bf16 v[24:27], a[56:59], v[84:87], v[24:27]
ds_read_b128 a[56:59], v1 offset:18432
v_cvt_pk_bf16_f32 v112, v160, v161
v_cvt_pk_bf16_f32 v113, v162, v163
v_mfma_f32_16x16x32_bf16 v[20:23], a[60:63], v[64:67], 0
v_cvt_pk_bf16_f32 v114, v164, v165
v_mfma_f32_16x16x32_bf16 v[28:31], a[60:63], v[76:79], 0
ds_read_b128 a[60:63], v1 offset:14592
v_cvt_pk_bf16_f32 v115, v166, v167
v_mfma_f32_16x16x32_bf16 v[20:23], a[64:67], v[68:71], v[20:23]
v_cvt_pk_bf16_f32 v116, v168, v169
v_mfma_f32_16x16x32_bf16 v[28:31], a[64:67], v[80:83], v[28:31]
ds_read_b128 a[64:67], v1 offset:16640
v_cvt_pk_bf16_f32 v117, v170, v171
v_cvt_pk_bf16_f32 v118, v172, v173
v_mfma_f32_16x16x32_bf16 v[20:23], a[68:71], v[72:75], v[20:23]
v_cvt_pk_bf16_f32 v119, v174, v175
v_mfma_f32_16x16x32_bf16 v[28:31], a[68:71], v[84:87], v[28:31]
ds_read_b128 a[68:71], v1 offset:18688
ds_read_b128 v[128:131], v3 offset:0
ds_read_b128 v[132:135], v3 offset:16
ds_read_b128 v[136:139], v3 offset:128
ds_read_b128 v[140:143], v3 offset:144
ds_read_b128 v[144:147], v3 offset:256
ds_read_b128 v[148:151], v3 offset:272
v_pk_fma_f32 v[48:49], v[16:17], v[16:17], s[60:61] neg_lo:[1,0,0] neg_hi:[1,0,0]
v_pk_fma_f32 v[50:51], v[18:19], v[18:19], s[60:61] neg_lo:[1,0,0] neg_hi:[1,0,0]
v_pk_fma_f32 v[52:53], v[20:21], v[20:21], s[60:61] neg_lo:[1,0,0] neg_hi:[1,0,0]
v_pk_fma_f32 v[54:55], v[22:23], v[22:23], s[60:61] neg_lo:[1,0,0] neg_hi:[1,0,0]
v_pk_fma_f32 v[56:57], v[24:25], v[24:25], s[60:61] neg_lo:[1,0,0] neg_hi:[1,0,0]
v_pk_fma_f32 v[58:59], v[26:27], v[26:27], s[60:61] neg_lo:[1,0,0] neg_hi:[1,0,0]
v_pk_fma_f32 v[60:61], v[28:29], v[28:29], s[60:61] neg_lo:[1,0,0] neg_hi:[1,0,0]
v_pk_fma_f32 v[62:63], v[30:31], v[30:31], s[60:61] neg_lo:[1,0,0] neg_hi:[1,0,0]
v_pk_mul_f32 v[48:49], v[48:49], v[16:17]
v_pk_mul_f32 v[50:51], v[50:51], v[18:19]
v_pk_mul_f32 v[52:53], v[52:53], v[20:21]
v_pk_mul_f32 v[54:55], v[54:55], v[22:23]
v_pk_mul_f32 v[56:57], v[56:57], v[24:25]
v_pk_mul_f32 v[58:59], v[58:59], v[26:27]
v_pk_mul_f32 v[60:61], v[60:61], v[28:29]
v_pk_mul_f32 v[62:63], v[62:63], v[30:31]
L_b2_0:
s_waitcnt lgkmcnt(0)
v_mfma_f32_16x16x32_bf16 v[152:155], v[8:11], a[252:255], v[128:131]
ds_read_b128 a[72:75], v0 offset:0
v_exp_f32 v48, v48
v_mfma_f32_16x16x32_bf16 v[128:131], v[8:11], a[240:243], v[128:131]
ds_read_b128 a[76:79], v0 offset:256
v_exp_f32 v49, v49
v_mfma_f32_16x16x32_bf16 v[156:159], v[12:15], a[252:255], v[132:135]
v_exp_f32 v50, v50
v_mfma_f32_16x16x32_bf16 v[132:135], v[12:15], a[240:243], v[132:135]
ds_read_b128 a[80:83], v0 offset:2048
v_exp_f32 v51, v51
v_mfma_f32_16x16x32_bf16 v[160:163], v[8:11], a[216:219], v[136:139]
ds_read_b128 a[84:87], v0 offset:2304
v_exp_f32 v52, v52
v_mfma_f32_16x16x32_bf16 v[136:139], v[8:11], a[244:247], v[136:139]
v_exp_f32 v53, v53
v_mfma_f32_16x16x32_bf16 v[164:167], v[12:15], a[216:219], v[140:143]
ds_read_b128 a[88:91], v0 offset:4096
v_exp_f32 v54, v54
v_mfma_f32_16x16x32_bf16 v[140:143], v[12:15], a[244:247], v[140:143]
ds_read_b128 a[92:95], v0 offset:4352
v_exp_f32 v55, v55
v_mfma_f32_16x16x32_bf16 v[168:171], v[8:11], a[220:223], v[144:147]
v_exp_f32 v56, v56
v_mfma_f32_16x16x32_bf16 v[144:147], v[8:11], a[248:251], v[144:147]
s_mov_b32 s85, 6291456
v_exp_f32 v57, v57
v_mfma_f32_16x16x32_bf16 v[172:175], v[12:15], a[220:223], v[148:151]
buffer_load_dwordx4 a[0:3], v4, s[24:27], s85 offen offset:0
v_exp_f32 v58, v58
v_mfma_f32_16x16x32_bf16 v[148:151], v[12:15], a[248:251], v[148:151]
v_exp_f32 v59, v59
v_exp_f32 v60, v60
v_exp_f32 v61, v61
v_exp_f32 v62, v62
v_exp_f32_e64 v63, v63
v_pk_add_f32 v[48:49], v[48:49], 1.0 op_sel_hi:[1,0]
v_pk_add_f32 v[50:51], v[50:51], 1.0 op_sel_hi:[1,0]
v_pk_add_f32 v[52:53], v[52:53], 1.0 op_sel_hi:[1,0]
v_pk_add_f32 v[54:55], v[54:55], 1.0 op_sel_hi:[1,0]
v_pk_add_f32 v[56:57], v[56:57], 1.0 op_sel_hi:[1,0]
v_pk_add_f32 v[58:59], v[58:59], 1.0 op_sel_hi:[1,0]
v_pk_add_f32 v[60:61], v[60:61], 1.0 op_sel_hi:[1,0]
v_pk_add_f32 v[62:63], v[62:63], 1.0 op_sel_hi:[1,0]
v_mfma_f32_16x16x32_bf16 v[32:35], a[48:51], v[64:67], 0
buffer_load_dwordx2 v[248:249], v6, s[40:43], s79 offen offset:256 sc1
v_rcp_f32 v48, v48
v_mfma_f32_16x16x32_bf16 v[40:43], a[48:51], v[76:79], 0
ds_read_b128 a[48:51], v1 offset:20480
v_rcp_f32 v49, v49
v_mfma_f32_16x16x32_bf16 v[32:35], a[52:55], v[68:71], v[32:35]
buffer_load_dwordx2 v[250:251], v6, s[40:43], s79 offen offset:384 sc1
v_rcp_f32_e64 v50, v50
v_mfma_f32_16x16x32_bf16 v[40:43], a[52:55], v[80:83], v[40:43]
ds_read_b128 a[52:55], v1 offset:22528
s_add_u32 s74, s87, L_b2_1-L_pc
v_rcp_f32 v51, v51
v_mfma_f32_16x16x32_bf16 v[32:35], a[56:59], v[72:75], v[32:35]
buffer_load_dwordx4 a[4:7], v4, s[24:27], s85 offen offset:64
v_rcp_f32 v52, v52
v_mfma_f32_16x16x32_bf16 v[40:43], a[56:59], v[84:87], v[40:43]
ds_read_b128 a[56:59], v1 offset:24576
v_rcp_f32 v53, v53
v_mfma_f32_16x16x32_bf16 v[36:39], a[60:63], v[64:67], 0
v_add_u32 v254, s74, v2
v_mfma_f32_16x16x32_bf16 v[44:47], a[60:63], v[76:79], 0
ds_read_b128 a[60:63], v1 offset:20736
s_add_u32 s81, s80, 18432
v_rcp_f32 v54, v54
v_mfma_f32_16x16x32_bf16 v[36:39], a[64:67], v[68:71], v[36:39]
v_rcp_f32 v55, v55
v_mfma_f32_16x16x32_bf16 v[44:47], a[64:67], v[80:83], v[44:47]
ds_read_b128 a[64:67], v1 offset:22784
buffer_load_dwordx4 a[144:147], v253, s[40:43], s81 offen offset:0 sc1
v_mfma_f32_16x16x32_bf16 v[36:39], a[68:71], v[72:75], v[36:39]
v_min_u32 v254, L_pf1-L_pc-4, v254
v_rcp_f32 v56, v56
v_mfma_f32_16x16x32_bf16 v[44:47], a[68:71], v[84:87], v[44:47]
ds_read_b128 a[68:71], v1 offset:24832
v_rcp_f32 v57, v57
v_rcp_f32 v58, v58
v_mov_b32 v255, s89
v_rcp_f32 v59, v59
v_rcp_f32 v60, v60
v_rcp_f32 v61, v61
v_add_co_u32 v254, vcc, s88, v254
v_rcp_f32 v62, v62
v_rcp_f32 v63, v63
v_addc_co_u32_e64 v255, vcc, 0, v255, vcc
v_pk_mul_f32 v[16:17], v[48:49], v[16:17]
v_pk_mul_f32 v[18:19], v[50:51], v[18:19]
v_pk_mul_f32 v[20:21], v[52:53], v[20:21]
v_pk_mul_f32 v[22:23], v[54:55], v[22:23]
v_pk_mul_f32 v[24:25], v[56:57], v[24:25]
v_pk_mul_f32 v[26:27], v[58:59], v[26:27]
v_pk_mul_f32 v[28:29], v[60:61], v[28:29]
v_pk_mul_f32 v[30:31], v[62:63], v[30:31]
v_pk_fma_f32 v[48:49], v[32:33], v[32:33], s[60:61] neg_lo:[1,0,0] neg_hi:[1,0,0]
v_pk_fma_f32 v[50:51], v[34:35], v[34:35], s[60:61] neg_lo:[1,0,0] neg_hi:[1,0,0]
v_pk_fma_f32 v[52:53], v[36:37], v[36:37], s[60:61] neg_lo:[1,0,0] neg_hi:[1,0,0]
v_pk_fma_f32 v[54:55], v[38:39], v[38:39], s[60:61] neg_lo:[1,0,0] neg_hi:[1,0,0]
v_pk_fma_f32 v[56:57], v[40:41], v[40:41], s[60:61] neg_lo:[1,0,0] neg_hi:[1,0,0]
v_pk_fma_f32 v[58:59], v[42:43], v[42:43], s[60:61] neg_lo:[1,0,0] neg_hi:[1,0,0]
v_pk_fma_f32 v[60:61], v[44:45], v[44:45], s[60:61] neg_lo:[1,0,0] neg_hi:[1,0,0]
v_pk_fma_f32 v[62:63], v[46:47], v[46:47], s[60:61] neg_lo:[1,0,0] neg_hi:[1,0,0]
v_pk_mul_f32 v[48:49], v[48:49], v[32:33]
v_pk_mul_f32 v[50:51], v[50:51], v[34:35]
v_pk_mul_f32 v[52:53], v[52:53], v[36:37]
v_pk_mul_f32 v[54:55], v[54:55], v[38:39]
v_pk_mul_f32 v[56:57], v[56:57], v[40:41]
v_pk_mul_f32 v[58:59], v[58:59], v[42:43]
v_pk_mul_f32 v[60:61], v[60:61], v[44:45]
v_pk_mul_f32 v[62:63], v[62:63], v[46:47]
v_cvt_pk_bf16_f32 v88, v16, v17
v_cvt_pk_bf16_f32 v89, v18, v19
v_cvt_pk_bf16_f32 v90, v20, v21
v_cvt_pk_bf16_f32 v91, v22, v23
v_cvt_pk_bf16_f32 v92, v24, v25
s_waitcnt lgkmcnt(0)
v_mfma_f32_16x16x32_bf16 v[128:131], a[72:75], v[88:91], v[128:131]
global_load_dword v255, v[254:255], off
v_cvt_pk_bf16_f32 v93, v26, v27
v_cvt_pk_bf16_f32 v94, v28, v29
v_mfma_f32_16x16x32_bf16 v[132:135], a[76:79], v[88:91], v[132:135]
v_cvt_pk_bf16_f32 v95, v30, v31
v_exp_f32 v48, v48
v_mfma_f32_16x16x32_bf16 v[136:139], a[80:83], v[88:91], v[136:139]
v_exp_f32_e64 v49, v49
v_mfma_f32_16x16x32_bf16 v[140:143], a[84:87], v[88:91], v[140:143]
v_cvt_pk_bf16_f32 v224, v176, v177
v_mfma_f32_16x16x32_bf16 v[144:147], a[88:91], v[88:91], v[144:147]
v_exp_f32 v50, v50
v_mfma_f32_16x16x32_bf16 v[148:151], a[92:95], v[88:91], v[148:151]
v_cvt_pk_bf16_f32 v225, v178, v179
v_exp_f32 v51, v51
v_mfma_f32_16x16x32_bf16 v[152:155], a[72:75], v[92:95], v[152:155]
ds_read_b128 a[72:75], v0 offset:6144
buffer_load_dwordx4 a[8:11], v4, s[24:27], s85 offen offset:128
v_mfma_f32_16x16x32_bf16 v[156:159], a[76:79], v[92:95], v[156:159]
ds_read_b128 a[76:79], v0 offset:6400
v_cvt_pk_bf16_f32 v226, v180, v181
v_exp_f32 v52, v52
v_mfma_f32_16x16x32_bf16 v[160:163], a[80:83], v[92:95], v[160:163]
ds_read_b128 a[80:83], v0 offset:8192
v_exp_f32 v53, v53
v_mfma_f32_16x16x32_bf16 v[164:167], a[84:87], v[92:95], v[164:167]
ds_read_b128 a[84:87], v0 offset:8448
v_cvt_pk_bf16_f32 v227, v182, v183
v_mfma_f32_16x16x32_bf16 v[168:171], a[88:91], v[92:95], v[168:171]
ds_read_b128 a[88:91], v0 offset:10240
v_exp_f32_e64 v54, v54
v_mfma_f32_16x16x32_bf16 v[172:175], a[92:95], v[92:95], v[172:175]
ds_read_b128 a[92:95], v0 offset:10496
v_cvt_pk_bf16_f32 v228, v184, v185
v_exp_f32 v55, v55
v_cvt_pk_bf16_f32 v229, v186, v187
v_exp_f32 v56, v56
v_exp_f32 v57, v57
v_cvt_pk_bf16_f32 v230, v188, v189
v_exp_f32 v58, v58
v_cvt_pk_bf16_f32 v231, v190, v191
v_exp_f32 v59, v59
v_cvt_pk_bf16_f32 v232, v192, v193
v_exp_f32 v60, v60
v_exp_f32 v61, v61
v_cvt_pk_bf16_f32 v233, v194, v195
v_exp_f32 v62, v62
v_cvt_pk_bf16_f32 v234, v196, v197
v_exp_f32_e64 v63, v63
v_cvt_pk_bf16_f32 v235, v198, v199
v_pk_add_f32 v[48:49], v[48:49], 1.0 op_sel_hi:[1,0]
v_pk_add_f32 v[50:51], v[50:51], 1.0 op_sel_hi:[1,0]
v_pk_add_f32 v[52:53], v[52:53], 1.0 op_sel_hi:[1,0]
v_pk_add_f32 v[54:55], v[54:55], 1.0 op_sel_hi:[1,0]
v_pk_add_f32 v[56:57], v[56:57], 1.0 op_sel_hi:[1,0]
v_pk_add_f32 v[58:59], v[58:59], 1.0 op_sel_hi:[1,0]
v_pk_add_f32 v[60:61], v[60:61], 1.0 op_sel_hi:[1,0]
v_pk_add_f32 v[62:63], v[62:63], 1.0 op_sel_hi:[1,0]
v_mfma_f32_16x16x32_bf16 v[16:19], a[48:51], v[64:67], 0
buffer_load_dwordx4 a[12:15], v4, s[24:27], s85 offen offset:3072
v_rcp_f32 v48, v48
v_mfma_f32_16x16x32_bf16 v[24:27], a[48:51], v[76:79], 0
ds_read_b128 a[48:51], v1 offset:26624
v_rcp_f32 v49, v49
v_mfma_f32_16x16x32_bf16 v[16:19], a[52:55], v[68:71], v[16:19]
v_cvt_pk_bf16_f32 v236, v200, v201
v_rcp_f32_e64 v50, v50
v_mfma_f32_16x16x32_bf16 v[24:27], a[52:55], v[80:83], v[24:27]
ds_read_b128 a[52:55], v1 offset:28672
v_cvt_pk_bf16_f32 v237, v202, v203
v_mfma_f32_16x16x32_bf16 v[16:19], a[56:59], v[72:75], v[16:19]
v_rcp_f32_e64 v51, v51
v_mfma_f32_16x16x32_bf16 v[24:27], a[56:59], v[84:87], v[24:27]
ds_read_b128 a[56:59], v1 offset:30720
v_cvt_pk_bf16_f32 v238, v204, v205
v_rcp_f32 v52, v52
v_mfma_f32_16x16x32_bf16 v[20:23], a[60:63], v[64:67], 0
v_rcp_f32 v53, v53
v_mfma_f32_16x16x32_bf16 v[28:31], a[60:63], v[76:79], 0
ds_read_b128 a[60:63], v1 offset:26880
v_cvt_pk_bf16_f32 v239, v206, v207
v_mfma_f32_16x16x32_bf16 v[20:23], a[64:67], v[68:71], v[20:23]
v_rcp_f32_e64 v54, v54
v_mfma_f32_16x16x32_bf16 v[28:31], a[64:67], v[80:83], v[28:31]
ds_read_b128 a[64:67], v1 offset:28928
v_cvt_pk_bf16_f32 v240, v208, v209
v_rcp_f32_e64 v55, v55
v_mfma_f32_16x16x32_bf16 v[20:23], a[68:71], v[72:75], v[20:23]
v_cvt_pk_bf16_f32 v241, v210, v211
v_mfma_f32_16x16x32_bf16 v[28:31], a[68:71], v[84:87], v[28:31]
ds_read_b128 a[68:71], v1 offset:30976
v_rcp_f32 v56, v56
v_rcp_f32 v57, v57
v_cvt_pk_bf16_f32 v242, v212, v213
v_rcp_f32 v58, v58
v_cvt_pk_bf16_f32 v243, v214, v215
v_rcp_f32 v59, v59
v_cvt_pk_bf16_f32 v244, v216, v217
v_rcp_f32 v60, v60
v_rcp_f32 v61, v61
v_cvt_pk_bf16_f32 v245, v218, v219
v_rcp_f32 v62, v62
v_cvt_pk_bf16_f32 v246, v220, v221
v_rcp_f32 v63, v63
v_cvt_pk_bf16_f32 v247, v222, v223
v_pk_mul_f32 v[32:33], v[48:49], v[32:33]
v_pk_mul_f32 v[34:35], v[50:51], v[34:35]
v_pk_mul_f32 v[36:37], v[52:53], v[36:37]
v_pk_mul_f32 v[38:39], v[54:55], v[38:39]
v_pk_mul_f32 v[40:41], v[56:57], v[40:41]
v_pk_mul_f32 v[42:43], v[58:59], v[42:43]
v_pk_mul_f32 v[44:45], v[60:61], v[44:45]
v_pk_mul_f32 v[46:47], v[62:63], v[46:47]
v_pk_fma_f32 v[48:49], v[16:17], v[16:17], s[60:61] neg_lo:[1,0,0] neg_hi:[1,0,0]
v_pk_fma_f32 v[50:51], v[18:19], v[18:19], s[60:61] neg_lo:[1,0,0] neg_hi:[1,0,0]
v_pk_fma_f32 v[52:53], v[20:21], v[20:21], s[60:61] neg_lo:[1,0,0] neg_hi:[1,0,0]
v_pk_fma_f32 v[54:55], v[22:23], v[22:23], s[60:61] neg_lo:[1,0,0] neg_hi:[1,0,0]
v_pk_fma_f32 v[56:57], v[24:25], v[24:25], s[60:61] neg_lo:[1,0,0] neg_hi:[1,0,0]
v_pk_fma_f32 v[58:59], v[26:27], v[26:27], s[60:61] neg_lo:[1,0,0] neg_hi:[1,0,0]
v_pk_fma_f32 v[60:61], v[28:29], v[28:29], s[60:61] neg_lo:[1,0,0] neg_hi:[1,0,0]
v_pk_fma_f32 v[62:63], v[30:31], v[30:31], s[60:61] neg_lo:[1,0,0] neg_hi:[1,0,0]
v_pk_mul_f32 v[48:49], v[48:49], v[16:17]
v_pk_mul_f32 v[50:51], v[50:51], v[18:19]
v_pk_mul_f32 v[52:53], v[52:53], v[20:21]
v_pk_mul_f32 v[54:55], v[54:55], v[22:23]
v_pk_mul_f32 v[56:57], v[56:57], v[24:25]
v_pk_mul_f32 v[58:59], v[58:59], v[26:27]
v_pk_mul_f32 v[60:61], v[60:61], v[28:29]
v_pk_mul_f32 v[62:63], v[62:63], v[30:31]
v_cvt_pk_bf16_f32 v88, v32, v33
v_cvt_pk_bf16_f32 v89, v34, v35
v_cvt_pk_bf16_f32 v90, v36, v37
v_cvt_pk_bf16_f32 v91, v38, v39
v_cvt_pk_bf16_f32 v92, v40, v41
s_waitcnt lgkmcnt(0)
v_mfma_f32_16x16x32_bf16 v[128:131], a[72:75], v[88:91], v[128:131]
buffer_load_dwordx4 a[16:19], v4, s[24:27], s85 offen offset:3136
v_cvt_pk_bf16_f32 v93, v42, v43
v_cvt_pk_bf16_f32 v94, v44, v45
v_mfma_f32_16x16x32_bf16 v[132:135], a[76:79], v[88:91], v[132:135]
v_cvt_pk_bf16_f32 v95, v46, v47
v_exp_f32 v48, v48
v_mfma_f32_16x16x32_bf16 v[136:139], a[80:83], v[88:91], v[136:139]
v_exp_f32 v49, v49
v_mfma_f32_16x16x32_bf16 v[140:143], a[84:87], v[88:91], v[140:143]
v_exp_f32 v50, v50
v_mfma_f32_16x16x32_bf16 v[144:147], a[88:91], v[88:91], v[144:147]
v_exp_f32 v51, v51
v_mfma_f32_16x16x32_bf16 v[148:151], a[92:95], v[88:91], v[148:151]
v_exp_f32 v52, v52
v_mfma_f32_16x16x32_bf16 v[152:155], a[72:75], v[92:95], v[152:155]
ds_read_b128 a[72:75], v0 offset:12288
v_exp_f32 v53, v53
v_mfma_f32_16x16x32_bf16 v[156:159], a[76:79], v[92:95], v[156:159]
ds_read_b128 a[76:79], v0 offset:12544
v_exp_f32 v54, v54
v_mfma_f32_16x16x32_bf16 v[160:163], a[80:83], v[92:95], v[160:163]
ds_read_b128 a[80:83], v0 offset:14336
v_exp_f32 v55, v55
v_mfma_f32_16x16x32_bf16 v[164:167], a[84:87], v[92:95], v[164:167]
ds_read_b128 a[84:87], v0 offset:14592
v_exp_f32 v56, v56
v_mfma_f32_16x16x32_bf16 v[168:171], a[88:91], v[92:95], v[168:171]
ds_read_b128 a[88:91], v0 offset:16384
v_exp_f32 v57, v57
v_mfma_f32_16x16x32_bf16 v[172:175], a[92:95], v[92:95], v[172:175]
ds_read_b128 a[92:95], v0 offset:16640
v_exp_f32 v58, v58
v_exp_f32 v59, v59
v_exp_f32 v60, v60
v_exp_f32 v61, v61
v_exp_f32 v62, v62
v_exp_f32_e64 v63, v63
v_pk_add_f32 v[48:49], v[48:49], 1.0 op_sel_hi:[1,0]
v_pk_add_f32 v[50:51], v[50:51], 1.0 op_sel_hi:[1,0]
v_pk_add_f32 v[52:53], v[52:53], 1.0 op_sel_hi:[1,0]
v_pk_add_f32 v[54:55], v[54:55], 1.0 op_sel_hi:[1,0]
v_pk_add_f32 v[56:57], v[56:57], 1.0 op_sel_hi:[1,0]
v_pk_add_f32 v[58:59], v[58:59], 1.0 op_sel_hi:[1,0]
v_pk_add_f32 v[60:61], v[60:61], 1.0 op_sel_hi:[1,0]
v_pk_add_f32 v[62:63], v[62:63], 1.0 op_sel_hi:[1,0]
v_mfma_f32_16x16x32_bf16 v[32:35], a[48:51], v[64:67], 0
buffer_load_dwordx4 a[20:23], v4, s[24:27], s85 offen offset:3200
v_rcp_f32 v48, v48
v_mfma_f32_16x16x32_bf16 v[40:43], a[48:51], v[76:79], 0
ds_read_b128 a[48:51], v1 offset:32768
v_rcp_f32 v49, v49
v_mfma_f32_16x16x32_bf16 v[32:35], a[52:55], v[68:71], v[32:35]
v_rcp_f32 v50, v50
v_mfma_f32_16x16x32_bf16 v[40:43], a[52:55], v[80:83], v[40:43]
ds_read_b128 a[52:55], v1 offset:34816
v_rcp_f32 v51, v51
v_mfma_f32_16x16x32_bf16 v[32:35], a[56:59], v[72:75], v[32:35]
v_rcp_f32 v52, v52
v_mfma_f32_16x16x32_bf16 v[40:43], a[56:59], v[84:87], v[40:43]
ds_read_b128 a[56:59], v1 offset:36864
v_rcp_f32 v53, v53
v_mfma_f32_16x16x32_bf16 v[36:39], a[60:63], v[64:67], 0
buffer_load_dwordx4 a[148:151], v253, s[40:43], s81 offen offset:1024 sc1
v_rcp_f32 v54, v54
v_mfma_f32_16x16x32_bf16 v[44:47], a[60:63], v[76:79], 0
ds_read_b128 a[60:63], v1 offset:33024
v_rcp_f32 v55, v55
v_mfma_f32_16x16x32_bf16 v[36:39], a[64:67], v[68:71], v[36:39]
v_rcp_f32 v56, v56
v_mfma_f32_16x16x32_bf16 v[44:47], a[64:67], v[80:83], v[44:47]
ds_read_b128 a[64:67], v1 offset:35072
v_rcp_f32 v57, v57
v_mfma_f32_16x16x32_bf16 v[36:39], a[68:71], v[72:75], v[36:39]
v_rcp_f32 v58, v58
v_mfma_f32_16x16x32_bf16 v[44:47], a[68:71], v[84:87], v[44:47]
ds_read_b128 a[68:71], v1 offset:37120
v_rcp_f32 v59, v59
v_rcp_f32 v60, v60
v_rcp_f32 v61, v61
v_rcp_f32 v62, v62
v_rcp_f32 v63, v63
v_pk_mul_f32 v[16:17], v[48:49], v[16:17]
v_pk_mul_f32 v[18:19], v[50:51], v[18:19]
v_pk_mul_f32 v[20:21], v[52:53], v[20:21]
v_pk_mul_f32 v[22:23], v[54:55], v[22:23]
v_pk_mul_f32 v[24:25], v[56:57], v[24:25]
v_pk_mul_f32 v[26:27], v[58:59], v[26:27]
v_pk_mul_f32 v[28:29], v[60:61], v[28:29]
v_pk_mul_f32 v[30:31], v[62:63], v[30:31]
v_pk_fma_f32 v[48:49], v[32:33], v[32:33], s[60:61] neg_lo:[1,0,0] neg_hi:[1,0,0]
v_pk_fma_f32 v[50:51], v[34:35], v[34:35], s[60:61] neg_lo:[1,0,0] neg_hi:[1,0,0]
v_pk_fma_f32 v[52:53], v[36:37], v[36:37], s[60:61] neg_lo:[1,0,0] neg_hi:[1,0,0]
v_pk_fma_f32 v[54:55], v[38:39], v[38:39], s[60:61] neg_lo:[1,0,0] neg_hi:[1,0,0]
v_pk_fma_f32 v[56:57], v[40:41], v[40:41], s[60:61] neg_lo:[1,0,0] neg_hi:[1,0,0]
v_pk_fma_f32 v[58:59], v[42:43], v[42:43], s[60:61] neg_lo:[1,0,0] neg_hi:[1,0,0]
v_pk_fma_f32 v[60:61], v[44:45], v[44:45], s[60:61] neg_lo:[1,0,0] neg_hi:[1,0,0]
v_pk_fma_f32 v[62:63], v[46:47], v[46:47], s[60:61] neg_lo:[1,0,0] neg_hi:[1,0,0]
v_pk_mul_f32 v[48:49], v[48:49], v[32:33]
v_pk_mul_f32 v[50:51], v[50:51], v[34:35]
v_pk_mul_f32 v[52:53], v[52:53], v[36:37]
v_pk_mul_f32 v[54:55], v[54:55], v[38:39]
v_pk_mul_f32 v[56:57], v[56:57], v[40:41]
v_pk_mul_f32 v[58:59], v[58:59], v[42:43]
v_pk_mul_f32 v[60:61], v[60:61], v[44:45]
v_pk_mul_f32 v[62:63], v[62:63], v[46:47]
v_cvt_pk_bf16_f32 v88, v16, v17
v_cvt_pk_bf16_f32 v89, v18, v19
v_cvt_pk_bf16_f32 v90, v20, v21
v_cvt_pk_bf16_f32 v91, v22, v23
v_cvt_pk_bf16_f32 v92, v24, v25
s_waitcnt lgkmcnt(0)
v_mfma_f32_16x16x32_bf16 v[128:131], a[72:75], v[88:91], v[128:131]
s_mov_b32 s65, 31457280
v_cvt_pk_bf16_f32 v93, v26, v27
v_cvt_pk_bf16_f32 v94, v28, v29
v_mfma_f32_16x16x32_bf16 v[132:135], a[76:79], v[88:91], v[132:135]
v_cvt_pk_bf16_f32 v95, v30, v31
v_exp_f32 v48, v48
v_mfma_f32_16x16x32_bf16 v[136:139], a[80:83], v[88:91], v[136:139]
v_exp_f32 v49, v49
v_mfma_f32_16x16x32_bf16 v[140:143], a[84:87], v[88:91], v[140:143]
v_exp_f32 v50, v50
v_mfma_f32_16x16x32_bf16 v[144:147], a[88:91], v[88:91], v[144:147]
v_exp_f32 v51, v51
v_mfma_f32_16x16x32_bf16 v[148:151], a[92:95], v[88:91], v[148:151]
v_exp_f32 v52, v52
v_mfma_f32_16x16x32_bf16 v[152:155], a[72:75], v[92:95], v[152:155]
ds_read_b128 a[72:75], v0 offset:18432
buffer_store_dwordx4 v[224:227], v4, s[28:31], s65 offen offset:0 sc1
v_mfma_f32_16x16x32_bf16 v[156:159], a[76:79], v[92:95], v[156:159]
ds_read_b128 a[76:79], v0 offset:18688
v_exp_f32 v53, v53
v_mfma_f32_16x16x32_bf16 v[160:163], a[80:83], v[92:95], v[160:163]
ds_read_b128 a[80:83], v0 offset:20480
v_exp_f32 v54, v54
v_mfma_f32_16x16x32_bf16 v[164:167], a[84:87], v[92:95], v[164:167]
ds_read_b128 a[84:87], v0 offset:20736
v_exp_f32 v55, v55
v_mfma_f32_16x16x32_bf16 v[168:171], a[88:91], v[92:95], v[168:171]
ds_read_b128 a[88:91], v0 offset:22528
v_exp_f32 v56, v56
v_mfma_f32_16x16x32_bf16 v[172:175], a[92:95], v[92:95], v[172:175]
ds_read_b128 a[92:95], v0 offset:22784
v_exp_f32 v57, v57
v_exp_f32 v58, v58
v_exp_f32 v59, v59
v_exp_f32 v60, v60
v_exp_f32 v61, v61
v_exp_f32 v62, v62
v_exp_f32_e64 v63, v63
v_pk_add_f32 v[48:49], v[48:49], 1.0 op_sel_hi:[1,0]
v_pk_add_f32 v[50:51], v[50:51], 1.0 op_sel_hi:[1,0]
v_pk_add_f32 v[52:53], v[52:53], 1.0 op_sel_hi:[1,0]
v_pk_add_f32 v[54:55], v[54:55], 1.0 op_sel_hi:[1,0]
v_pk_add_f32 v[56:57], v[56:57], 1.0 op_sel_hi:[1,0]
v_pk_add_f32 v[58:59], v[58:59], 1.0 op_sel_hi:[1,0]
v_pk_add_f32 v[60:61], v[60:61], 1.0 op_sel_hi:[1,0]
v_pk_add_f32 v[62:63], v[62:63], 1.0 op_sel_hi:[1,0]
v_mfma_f32_16x16x32_bf16 v[16:19], a[48:51], v[64:67], 0
s_mov_b32 s64, 18874368
v_rcp_f32 v48, v48
v_mfma_f32_16x16x32_bf16 v[24:27], a[48:51], v[76:79], 0
ds_read_b128 a[48:51], v1 offset:38912
v_rcp_f32 v49, v49
v_mfma_f32_16x16x32_bf16 v[16:19], a[52:55], v[68:71], v[16:19]
v_rcp_f32_e64 v50, v50
v_mfma_f32_16x16x32_bf16 v[24:27], a[52:55], v[80:83], v[24:27]
ds_read_b128 a[52:55], v1 offset:40960
buffer_load_dwordx4 a[240:243], v4, s[24:27], s64 offen offset:0
v_rcp_f32 v51, v51
v_mfma_f32_16x16x32_bf16 v[16:19], a[56:59], v[72:75], v[16:19]
v_rcp_f32 v52, v52
v_mfma_f32_16x16x32_bf16 v[24:27], a[56:59], v[84:87], v[24:27]
ds_read_b128 a[56:59], v1 offset:43008
v_rcp_f32 v53, v53
v_mfma_f32_16x16x32_bf16 v[20:23], a[60:63], v[64:67], 0
s_mov_b32 s84, 37748736
v_rcp_f32 v54, v54
v_mfma_f32_16x16x32_bf16 v[28:31], a[60:63], v[76:79], 0
ds_read_b128 a[60:63], v1 offset:39168
v_rcp_f32 v55, v55
v_mfma_f32_16x16x32_bf16 v[20:23], a[64:67], v[68:71], v[20:23]
v_rcp_f32 v56, v56
v_mfma_f32_16x16x32_bf16 v[28:31], a[64:67], v[80:83], v[28:31]
ds_read_b128 a[64:67], v1 offset:41216
buffer_store_dwordx4 a[96:99], v4, s[28:31], s84 offen offset:0 sc1
v_mfma_f32_16x16x32_bf16 v[20:23], a[68:71], v[72:75], v[20:23]
v_rcp_f32 v57, v57
v_mfma_f32_16x16x32_bf16 v[28:31], a[68:71], v[84:87], v[28:31]
ds_read_b128 a[68:71], v1 offset:43264
v_rcp_f32 v58, v58
v_rcp_f32 v59, v59
v_rcp_f32 v60, v60
v_rcp_f32 v61, v61
v_rcp_f32 v62, v62
v_rcp_f32_e64 v63, v63
v_pk_mul_f32 v[32:33], v[48:49], v[32:33]
v_pk_mul_f32 v[34:35], v[50:51], v[34:35]
v_pk_mul_f32 v[36:37], v[52:53], v[36:37]
v_pk_mul_f32 v[38:39], v[54:55], v[38:39]
v_pk_mul_f32 v[40:41], v[56:57], v[40:41]
v_pk_mul_f32 v[42:43], v[58:59], v[42:43]
v_pk_mul_f32 v[44:45], v[60:61], v[44:45]
v_pk_mul_f32 v[46:47], v[62:63], v[46:47]
v_pk_fma_f32 v[48:49], v[16:17], v[16:17], s[60:61] neg_lo:[1,0,0] neg_hi:[1,0,0]
v_pk_fma_f32 v[50:51], v[18:19], v[18:19], s[60:61] neg_lo:[1,0,0] neg_hi:[1,0,0]
v_pk_fma_f32 v[52:53], v[20:21], v[20:21], s[60:61] neg_lo:[1,0,0] neg_hi:[1,0,0]
v_pk_fma_f32 v[54:55], v[22:23], v[22:23], s[60:61] neg_lo:[1,0,0] neg_hi:[1,0,0]
v_pk_fma_f32 v[56:57], v[24:25], v[24:25], s[60:61] neg_lo:[1,0,0] neg_hi:[1,0,0]
v_pk_fma_f32 v[58:59], v[26:27], v[26:27], s[60:61] neg_lo:[1,0,0] neg_hi:[1,0,0]
v_pk_fma_f32 v[60:61], v[28:29], v[28:29], s[60:61] neg_lo:[1,0,0] neg_hi:[1,0,0]
v_pk_fma_f32 v[62:63], v[30:31], v[30:31], s[60:61] neg_lo:[1,0,0] neg_hi:[1,0,0]
v_pk_mul_f32 v[48:49], v[48:49], v[16:17]
v_pk_mul_f32 v[50:51], v[50:51], v[18:19]
v_pk_mul_f32 v[52:53], v[52:53], v[20:21]
v_pk_mul_f32 v[54:55], v[54:55], v[22:23]
v_pk_mul_f32 v[56:57], v[56:57], v[24:25]
v_pk_mul_f32 v[58:59], v[58:59], v[26:27]
v_pk_mul_f32 v[60:61], v[60:61], v[28:29]
v_pk_mul_f32 v[62:63], v[62:63], v[30:31]
v_cvt_pk_bf16_f32 v88, v32, v33
v_cvt_pk_bf16_f32 v89, v34, v35
v_cvt_pk_bf16_f32 v90, v36, v37
v_cvt_pk_bf16_f32 v91, v38, v39
v_cvt_pk_bf16_f32 v92, v40, v41
s_waitcnt lgkmcnt(0)
v_mfma_f32_16x16x32_bf16 v[128:131], a[72:75], v[88:91], v[128:131]
buffer_store_dwordx4 v[228:231], v4, s[28:31], s65 offen offset:64 sc1
v_cvt_pk_bf16_f32 v93, v42, v43
v_cvt_pk_bf16_f32 v94, v44, v45
v_mfma_f32_16x16x32_bf16 v[132:135], a[76:79], v[88:91], v[132:135]
v_cvt_pk_bf16_f32 v95, v46, v47
v_exp_f32 v48, v48
v_mfma_f32_16x16x32_bf16 v[136:139], a[80:83], v[88:91], v[136:139]
v_exp_f32 v49, v49
v_mfma_f32_16x16x32_bf16 v[140:143], a[84:87], v[88:91], v[140:143]
v_exp_f32 v50, v50
v_mfma_f32_16x16x32_bf16 v[144:147], a[88:91], v[88:91], v[144:147]
v_exp_f32 v51, v51
v_mfma_f32_16x16x32_bf16 v[148:151], a[92:95], v[88:91], v[148:151]
v_exp_f32 v52, v52
v_mfma_f32_16x16x32_bf16 v[152:155], a[72:75], v[92:95], v[152:155]
ds_read_b128 a[72:75], v0 offset:24576
v_exp_f32 v53, v53
v_mfma_f32_16x16x32_bf16 v[156:159], a[76:79], v[92:95], v[156:159]
ds_read_b128 a[76:79], v0 offset:24832
v_exp_f32 v54, v54
v_mfma_f32_16x16x32_bf16 v[160:163], a[80:83], v[92:95], v[160:163]
ds_read_b128 a[80:83], v0 offset:26624
v_exp_f32 v55, v55
v_mfma_f32_16x16x32_bf16 v[164:167], a[84:87], v[92:95], v[164:167]
ds_read_b128 a[84:87], v0 offset:26880
v_exp_f32 v56, v56
v_mfma_f32_16x16x32_bf16 v[168:171], a[88:91], v[92:95], v[168:171]
ds_read_b128 a[88:91], v0 offset:28672
v_exp_f32 v57, v57
v_mfma_f32_16x16x32_bf16 v[172:175], a[92:95], v[92:95], v[172:175]
ds_read_b128 a[92:95], v0 offset:28928
v_exp_f32 v58, v58
v_exp_f32 v59, v59
v_exp_f32 v60, v60
v_exp_f32 v61, v61
v_exp_f32 v62, v62
v_exp_f32_e64 v63, v63
v_pk_add_f32 v[48:49], v[48:49], 1.0 op_sel_hi:[1,0]
v_pk_add_f32 v[50:51], v[50:51], 1.0 op_sel_hi:[1,0]
v_pk_add_f32 v[52:53], v[52:53], 1.0 op_sel_hi:[1,0]
v_pk_add_f32 v[54:55], v[54:55], 1.0 op_sel_hi:[1,0]
v_pk_add_f32 v[56:57], v[56:57], 1.0 op_sel_hi:[1,0]
v_pk_add_f32 v[58:59], v[58:59], 1.0 op_sel_hi:[1,0]
v_pk_add_f32 v[60:61], v[60:61], 1.0 op_sel_hi:[1,0]
v_pk_add_f32 v[62:63], v[62:63], 1.0 op_sel_hi:[1,0]
v_mfma_f32_16x16x32_bf16 v[32:35], a[48:51], v[64:67], 0
buffer_store_dwordx4 a[100:103], v4, s[28:31], s84 offen offset:64 sc1
v_rcp_f32 v48, v48
v_mfma_f32_16x16x32_bf16 v[40:43], a[48:51], v[76:79], 0
ds_read_b128 a[48:51], v1 offset:45056
v_rcp_f32 v49, v49
v_mfma_f32_16x16x32_bf16 v[32:35], a[52:55], v[68:71], v[32:35]
v_rcp_f32 v50, v50
v_mfma_f32_16x16x32_bf16 v[40:43], a[52:55], v[80:83], v[40:43]
ds_read_b128 a[52:55], v1 offset:47104
v_rcp_f32 v51, v51
v_mfma_f32_16x16x32_bf16 v[32:35], a[56:59], v[72:75], v[32:35]
v_rcp_f32 v52, v52
v_mfma_f32_16x16x32_bf16 v[40:43], a[56:59], v[84:87], v[40:43]
ds_read_b128 a[56:59], v1 offset:49152
v_rcp_f32 v53, v53
v_mfma_f32_16x16x32_bf16 v[36:39], a[60:63], v[64:67], 0
v_rcp_f32 v54, v54
v_mfma_f32_16x16x32_bf16 v[44:47], a[60:63], v[76:79], 0
ds_read_b128 a[60:63], v1 offset:45312
v_rcp_f32 v55, v55
v_mfma_f32_16x16x32_bf16 v[36:39], a[64:67], v[68:71], v[36:39]
v_rcp_f32 v56, v56
v_mfma_f32_16x16x32_bf16 v[44:47], a[64:67], v[80:83], v[44:47]
ds_read_b128 a[64:67], v1 offset:47360
v_rcp_f32 v57, v57
v_mfma_f32_16x16x32_bf16 v[36:39], a[68:71], v[72:75], v[36:39]
v_rcp_f32 v58, v58
v_mfma_f32_16x16x32_bf16 v[44:47], a[68:71], v[84:87], v[44:47]
ds_read_b128 a[68:71], v1 offset:49408
v_rcp_f32 v59, v59
v_rcp_f32 v60, v60
v_rcp_f32 v61, v61
v_rcp_f32 v62, v62
v_rcp_f32 v63, v63
v_pk_mul_f32 v[16:17], v[48:49], v[16:17]
v_pk_mul_f32 v[18:19], v[50:51], v[18:19]
v_pk_mul_f32 v[20:21], v[52:53], v[20:21]
v_pk_mul_f32 v[22:23], v[54:55], v[22:23]
v_pk_mul_f32 v[24:25], v[56:57], v[24:25]
v_pk_mul_f32 v[26:27], v[58:59], v[26:27]
v_pk_mul_f32 v[28:29], v[60:61], v[28:29]
v_pk_mul_f32 v[30:31], v[62:63], v[30:31]
v_pk_fma_f32 v[48:49], v[32:33], v[32:33], s[60:61] neg_lo:[1,0,0] neg_hi:[1,0,0]
v_pk_fma_f32 v[50:51], v[34:35], v[34:35], s[60:61] neg_lo:[1,0,0] neg_hi:[1,0,0]
v_pk_fma_f32 v[52:53], v[36:37], v[36:37], s[60:61] neg_lo:[1,0,0] neg_hi:[1,0,0]
v_pk_fma_f32 v[54:55], v[38:39], v[38:39], s[60:61] neg_lo:[1,0,0] neg_hi:[1,0,0]
v_pk_fma_f32 v[56:57], v[40:41], v[40:41], s[60:61] neg_lo:[1,0,0] neg_hi:[1,0,0]
v_pk_fma_f32 v[58:59], v[42:43], v[42:43], s[60:61] neg_lo:[1,0,0] neg_hi:[1,0,0]
v_pk_fma_f32 v[60:61], v[44:45], v[44:45], s[60:61] neg_lo:[1,0,0] neg_hi:[1,0,0]
v_pk_fma_f32 v[62:63], v[46:47], v[46:47], s[60:61] neg_lo:[1,0,0] neg_hi:[1,0,0]
v_pk_mul_f32 v[48:49], v[48:49], v[32:33]
v_pk_mul_f32 v[50:51], v[50:51], v[34:35]
v_pk_mul_f32 v[52:53], v[52:53], v[36:37]
v_pk_mul_f32 v[54:55], v[54:55], v[38:39]
v_pk_mul_f32 v[56:57], v[56:57], v[40:41]
v_pk_mul_f32 v[58:59], v[58:59], v[42:43]
v_pk_mul_f32 v[60:61], v[60:61], v[44:45]
v_pk_mul_f32 v[62:63], v[62:63], v[46:47]
v_cvt_pk_bf16_f32 v88, v16, v17
v_cvt_pk_bf16_f32 v89, v18, v19
v_cvt_pk_bf16_f32 v90, v20, v21
v_cvt_pk_bf16_f32 v91, v22, v23
v_cvt_pk_bf16_f32 v92, v24, v25
s_waitcnt lgkmcnt(0)
v_mfma_f32_16x16x32_bf16 v[128:131], a[72:75], v[88:91], v[128:131]
buffer_store_dwordx4 v[232:235], v4, s[28:31], s65 offen offset:128 sc1
v_cvt_pk_bf16_f32 v93, v26, v27
v_cvt_pk_bf16_f32 v94, v28, v29
v_mfma_f32_16x16x32_bf16 v[132:135], a[76:79], v[88:91], v[132:135]
v_cvt_pk_bf16_f32 v95, v30, v31
v_exp_f32 v48, v48
v_mfma_f32_16x16x32_bf16 v[136:139], a[80:83], v[88:91], v[136:139]
buffer_load_dwordx4 a[244:247], v4, s[24:27], s64 offen offset:64
v_exp_f32 v49, v49
v_mfma_f32_16x16x32_bf16 v[140:143], a[84:87], v[88:91], v[140:143]
v_exp_f32 v50, v50
v_mfma_f32_16x16x32_bf16 v[144:147], a[88:91], v[88:91], v[144:147]
buffer_store_dwordx4 a[104:107], v4, s[28:31], s84 offen offset:128 sc1
v_exp_f32 v51, v51
v_mfma_f32_16x16x32_bf16 v[148:151], a[92:95], v[88:91], v[148:151]
v_exp_f32 v52, v52
v_mfma_f32_16x16x32_bf16 v[152:155], a[72:75], v[92:95], v[152:155]
ds_read_b128 a[72:75], v0 offset:30720
v_exp_f32_e64 v53, v53
v_mfma_f32_16x16x32_bf16 v[156:159], a[76:79], v[92:95], v[156:159]
ds_read_b128 a[76:79], v0 offset:30976
s_add_u32 s81, s80, 20480
v_mfma_f32_16x16x32_bf16 v[160:163], a[80:83], v[92:95], v[160:163]
ds_read_b128 a[80:83], v0 offset:32768
v_exp_f32_e64 v54, v54
v_mfma_f32_16x16x32_bf16 v[164:167], a[84:87], v[92:95], v[164:167]
ds_read_b128 a[84:87], v0 offset:33024
buffer_load_dwordx4 a[152:155], v253, s[40:43], s81 offen offset:0 sc1
v_exp_f32 v55, v55
v_mfma_f32_16x16x32_bf16 v[168:171], a[88:91], v[92:95], v[168:171]
ds_read_b128 a[88:91], v0 offset:34816
v_exp_f32 v56, v56
v_mfma_f32_16x16x32_bf16 v[172:175], a[92:95], v[92:95], v[172:175]
ds_read_b128 a[92:95], v0 offset:35072
v_exp_f32 v57, v57
v_exp_f32 v58, v58
v_exp_f32 v59, v59
v_exp_f32 v60, v60
v_exp_f32 v61, v61
v_exp_f32 v62, v62
v_exp_f32_e64 v63, v63
v_pk_add_f32 v[48:49], v[48:49], 1.0 op_sel_hi:[1,0]
v_pk_add_f32 v[50:51], v[50:51], 1.0 op_sel_hi:[1,0]
v_pk_add_f32 v[52:53], v[52:53], 1.0 op_sel_hi:[1,0]
v_pk_add_f32 v[54:55], v[54:55], 1.0 op_sel_hi:[1,0]
v_pk_add_f32 v[56:57], v[56:57], 1.0 op_sel_hi:[1,0]
v_pk_add_f32 v[58:59], v[58:59], 1.0 op_sel_hi:[1,0]
v_pk_add_f32 v[60:61], v[60:61], 1.0 op_sel_hi:[1,0]
v_pk_add_f32 v[62:63], v[62:63], 1.0 op_sel_hi:[1,0]
v_mfma_f32_16x16x32_bf16 v[16:19], a[48:51], v[64:67], 0
v_rcp_f32 v48, v48
v_mfma_f32_16x16x32_bf16 v[24:27], a[48:51], v[76:79], 0
ds_read_b128 a[48:51], v1 offset:51200
v_rcp_f32 v49, v49
v_mfma_f32_16x16x32_bf16 v[16:19], a[52:55], v[68:71], v[16:19]
v_mfma_f32_16x16x32_bf16 v[24:27], a[52:55], v[80:83], v[24:27]
ds_read_b128 a[52:55], v1 offset:53248
v_rcp_f32 v50, v50
v_mfma_f32_16x16x32_bf16 v[16:19], a[56:59], v[72:75], v[16:19]
v_rcp_f32 v51, v51
v_mfma_f32_16x16x32_bf16 v[24:27], a[56:59], v[84:87], v[24:27]
ds_read_b128 a[56:59], v1 offset:55296
v_rcp_f32 v52, v52
v_mfma_f32_16x16x32_bf16 v[20:23], a[60:63], v[64:67], 0
v_rcp_f32 v53, v53
v_mfma_f32_16x16x32_bf16 v[28:31], a[60:63], v[76:79], 0
ds_read_b128 a[60:63], v1 offset:51456
v_mfma_f32_16x16x32_bf16 v[20:23], a[64:67], v[68:71], v[20:23]
v_rcp_f32 v54, v54
v_mfma_f32_16x16x32_bf16 v[28:31], a[64:67], v[80:83], v[28:31]
ds_read_b128 a[64:67], v1 offset:53504
v_rcp_f32 v55, v55
v_mfma_f32_16x16x32_bf16 v[20:23], a[68:71], v[72:75], v[20:23]
v_rcp_f32 v56, v56
v_mfma_f32_16x16x32_bf16 v[28:31], a[68:71], v[84:87], v[28:31]
ds_read_b128 a[68:71], v1 offset:55552
v_rcp_f32 v57, v57
s_waitcnt vmcnt(15)
v_mfma_f32_16x16x32_bf16 v[176:179], a[24:27], a[0:3], 0
v_mfma_f32_16x16x32_bf16 v[180:183], a[28:31], a[0:3], 0
v_rcp_f32 v58, v58
v_mfma_f32_16x16x32_bf16 v[184:187], a[32:35], a[4:7], 0
v_rcp_f32 v59, v59
v_mfma_f32_16x16x32_bf16 v[188:191], a[36:39], a[4:7], 0
v_rcp_f32 v60, v60
s_waitcnt vmcnt(13)
v_mfma_f32_16x16x32_bf16 v[192:195], a[40:43], a[8:11], 0
v_rcp_f32 v61, v61
v_mfma_f32_16x16x32_bf16 v[196:199], a[44:47], a[8:11], 0
v_rcp_f32 v62, v62
v_rcp_f32 v63, v63
v_pk_mul_f32 v[32:33], v[48:49], v[32:33]
v_pk_mul_f32 v[34:35], v[50:51], v[34:35]
v_pk_mul_f32 v[36:37], v[52:53], v[36:37]
v_pk_mul_f32 v[38:39], v[54:55], v[38:39]
v_pk_mul_f32 v[40:41], v[56:57], v[40:41]
v_pk_mul_f32 v[42:43], v[58:59], v[42:43]
v_pk_mul_f32 v[44:45], v[60:61], v[44:45]
v_pk_mul_f32 v[46:47], v[62:63], v[46:47]
v_pk_fma_f32 v[48:49], v[16:17], v[16:17], s[60:61] neg_lo:[1,0,0] neg_hi:[1,0,0]
v_pk_fma_f32 v[50:51], v[18:19], v[18:19], s[60:61] neg_lo:[1,0,0] neg_hi:[1,0,0]
v_pk_fma_f32 v[52:53], v[20:21], v[20:21], s[60:61] neg_lo:[1,0,0] neg_hi:[1,0,0]
v_pk_fma_f32 v[54:55], v[22:23], v[22:23], s[60:61] neg_lo:[1,0,0] neg_hi:[1,0,0]
v_pk_fma_f32 v[56:57], v[24:25], v[24:25], s[60:61] neg_lo:[1,0,0] neg_hi:[1,0,0]
v_pk_fma_f32 v[58:59], v[26:27], v[26:27], s[60:61] neg_lo:[1,0,0] neg_hi:[1,0,0]
v_pk_fma_f32 v[60:61], v[28:29], v[28:29], s[60:61] neg_lo:[1,0,0] neg_hi:[1,0,0]
v_pk_fma_f32 v[62:63], v[30:31], v[30:31], s[60:61] neg_lo:[1,0,0] neg_hi:[1,0,0]
v_pk_mul_f32 v[48:49], v[48:49], v[16:17]
v_pk_mul_f32 v[50:51], v[50:51], v[18:19]
v_pk_mul_f32 v[52:53], v[52:53], v[20:21]
v_pk_mul_f32 v[54:55], v[54:55], v[22:23]
v_pk_mul_f32 v[56:57], v[56:57], v[24:25]
v_pk_mul_f32 v[58:59], v[58:59], v[26:27]
v_pk_mul_f32 v[60:61], v[60:61], v[28:29]
v_pk_mul_f32 v[62:63], v[62:63], v[30:31]
v_cvt_pk_bf16_f32 v88, v32, v33
v_cvt_pk_bf16_f32 v89, v34, v35
v_cvt_pk_bf16_f32 v90, v36, v37
v_cvt_pk_bf16_f32 v91, v38, v39
v_cvt_pk_bf16_f32 v92, v40, v41
s_waitcnt lgkmcnt(0)
v_mfma_f32_16x16x32_bf16 v[128:131], a[72:75], v[88:91], v[128:131]
buffer_store_dwordx4 v[236:239], v4, s[28:31], s65 offen offset:3072 sc1
v_cvt_pk_bf16_f32 v93, v42, v43
v_cvt_pk_bf16_f32 v94, v44, v45
v_mfma_f32_16x16x32_bf16 v[132:135], a[76:79], v[88:91], v[132:135]
v_cvt_pk_bf16_f32 v95, v46, v47
v_mfma_f32_16x16x32_bf16 v[136:139], a[80:83], v[88:91], v[136:139]
v_exp_f32 v48, v48
v_mfma_f32_16x16x32_bf16 v[140:143], a[84:87], v[88:91], v[140:143]
v_exp_f32 v49, v49
v_mfma_f32_16x16x32_bf16 v[144:147], a[88:91], v[88:91], v[144:147]
v_exp_f32 v50, v50
v_mfma_f32_16x16x32_bf16 v[148:151], a[92:95], v[88:91], v[148:151]
v_exp_f32 v51, v51
v_mfma_f32_16x16x32_bf16 v[152:155], a[72:75], v[92:95], v[152:155]
ds_read_b128 a[72:75], v0 offset:36864
v_exp_f32 v52, v52
v_mfma_f32_16x16x32_bf16 v[156:159], a[76:79], v[92:95], v[156:159]
ds_read_b128 a[76:79], v0 offset:37120
v_exp_f32 v53, v53
v_mfma_f32_16x16x32_bf16 v[160:163], a[80:83], v[92:95], v[160:163]
ds_read_b128 a[80:83], v0 offset:38912
v_exp_f32 v54, v54
v_mfma_f32_16x16x32_bf16 v[164:167], a[84:87], v[92:95], v[164:167]
ds_read_b128 a[84:87], v0 offset:39168
buffer_store_dwordx4 a[108:111], v4, s[28:31], s84 offen offset:3072 sc1
v_mfma_f32_16x16x32_bf16 v[168:171], a[88:91], v[92:95], v[168:171]
ds_read_b128 a[88:91], v0 offset:40960
v_exp_f32 v55, v55
v_mfma_f32_16x16x32_bf16 v[172:175], a[92:95], v[92:95], v[172:175]
ds_read_b128 a[92:95], v0 offset:41216
v_exp_f32 v56, v56
s_waitcnt vmcnt(14)
v_mfma_f32_16x16x32_bf16 v[200:203], a[24:27], a[12:15], 0
v_exp_f32 v57, v57
v_mfma_f32_16x16x32_bf16 v[204:207], a[28:31], a[12:15], 0
v_exp_f32 v58, v58
s_waitcnt vmcnt(13)
v_mfma_f32_16x16x32_bf16 v[208:211], a[32:35], a[16:19], 0
v_exp_f32 v59, v59
v_mfma_f32_16x16x32_bf16 v[212:215], a[36:39], a[16:19], 0
v_exp_f32 v60, v60
s_waitcnt vmcnt(12)
v_mfma_f32_16x16x32_bf16 v[216:219], a[40:43], a[20:23], 0
v_exp_f32 v61, v61
v_mfma_f32_16x16x32_bf16 v[220:223], a[44:47], a[20:23], 0
v_exp_f32 v62, v62
v_exp_f32 v63, v63
v_pk_add_f32 v[48:49], v[48:49], 1.0 op_sel_hi:[1,0]
v_pk_add_f32 v[50:51], v[50:51], 1.0 op_sel_hi:[1,0]
v_pk_add_f32 v[52:53], v[52:53], 1.0 op_sel_hi:[1,0]
v_pk_add_f32 v[54:55], v[54:55], 1.0 op_sel_hi:[1,0]
v_pk_add_f32 v[56:57], v[56:57], 1.0 op_sel_hi:[1,0]
v_pk_add_f32 v[58:59], v[58:59], 1.0 op_sel_hi:[1,0]
v_pk_add_f32 v[60:61], v[60:61], 1.0 op_sel_hi:[1,0]
v_pk_add_f32 v[62:63], v[62:63], 1.0 op_sel_hi:[1,0]
v_mfma_f32_16x16x32_bf16 v[32:35], a[48:51], v[64:67], 0
buffer_load_dwordx4 a[248:251], v4, s[24:27], s64 offen offset:128
v_rcp_f32 v48, v48
v_mfma_f32_16x16x32_bf16 v[40:43], a[48:51], v[76:79], 0
ds_read_b128 a[48:51], v1 offset:57344
v_rcp_f32 v49, v49
v_mfma_f32_16x16x32_bf16 v[32:35], a[52:55], v[68:71], v[32:35]
v_rcp_f32 v50, v50
v_mfma_f32_16x16x32_bf16 v[40:43], a[52:55], v[80:83], v[40:43]
ds_read_b128 a[52:55], v1 offset:59392
v_rcp_f32 v51, v51
v_mfma_f32_16x16x32_bf16 v[32:35], a[56:59], v[72:75], v[32:35]
v_rcp_f32 v52, v52
v_mfma_f32_16x16x32_bf16 v[40:43], a[56:59], v[84:87], v[40:43]
ds_read_b128 a[56:59], v1 offset:61440
v_rcp_f32 v53, v53
v_mfma_f32_16x16x32_bf16 v[36:39], a[60:63], v[64:67], 0
buffer_store_dwordx4 a[112:115], v4, s[28:31], s84 offen offset:3136 sc1
v_rcp_f32 v54, v54
v_mfma_f32_16x16x32_bf16 v[44:47], a[60:63], v[76:79], 0
ds_read_b128 a[60:63], v1 offset:57600
v_rcp_f32 v55, v55
v_mfma_f32_16x16x32_bf16 v[36:39], a[64:67], v[68:71], v[36:39]
v_rcp_f32 v56, v56
v_mfma_f32_16x16x32_bf16 v[44:47], a[64:67], v[80:83], v[44:47]
ds_read_b128 a[64:67], v1 offset:59648
v_rcp_f32 v57, v57
v_mfma_f32_16x16x32_bf16 v[36:39], a[68:71], v[72:75], v[36:39]
v_rcp_f32 v58, v58
v_mfma_f32_16x16x32_bf16 v[44:47], a[68:71], v[84:87], v[44:47]
ds_read_b128 a[68:71], v1 offset:61696
v_rcp_f32 v59, v59
v_rcp_f32 v60, v60
v_rcp_f32 v61, v61
v_rcp_f32 v62, v62
v_rcp_f32 v63, v63
v_pk_mul_f32 v[16:17], v[48:49], v[16:17]
v_pk_mul_f32 v[18:19], v[50:51], v[18:19]
v_pk_mul_f32 v[20:21], v[52:53], v[20:21]
v_pk_mul_f32 v[22:23], v[54:55], v[22:23]
v_pk_mul_f32 v[24:25], v[56:57], v[24:25]
v_pk_mul_f32 v[26:27], v[58:59], v[26:27]
v_pk_mul_f32 v[28:29], v[60:61], v[28:29]
v_pk_mul_f32 v[30:31], v[62:63], v[30:31]
v_pk_fma_f32 v[48:49], v[32:33], v[32:33], s[60:61] neg_lo:[1,0,0] neg_hi:[1,0,0]
v_pk_fma_f32 v[50:51], v[34:35], v[34:35], s[60:61] neg_lo:[1,0,0] neg_hi:[1,0,0]
v_pk_fma_f32 v[52:53], v[36:37], v[36:37], s[60:61] neg_lo:[1,0,0] neg_hi:[1,0,0]
v_pk_fma_f32 v[54:55], v[38:39], v[38:39], s[60:61] neg_lo:[1,0,0] neg_hi:[1,0,0]
v_pk_fma_f32 v[56:57], v[40:41], v[40:41], s[60:61] neg_lo:[1,0,0] neg_hi:[1,0,0]
v_pk_fma_f32 v[58:59], v[42:43], v[42:43], s[60:61] neg_lo:[1,0,0] neg_hi:[1,0,0]
v_pk_fma_f32 v[60:61], v[44:45], v[44:45], s[60:61] neg_lo:[1,0,0] neg_hi:[1,0,0]
v_pk_fma_f32 v[62:63], v[46:47], v[46:47], s[60:61] neg_lo:[1,0,0] neg_hi:[1,0,0]
v_pk_mul_f32 v[48:49], v[48:49], v[32:33]
v_pk_mul_f32 v[50:51], v[50:51], v[34:35]
v_pk_mul_f32 v[52:53], v[52:53], v[36:37]
v_pk_mul_f32 v[54:55], v[54:55], v[38:39]
v_pk_mul_f32 v[56:57], v[56:57], v[40:41]
v_pk_mul_f32 v[58:59], v[58:59], v[42:43]
v_pk_mul_f32 v[60:61], v[60:61], v[44:45]
v_pk_mul_f32 v[62:63], v[62:63], v[46:47]
v_pk_fma_f32 v[176:177], v[176:177], v[248:249], v[248:249] op_sel:[0,0,1] op_sel_hi:[1,0,1] neg_lo:[0,0,1] neg_hi:[0,0,1]
v_pk_fma_f32 v[178:179], v[178:179], v[248:249], v[248:249] op_sel:[0,0,1] op_sel_hi:[1,0,1] neg_lo:[0,0,1] neg_hi:[0,0,1]
v_pk_fma_f32 v[180:181], v[180:181], v[248:249], v[248:249] op_sel:[0,0,1] op_sel_hi:[1,0,1] neg_lo:[0,0,1] neg_hi:[0,0,1]
v_pk_fma_f32 v[182:183], v[182:183], v[248:249], v[248:249] op_sel:[0,0,1] op_sel_hi:[1,0,1] neg_lo:[0,0,1] neg_hi:[0,0,1]
v_pk_fma_f32 v[184:185], v[184:185], v[248:249], v[248:249] op_sel:[0,0,1] op_sel_hi:[1,0,1] neg_lo:[0,0,1] neg_hi:[0,0,1]
v_pk_fma_f32 v[186:187], v[186:187], v[248:249], v[248:249] op_sel:[0,0,1] op_sel_hi:[1,0,1] neg_lo:[0,0,1] neg_hi:[0,0,1]
v_pk_fma_f32 v[188:189], v[188:189], v[248:249], v[248:249] op_sel:[0,0,1] op_sel_hi:[1,0,1] neg_lo:[0,0,1] neg_hi:[0,0,1]
v_pk_fma_f32 v[190:191], v[190:191], v[248:249], v[248:249] op_sel:[0,0,1] op_sel_hi:[1,0,1] neg_lo:[0,0,1] neg_hi:[0,0,1]
v_pk_fma_f32 v[192:193], v[192:193], v[248:249], v[248:249] op_sel:[0,0,1] op_sel_hi:[1,0,1] neg_lo:[0,0,1] neg_hi:[0,0,1]
v_pk_fma_f32 v[194:195], v[194:195], v[248:249], v[248:249] op_sel:[0,0,1] op_sel_hi:[1,0,1] neg_lo:[0,0,1] neg_hi:[0,0,1]
v_pk_fma_f32 v[196:197], v[196:197], v[248:249], v[248:249] op_sel:[0,0,1] op_sel_hi:[1,0,1] neg_lo:[0,0,1] neg_hi:[0,0,1]
v_pk_fma_f32 v[198:199], v[198:199], v[248:249], v[248:249] op_sel:[0,0,1] op_sel_hi:[1,0,1] neg_lo:[0,0,1] neg_hi:[0,0,1]
v_cvt_pk_bf16_f32 v88, v16, v17
v_cvt_pk_bf16_f32 v89, v18, v19
v_cvt_pk_bf16_f32 v90, v20, v21
v_cvt_pk_bf16_f32 v91, v22, v23
v_cvt_pk_bf16_f32 v92, v24, v25
s_waitcnt lgkmcnt(0)
v_mfma_f32_16x16x32_bf16 v[128:131], a[72:75], v[88:91], v[128:131]
buffer_store_dwordx4 v[240:243], v4, s[28:31], s65 offen offset:3136 sc1
v_cvt_pk_bf16_f32 v93, v26, v27
v_cvt_pk_bf16_f32 v94, v28, v29
v_mfma_f32_16x16x32_bf16 v[132:135], a[76:79], v[88:91], v[132:135]
v_cvt_pk_bf16_f32 v95, v30, v31
v_exp_f32 v48, v48
v_mfma_f32_16x16x32_bf16 v[136:139], a[80:83], v[88:91], v[136:139]
v_exp_f32 v49, v49
v_mfma_f32_16x16x32_bf16 v[140:143], a[84:87], v[88:91], v[140:143]
v_exp_f32 v50, v50
v_mfma_f32_16x16x32_bf16 v[144:147], a[88:91], v[88:91], v[144:147]
v_exp_f32 v51, v51
v_mfma_f32_16x16x32_bf16 v[148:151], a[92:95], v[88:91], v[148:151]
v_exp_f32 v52, v52
v_mfma_f32_16x16x32_bf16 v[152:155], a[72:75], v[92:95], v[152:155]
ds_read_b128 a[72:75], v0 offset:43008
buffer_load_dwordx4 a[156:159], v253, s[40:43], s81 offen offset:1024 sc1
v_mfma_f32_16x16x32_bf16 v[156:159], a[76:79], v[92:95], v[156:159]
ds_read_b128 a[76:79], v0 offset:43264
v_exp_f32 v53, v53
v_mfma_f32_16x16x32_bf16 v[160:163], a[80:83], v[92:95], v[160:163]
ds_read_b128 a[80:83], v0 offset:45056
v_exp_f32 v54, v54
v_mfma_f32_16x16x32_bf16 v[164:167], a[84:87], v[92:95], v[164:167]
ds_read_b128 a[84:87], v0 offset:45312
v_exp_f32 v55, v55
v_mfma_f32_16x16x32_bf16 v[168:171], a[88:91], v[92:95], v[168:171]
ds_read_b128 a[88:91], v0 offset:47104
v_exp_f32 v56, v56
v_mfma_f32_16x16x32_bf16 v[172:175], a[92:95], v[92:95], v[172:175]
ds_read_b128 a[92:95], v0 offset:47360
v_exp_f32 v57, v57
v_exp_f32 v58, v58
v_exp_f32 v59, v59
v_exp_f32 v60, v60
v_exp_f32 v61, v61
v_exp_f32 v62, v62
v_exp_f32_e64 v63, v63
v_pk_add_f32 v[48:49], v[48:49], 1.0 op_sel_hi:[1,0]
v_pk_add_f32 v[50:51], v[50:51], 1.0 op_sel_hi:[1,0]
v_pk_add_f32 v[52:53], v[52:53], 1.0 op_sel_hi:[1,0]
v_pk_add_f32 v[54:55], v[54:55], 1.0 op_sel_hi:[1,0]
v_pk_add_f32 v[56:57], v[56:57], 1.0 op_sel_hi:[1,0]
v_pk_add_f32 v[58:59], v[58:59], 1.0 op_sel_hi:[1,0]
v_pk_add_f32 v[60:61], v[60:61], 1.0 op_sel_hi:[1,0]
v_pk_add_f32 v[62:63], v[62:63], 1.0 op_sel_hi:[1,0]
v_mfma_f32_16x16x32_bf16 v[16:19], a[48:51], v[64:67], 0
buffer_store_dwordx4 a[116:119], v4, s[28:31], s84 offen offset:3200 sc1
v_rcp_f32 v48, v48
v_mfma_f32_16x16x32_bf16 v[24:27], a[48:51], v[76:79], 0
ds_read_b128 a[48:51], v1 offset:63488
v_rcp_f32 v49, v49
v_mfma_f32_16x16x32_bf16 v[16:19], a[52:55], v[68:71], v[16:19]
v_rcp_f32 v50, v50
v_mfma_f32_16x16x32_bf16 v[24:27], a[52:55], v[80:83], v[24:27]
ds_read_b128 a[52:55], v7 offset:0
v_rcp_f32 v51, v51
v_mfma_f32_16x16x32_bf16 v[16:19], a[56:59], v[72:75], v[16:19]
v_rcp_f32 v52, v52
v_mfma_f32_16x16x32_bf16 v[24:27], a[56:59], v[84:87], v[24:27]
ds_read_b128 a[56:59], v7 offset:2048
v_rcp_f32 v53, v53
v_mfma_f32_16x16x32_bf16 v[20:23], a[60:63], v[64:67], 0
v_rcp_f32 v54, v54
v_mfma_f32_16x16x32_bf16 v[28:31], a[60:63], v[76:79], 0
ds_read_b128 a[60:63], v1 offset:63744
v_rcp_f32 v55, v55
v_mfma_f32_16x16x32_bf16 v[20:23], a[64:67], v[68:71], v[20:23]
v_rcp_f32 v56, v56
v_mfma_f32_16x16x32_bf16 v[28:31], a[64:67], v[80:83], v[28:31]
ds_read_b128 a[64:67], v7 offset:256
v_rcp_f32 v57, v57
v_mfma_f32_16x16x32_bf16 v[20:23], a[68:71], v[72:75], v[20:23]
v_rcp_f32 v58, v58
v_mfma_f32_16x16x32_bf16 v[28:31], a[68:71], v[84:87], v[28:31]
ds_read_b128 a[68:71], v7 offset:2304
v_rcp_f32 v59, v59
v_rcp_f32 v60, v60
v_rcp_f32 v61, v61
v_rcp_f32 v62, v62
v_rcp_f32 v63, v63
v_pk_mul_f32 v[32:33], v[48:49], v[32:33]
v_pk_mul_f32 v[34:35], v[50:51], v[34:35]
v_pk_mul_f32 v[36:37], v[52:53], v[36:37]
v_pk_mul_f32 v[38:39], v[54:55], v[38:39]
v_pk_mul_f32 v[40:41], v[56:57], v[40:41]
v_pk_mul_f32 v[42:43], v[58:59], v[42:43]
v_pk_mul_f32 v[44:45], v[60:61], v[44:45]
v_pk_mul_f32 v[46:47], v[62:63], v[46:47]
v_pk_fma_f32 v[48:49], v[16:17], v[16:17], s[60:61] neg_lo:[1,0,0] neg_hi:[1,0,0]
v_pk_fma_f32 v[50:51], v[18:19], v[18:19], s[60:61] neg_lo:[1,0,0] neg_hi:[1,0,0]
v_pk_fma_f32 v[52:53], v[20:21], v[20:21], s[60:61] neg_lo:[1,0,0] neg_hi:[1,0,0]
v_pk_fma_f32 v[54:55], v[22:23], v[22:23], s[60:61] neg_lo:[1,0,0] neg_hi:[1,0,0]
v_pk_fma_f32 v[56:57], v[24:25], v[24:25], s[60:61] neg_lo:[1,0,0] neg_hi:[1,0,0]
v_pk_fma_f32 v[58:59], v[26:27], v[26:27], s[60:61] neg_lo:[1,0,0] neg_hi:[1,0,0]
v_pk_fma_f32 v[60:61], v[28:29], v[28:29], s[60:61] neg_lo:[1,0,0] neg_hi:[1,0,0]
v_pk_fma_f32 v[62:63], v[30:31], v[30:31], s[60:61] neg_lo:[1,0,0] neg_hi:[1,0,0]
v_pk_mul_f32 v[48:49], v[48:49], v[16:17]
v_pk_mul_f32 v[50:51], v[50:51], v[18:19]
v_pk_mul_f32 v[52:53], v[52:53], v[20:21]
v_pk_mul_f32 v[54:55], v[54:55], v[22:23]
v_pk_mul_f32 v[56:57], v[56:57], v[24:25]
v_pk_mul_f32 v[58:59], v[58:59], v[26:27]
v_pk_mul_f32 v[60:61], v[60:61], v[28:29]
v_pk_mul_f32 v[62:63], v[62:63], v[30:31]
v_pk_fma_f32 v[200:201], v[200:201], v[250:251], v[250:251] op_sel:[0,0,1] op_sel_hi:[1,0,1] neg_lo:[0,0,1] neg_hi:[0,0,1]
v_pk_fma_f32 v[202:203], v[202:203], v[250:251], v[250:251] op_sel:[0,0,1] op_sel_hi:[1,0,1] neg_lo:[0,0,1] neg_hi:[0,0,1]
v_pk_fma_f32 v[204:205], v[204:205], v[250:251], v[250:251] op_sel:[0,0,1] op_sel_hi:[1,0,1] neg_lo:[0,0,1] neg_hi:[0,0,1]
v_pk_fma_f32 v[206:207], v[206:207], v[250:251], v[250:251] op_sel:[0,0,1] op_sel_hi:[1,0,1] neg_lo:[0,0,1] neg_hi:[0,0,1]
v_pk_fma_f32 v[208:209], v[208:209], v[250:251], v[250:251] op_sel:[0,0,1] op_sel_hi:[1,0,1] neg_lo:[0,0,1] neg_hi:[0,0,1]
v_pk_fma_f32 v[210:211], v[210:211], v[250:251], v[250:251] op_sel:[0,0,1] op_sel_hi:[1,0,1] neg_lo:[0,0,1] neg_hi:[0,0,1]
v_pk_fma_f32 v[212:213], v[212:213], v[250:251], v[250:251] op_sel:[0,0,1] op_sel_hi:[1,0,1] neg_lo:[0,0,1] neg_hi:[0,0,1]
v_pk_fma_f32 v[214:215], v[214:215], v[250:251], v[250:251] op_sel:[0,0,1] op_sel_hi:[1,0,1] neg_lo:[0,0,1] neg_hi:[0,0,1]
v_pk_fma_f32 v[216:217], v[216:217], v[250:251], v[250:251] op_sel:[0,0,1] op_sel_hi:[1,0,1] neg_lo:[0,0,1] neg_hi:[0,0,1]
v_pk_fma_f32 v[218:219], v[218:219], v[250:251], v[250:251] op_sel:[0,0,1] op_sel_hi:[1,0,1] neg_lo:[0,0,1] neg_hi:[0,0,1]
v_pk_fma_f32 v[220:221], v[220:221], v[250:251], v[250:251] op_sel:[0,0,1] op_sel_hi:[1,0,1] neg_lo:[0,0,1] neg_hi:[0,0,1]
v_pk_fma_f32 v[222:223], v[222:223], v[250:251], v[250:251] op_sel:[0,0,1] op_sel_hi:[1,0,1] neg_lo:[0,0,1] neg_hi:[0,0,1]
v_cvt_pk_bf16_f32 v88, v32, v33
v_cvt_pk_bf16_f32 v89, v34, v35
v_cvt_pk_bf16_f32 v90, v36, v37
v_cvt_pk_bf16_f32 v91, v38, v39
v_cvt_pk_bf16_f32 v92, v40, v41
s_waitcnt lgkmcnt(0)
v_mfma_f32_16x16x32_bf16 v[128:131], a[72:75], v[88:91], v[128:131]
buffer_store_dwordx4 v[244:247], v4, s[28:31], s65 offen offset:3200 sc1
v_cvt_pk_bf16_f32 v93, v42, v43
v_cvt_pk_bf16_f32 v94, v44, v45
v_mfma_f32_16x16x32_bf16 v[132:135], a[76:79], v[88:91], v[132:135]
v_cvt_pk_bf16_f32 v95, v46, v47
v_exp_f32 v48, v48
v_mfma_f32_16x16x32_bf16 v[136:139], a[80:83], v[88:91], v[136:139]
v_exp_f32 v49, v49
v_mfma_f32_16x16x32_bf16 v[140:143], a[84:87], v[88:91], v[140:143]
v_exp_f32 v50, v50
v_mfma_f32_16x16x32_bf16 v[144:147], a[88:91], v[88:91], v[144:147]
v_exp_f32 v51, v51
v_mfma_f32_16x16x32_bf16 v[148:151], a[92:95], v[88:91], v[148:151]
v_exp_f32 v52, v52
v_mfma_f32_16x16x32_bf16 v[152:155], a[72:75], v[92:95], v[152:155]
ds_read_b128 a[72:75], v0 offset:49152
v_exp_f32 v53, v53
v_mfma_f32_16x16x32_bf16 v[156:159], a[76:79], v[92:95], v[156:159]
ds_read_b128 a[76:79], v0 offset:49408
v_exp_f32 v54, v54
v_mfma_f32_16x16x32_bf16 v[160:163], a[80:83], v[92:95], v[160:163]
ds_read_b128 a[80:83], v0 offset:51200
v_exp_f32 v55, v55
v_mfma_f32_16x16x32_bf16 v[164:167], a[84:87], v[92:95], v[164:167]
ds_read_b128 a[84:87], v0 offset:51456
v_exp_f32 v56, v56
v_mfma_f32_16x16x32_bf16 v[168:171], a[88:91], v[92:95], v[168:171]
ds_read_b128 a[88:91], v0 offset:53248
v_exp_f32 v57, v57
v_mfma_f32_16x16x32_bf16 v[172:175], a[92:95], v[92:95], v[172:175]
ds_read_b128 a[92:95], v0 offset:53504
v_exp_f32 v58, v58
v_exp_f32 v59, v59
v_exp_f32 v60, v60
v_exp_f32 v61, v61
v_exp_f32 v62, v62
v_exp_f32_e64 v63, v63
v_pk_add_f32 v[48:49], v[48:49], 1.0 op_sel_hi:[1,0]
v_pk_add_f32 v[50:51], v[50:51], 1.0 op_sel_hi:[1,0]
v_pk_add_f32 v[52:53], v[52:53], 1.0 op_sel_hi:[1,0]
v_pk_add_f32 v[54:55], v[54:55], 1.0 op_sel_hi:[1,0]
v_pk_add_f32 v[56:57], v[56:57], 1.0 op_sel_hi:[1,0]
v_pk_add_f32 v[58:59], v[58:59], 1.0 op_sel_hi:[1,0]
v_pk_add_f32 v[60:61], v[60:61], 1.0 op_sel_hi:[1,0]
v_pk_add_f32 v[62:63], v[62:63], 1.0 op_sel_hi:[1,0]
v_mfma_f32_16x16x32_bf16 v[32:35], a[48:51], v[64:67], 0
buffer_load_dwordx4 a[252:255], v4, s[24:27], s64 offen offset:3072
v_rcp_f32 v48, v48
v_mfma_f32_16x16x32_bf16 v[40:43], a[48:51], v[76:79], 0
ds_read_b128 a[48:51], v7 offset:4096
v_rcp_f32 v49, v49
v_mfma_f32_16x16x32_bf16 v[32:35], a[52:55], v[68:71], v[32:35]
v_cvt_pk_bf16_f32 v224, v176, v177
v_rcp_f32_e64 v50, v50
v_mfma_f32_16x16x32_bf16 v[40:43], a[52:55], v[80:83], v[40:43]
ds_read_b128 a[52:55], v7 offset:6144
v_cvt_pk_bf16_f32 v225, v178, v179
v_mfma_f32_16x16x32_bf16 v[32:35], a[56:59], v[72:75], v[32:35]
s_mov_b32 s85, 25165824
v_rcp_f32_e64 v51, v51
v_mfma_f32_16x16x32_bf16 v[40:43], a[56:59], v[84:87], v[40:43]
ds_read_b128 a[56:59], v7 offset:8192
v_cvt_pk_bf16_f32 v226, v180, v181
v_rcp_f32 v52, v52
v_mfma_f32_16x16x32_bf16 v[36:39], a[60:63], v[64:67], 0
v_rcp_f32 v53, v53
v_mfma_f32_16x16x32_bf16 v[44:47], a[60:63], v[76:79], 0
ds_read_b128 a[60:63], v7 offset:4352
v_cvt_pk_bf16_f32 v227, v182, v183
v_mfma_f32_16x16x32_bf16 v[36:39], a[64:67], v[68:71], v[36:39]
buffer_store_dwordx4 v[96:99], v4, s[28:31], s85 offen offset:0 sc1
v_rcp_f32_e64 v54, v54
v_mfma_f32_16x16x32_bf16 v[44:47], a[64:67], v[80:83], v[44:47]
ds_read_b128 a[64:67], v7 offset:6400
v_cvt_pk_bf16_f32 v228, v184, v185
v_rcp_f32_e64 v55, v55
v_mfma_f32_16x16x32_bf16 v[36:39], a[68:71], v[72:75], v[36:39]
v_cvt_pk_bf16_f32 v229, v186, v187
v_mfma_f32_16x16x32_bf16 v[44:47], a[68:71], v[84:87], v[44:47]
ds_read_b128 a[68:71], v7 offset:8448
v_rcp_f32 v56, v56
v_rcp_f32 v57, v57
v_cvt_pk_bf16_f32 v230, v188, v189
v_rcp_f32 v58, v58
v_cvt_pk_bf16_f32 v231, v190, v191
v_rcp_f32 v59, v59
v_cvt_pk_bf16_f32 v232, v192, v193
v_rcp_f32 v60, v60
v_rcp_f32 v61, v61
v_cvt_pk_bf16_f32 v233, v194, v195
v_rcp_f32 v62, v62
v_cvt_pk_bf16_f32 v234, v196, v197
v_rcp_f32 v63, v63
v_cvt_pk_bf16_f32 v235, v198, v199
v_pk_mul_f32 v[16:17], v[48:49], v[16:17]
v_pk_mul_f32 v[18:19], v[50:51], v[18:19]
v_pk_mul_f32 v[20:21], v[52:53], v[20:21]
v_pk_mul_f32 v[22:23], v[54:55], v[22:23]
v_pk_mul_f32 v[24:25], v[56:57], v[24:25]
v_pk_mul_f32 v[26:27], v[58:59], v[26:27]
v_pk_mul_f32 v[28:29], v[60:61], v[28:29]
v_pk_mul_f32 v[30:31], v[62:63], v[30:31]
v_pk_fma_f32 v[48:49], v[32:33], v[32:33], s[60:61] neg_lo:[1,0,0] neg_hi:[1,0,0]
v_pk_fma_f32 v[50:51], v[34:35], v[34:35], s[60:61] neg_lo:[1,0,0] neg_hi:[1,0,0]
v_pk_fma_f32 v[52:53], v[36:37], v[36:37], s[60:61] neg_lo:[1,0,0] neg_hi:[1,0,0]
v_pk_fma_f32 v[54:55], v[38:39], v[38:39], s[60:61] neg_lo:[1,0,0] neg_hi:[1,0,0]
v_pk_fma_f32 v[56:57], v[40:41], v[40:41], s[60:61] neg_lo:[1,0,0] neg_hi:[1,0,0]
v_pk_fma_f32 v[58:59], v[42:43], v[42:43], s[60:61] neg_lo:[1,0,0] neg_hi:[1,0,0]
v_pk_fma_f32 v[60:61], v[44:45], v[44:45], s[60:61] neg_lo:[1,0,0] neg_hi:[1,0,0]
v_pk_fma_f32 v[62:63], v[46:47], v[46:47], s[60:61] neg_lo:[1,0,0] neg_hi:[1,0,0]
v_pk_mul_f32 v[48:49], v[48:49], v[32:33]
v_pk_mul_f32 v[50:51], v[50:51], v[34:35]
v_pk_mul_f32 v[52:53], v[52:53], v[36:37]
v_pk_mul_f32 v[54:55], v[54:55], v[38:39]
v_pk_mul_f32 v[56:57], v[56:57], v[40:41]
v_pk_mul_f32 v[58:59], v[58:59], v[42:43]
v_pk_mul_f32 v[60:61], v[60:61], v[44:45]
v_pk_mul_f32 v[62:63], v[62:63], v[46:47]
v_cvt_pk_bf16_f32 v88, v16, v17
v_cvt_pk_bf16_f32 v89, v18, v19
v_cvt_pk_bf16_f32 v90, v20, v21
v_cvt_pk_bf16_f32 v91, v22, v23
v_cvt_pk_bf16_f32 v92, v24, v25
s_waitcnt lgkmcnt(0)
v_mfma_f32_16x16x32_bf16 v[128:131], a[72:75], v[88:91], v[128:131]
buffer_store_dwordx4 v[100:103], v4, s[28:31], s85 offen offset:64 sc1
v_cvt_pk_bf16_f32 v93, v26, v27
v_cvt_pk_bf16_f32 v94, v28, v29
v_mfma_f32_16x16x32_bf16 v[132:135], a[76:79], v[88:91], v[132:135]
v_cvt_pk_bf16_f32 v95, v30, v31
v_exp_f32 v48, v48
v_mfma_f32_16x16x32_bf16 v[136:139], a[80:83], v[88:91], v[136:139]
v_exp_f32_e64 v49, v49
v_mfma_f32_16x16x32_bf16 v[140:143], a[84:87], v[88:91], v[140:143]
v_cvt_pk_bf16_f32 v236, v200, v201
v_mfma_f32_16x16x32_bf16 v[144:147], a[88:91], v[88:91], v[144:147]
v_exp_f32 v50, v50
v_mfma_f32_16x16x32_bf16 v[148:151], a[92:95], v[88:91], v[148:151]
v_cvt_pk_bf16_f32 v237, v202, v203
v_exp_f32 v51, v51
v_mfma_f32_16x16x32_bf16 v[152:155], a[72:75], v[92:95], v[152:155]
ds_read_b128 a[72:75], v0 offset:55296
v_cvt_pk_bf16_f32 v238, v204, v205
v_mfma_f32_16x16x32_bf16 v[156:159], a[76:79], v[92:95], v[156:159]
ds_read_b128 a[76:79], v0 offset:55552
v_exp_f32 v52, v52
v_mfma_f32_16x16x32_bf16 v[160:163], a[80:83], v[92:95], v[160:163]
ds_read_b128 a[80:83], v0 offset:57344
v_exp_f32 v53, v53
v_mfma_f32_16x16x32_bf16 v[164:167], a[84:87], v[92:95], v[164:167]
ds_read_b128 a[84:87], v0 offset:57600
v_cvt_pk_bf16_f32 v239, v206, v207
v_exp_f32_e64 v54, v54
v_mfma_f32_16x16x32_bf16 v[168:171], a[88:91], v[92:95], v[168:171]
ds_read_b128 a[88:91], v0 offset:59392
v_cvt_pk_bf16_f32 v240, v208, v209
v_mfma_f32_16x16x32_bf16 v[172:175], a[92:95], v[92:95], v[172:175]
ds_read_b128 a[92:95], v0 offset:59648
v_exp_f32 v55, v55
v_cvt_pk_bf16_f32 v241, v210, v211
v_exp_f32 v56, v56
v_exp_f32 v57, v57
v_cvt_pk_bf16_f32 v242, v212, v213
v_exp_f32 v58, v58
v_cvt_pk_bf16_f32 v243, v214, v215
v_exp_f32 v59, v59
v_cvt_pk_bf16_f32 v244, v216, v217
v_exp_f32 v60, v60
v_exp_f32 v61, v61
v_cvt_pk_bf16_f32 v245, v218, v219
v_exp_f32 v62, v62
v_cvt_pk_bf16_f32 v246, v220, v221
v_exp_f32_e64 v63, v63
v_cvt_pk_bf16_f32 v247, v222, v223
v_pk_add_f32 v[48:49], v[48:49], 1.0 op_sel_hi:[1,0]
v_pk_add_f32 v[50:51], v[50:51], 1.0 op_sel_hi:[1,0]
v_pk_add_f32 v[52:53], v[52:53], 1.0 op_sel_hi:[1,0]
v_pk_add_f32 v[54:55], v[54:55], 1.0 op_sel_hi:[1,0]
v_pk_add_f32 v[56:57], v[56:57], 1.0 op_sel_hi:[1,0]
v_pk_add_f32 v[58:59], v[58:59], 1.0 op_sel_hi:[1,0]
v_pk_add_f32 v[60:61], v[60:61], 1.0 op_sel_hi:[1,0]
v_pk_add_f32 v[62:63], v[62:63], 1.0 op_sel_hi:[1,0]
v_mfma_f32_16x16x32_bf16 v[16:19], a[48:51], v[64:67], 0
buffer_store_dwordx4 v[104:107], v4, s[28:31], s85 offen offset:128 sc1
v_rcp_f32_e64 v48, v48
v_mfma_f32_16x16x32_bf16 v[24:27], a[48:51], v[76:79], 0
ds_read_b128 a[48:51], v7 offset:10240
s_add_u32 s81, s80, 22528
v_rcp_f32 v49, v49
v_mfma_f32_16x16x32_bf16 v[16:19], a[52:55], v[68:71], v[16:19]
buffer_load_dwordx4 a[160:163], v253, s[40:43], s81 offen offset:0 sc1
v_rcp_f32 v50, v50
v_mfma_f32_16x16x32_bf16 v[24:27], a[52:55], v[80:83], v[24:27]
ds_read_b128 a[52:55], v7 offset:12288
v_rcp_f32 v51, v51
v_mfma_f32_16x16x32_bf16 v[16:19], a[56:59], v[72:75], v[16:19]
ds_read_b128 v[176:179], v3 offset:0
v_rcp_f32 v52, v52
v_mfma_f32_16x16x32_bf16 v[24:27], a[56:59], v[84:87], v[24:27]
ds_read_b128 a[56:59], v7 offset:14336
ds_read_b128 v[180:183], v3 offset:16
v_mfma_f32_16x16x32_bf16 v[20:23], a[60:63], v[64:67], 0
ds_read_b128 v[184:187], v3 offset:128
v_rcp_f32 v53, v53
v_mfma_f32_16x16x32_bf16 v[28:31], a[60:63], v[76:79], 0
ds_read_b128 a[60:63], v7 offset:10496
v_rcp_f32 v54, v54
v_mfma_f32_16x16x32_bf16 v[20:23], a[64:67], v[68:71], v[20:23]
ds_read_b128 v[188:191], v3 offset:144
v_rcp_f32_e64 v55, v55
v_mfma_f32_16x16x32_bf16 v[28:31], a[64:67], v[80:83], v[28:31]
ds_read_b128 a[64:67], v7 offset:12544
ds_read_b128 v[192:195], v3 offset:256
v_rcp_f32 v56, v56
v_mfma_f32_16x16x32_bf16 v[20:23], a[68:71], v[72:75], v[20:23]
ds_read_b128 v[196:199], v3 offset:272
v_rcp_f32 v57, v57
v_mfma_f32_16x16x32_bf16 v[28:31], a[68:71], v[84:87], v[28:31]
ds_read_b128 a[68:71], v7 offset:14592
v_rcp_f32 v58, v58
v_rcp_f32 v59, v59
v_rcp_f32 v60, v60
v_rcp_f32 v61, v61
v_rcp_f32 v62, v62
v_rcp_f32 v63, v63
v_pk_mul_f32 v[32:33], v[48:49], v[32:33]
v_pk_mul_f32 v[34:35], v[50:51], v[34:35]
v_pk_mul_f32 v[36:37], v[52:53], v[36:37]
v_pk_mul_f32 v[38:39], v[54:55], v[38:39]
v_pk_mul_f32 v[40:41], v[56:57], v[40:41]
v_pk_mul_f32 v[42:43], v[58:59], v[42:43]
v_pk_mul_f32 v[44:45], v[60:61], v[44:45]
v_pk_mul_f32 v[46:47], v[62:63], v[46:47]
v_pk_fma_f32 v[48:49], v[16:17], v[16:17], s[60:61] neg_lo:[1,0,0] neg_hi:[1,0,0]
v_pk_fma_f32 v[50:51], v[18:19], v[18:19], s[60:61] neg_lo:[1,0,0] neg_hi:[1,0,0]
v_pk_fma_f32 v[52:53], v[20:21], v[20:21], s[60:61] neg_lo:[1,0,0] neg_hi:[1,0,0]
v_pk_fma_f32 v[54:55], v[22:23], v[22:23], s[60:61] neg_lo:[1,0,0] neg_hi:[1,0,0]
v_pk_fma_f32 v[56:57], v[24:25], v[24:25], s[60:61] neg_lo:[1,0,0] neg_hi:[1,0,0]
v_pk_fma_f32 v[58:59], v[26:27], v[26:27], s[60:61] neg_lo:[1,0,0] neg_hi:[1,0,0]
v_pk_fma_f32 v[60:61], v[28:29], v[28:29], s[60:61] neg_lo:[1,0,0] neg_hi:[1,0,0]
v_pk_fma_f32 v[62:63], v[30:31], v[30:31], s[60:61] neg_lo:[1,0,0] neg_hi:[1,0,0]
v_pk_mul_f32 v[48:49], v[48:49], v[16:17]
v_pk_mul_f32 v[50:51], v[50:51], v[18:19]
v_pk_mul_f32 v[52:53], v[52:53], v[20:21]
v_pk_mul_f32 v[54:55], v[54:55], v[22:23]
v_pk_mul_f32 v[56:57], v[56:57], v[24:25]
v_pk_mul_f32 v[58:59], v[58:59], v[26:27]
v_pk_mul_f32 v[60:61], v[60:61], v[28:29]
v_pk_mul_f32 v[62:63], v[62:63], v[30:31]
v_cvt_pk_bf16_f32 v88, v32, v33
v_cvt_pk_bf16_f32 v89, v34, v35
v_cvt_pk_bf16_f32 v90, v36, v37
v_cvt_pk_bf16_f32 v91, v38, v39
v_cvt_pk_bf16_f32 v92, v40, v41
s_waitcnt lgkmcnt(0)
v_mfma_f32_16x16x32_bf16 v[128:131], a[72:75], v[88:91], v[128:131]
buffer_load_dwordx4 a[216:219], v4, s[24:27], s64 offen offset:3136
v_cvt_pk_bf16_f32 v93, v42, v43
v_cvt_pk_bf16_f32 v94, v44, v45
v_mfma_f32_16x16x32_bf16 v[132:135], a[76:79], v[88:91], v[132:135]
v_cvt_pk_bf16_f32 v95, v46, v47
v_mfma_f32_16x16x32_bf16 v[136:139], a[80:83], v[88:91], v[136:139]
v_exp_f32 v48, v48
v_mfma_f32_16x16x32_bf16 v[140:143], a[84:87], v[88:91], v[140:143]
v_exp_f32 v49, v49
v_mfma_f32_16x16x32_bf16 v[144:147], a[88:91], v[88:91], v[144:147]
v_exp_f32 v50, v50
v_mfma_f32_16x16x32_bf16 v[148:151], a[92:95], v[88:91], v[148:151]
v_exp_f32 v51, v51
v_mfma_f32_16x16x32_bf16 v[152:155], a[72:75], v[92:95], v[152:155]
ds_read_b128 a[72:75], v0 offset:61440
v_exp_f32 v52, v52
v_mfma_f32_16x16x32_bf16 v[156:159], a[76:79], v[92:95], v[156:159]
ds_read_b128 a[76:79], v0 offset:61696
v_exp_f32_e64 v53, v53
v_mfma_f32_16x16x32_bf16 v[160:163], a[80:83], v[92:95], v[160:163]
ds_read_b128 a[80:83], v0 offset:63488
v_mfma_f32_16x16x32_bf16 v[164:167], a[84:87], v[92:95], v[164:167]
ds_read_b128 a[84:87], v0 offset:63744
v_exp_f32 v54, v54
v_mfma_f32_16x16x32_bf16 v[168:171], a[88:91], v[92:95], v[168:171]
ds_read_b128 a[88:91], v1 offset:0
v_exp_f32 v55, v55
v_mfma_f32_16x16x32_bf16 v[172:175], a[92:95], v[92:95], v[172:175]
ds_read_b128 a[92:95], v1 offset:256
v_exp_f32 v56, v56
v_mfma_f32_16x16x32_bf16 v[200:203], v[8:11], a[12:15], v[176:179]
v_exp_f32 v57, v57
v_mfma_f32_16x16x32_bf16 v[176:179], v[8:11], a[0:3], v[176:179]
v_exp_f32 v58, v58
v_mfma_f32_16x16x32_bf16 v[204:207], v[12:15], a[12:15], v[180:183]
v_exp_f32 v59, v59
v_mfma_f32_16x16x32_bf16 v[180:183], v[12:15], a[0:3], v[180:183]
v_exp_f32 v60, v60
v_mfma_f32_16x16x32_bf16 v[208:211], v[8:11], a[16:19], v[184:187]
v_exp_f32 v61, v61
v_mfma_f32_16x16x32_bf16 v[184:187], v[8:11], a[4:7], v[184:187]
v_exp_f32 v62, v62
v_exp_f32 v63, v63
v_pk_add_f32 v[48:49], v[48:49], 1.0 op_sel_hi:[1,0]
v_pk_add_f32 v[50:51], v[50:51], 1.0 op_sel_hi:[1,0]
v_pk_add_f32 v[52:53], v[52:53], 1.0 op_sel_hi:[1,0]
v_pk_add_f32 v[54:55], v[54:55], 1.0 op_sel_hi:[1,0]
v_pk_add_f32 v[56:57], v[56:57], 1.0 op_sel_hi:[1,0]
v_pk_add_f32 v[58:59], v[58:59], 1.0 op_sel_hi:[1,0]
v_pk_add_f32 v[60:61], v[60:61], 1.0 op_sel_hi:[1,0]
v_pk_add_f32 v[62:63], v[62:63], 1.0 op_sel_hi:[1,0]
v_mfma_f32_16x16x32_bf16 v[32:35], a[48:51], v[64:67], 0
buffer_store_dwordx4 v[108:111], v4, s[28:31], s85 offen offset:3072 sc1
v_rcp_f32 v48, v48
v_mfma_f32_16x16x32_bf16 v[40:43], a[48:51], v[76:79], 0
ds_read_b128 a[48:51], v1 offset:8192
v_rcp_f32 v49, v49
v_mfma_f32_16x16x32_bf16 v[32:35], a[52:55], v[68:71], v[32:35]
v_mfma_f32_16x16x32_bf16 v[40:43], a[52:55], v[80:83], v[40:43]
ds_read_b128 a[52:55], v1 offset:10240
v_rcp_f32 v50, v50
v_mfma_f32_16x16x32_bf16 v[32:35], a[56:59], v[72:75], v[32:35]
v_rcp_f32 v51, v51
v_mfma_f32_16x16x32_bf16 v[40:43], a[56:59], v[84:87], v[40:43]
ds_read_b128 a[56:59], v1 offset:12288
v_rcp_f32 v52, v52
v_mfma_f32_16x16x32_bf16 v[36:39], a[60:63], v[64:67], 0
v_rcp_f32 v53, v53
v_mfma_f32_16x16x32_bf16 v[44:47], a[60:63], v[76:79], 0
ds_read_b128 a[60:63], v1 offset:8448
v_mfma_f32_16x16x32_bf16 v[36:39], a[64:67], v[68:71], v[36:39]
v_rcp_f32 v54, v54
v_mfma_f32_16x16x32_bf16 v[44:47], a[64:67], v[80:83], v[44:47]
ds_read_b128 a[64:67], v1 offset:10496
v_rcp_f32 v55, v55
v_mfma_f32_16x16x32_bf16 v[36:39], a[68:71], v[72:75], v[36:39]
v_rcp_f32 v56, v56
v_mfma_f32_16x16x32_bf16 v[44:47], a[68:71], v[84:87], v[44:47]
ds_read_b128 a[68:71], v1 offset:12544
v_rcp_f32 v57, v57
v_mfma_f32_16x16x32_bf16 v[212:215], v[12:15], a[16:19], v[188:191]
v_mfma_f32_16x16x32_bf16 v[188:191], v[12:15], a[4:7], v[188:191]
v_rcp_f32 v58, v58
v_mfma_f32_16x16x32_bf16 v[216:219], v[8:11], a[20:23], v[192:195]
v_rcp_f32 v59, v59
v_mfma_f32_16x16x32_bf16 v[192:195], v[8:11], a[8:11], v[192:195]
v_rcp_f32 v60, v60
v_mfma_f32_16x16x32_bf16 v[220:223], v[12:15], a[20:23], v[196:199]
v_rcp_f32 v61, v61
v_mfma_f32_16x16x32_bf16 v[196:199], v[12:15], a[8:11], v[196:199]
v_rcp_f32 v62, v62
v_rcp_f32 v63, v63
v_pk_mul_f32 v[16:17], v[48:49], v[16:17]
v_pk_mul_f32 v[18:19], v[50:51], v[18:19]
v_pk_mul_f32 v[20:21], v[52:53], v[20:21]
v_pk_mul_f32 v[22:23], v[54:55], v[22:23]
v_pk_mul_f32 v[24:25], v[56:57], v[24:25]
v_pk_mul_f32 v[26:27], v[58:59], v[26:27]
v_pk_mul_f32 v[28:29], v[60:61], v[28:29]
v_pk_mul_f32 v[30:31], v[62:63], v[30:31]
v_pk_fma_f32 v[48:49], v[32:33], v[32:33], s[60:61] neg_lo:[1,0,0] neg_hi:[1,0,0]
v_pk_fma_f32 v[50:51], v[34:35], v[34:35], s[60:61] neg_lo:[1,0,0] neg_hi:[1,0,0]
v_pk_fma_f32 v[52:53], v[36:37], v[36:37], s[60:61] neg_lo:[1,0,0] neg_hi:[1,0,0]
v_pk_fma_f32 v[54:55], v[38:39], v[38:39], s[60:61] neg_lo:[1,0,0] neg_hi:[1,0,0]
v_pk_fma_f32 v[56:57], v[40:41], v[40:41], s[60:61] neg_lo:[1,0,0] neg_hi:[1,0,0]
v_pk_fma_f32 v[58:59], v[42:43], v[42:43], s[60:61] neg_lo:[1,0,0] neg_hi:[1,0,0]
v_pk_fma_f32 v[60:61], v[44:45], v[44:45], s[60:61] neg_lo:[1,0,0] neg_hi:[1,0,0]
v_pk_fma_f32 v[62:63], v[46:47], v[46:47], s[60:61] neg_lo:[1,0,0] neg_hi:[1,0,0]
v_pk_mul_f32 v[48:49], v[48:49], v[32:33]
v_pk_mul_f32 v[50:51], v[50:51], v[34:35]
v_pk_mul_f32 v[52:53], v[52:53], v[36:37]
v_pk_mul_f32 v[54:55], v[54:55], v[38:39]
v_pk_mul_f32 v[56:57], v[56:57], v[40:41]
v_pk_mul_f32 v[58:59], v[58:59], v[42:43]
v_pk_mul_f32 v[60:61], v[60:61], v[44:45]
v_pk_mul_f32 v[62:63], v[62:63], v[46:47]
v_cvt_pk_bf16_f32 v88, v16, v17
v_cvt_pk_bf16_f32 v89, v18, v19
v_cvt_pk_bf16_f32 v90, v20, v21
v_cvt_pk_bf16_f32 v91, v22, v23
v_cvt_pk_bf16_f32 v92, v24, v25
s_waitcnt lgkmcnt(0)
v_mfma_f32_16x16x32_bf16 v[128:131], a[72:75], v[88:91], v[128:131]
buffer_store_dwordx4 v[112:115], v4, s[28:31], s85 offen offset:3136 sc1
v_cvt_pk_bf16_f32 v93, v26, v27
v_cvt_pk_bf16_f32 v94, v28, v29
v_mfma_f32_16x16x32_bf16 v[132:135], a[76:79], v[88:91], v[132:135]
v_cvt_pk_bf16_f32 v95, v30, v31
v_exp_f32 v48, v48
v_mfma_f32_16x16x32_bf16 v[136:139], a[80:83], v[88:91], v[136:139]
v_exp_f32 v49, v49
v_mfma_f32_16x16x32_bf16 v[140:143], a[84:87], v[88:91], v[140:143]
v_exp_f32 v50, v50
v_mfma_f32_16x16x32_bf16 v[144:147], a[88:91], v[88:91], v[144:147]
v_exp_f32 v51, v51
v_mfma_f32_16x16x32_bf16 v[148:151], a[92:95], v[88:91], v[148:151]
v_exp_f32 v52, v52
v_mfma_f32_16x16x32_bf16 v[152:155], a[72:75], v[92:95], v[152:155]
ds_read_b128 a[72:75], v1 offset:2048
v_exp_f32 v53, v53
v_mfma_f32_16x16x32_bf16 v[156:159], a[76:79], v[92:95], v[156:159]
ds_read_b128 a[76:79], v1 offset:2304
v_exp_f32 v54, v54
v_mfma_f32_16x16x32_bf16 v[160:163], a[80:83], v[92:95], v[160:163]
ds_read_b128 a[80:83], v1 offset:4096
v_exp_f32 v55, v55
v_mfma_f32_16x16x32_bf16 v[164:167], a[84:87], v[92:95], v[164:167]
ds_read_b128 a[84:87], v1 offset:4352
v_exp_f32 v56, v56
v_mfma_f32_16x16x32_bf16 v[168:171], a[88:91], v[92:95], v[168:171]
ds_read_b128 a[88:91], v1 offset:6144
v_exp_f32 v57, v57
v_mfma_f32_16x16x32_bf16 v[172:175], a[92:95], v[92:95], v[172:175]
ds_read_b128 a[92:95], v1 offset:6400
v_exp_f32 v58, v58
v_exp_f32 v59, v59
v_exp_f32 v60, v60
v_exp_f32 v61, v61
v_exp_f32 v62, v62
v_exp_f32_e64 v63, v63
v_pk_add_f32 v[48:49], v[48:49], 1.0 op_sel_hi:[1,0]
v_pk_add_f32 v[50:51], v[50:51], 1.0 op_sel_hi:[1,0]
v_pk_add_f32 v[52:53], v[52:53], 1.0 op_sel_hi:[1,0]
v_pk_add_f32 v[54:55], v[54:55], 1.0 op_sel_hi:[1,0]
v_pk_add_f32 v[56:57], v[56:57], 1.0 op_sel_hi:[1,0]
v_pk_add_f32 v[58:59], v[58:59], 1.0 op_sel_hi:[1,0]
v_pk_add_f32 v[60:61], v[60:61], 1.0 op_sel_hi:[1,0]
v_pk_add_f32 v[62:63], v[62:63], 1.0 op_sel_hi:[1,0]
v_mfma_f32_16x16x32_bf16 v[16:19], a[48:51], v[224:227], 0
buffer_load_dwordx4 a[220:223], v4, s[24:27], s64 offen offset:3200
v_rcp_f32 v48, v48
v_mfma_f32_16x16x32_bf16 v[24:27], a[48:51], v[236:239], 0
ds_read_b128 a[48:51], v1 offset:14336
v_rcp_f32 v49, v49
v_mfma_f32_16x16x32_bf16 v[16:19], a[52:55], v[228:231], v[16:19]
v_rcp_f32 v50, v50
v_mfma_f32_16x16x32_bf16 v[24:27], a[52:55], v[240:243], v[24:27]
ds_read_b128 a[52:55], v1 offset:16384
v_rcp_f32 v51, v51
v_mfma_f32_16x16x32_bf16 v[16:19], a[56:59], v[232:235], v[16:19]
buffer_store_dwordx4 v[116:119], v4, s[28:31], s85 offen offset:3200 sc1
v_rcp_f32 v52, v52
v_mfma_f32_16x16x32_bf16 v[24:27], a[56:59], v[244:247], v[24:27]
ds_read_b128 a[56:59], v1 offset:18432
v_rcp_f32 v53, v53
v_mfma_f32_16x16x32_bf16 v[20:23], a[60:63], v[224:227], 0
v_rcp_f32 v54, v54
v_mfma_f32_16x16x32_bf16 v[28:31], a[60:63], v[236:239], 0
ds_read_b128 a[60:63], v1 offset:14592
v_rcp_f32 v55, v55
v_mfma_f32_16x16x32_bf16 v[20:23], a[64:67], v[228:231], v[20:23]
buffer_load_dwordx4 a[164:167], v253, s[40:43], s81 offen offset:1024 sc1
v_rcp_f32 v56, v56
v_mfma_f32_16x16x32_bf16 v[28:31], a[64:67], v[240:243], v[28:31]
ds_read_b128 a[64:67], v1 offset:16640
v_rcp_f32 v57, v57
v_mfma_f32_16x16x32_bf16 v[20:23], a[68:71], v[232:235], v[20:23]
v_rcp_f32 v58, v58
v_mfma_f32_16x16x32_bf16 v[28:31], a[68:71], v[244:247], v[28:31]
ds_read_b128 a[68:71], v1 offset:18688
v_rcp_f32 v59, v59
v_rcp_f32 v60, v60
v_rcp_f32 v61, v61
v_rcp_f32 v62, v62
v_rcp_f32 v63, v63
v_pk_mul_f32 v[32:33], v[48:49], v[32:33]
v_pk_mul_f32 v[34:35], v[50:51], v[34:35]
v_pk_mul_f32 v[36:37], v[52:53], v[36:37]
v_pk_mul_f32 v[38:39], v[54:55], v[38:39]
v_pk_mul_f32 v[40:41], v[56:57], v[40:41]
v_pk_mul_f32 v[42:43], v[58:59], v[42:43]
v_pk_mul_f32 v[44:45], v[60:61], v[44:45]
v_pk_mul_f32 v[46:47], v[62:63], v[46:47]
v_pk_fma_f32 v[48:49], v[16:17], v[16:17], s[60:61] neg_lo:[1,0,0] neg_hi:[1,0,0]
v_pk_fma_f32 v[50:51], v[18:19], v[18:19], s[60:61] neg_lo:[1,0,0] neg_hi:[1,0,0]
v_pk_fma_f32 v[52:53], v[20:21], v[20:21], s[60:61] neg_lo:[1,0,0] neg_hi:[1,0,0]
v_pk_fma_f32 v[54:55], v[22:23], v[22:23], s[60:61] neg_lo:[1,0,0] neg_hi:[1,0,0]
v_pk_fma_f32 v[56:57], v[24:25], v[24:25], s[60:61] neg_lo:[1,0,0] neg_hi:[1,0,0]
v_pk_fma_f32 v[58:59], v[26:27], v[26:27], s[60:61] neg_lo:[1,0,0] neg_hi:[1,0,0]
v_pk_fma_f32 v[60:61], v[28:29], v[28:29], s[60:61] neg_lo:[1,0,0] neg_hi:[1,0,0]
v_pk_fma_f32 v[62:63], v[30:31], v[30:31], s[60:61] neg_lo:[1,0,0] neg_hi:[1,0,0]
v_pk_mul_f32 v[48:49], v[48:49], v[16:17]
v_pk_mul_f32 v[50:51], v[50:51], v[18:19]
v_pk_mul_f32 v[52:53], v[52:53], v[20:21]
v_pk_mul_f32 v[54:55], v[54:55], v[22:23]
v_pk_mul_f32 v[56:57], v[56:57], v[24:25]
v_pk_mul_f32 v[58:59], v[58:59], v[26:27]
v_pk_mul_f32 v[60:61], v[60:61], v[28:29]
v_pk_mul_f32 v[62:63], v[62:63], v[30:31]
L_b2_1:
v_cvt_pk_bf16_f32 v88, v32, v33
v_cvt_pk_bf16_f32 v89, v34, v35
v_cvt_pk_bf16_f32 v90, v36, v37
v_cvt_pk_bf16_f32 v91, v38, v39
v_cvt_pk_bf16_f32 v92, v40, v41
s_waitcnt lgkmcnt(0)
v_mfma_f32_16x16x32_bf16 v[128:131], a[72:75], v[88:91], v[128:131]
s_add_u32 s81, s80, 24576
v_cvt_pk_bf16_f32 v93, v42, v43
v_cvt_pk_bf16_f32 v94, v44, v45
v_mfma_f32_16x16x32_bf16 v[132:135], a[76:79], v[88:91], v[132:135]
v_cvt_pk_bf16_f32 v95, v46, v47
v_exp_f32 v48, v48
v_mfma_f32_16x16x32_bf16 v[136:139], a[80:83], v[88:91], v[136:139]
v_exp_f32 v49, v49
v_mfma_f32_16x16x32_bf16 v[140:143], a[84:87], v[88:91], v[140:143]
v_exp_f32 v50, v50
v_mfma_f32_16x16x32_bf16 v[144:147], a[88:91], v[88:91], v[144:147]
v_exp_f32 v51, v51
v_mfma_f32_16x16x32_bf16 v[148:151], a[92:95], v[88:91], v[148:151]
v_exp_f32 v52, v52
v_mfma_f32_16x16x32_bf16 v[152:155], a[72:75], v[92:95], v[152:155]
ds_read_b128 a[72:75], v0 offset:0
buffer_load_dwordx4 a[168:171], v253, s[40:43], s81 offen offset:0 sc1
v_mfma_f32_16x16x32_bf16 v[156:159], a[76:79], v[92:95], v[156:159]
ds_read_b128 a[76:79], v0 offset:256
v_exp_f32 v53, v53
v_mfma_f32_16x16x32_bf16 v[160:163], a[80:83], v[92:95], v[160:163]
ds_read_b128 a[80:83], v0 offset:2048
v_exp_f32 v54, v54
v_mfma_f32_16x16x32_bf16 v[164:167], a[84:87], v[92:95], v[164:167]
ds_read_b128 a[84:87], v0 offset:2304
v_exp_f32 v55, v55
v_mfma_f32_16x16x32_bf16 v[168:171], a[88:91], v[92:95], v[168:171]
ds_read_b128 a[88:91], v0 offset:4096
v_exp_f32 v56, v56
v_mfma_f32_16x16x32_bf16 v[172:175], a[92:95], v[92:95], v[172:175]
ds_read_b128 a[92:95], v0 offset:4352
v_exp_f32 v57, v57
v_exp_f32 v58, v58
v_exp_f32 v59, v59
v_exp_f32 v60, v60
v_exp_f32 v61, v61
v_exp_f32 v62, v62
v_exp_f32_e64 v63, v63
v_pk_add_f32 v[48:49], v[48:49], 1.0 op_sel_hi:[1,0]
v_pk_add_f32 v[50:51], v[50:51], 1.0 op_sel_hi:[1,0]
v_pk_add_f32 v[52:53], v[52:53], 1.0 op_sel_hi:[1,0]
v_pk_add_f32 v[54:55], v[54:55], 1.0 op_sel_hi:[1,0]
v_pk_add_f32 v[56:57], v[56:57], 1.0 op_sel_hi:[1,0]
v_pk_add_f32 v[58:59], v[58:59], 1.0 op_sel_hi:[1,0]
v_pk_add_f32 v[60:61], v[60:61], 1.0 op_sel_hi:[1,0]
v_pk_add_f32 v[62:63], v[62:63], 1.0 op_sel_hi:[1,0]
v_mfma_f32_16x16x32_bf16 v[32:35], a[48:51], v[224:227], 0
buffer_load_dwordx4 a[172:175], v253, s[40:43], s81 offen offset:1024 sc1
v_rcp_f32 v48, v48
v_mfma_f32_16x16x32_bf16 v[40:43], a[48:51], v[236:239], 0
ds_read_b128 a[48:51], v1 offset:20480
v_rcp_f32 v49, v49
v_mfma_f32_16x16x32_bf16 v[32:35], a[52:55], v[228:231], v[32:35]
v_rcp_f32_e64 v50, v50
v_mfma_f32_16x16x32_bf16 v[40:43], a[52:55], v[240:243], v[40:43]
ds_read_b128 a[52:55], v1 offset:22528
s_add_u32 s74, s87, L_tail-L_pc
v_rcp_f32 v51, v51
v_mfma_f32_16x16x32_bf16 v[32:35], a[56:59], v[232:235], v[32:35]
v_rcp_f32 v52, v52
v_mfma_f32_16x16x32_bf16 v[40:43], a[56:59], v[244:247], v[40:43]
ds_read_b128 a[56:59], v1 offset:24576
v_rcp_f32 v53, v53
v_mfma_f32_16x16x32_bf16 v[36:39], a[60:63], v[224:227], 0
v_add_u32 v254, s74, v2
v_mfma_f32_16x16x32_bf16 v[44:47], a[60:63], v[236:239], 0
ds_read_b128 a[60:63], v1 offset:20736
v_rcp_f32 v54, v54
v_mfma_f32_16x16x32_bf16 v[36:39], a[64:67], v[228:231], v[36:39]
v_rcp_f32 v55, v55
v_mfma_f32_16x16x32_bf16 v[44:47], a[64:67], v[240:243], v[44:47]
ds_read_b128 a[64:67], v1 offset:22784
v_min_u32 v254, L_pf1-L_pc-4, v254
v_rcp_f32 v56, v56
v_mfma_f32_16x16x32_bf16 v[36:39], a[68:71], v[232:235], v[36:39]
v_rcp_f32 v57, v57
v_mfma_f32_16x16x32_bf16 v[44:47], a[68:71], v[244:247], v[44:47]
ds_read_b128 a[68:71], v1 offset:24832
v_rcp_f32 v58, v58
v_mov_b32 v255, s89
v_rcp_f32 v59, v59
v_rcp_f32 v60, v60
v_rcp_f32 v61, v61
v_add_co_u32 v254, vcc, s88, v254
v_rcp_f32 v62, v62
v_rcp_f32 v63, v63
v_addc_co_u32_e64 v255, vcc, 0, v255, vcc
v_pk_mul_f32 v[16:17], v[48:49], v[16:17]
v_pk_mul_f32 v[18:19], v[50:51], v[18:19]
v_pk_mul_f32 v[20:21], v[52:53], v[20:21]
v_pk_mul_f32 v[22:23], v[54:55], v[22:23]
v_pk_mul_f32 v[24:25], v[56:57], v[24:25]
v_pk_mul_f32 v[26:27], v[58:59], v[26:27]
v_pk_mul_f32 v[28:29], v[60:61], v[28:29]
v_pk_mul_f32 v[30:31], v[62:63], v[30:31]
v_pk_fma_f32 v[48:49], v[32:33], v[32:33], s[60:61] neg_lo:[1,0,0] neg_hi:[1,0,0]
v_pk_fma_f32 v[50:51], v[34:35], v[34:35], s[60:61] neg_lo:[1,0,0] neg_hi:[1,0,0]
v_pk_fma_f32 v[52:53], v[36:37], v[36:37], s[60:61] neg_lo:[1,0,0] neg_hi:[1,0,0]
v_pk_fma_f32 v[54:55], v[38:39], v[38:39], s[60:61] neg_lo:[1,0,0] neg_hi:[1,0,0]
v_pk_fma_f32 v[56:57], v[40:41], v[40:41], s[60:61] neg_lo:[1,0,0] neg_hi:[1,0,0]
v_pk_fma_f32 v[58:59], v[42:43], v[42:43], s[60:61] neg_lo:[1,0,0] neg_hi:[1,0,0]
v_pk_fma_f32 v[60:61], v[44:45], v[44:45], s[60:61] neg_lo:[1,0,0] neg_hi:[1,0,0]
v_pk_fma_f32 v[62:63], v[46:47], v[46:47], s[60:61] neg_lo:[1,0,0] neg_hi:[1,0,0]
v_pk_mul_f32 v[48:49], v[48:49], v[32:33]
v_pk_mul_f32 v[50:51], v[50:51], v[34:35]
v_pk_mul_f32 v[52:53], v[52:53], v[36:37]
v_pk_mul_f32 v[54:55], v[54:55], v[38:39]
v_pk_mul_f32 v[56:57], v[56:57], v[40:41]
v_pk_mul_f32 v[58:59], v[58:59], v[42:43]
v_pk_mul_f32 v[60:61], v[60:61], v[44:45]
v_pk_mul_f32 v[62:63], v[62:63], v[46:47]
v_cvt_pk_bf16_f32 v88, v16, v17
v_cvt_pk_bf16_f32 v89, v18, v19
v_cvt_pk_bf16_f32 v90, v20, v21
v_cvt_pk_bf16_f32 v91, v22, v23
v_cvt_pk_bf16_f32 v92, v24, v25
s_waitcnt lgkmcnt(0)
v_mfma_f32_16x16x32_bf16 v[176:179], a[72:75], v[88:91], v[176:179]
global_load_dword v255, v[254:255], off
v_cvt_pk_bf16_f32 v93, v26, v27
v_cvt_pk_bf16_f32 v94, v28, v29
v_mfma_f32_16x16x32_bf16 v[180:183], a[76:79], v[88:91], v[180:183]
v_cvt_pk_bf16_f32 v95, v30, v31
v_exp_f32 v48, v48
v_mfma_f32_16x16x32_bf16 v[184:187], a[80:83], v[88:91], v[184:187]
s_mov_b32 s84, 44040192
v_exp_f32_e64 v49, v49
v_mfma_f32_16x16x32_bf16 v[188:191], a[84:87], v[88:91], v[188:191]
v_cvt_pk_bf16_f32 v64, v128, v129
v_mfma_f32_16x16x32_bf16 v[192:195], a[88:91], v[88:91], v[192:195]
buffer_store_dwordx4 a[120:123], v4, s[28:31], s84 offen offset:0 sc1
v_exp_f32 v50, v50
v_mfma_f32_16x16x32_bf16 v[196:199], a[92:95], v[88:91], v[196:199]
v_cvt_pk_bf16_f32 v65, v130, v131
v_exp_f32 v51, v51
v_mfma_f32_16x16x32_bf16 v[200:203], a[72:75], v[92:95], v[200:203]
ds_read_b128 a[72:75], v0 offset:6144
v_cvt_pk_bf16_f32 v66, v132, v133
v_mfma_f32_16x16x32_bf16 v[204:207], a[76:79], v[92:95], v[204:207]
ds_read_b128 a[76:79], v0 offset:6400
s_add_u32 s81, s80, 26624
v_exp_f32 v52, v52
v_mfma_f32_16x16x32_bf16 v[208:211], a[80:83], v[92:95], v[208:211]
ds_read_b128 a[80:83], v0 offset:8192
v_exp_f32 v53, v53
v_mfma_f32_16x16x32_bf16 v[212:215], a[84:87], v[92:95], v[212:215]
ds_read_b128 a[84:87], v0 offset:8448
buffer_load_dwordx4 a[176:179], v253, s[40:43], s81 offen offset:0 sc1
v_mfma_f32_16x16x32_bf16 v[216:219], a[88:91], v[92:95], v[216:219]
ds_read_b128 a[88:91], v0 offset:10240
v_cvt_pk_bf16_f32 v67, v134, v135
v_exp_f32_e64 v54, v54
v_mfma_f32_16x16x32_bf16 v[220:223], a[92:95], v[92:95], v[220:223]
ds_read_b128 a[92:95], v0 offset:10496
v_cvt_pk_bf16_f32 v68, v136, v137
v_exp_f32 v55, v55
v_cvt_pk_bf16_f32 v69, v138, v139
v_exp_f32 v56, v56
v_exp_f32 v57, v57
v_cvt_pk_bf16_f32 v70, v140, v141
v_exp_f32 v58, v58
v_cvt_pk_bf16_f32 v71, v142, v143
v_exp_f32 v59, v59
v_cvt_pk_bf16_f32 v72, v144, v145
v_exp_f32 v60, v60
v_exp_f32 v61, v61
v_cvt_pk_bf16_f32 v73, v146, v147
v_exp_f32 v62, v62
v_cvt_pk_bf16_f32 v74, v148, v149
v_exp_f32_e64 v63, v63
v_cvt_pk_bf16_f32 v75, v150, v151
v_pk_add_f32 v[48:49], v[48:49], 1.0 op_sel_hi:[1,0]
v_pk_add_f32 v[50:51], v[50:51], 1.0 op_sel_hi:[1,0]
v_pk_add_f32 v[52:53], v[52:53], 1.0 op_sel_hi:[1,0]
v_pk_add_f32 v[54:55], v[54:55], 1.0 op_sel_hi:[1,0]
v_pk_add_f32 v[56:57], v[56:57], 1.0 op_sel_hi:[1,0]
v_pk_add_f32 v[58:59], v[58:59], 1.0 op_sel_hi:[1,0]
v_pk_add_f32 v[60:61], v[60:61], 1.0 op_sel_hi:[1,0]
v_pk_add_f32 v[62:63], v[62:63], 1.0 op_sel_hi:[1,0]
v_mfma_f32_16x16x32_bf16 v[16:19], a[48:51], v[224:227], 0
buffer_load_dwordx4 a[180:183], v253, s[40:43], s81 offen offset:1024 sc1
v_rcp_f32 v48, v48
v_mfma_f32_16x16x32_bf16 v[24:27], a[48:51], v[236:239], 0
ds_read_b128 a[48:51], v1 offset:26624
v_rcp_f32 v49, v49
v_mfma_f32_16x16x32_bf16 v[16:19], a[52:55], v[228:231], v[16:19]
v_cvt_pk_bf16_f32 v76, v152, v153
v_rcp_f32_e64 v50, v50
v_mfma_f32_16x16x32_bf16 v[24:27], a[52:55], v[240:243], v[24:27]
ds_read_b128 a[52:55], v1 offset:28672
v_cvt_pk_bf16_f32 v77, v154, v155
v_mfma_f32_16x16x32_bf16 v[16:19], a[56:59], v[232:235], v[16:19]
v_rcp_f32_e64 v51, v51
v_mfma_f32_16x16x32_bf16 v[24:27], a[56:59], v[244:247], v[24:27]
ds_read_b128 a[56:59], v1 offset:30720
v_cvt_pk_bf16_f32 v78, v156, v157
v_rcp_f32 v52, v52
v_mfma_f32_16x16x32_bf16 v[20:23], a[60:63], v[224:227], 0
v_rcp_f32 v53, v53
v_mfma_f32_16x16x32_bf16 v[28:31], a[60:63], v[236:239], 0
ds_read_b128 a[60:63], v1 offset:26880
v_cvt_pk_bf16_f32 v79, v158, v159
v_mfma_f32_16x16x32_bf16 v[20:23], a[64:67], v[228:231], v[20:23]
v_rcp_f32_e64 v54, v54
v_mfma_f32_16x16x32_bf16 v[28:31], a[64:67], v[240:243], v[28:31]
ds_read_b128 a[64:67], v1 offset:28928
v_cvt_pk_bf16_f32 v80, v160, v161
v_rcp_f32_e64 v55, v55
v_mfma_f32_16x16x32_bf16 v[20:23], a[68:71], v[232:235], v[20:23]
v_cvt_pk_bf16_f32 v81, v162, v163
v_mfma_f32_16x16x32_bf16 v[28:31], a[68:71], v[244:247], v[28:31]
ds_read_b128 a[68:71], v1 offset:30976
v_rcp_f32 v56, v56
v_rcp_f32 v57, v57
v_cvt_pk_bf16_f32 v82, v164, v165
v_rcp_f32 v58, v58
v_cvt_pk_bf16_f32 v83, v166, v167
v_rcp_f32 v59, v59
v_cvt_pk_bf16_f32 v84, v168, v169
v_rcp_f32 v60, v60
v_rcp_f32 v61, v61
v_cvt_pk_bf16_f32 v85, v170, v171
v_rcp_f32 v62, v62
v_cvt_pk_bf16_f32 v86, v172, v173
v_rcp_f32 v63, v63
v_cvt_pk_bf16_f32 v87, v174, v175
v_pk_mul_f32 v[32:33], v[48:49], v[32:33]
v_pk_mul_f32 v[34:35], v[50:51], v[34:35]
v_pk_mul_f32 v[36:37], v[52:53], v[36:37]
v_pk_mul_f32 v[38:39], v[54:55], v[38:39]
v_pk_mul_f32 v[40:41], v[56:57], v[40:41]
v_pk_mul_f32 v[42:43], v[58:59], v[42:43]
v_pk_mul_f32 v[44:45], v[60:61], v[44:45]
v_pk_mul_f32 v[46:47], v[62:63], v[46:47]
v_pk_fma_f32 v[48:49], v[16:17], v[16:17], s[60:61] neg_lo:[1,0,0] neg_hi:[1,0,0]
v_pk_fma_f32 v[50:51], v[18:19], v[18:19], s[60:61] neg_lo:[1,0,0] neg_hi:[1,0,0]
v_pk_fma_f32 v[52:53], v[20:21], v[20:21], s[60:61] neg_lo:[1,0,0] neg_hi:[1,0,0]
v_pk_fma_f32 v[54:55], v[22:23], v[22:23], s[60:61] neg_lo:[1,0,0] neg_hi:[1,0,0]
v_pk_fma_f32 v[56:57], v[24:25], v[24:25], s[60:61] neg_lo:[1,0,0] neg_hi:[1,0,0]
v_pk_fma_f32 v[58:59], v[26:27], v[26:27], s[60:61] neg_lo:[1,0,0] neg_hi:[1,0,0]
v_pk_fma_f32 v[60:61], v[28:29], v[28:29], s[60:61] neg_lo:[1,0,0] neg_hi:[1,0,0]
v_pk_fma_f32 v[62:63], v[30:31], v[30:31], s[60:61] neg_lo:[1,0,0] neg_hi:[1,0,0]
v_pk_mul_f32 v[48:49], v[48:49], v[16:17]
v_pk_mul_f32 v[50:51], v[50:51], v[18:19]
v_pk_mul_f32 v[52:53], v[52:53], v[20:21]
v_pk_mul_f32 v[54:55], v[54:55], v[22:23]
v_pk_mul_f32 v[56:57], v[56:57], v[24:25]
v_pk_mul_f32 v[58:59], v[58:59], v[26:27]
v_pk_mul_f32 v[60:61], v[60:61], v[28:29]
v_pk_mul_f32 v[62:63], v[62:63], v[30:31]
v_cvt_pk_bf16_f32 v88, v32, v33
v_cvt_pk_bf16_f32 v89, v34, v35
v_cvt_pk_bf16_f32 v90, v36, v37
v_cvt_pk_bf16_f32 v91, v38, v39
v_cvt_pk_bf16_f32 v92, v40, v41
s_waitcnt lgkmcnt(0)
v_mfma_f32_16x16x32_bf16 v[176:179], a[72:75], v[88:91], v[176:179]
s_mov_b32 s65, 0
v_cvt_pk_bf16_f32 v93, v42, v43
v_cvt_pk_bf16_f32 v94, v44, v45
v_mfma_f32_16x16x32_bf16 v[180:183], a[76:79], v[88:91], v[180:183]
v_cvt_pk_bf16_f32 v95, v46, v47
v_exp_f32 v48, v48
v_mfma_f32_16x16x32_bf16 v[184:187], a[80:83], v[88:91], v[184:187]
buffer_store_dwordx4 v[64:67], v4, s[28:31], s65 offen offset:0 sc1
v_exp_f32 v49, v49
v_mfma_f32_16x16x32_bf16 v[188:191], a[84:87], v[88:91], v[188:191]
v_exp_f32 v50, v50
v_mfma_f32_16x16x32_bf16 v[192:195], a[88:91], v[88:91], v[192:195]
buffer_store_dwordx4 a[124:127], v4, s[28:31], s84 offen offset:64 sc1
v_exp_f32 v51, v51
v_mfma_f32_16x16x32_bf16 v[196:199], a[92:95], v[88:91], v[196:199]
v_exp_f32 v52, v52
v_mfma_f32_16x16x32_bf16 v[200:203], a[72:75], v[92:95], v[200:203]
ds_read_b128 a[72:75], v0 offset:12288
v_exp_f32 v53, v53
v_mfma_f32_16x16x32_bf16 v[204:207], a[76:79], v[92:95], v[204:207]
ds_read_b128 a[76:79], v0 offset:12544
s_add_u32 s81, s80, 28672
v_mfma_f32_16x16x32_bf16 v[208:211], a[80:83], v[92:95], v[208:211]
ds_read_b128 a[80:83], v0 offset:14336
v_exp_f32_e64 v54, v54
v_mfma_f32_16x16x32_bf16 v[212:215], a[84:87], v[92:95], v[212:215]
ds_read_b128 a[84:87], v0 offset:14592
buffer_load_dwordx4 a[184:187], v253, s[40:43], s81 offen offset:0 sc1
v_exp_f32 v55, v55
v_mfma_f32_16x16x32_bf16 v[216:219], a[88:91], v[92:95], v[216:219]
ds_read_b128 a[88:91], v0 offset:16384
v_exp_f32 v56, v56
v_mfma_f32_16x16x32_bf16 v[220:223], a[92:95], v[92:95], v[220:223]
ds_read_b128 a[92:95], v0 offset:16640
v_exp_f32 v57, v57
v_exp_f32 v58, v58
v_exp_f32 v59, v59
v_exp_f32 v60, v60
v_exp_f32 v61, v61
v_exp_f32 v62, v62
v_exp_f32_e64 v63, v63
v_pk_add_f32 v[48:49], v[48:49], 1.0 op_sel_hi:[1,0]
v_pk_add_f32 v[50:51], v[50:51], 1.0 op_sel_hi:[1,0]
v_pk_add_f32 v[52:53], v[52:53], 1.0 op_sel_hi:[1,0]
v_pk_add_f32 v[54:55], v[54:55], 1.0 op_sel_hi:[1,0]
v_pk_add_f32 v[56:57], v[56:57], 1.0 op_sel_hi:[1,0]
v_pk_add_f32 v[58:59], v[58:59], 1.0 op_sel_hi:[1,0]
v_pk_add_f32 v[60:61], v[60:61], 1.0 op_sel_hi:[1,0]
v_pk_add_f32 v[62:63], v[62:63], 1.0 op_sel_hi:[1,0]
v_mfma_f32_16x16x32_bf16 v[32:35], a[48:51], v[224:227], 0
buffer_load_dwordx4 a[188:191], v253, s[40:43], s81 offen offset:1024 sc1
v_rcp_f32 v48, v48
v_mfma_f32_16x16x32_bf16 v[40:43], a[48:51], v[236:239], 0
ds_read_b128 a[48:51], v1 offset:32768
v_rcp_f32 v49, v49
v_mfma_f32_16x16x32_bf16 v[32:35], a[52:55], v[228:231], v[32:35]
v_rcp_f32 v50, v50
v_mfma_f32_16x16x32_bf16 v[40:43], a[52:55], v[240:243], v[40:43]
ds_read_b128 a[52:55], v1 offset:34816
v_rcp_f32 v51, v51
v_mfma_f32_16x16x32_bf16 v[32:35], a[56:59], v[232:235], v[32:35]
v_rcp_f32 v52, v52
v_mfma_f32_16x16x32_bf16 v[40:43], a[56:59], v[244:247], v[40:43]
ds_read_b128 a[56:59], v1 offset:36864
v_rcp_f32 v53, v53
v_mfma_f32_16x16x32_bf16 v[36:39], a[60:63], v[224:227], 0
v_rcp_f32 v54, v54
v_mfma_f32_16x16x32_bf16 v[44:47], a[60:63], v[236:239], 0
ds_read_b128 a[60:63], v1 offset:33024
v_rcp_f32 v55, v55
v_mfma_f32_16x16x32_bf16 v[36:39], a[64:67], v[228:231], v[36:39]
v_rcp_f32 v56, v56
v_mfma_f32_16x16x32_bf16 v[44:47], a[64:67], v[240:243], v[44:47]
ds_read_b128 a[64:67], v1 offset:35072
v_rcp_f32 v57, v57
v_mfma_f32_16x16x32_bf16 v[36:39], a[68:71], v[232:235], v[36:39]
v_rcp_f32 v58, v58
v_mfma_f32_16x16x32_bf16 v[44:47], a[68:71], v[244:247], v[44:47]
ds_read_b128 a[68:71], v1 offset:37120
v_rcp_f32 v59, v59
v_rcp_f32 v60, v60
v_rcp_f32 v61, v61
v_rcp_f32 v62, v62
v_rcp_f32 v63, v63
v_pk_mul_f32 v[16:17], v[48:49], v[16:17]
v_pk_mul_f32 v[18:19], v[50:51], v[18:19]
v_pk_mul_f32 v[20:21], v[52:53], v[20:21]
v_pk_mul_f32 v[22:23], v[54:55], v[22:23]
v_pk_mul_f32 v[24:25], v[56:57], v[24:25]
v_pk_mul_f32 v[26:27], v[58:59], v[26:27]
v_pk_mul_f32 v[28:29], v[60:61], v[28:29]
v_pk_mul_f32 v[30:31], v[62:63], v[30:31]
v_pk_fma_f32 v[48:49], v[32:33], v[32:33], s[60:61] neg_lo:[1,0,0] neg_hi:[1,0,0]
v_pk_fma_f32 v[50:51], v[34:35], v[34:35], s[60:61] neg_lo:[1,0,0] neg_hi:[1,0,0]
v_pk_fma_f32 v[52:53], v[36:37], v[36:37], s[60:61] neg_lo:[1,0,0] neg_hi:[1,0,0]
v_pk_fma_f32 v[54:55], v[38:39], v[38:39], s[60:61] neg_lo:[1,0,0] neg_hi:[1,0,0]
v_pk_fma_f32 v[56:57], v[40:41], v[40:41], s[60:61] neg_lo:[1,0,0] neg_hi:[1,0,0]
v_pk_fma_f32 v[58:59], v[42:43], v[42:43], s[60:61] neg_lo:[1,0,0] neg_hi:[1,0,0]
v_pk_fma_f32 v[60:61], v[44:45], v[44:45], s[60:61] neg_lo:[1,0,0] neg_hi:[1,0,0]
v_pk_fma_f32 v[62:63], v[46:47], v[46:47], s[60:61] neg_lo:[1,0,0] neg_hi:[1,0,0]
v_pk_mul_f32 v[48:49], v[48:49], v[32:33]
v_pk_mul_f32 v[50:51], v[50:51], v[34:35]
v_pk_mul_f32 v[52:53], v[52:53], v[36:37]
v_pk_mul_f32 v[54:55], v[54:55], v[38:39]
v_pk_mul_f32 v[56:57], v[56:57], v[40:41]
v_pk_mul_f32 v[58:59], v[58:59], v[42:43]
v_pk_mul_f32 v[60:61], v[60:61], v[44:45]
v_pk_mul_f32 v[62:63], v[62:63], v[46:47]
v_cvt_pk_bf16_f32 v88, v16, v17
v_cvt_pk_bf16_f32 v89, v18, v19
v_cvt_pk_bf16_f32 v90, v20, v21
v_cvt_pk_bf16_f32 v91, v22, v23
v_cvt_pk_bf16_f32 v92, v24, v25
s_waitcnt lgkmcnt(0)
v_mfma_f32_16x16x32_bf16 v[176:179], a[72:75], v[88:91], v[176:179]
buffer_store_dwordx4 v[68:71], v4, s[28:31], s65 offen offset:64 sc1
v_cvt_pk_bf16_f32 v93, v26, v27
v_cvt_pk_bf16_f32 v94, v28, v29
v_mfma_f32_16x16x32_bf16 v[180:183], a[76:79], v[88:91], v[180:183]
v_cvt_pk_bf16_f32 v95, v30, v31
v_exp_f32 v48, v48
v_mfma_f32_16x16x32_bf16 v[184:187], a[80:83], v[88:91], v[184:187]
v_exp_f32 v49, v49
v_mfma_f32_16x16x32_bf16 v[188:191], a[84:87], v[88:91], v[188:191]
v_exp_f32 v50, v50
v_mfma_f32_16x16x32_bf16 v[192:195], a[88:91], v[88:91], v[192:195]
v_exp_f32 v51, v51
v_mfma_f32_16x16x32_bf16 v[196:199], a[92:95], v[88:91], v[196:199]
v_exp_f32 v52, v52
v_mfma_f32_16x16x32_bf16 v[200:203], a[72:75], v[92:95], v[200:203]
ds_read_b128 a[72:75], v0 offset:18432
buffer_store_dwordx4 a[128:131], v4, s[28:31], s84 offen offset:128 sc1
v_mfma_f32_16x16x32_bf16 v[204:207], a[76:79], v[92:95], v[204:207]
ds_read_b128 a[76:79], v0 offset:18688
v_exp_f32 v53, v53
v_mfma_f32_16x16x32_bf16 v[208:211], a[80:83], v[92:95], v[208:211]
ds_read_b128 a[80:83], v0 offset:20480
v_exp_f32 v54, v54
v_mfma_f32_16x16x32_bf16 v[212:215], a[84:87], v[92:95], v[212:215]
ds_read_b128 a[84:87], v0 offset:20736
v_exp_f32 v55, v55
v_mfma_f32_16x16x32_bf16 v[216:219], a[88:91], v[92:95], v[216:219]
ds_read_b128 a[88:91], v0 offset:22528
v_exp_f32 v56, v56
v_mfma_f32_16x16x32_bf16 v[220:223], a[92:95], v[92:95], v[220:223]
ds_read_b128 a[92:95], v0 offset:22784
v_exp_f32 v57, v57
v_exp_f32 v58, v58
v_exp_f32 v59, v59
v_exp_f32 v60, v60
v_exp_f32 v61, v61
v_exp_f32 v62, v62
v_exp_f32_e64 v63, v63
v_pk_add_f32 v[48:49], v[48:49], 1.0 op_sel_hi:[1,0]
v_pk_add_f32 v[50:51], v[50:51], 1.0 op_sel_hi:[1,0]
v_pk_add_f32 v[52:53], v[52:53], 1.0 op_sel_hi:[1,0]
v_pk_add_f32 v[54:55], v[54:55], 1.0 op_sel_hi:[1,0]
v_pk_add_f32 v[56:57], v[56:57], 1.0 op_sel_hi:[1,0]
v_pk_add_f32 v[58:59], v[58:59], 1.0 op_sel_hi:[1,0]
v_pk_add_f32 v[60:61], v[60:61], 1.0 op_sel_hi:[1,0]
v_pk_add_f32 v[62:63], v[62:63], 1.0 op_sel_hi:[1,0]
v_mfma_f32_16x16x32_bf16 v[16:19], a[48:51], v[224:227], 0
s_add_u32 s81, s80, 6144
v_rcp_f32 v48, v48
v_mfma_f32_16x16x32_bf16 v[24:27], a[48:51], v[236:239], 0
ds_read_b128 a[48:51], v1 offset:38912
v_rcp_f32 v49, v49
v_mfma_f32_16x16x32_bf16 v[16:19], a[52:55], v[228:231], v[16:19]
v_rcp_f32 v50, v50
v_mfma_f32_16x16x32_bf16 v[24:27], a[52:55], v[240:243], v[24:27]
ds_read_b128 a[52:55], v1 offset:40960
v_rcp_f32 v51, v51
v_mfma_f32_16x16x32_bf16 v[16:19], a[56:59], v[232:235], v[16:19]
v_rcp_f32 v52, v52
v_mfma_f32_16x16x32_bf16 v[24:27], a[56:59], v[244:247], v[24:27]
ds_read_b128 a[56:59], v1 offset:43008
v_rcp_f32 v53, v53
v_mfma_f32_16x16x32_bf16 v[20:23], a[60:63], v[224:227], 0
buffer_load_dwordx4 a[96:99], v253, s[40:43], s81 offen offset:0 sc1
v_rcp_f32 v54, v54
v_mfma_f32_16x16x32_bf16 v[28:31], a[60:63], v[236:239], 0
ds_read_b128 a[60:63], v1 offset:39168
v_rcp_f32 v55, v55
v_mfma_f32_16x16x32_bf16 v[20:23], a[64:67], v[228:231], v[20:23]
v_rcp_f32 v56, v56
v_mfma_f32_16x16x32_bf16 v[28:31], a[64:67], v[240:243], v[28:31]
ds_read_b128 a[64:67], v1 offset:41216
v_rcp_f32 v57, v57
v_mfma_f32_16x16x32_bf16 v[20:23], a[68:71], v[232:235], v[20:23]
v_rcp_f32 v58, v58
v_mfma_f32_16x16x32_bf16 v[28:31], a[68:71], v[244:247], v[28:31]
ds_read_b128 a[68:71], v1 offset:43264
v_rcp_f32 v59, v59
v_rcp_f32 v60, v60
v_rcp_f32 v61, v61
v_rcp_f32 v62, v62
v_rcp_f32 v63, v63
v_pk_mul_f32 v[32:33], v[48:49], v[32:33]
v_pk_mul_f32 v[34:35], v[50:51], v[34:35]
v_pk_mul_f32 v[36:37], v[52:53], v[36:37]
v_pk_mul_f32 v[38:39], v[54:55], v[38:39]
v_pk_mul_f32 v[40:41], v[56:57], v[40:41]
v_pk_mul_f32 v[42:43], v[58:59], v[42:43]
v_pk_mul_f32 v[44:45], v[60:61], v[44:45]
v_pk_mul_f32 v[46:47], v[62:63], v[46:47]
v_pk_fma_f32 v[48:49], v[16:17], v[16:17], s[60:61] neg_lo:[1,0,0] neg_hi:[1,0,0]
v_pk_fma_f32 v[50:51], v[18:19], v[18:19], s[60:61] neg_lo:[1,0,0] neg_hi:[1,0,0]
v_pk_fma_f32 v[52:53], v[20:21], v[20:21], s[60:61] neg_lo:[1,0,0] neg_hi:[1,0,0]
v_pk_fma_f32 v[54:55], v[22:23], v[22:23], s[60:61] neg_lo:[1,0,0] neg_hi:[1,0,0]
v_pk_fma_f32 v[56:57], v[24:25], v[24:25], s[60:61] neg_lo:[1,0,0] neg_hi:[1,0,0]
v_pk_fma_f32 v[58:59], v[26:27], v[26:27], s[60:61] neg_lo:[1,0,0] neg_hi:[1,0,0]
v_pk_fma_f32 v[60:61], v[28:29], v[28:29], s[60:61] neg_lo:[1,0,0] neg_hi:[1,0,0]
v_pk_fma_f32 v[62:63], v[30:31], v[30:31], s[60:61] neg_lo:[1,0,0] neg_hi:[1,0,0]
v_pk_mul_f32 v[48:49], v[48:49], v[16:17]
v_pk_mul_f32 v[50:51], v[50:51], v[18:19]
v_pk_mul_f32 v[52:53], v[52:53], v[20:21]
v_pk_mul_f32 v[54:55], v[54:55], v[22:23]
v_pk_mul_f32 v[56:57], v[56:57], v[24:25]
v_pk_mul_f32 v[58:59], v[58:59], v[26:27]
v_pk_mul_f32 v[60:61], v[60:61], v[28:29]
v_pk_mul_f32 v[62:63], v[62:63], v[30:31]
v_cvt_pk_bf16_f32 v88, v32, v33
v_cvt_pk_bf16_f32 v89, v34, v35
v_cvt_pk_bf16_f32 v90, v36, v37
v_cvt_pk_bf16_f32 v91, v38, v39
v_cvt_pk_bf16_f32 v92, v40, v41
s_waitcnt lgkmcnt(0)
v_mfma_f32_16x16x32_bf16 v[176:179], a[72:75], v[88:91], v[176:179]
buffer_store_dwordx4 a[132:135], v4, s[28:31], s84 offen offset:3072 sc1
v_cvt_pk_bf16_f32 v93, v42, v43
v_cvt_pk_bf16_f32 v94, v44, v45
v_mfma_f32_16x16x32_bf16 v[180:183], a[76:79], v[88:91], v[180:183]
v_cvt_pk_bf16_f32 v95, v46, v47
v_exp_f32 v48, v48
v_mfma_f32_16x16x32_bf16 v[184:187], a[80:83], v[88:91], v[184:187]
v_exp_f32 v49, v49
v_mfma_f32_16x16x32_bf16 v[188:191], a[84:87], v[88:91], v[188:191]
v_exp_f32 v50, v50
v_mfma_f32_16x16x32_bf16 v[192:195], a[88:91], v[88:91], v[192:195]
v_exp_f32 v51, v51
v_mfma_f32_16x16x32_bf16 v[196:199], a[92:95], v[88:91], v[196:199]
v_exp_f32 v52, v52
v_mfma_f32_16x16x32_bf16 v[200:203], a[72:75], v[92:95], v[200:203]
ds_read_b128 a[72:75], v0 offset:24576
buffer_load_dwordx4 a[100:103], v253, s[40:43], s81 offen offset:1024 sc1
v_mfma_f32_16x16x32_bf16 v[204:207], a[76:79], v[92:95], v[204:207]
ds_read_b128 a[76:79], v0 offset:24832
v_exp_f32 v53, v53
v_mfma_f32_16x16x32_bf16 v[208:211], a[80:83], v[92:95], v[208:211]
ds_read_b128 a[80:83], v0 offset:26624
v_exp_f32 v54, v54
v_mfma_f32_16x16x32_bf16 v[212:215], a[84:87], v[92:95], v[212:215]
ds_read_b128 a[84:87], v0 offset:26880
v_exp_f32 v55, v55
v_mfma_f32_16x16x32_bf16 v[216:219], a[88:91], v[92:95], v[216:219]
ds_read_b128 a[88:91], v0 offset:28672
v_exp_f32 v56, v56
v_mfma_f32_16x16x32_bf16 v[220:223], a[92:95], v[92:95], v[220:223]
ds_read_b128 a[92:95], v0 offset:28928
v_exp_f32 v57, v57
v_exp_f32 v58, v58
v_exp_f32 v59, v59
v_exp_f32 v60, v60
v_exp_f32 v61, v61
v_exp_f32 v62, v62
v_exp_f32_e64 v63, v63
v_pk_add_f32 v[48:49], v[48:49], 1.0 op_sel_hi:[1,0]
v_pk_add_f32 v[50:51], v[50:51], 1.0 op_sel_hi:[1,0]
v_pk_add_f32 v[52:53], v[52:53], 1.0 op_sel_hi:[1,0]
v_pk_add_f32 v[54:55], v[54:55], 1.0 op_sel_hi:[1,0]
v_pk_add_f32 v[56:57], v[56:57], 1.0 op_sel_hi:[1,0]
v_pk_add_f32 v[58:59], v[58:59], 1.0 op_sel_hi:[1,0]
v_pk_add_f32 v[60:61], v[60:61], 1.0 op_sel_hi:[1,0]
v_pk_add_f32 v[62:63], v[62:63], 1.0 op_sel_hi:[1,0]
v_mfma_f32_16x16x32_bf16 v[32:35], a[48:51], v[224:227], 0
buffer_store_dwordx4 v[72:75], v4, s[28:31], s65 offen offset:128 sc1
v_rcp_f32 v48, v48
v_mfma_f32_16x16x32_bf16 v[40:43], a[48:51], v[236:239], 0
ds_read_b128 a[48:51], v1 offset:45056
v_rcp_f32 v49, v49
v_mfma_f32_16x16x32_bf16 v[32:35], a[52:55], v[228:231], v[32:35]
v_rcp_f32 v50, v50
v_mfma_f32_16x16x32_bf16 v[40:43], a[52:55], v[240:243], v[40:43]
ds_read_b128 a[52:55], v1 offset:47104
v_rcp_f32 v51, v51
v_mfma_f32_16x16x32_bf16 v[32:35], a[56:59], v[232:235], v[32:35]
s_add_u32 s81, s80, 8192
v_rcp_f32 v52, v52
v_mfma_f32_16x16x32_bf16 v[40:43], a[56:59], v[244:247], v[40:43]
ds_read_b128 a[56:59], v1 offset:49152
v_rcp_f32 v53, v53
v_mfma_f32_16x16x32_bf16 v[36:39], a[60:63], v[224:227], 0
v_rcp_f32 v54, v54
v_mfma_f32_16x16x32_bf16 v[44:47], a[60:63], v[236:239], 0
ds_read_b128 a[60:63], v1 offset:45312
v_rcp_f32 v55, v55
v_mfma_f32_16x16x32_bf16 v[36:39], a[64:67], v[228:231], v[36:39]
buffer_load_dwordx4 a[104:107], v253, s[40:43], s81 offen offset:0 sc1
v_rcp_f32 v56, v56
v_mfma_f32_16x16x32_bf16 v[44:47], a[64:67], v[240:243], v[44:47]
ds_read_b128 a[64:67], v1 offset:47360
v_rcp_f32 v57, v57
v_mfma_f32_16x16x32_bf16 v[36:39], a[68:71], v[232:235], v[36:39]
v_rcp_f32 v58, v58
v_mfma_f32_16x16x32_bf16 v[44:47], a[68:71], v[244:247], v[44:47]
ds_read_b128 a[68:71], v1 offset:49408
v_rcp_f32 v59, v59
v_rcp_f32 v60, v60
v_rcp_f32 v61, v61
v_rcp_f32 v62, v62
v_rcp_f32 v63, v63
v_pk_mul_f32 v[16:17], v[48:49], v[16:17]
v_pk_mul_f32 v[18:19], v[50:51], v[18:19]
v_pk_mul_f32 v[20:21], v[52:53], v[20:21]
v_pk_mul_f32 v[22:23], v[54:55], v[22:23]
v_pk_mul_f32 v[24:25], v[56:57], v[24:25]
v_pk_mul_f32 v[26:27], v[58:59], v[26:27]
v_pk_mul_f32 v[28:29], v[60:61], v[28:29]
v_pk_mul_f32 v[30:31], v[62:63], v[30:31]
v_pk_fma_f32 v[48:49], v[32:33], v[32:33], s[60:61] neg_lo:[1,0,0] neg_hi:[1,0,0]
v_pk_fma_f32 v[50:51], v[34:35], v[34:35], s[60:61] neg_lo:[1,0,0] neg_hi:[1,0,0]
v_pk_fma_f32 v[52:53], v[36:37], v[36:37], s[60:61] neg_lo:[1,0,0] neg_hi:[1,0,0]
v_pk_fma_f32 v[54:55], v[38:39], v[38:39], s[60:61] neg_lo:[1,0,0] neg_hi:[1,0,0]
v_pk_fma_f32 v[56:57], v[40:41], v[40:41], s[60:61] neg_lo:[1,0,0] neg_hi:[1,0,0]
v_pk_fma_f32 v[58:59], v[42:43], v[42:43], s[60:61] neg_lo:[1,0,0] neg_hi:[1,0,0]
v_pk_fma_f32 v[60:61], v[44:45], v[44:45], s[60:61] neg_lo:[1,0,0] neg_hi:[1,0,0]
v_pk_fma_f32 v[62:63], v[46:47], v[46:47], s[60:61] neg_lo:[1,0,0] neg_hi:[1,0,0]
v_pk_mul_f32 v[48:49], v[48:49], v[32:33]
v_pk_mul_f32 v[50:51], v[50:51], v[34:35]
v_pk_mul_f32 v[52:53], v[52:53], v[36:37]
v_pk_mul_f32 v[54:55], v[54:55], v[38:39]
v_pk_mul_f32 v[56:57], v[56:57], v[40:41]
v_pk_mul_f32 v[58:59], v[58:59], v[42:43]
v_pk_mul_f32 v[60:61], v[60:61], v[44:45]
v_pk_mul_f32 v[62:63], v[62:63], v[46:47]
v_cvt_pk_bf16_f32 v88, v16, v17
v_cvt_pk_bf16_f32 v89, v18, v19
v_cvt_pk_bf16_f32 v90, v20, v21
v_cvt_pk_bf16_f32 v91, v22, v23
v_cvt_pk_bf16_f32 v92, v24, v25
s_waitcnt lgkmcnt(0)
v_mfma_f32_16x16x32_bf16 v[176:179], a[72:75], v[88:91], v[176:179]
buffer_store_dwordx4 a[136:139], v4, s[28:31], s84 offen offset:3136 sc1
v_cvt_pk_bf16_f32 v93, v26, v27
v_cvt_pk_bf16_f32 v94, v28, v29
v_mfma_f32_16x16x32_bf16 v[180:183], a[76:79], v[88:91], v[180:183]
v_cvt_pk_bf16_f32 v95, v30, v31
v_exp_f32 v48, v48
v_mfma_f32_16x16x32_bf16 v[184:187], a[80:83], v[88:91], v[184:187]
v_exp_f32 v49, v49
v_mfma_f32_16x16x32_bf16 v[188:191], a[84:87], v[88:91], v[188:191]
v_exp_f32 v50, v50
v_mfma_f32_16x16x32_bf16 v[192:195], a[88:91], v[88:91], v[192:195]
v_exp_f32 v51, v51
v_mfma_f32_16x16x32_bf16 v[196:199], a[92:95], v[88:91], v[196:199]
v_exp_f32 v52, v52
v_mfma_f32_16x16x32_bf16 v[200:203], a[72:75], v[92:95], v[200:203]
ds_read_b128 a[72:75], v0 offset:30720
buffer_load_dwordx4 a[108:111], v253, s[40:43], s81 offen offset:1024 sc1
v_mfma_f32_16x16x32_bf16 v[204:207], a[76:79], v[92:95], v[204:207]
ds_read_b128 a[76:79], v0 offset:30976
v_exp_f32 v53, v53
v_mfma_f32_16x16x32_bf16 v[208:211], a[80:83], v[92:95], v[208:211]
ds_read_b128 a[80:83], v0 offset:32768
v_exp_f32 v54, v54
v_mfma_f32_16x16x32_bf16 v[212:215], a[84:87], v[92:95], v[212:215]
ds_read_b128 a[84:87], v0 offset:33024
v_exp_f32 v55, v55
v_mfma_f32_16x16x32_bf16 v[216:219], a[88:91], v[92:95], v[216:219]
ds_read_b128 a[88:91], v0 offset:34816
v_exp_f32 v56, v56
v_mfma_f32_16x16x32_bf16 v[220:223], a[92:95], v[92:95], v[220:223]
ds_read_b128 a[92:95], v0 offset:35072
v_exp_f32 v57, v57
v_exp_f32 v58, v58
v_exp_f32 v59, v59
v_exp_f32 v60, v60
v_exp_f32 v61, v61
v_exp_f32 v62, v62
v_exp_f32_e64 v63, v63
v_pk_add_f32 v[48:49], v[48:49], 1.0 op_sel_hi:[1,0]
v_pk_add_f32 v[50:51], v[50:51], 1.0 op_sel_hi:[1,0]
v_pk_add_f32 v[52:53], v[52:53], 1.0 op_sel_hi:[1,0]
v_pk_add_f32 v[54:55], v[54:55], 1.0 op_sel_hi:[1,0]
v_pk_add_f32 v[56:57], v[56:57], 1.0 op_sel_hi:[1,0]
v_pk_add_f32 v[58:59], v[58:59], 1.0 op_sel_hi:[1,0]
v_pk_add_f32 v[60:61], v[60:61], 1.0 op_sel_hi:[1,0]
v_pk_add_f32 v[62:63], v[62:63], 1.0 op_sel_hi:[1,0]
v_mfma_f32_16x16x32_bf16 v[16:19], a[48:51], v[224:227], 0
buffer_store_dwordx4 v[76:79], v4, s[28:31], s65 offen offset:3072 sc1
v_rcp_f32 v48, v48
v_mfma_f32_16x16x32_bf16 v[24:27], a[48:51], v[236:239], 0
ds_read_b128 a[48:51], v1 offset:51200
v_rcp_f32 v49, v49
v_mfma_f32_16x16x32_bf16 v[16:19], a[52:55], v[228:231], v[16:19]
v_rcp_f32 v50, v50
v_mfma_f32_16x16x32_bf16 v[24:27], a[52:55], v[240:243], v[24:27]
ds_read_b128 a[52:55], v1 offset:53248
v_rcp_f32 v51, v51
v_mfma_f32_16x16x32_bf16 v[16:19], a[56:59], v[232:235], v[16:19]
s_add_u32 s81, s80, 10240
v_rcp_f32 v52, v52
v_mfma_f32_16x16x32_bf16 v[24:27], a[56:59], v[244:247], v[24:27]
ds_read_b128 a[56:59], v1 offset:55296
v_rcp_f32 v53, v53
v_mfma_f32_16x16x32_bf16 v[20:23], a[60:63], v[224:227], 0
v_rcp_f32 v54, v54
v_mfma_f32_16x16x32_bf16 v[28:31], a[60:63], v[236:239], 0
ds_read_b128 a[60:63], v1 offset:51456
v_rcp_f32 v55, v55
v_mfma_f32_16x16x32_bf16 v[20:23], a[64:67], v[228:231], v[20:23]
buffer_load_dwordx4 a[112:115], v253, s[40:43], s81 offen offset:0 sc1
v_rcp_f32 v56, v56
v_mfma_f32_16x16x32_bf16 v[28:31], a[64:67], v[240:243], v[28:31]
ds_read_b128 a[64:67], v1 offset:53504
v_rcp_f32 v57, v57
v_mfma_f32_16x16x32_bf16 v[20:23], a[68:71], v[232:235], v[20:23]
v_rcp_f32 v58, v58
v_mfma_f32_16x16x32_bf16 v[28:31], a[68:71], v[244:247], v[28:31]
ds_read_b128 a[68:71], v1 offset:55552
v_rcp_f32 v59, v59
v_rcp_f32 v60, v60
v_rcp_f32 v61, v61
v_rcp_f32 v62, v62
v_rcp_f32 v63, v63
v_pk_mul_f32 v[32:33], v[48:49], v[32:33]
v_pk_mul_f32 v[34:35], v[50:51], v[34:35]
v_pk_mul_f32 v[36:37], v[52:53], v[36:37]
v_pk_mul_f32 v[38:39], v[54:55], v[38:39]
v_pk_mul_f32 v[40:41], v[56:57], v[40:41]
v_pk_mul_f32 v[42:43], v[58:59], v[42:43]
v_pk_mul_f32 v[44:45], v[60:61], v[44:45]
v_pk_mul_f32 v[46:47], v[62:63], v[46:47]
v_pk_fma_f32 v[48:49], v[16:17], v[16:17], s[60:61] neg_lo:[1,0,0] neg_hi:[1,0,0]
v_pk_fma_f32 v[50:51], v[18:19], v[18:19], s[60:61] neg_lo:[1,0,0] neg_hi:[1,0,0]
v_pk_fma_f32 v[52:53], v[20:21], v[20:21], s[60:61] neg_lo:[1,0,0] neg_hi:[1,0,0]
v_pk_fma_f32 v[54:55], v[22:23], v[22:23], s[60:61] neg_lo:[1,0,0] neg_hi:[1,0,0]
v_pk_fma_f32 v[56:57], v[24:25], v[24:25], s[60:61] neg_lo:[1,0,0] neg_hi:[1,0,0]
v_pk_fma_f32 v[58:59], v[26:27], v[26:27], s[60:61] neg_lo:[1,0,0] neg_hi:[1,0,0]
v_pk_fma_f32 v[60:61], v[28:29], v[28:29], s[60:61] neg_lo:[1,0,0] neg_hi:[1,0,0]
v_pk_fma_f32 v[62:63], v[30:31], v[30:31], s[60:61] neg_lo:[1,0,0] neg_hi:[1,0,0]
v_pk_mul_f32 v[48:49], v[48:49], v[16:17]
v_pk_mul_f32 v[50:51], v[50:51], v[18:19]
v_pk_mul_f32 v[52:53], v[52:53], v[20:21]
v_pk_mul_f32 v[54:55], v[54:55], v[22:23]
v_pk_mul_f32 v[56:57], v[56:57], v[24:25]
v_pk_mul_f32 v[58:59], v[58:59], v[26:27]
v_pk_mul_f32 v[60:61], v[60:61], v[28:29]
v_pk_mul_f32 v[62:63], v[62:63], v[30:31]
v_cvt_pk_bf16_f32 v88, v32, v33
v_cvt_pk_bf16_f32 v89, v34, v35
v_cvt_pk_bf16_f32 v90, v36, v37
v_cvt_pk_bf16_f32 v91, v38, v39
v_cvt_pk_bf16_f32 v92, v40, v41
s_waitcnt lgkmcnt(0)
v_mfma_f32_16x16x32_bf16 v[176:179], a[72:75], v[88:91], v[176:179]
buffer_store_dwordx4 a[140:143], v4, s[28:31], s84 offen offset:3200 sc1
v_cvt_pk_bf16_f32 v93, v42, v43
v_cvt_pk_bf16_f32 v94, v44, v45
v_mfma_f32_16x16x32_bf16 v[180:183], a[76:79], v[88:91], v[180:183]
v_cvt_pk_bf16_f32 v95, v46, v47
v_exp_f32 v48, v48
v_mfma_f32_16x16x32_bf16 v[184:187], a[80:83], v[88:91], v[184:187]
v_exp_f32 v49, v49
v_mfma_f32_16x16x32_bf16 v[188:191], a[84:87], v[88:91], v[188:191]
v_exp_f32 v50, v50
v_mfma_f32_16x16x32_bf16 v[192:195], a[88:91], v[88:91], v[192:195]
v_exp_f32 v51, v51
v_mfma_f32_16x16x32_bf16 v[196:199], a[92:95], v[88:91], v[196:199]
v_exp_f32 v52, v52
v_mfma_f32_16x16x32_bf16 v[200:203], a[72:75], v[92:95], v[200:203]
ds_read_b128 a[72:75], v0 offset:36864
buffer_load_dwordx4 a[116:119], v253, s[40:43], s81 offen offset:1024 sc1
v_mfma_f32_16x16x32_bf16 v[204:207], a[76:79], v[92:95], v[204:207]
ds_read_b128 a[76:79], v0 offset:37120
v_exp_f32 v53, v53
v_mfma_f32_16x16x32_bf16 v[208:211], a[80:83], v[92:95], v[208:211]
ds_read_b128 a[80:83], v0 offset:38912
v_exp_f32 v54, v54
v_mfma_f32_16x16x32_bf16 v[212:215], a[84:87], v[92:95], v[212:215]
ds_read_b128 a[84:87], v0 offset:39168
v_exp_f32 v55, v55
v_mfma_f32_16x16x32_bf16 v[216:219], a[88:91], v[92:95], v[216:219]
ds_read_b128 a[88:91], v0 offset:40960
v_exp_f32 v56, v56
v_mfma_f32_16x16x32_bf16 v[220:223], a[92:95], v[92:95], v[220:223]
ds_read_b128 a[92:95], v0 offset:41216
v_exp_f32 v57, v57
v_exp_f32 v58, v58
v_exp_f32 v59, v59
v_exp_f32 v60, v60
v_exp_f32 v61, v61
v_exp_f32 v62, v62
v_exp_f32_e64 v63, v63
v_pk_add_f32 v[48:49], v[48:49], 1.0 op_sel_hi:[1,0]
v_pk_add_f32 v[50:51], v[50:51], 1.0 op_sel_hi:[1,0]
v_pk_add_f32 v[52:53], v[52:53], 1.0 op_sel_hi:[1,0]
v_pk_add_f32 v[54:55], v[54:55], 1.0 op_sel_hi:[1,0]
v_pk_add_f32 v[56:57], v[56:57], 1.0 op_sel_hi:[1,0]
v_pk_add_f32 v[58:59], v[58:59], 1.0 op_sel_hi:[1,0]
v_pk_add_f32 v[60:61], v[60:61], 1.0 op_sel_hi:[1,0]
v_pk_add_f32 v[62:63], v[62:63], 1.0 op_sel_hi:[1,0]
v_mfma_f32_16x16x32_bf16 v[32:35], a[48:51], v[224:227], 0
s_add_u32 s81, s80, 12288
v_rcp_f32 v48, v48
v_mfma_f32_16x16x32_bf16 v[40:43], a[48:51], v[236:239], 0
ds_read_b128 a[48:51], v1 offset:57344
v_rcp_f32 v49, v49
v_mfma_f32_16x16x32_bf16 v[32:35], a[52:55], v[228:231], v[32:35]
v_rcp_f32 v50, v50
v_mfma_f32_16x16x32_bf16 v[40:43], a[52:55], v[240:243], v[40:43]
ds_read_b128 a[52:55], v1 offset:59392
v_rcp_f32 v51, v51
v_mfma_f32_16x16x32_bf16 v[32:35], a[56:59], v[232:235], v[32:35]
v_rcp_f32 v52, v52
v_mfma_f32_16x16x32_bf16 v[40:43], a[56:59], v[244:247], v[40:43]
ds_read_b128 a[56:59], v1 offset:61440
v_rcp_f32 v53, v53
v_mfma_f32_16x16x32_bf16 v[36:39], a[60:63], v[224:227], 0
buffer_load_dwordx4 a[120:123], v253, s[40:43], s81 offen offset:0 sc1
v_rcp_f32 v54, v54
v_mfma_f32_16x16x32_bf16 v[44:47], a[60:63], v[236:239], 0
ds_read_b128 a[60:63], v1 offset:57600
v_rcp_f32 v55, v55
v_mfma_f32_16x16x32_bf16 v[36:39], a[64:67], v[228:231], v[36:39]
v_rcp_f32 v56, v56
v_mfma_f32_16x16x32_bf16 v[44:47], a[64:67], v[240:243], v[44:47]
ds_read_b128 a[64:67], v1 offset:59648
v_rcp_f32 v57, v57
v_mfma_f32_16x16x32_bf16 v[36:39], a[68:71], v[232:235], v[36:39]
v_rcp_f32 v58, v58
v_mfma_f32_16x16x32_bf16 v[44:47], a[68:71], v[244:247], v[44:47]
ds_read_b128 a[68:71], v1 offset:61696
v_rcp_f32 v59, v59
v_rcp_f32 v60, v60
v_rcp_f32 v61, v61
v_rcp_f32 v62, v62
v_rcp_f32 v63, v63
v_pk_mul_f32 v[16:17], v[48:49], v[16:17]
v_pk_mul_f32 v[18:19], v[50:51], v[18:19]
v_pk_mul_f32 v[20:21], v[52:53], v[20:21]
v_pk_mul_f32 v[22:23], v[54:55], v[22:23]
v_pk_mul_f32 v[24:25], v[56:57], v[24:25]
v_pk_mul_f32 v[26:27], v[58:59], v[26:27]
v_pk_mul_f32 v[28:29], v[60:61], v[28:29]
v_pk_mul_f32 v[30:31], v[62:63], v[30:31]
v_pk_fma_f32 v[48:49], v[32:33], v[32:33], s[60:61] neg_lo:[1,0,0] neg_hi:[1,0,0]
v_pk_fma_f32 v[50:51], v[34:35], v[34:35], s[60:61] neg_lo:[1,0,0] neg_hi:[1,0,0]
v_pk_fma_f32 v[52:53], v[36:37], v[36:37], s[60:61] neg_lo:[1,0,0] neg_hi:[1,0,0]
v_pk_fma_f32 v[54:55], v[38:39], v[38:39], s[60:61] neg_lo:[1,0,0] neg_hi:[1,0,0]
v_pk_fma_f32 v[56:57], v[40:41], v[40:41], s[60:61] neg_lo:[1,0,0] neg_hi:[1,0,0]
v_pk_fma_f32 v[58:59], v[42:43], v[42:43], s[60:61] neg_lo:[1,0,0] neg_hi:[1,0,0]
v_pk_fma_f32 v[60:61], v[44:45], v[44:45], s[60:61] neg_lo:[1,0,0] neg_hi:[1,0,0]
v_pk_fma_f32 v[62:63], v[46:47], v[46:47], s[60:61] neg_lo:[1,0,0] neg_hi:[1,0,0]
v_pk_mul_f32 v[48:49], v[48:49], v[32:33]
v_pk_mul_f32 v[50:51], v[50:51], v[34:35]
v_pk_mul_f32 v[52:53], v[52:53], v[36:37]
v_pk_mul_f32 v[54:55], v[54:55], v[38:39]
v_pk_mul_f32 v[56:57], v[56:57], v[40:41]
v_pk_mul_f32 v[58:59], v[58:59], v[42:43]
v_pk_mul_f32 v[60:61], v[60:61], v[44:45]
v_pk_mul_f32 v[62:63], v[62:63], v[46:47]
v_cvt_pk_bf16_f32 v88, v16, v17
v_cvt_pk_bf16_f32 v89, v18, v19
v_cvt_pk_bf16_f32 v90, v20, v21
v_cvt_pk_bf16_f32 v91, v22, v23
v_cvt_pk_bf16_f32 v92, v24, v25
s_waitcnt lgkmcnt(0)
v_mfma_f32_16x16x32_bf16 v[176:179], a[72:75], v[88:91], v[176:179]
buffer_store_dwordx4 v[80:83], v4, s[28:31], s65 offen offset:3136 sc1
v_cvt_pk_bf16_f32 v93, v26, v27
v_cvt_pk_bf16_f32 v94, v28, v29
v_mfma_f32_16x16x32_bf16 v[180:183], a[76:79], v[88:91], v[180:183]
v_cvt_pk_bf16_f32 v95, v30, v31
v_exp_f32 v48, v48
v_mfma_f32_16x16x32_bf16 v[184:187], a[80:83], v[88:91], v[184:187]
v_exp_f32 v49, v49
v_mfma_f32_16x16x32_bf16 v[188:191], a[84:87], v[88:91], v[188:191]
v_exp_f32 v50, v50
v_mfma_f32_16x16x32_bf16 v[192:195], a[88:91], v[88:91], v[192:195]
v_exp_f32 v51, v51
v_mfma_f32_16x16x32_bf16 v[196:199], a[92:95], v[88:91], v[196:199]
v_exp_f32 v52, v52
v_mfma_f32_16x16x32_bf16 v[200:203], a[72:75], v[92:95], v[200:203]
ds_read_b128 a[72:75], v0 offset:43008
buffer_load_dwordx4 a[124:127], v253, s[40:43], s81 offen offset:1024 sc1
v_mfma_f32_16x16x32_bf16 v[204:207], a[76:79], v[92:95], v[204:207]
ds_read_b128 a[76:79], v0 offset:43264
v_exp_f32 v53, v53
v_mfma_f32_16x16x32_bf16 v[208:211], a[80:83], v[92:95], v[208:211]
ds_read_b128 a[80:83], v0 offset:45056
v_exp_f32 v54, v54
v_mfma_f32_16x16x32_bf16 v[212:215], a[84:87], v[92:95], v[212:215]
ds_read_b128 a[84:87], v0 offset:45312
v_exp_f32 v55, v55
v_mfma_f32_16x16x32_bf16 v[216:219], a[88:91], v[92:95], v[216:219]
ds_read_b128 a[88:91], v0 offset:47104
v_exp_f32 v56, v56
v_mfma_f32_16x16x32_bf16 v[220:223], a[92:95], v[92:95], v[220:223]
ds_read_b128 a[92:95], v0 offset:47360
v_exp_f32 v57, v57
v_exp_f32 v58, v58
v_exp_f32 v59, v59
v_exp_f32 v60, v60
v_exp_f32 v61, v61
v_exp_f32 v62, v62
v_exp_f32_e64 v63, v63
v_pk_add_f32 v[48:49], v[48:49], 1.0 op_sel_hi:[1,0]
v_pk_add_f32 v[50:51], v[50:51], 1.0 op_sel_hi:[1,0]
v_pk_add_f32 v[52:53], v[52:53], 1.0 op_sel_hi:[1,0]
v_pk_add_f32 v[54:55], v[54:55], 1.0 op_sel_hi:[1,0]
v_pk_add_f32 v[56:57], v[56:57], 1.0 op_sel_hi:[1,0]
v_pk_add_f32 v[58:59], v[58:59], 1.0 op_sel_hi:[1,0]
v_pk_add_f32 v[60:61], v[60:61], 1.0 op_sel_hi:[1,0]
v_pk_add_f32 v[62:63], v[62:63], 1.0 op_sel_hi:[1,0]
v_mfma_f32_16x16x32_bf16 v[16:19], a[48:51], v[224:227], 0
s_add_u32 s81, s80, 14336
v_rcp_f32 v48, v48
v_mfma_f32_16x16x32_bf16 v[24:27], a[48:51], v[236:239], 0
ds_read_b128 a[48:51], v1 offset:63488
v_rcp_f32 v49, v49
v_mfma_f32_16x16x32_bf16 v[16:19], a[52:55], v[228:231], v[16:19]
v_rcp_f32 v50, v50
v_mfma_f32_16x16x32_bf16 v[24:27], a[52:55], v[240:243], v[24:27]
ds_read_b128 a[52:55], v7 offset:0
v_rcp_f32 v51, v51
v_mfma_f32_16x16x32_bf16 v[16:19], a[56:59], v[232:235], v[16:19]
v_rcp_f32 v52, v52
v_mfma_f32_16x16x32_bf16 v[24:27], a[56:59], v[244:247], v[24:27]
ds_read_b128 a[56:59], v7 offset:2048
v_rcp_f32 v53, v53
v_mfma_f32_16x16x32_bf16 v[20:23], a[60:63], v[224:227], 0
buffer_load_dwordx4 a[128:131], v253, s[40:43], s81 offen offset:0 sc1
v_rcp_f32 v54, v54
v_mfma_f32_16x16x32_bf16 v[28:31], a[60:63], v[236:239], 0
ds_read_b128 a[60:63], v1 offset:63744
v_rcp_f32 v55, v55
v_mfma_f32_16x16x32_bf16 v[20:23], a[64:67], v[228:231], v[20:23]
v_rcp_f32 v56, v56
v_mfma_f32_16x16x32_bf16 v[28:31], a[64:67], v[240:243], v[28:31]
ds_read_b128 a[64:67], v7 offset:256
v_rcp_f32 v57, v57
v_mfma_f32_16x16x32_bf16 v[20:23], a[68:71], v[232:235], v[20:23]
v_rcp_f32 v58, v58
v_mfma_f32_16x16x32_bf16 v[28:31], a[68:71], v[244:247], v[28:31]
ds_read_b128 a[68:71], v7 offset:2304
v_rcp_f32 v59, v59
v_rcp_f32 v60, v60
v_rcp_f32 v61, v61
v_rcp_f32 v62, v62
v_rcp_f32 v63, v63
v_pk_mul_f32 v[32:33], v[48:49], v[32:33]
v_pk_mul_f32 v[34:35], v[50:51], v[34:35]
v_pk_mul_f32 v[36:37], v[52:53], v[36:37]
v_pk_mul_f32 v[38:39], v[54:55], v[38:39]
v_pk_mul_f32 v[40:41], v[56:57], v[40:41]
v_pk_mul_f32 v[42:43], v[58:59], v[42:43]
v_pk_mul_f32 v[44:45], v[60:61], v[44:45]
v_pk_mul_f32 v[46:47], v[62:63], v[46:47]
v_pk_fma_f32 v[48:49], v[16:17], v[16:17], s[60:61] neg_lo:[1,0,0] neg_hi:[1,0,0]
v_pk_fma_f32 v[50:51], v[18:19], v[18:19], s[60:61] neg_lo:[1,0,0] neg_hi:[1,0,0]
v_pk_fma_f32 v[52:53], v[20:21], v[20:21], s[60:61] neg_lo:[1,0,0] neg_hi:[1,0,0]
v_pk_fma_f32 v[54:55], v[22:23], v[22:23], s[60:61] neg_lo:[1,0,0] neg_hi:[1,0,0]
v_pk_fma_f32 v[56:57], v[24:25], v[24:25], s[60:61] neg_lo:[1,0,0] neg_hi:[1,0,0]
v_pk_fma_f32 v[58:59], v[26:27], v[26:27], s[60:61] neg_lo:[1,0,0] neg_hi:[1,0,0]
v_pk_fma_f32 v[60:61], v[28:29], v[28:29], s[60:61] neg_lo:[1,0,0] neg_hi:[1,0,0]
v_pk_fma_f32 v[62:63], v[30:31], v[30:31], s[60:61] neg_lo:[1,0,0] neg_hi:[1,0,0]
v_pk_mul_f32 v[48:49], v[48:49], v[16:17]
v_pk_mul_f32 v[50:51], v[50:51], v[18:19]
v_pk_mul_f32 v[52:53], v[52:53], v[20:21]
v_pk_mul_f32 v[54:55], v[54:55], v[22:23]
v_pk_mul_f32 v[56:57], v[56:57], v[24:25]
v_pk_mul_f32 v[58:59], v[58:59], v[26:27]
v_pk_mul_f32 v[60:61], v[60:61], v[28:29]
v_pk_mul_f32 v[62:63], v[62:63], v[30:31]
v_cvt_pk_bf16_f32 v88, v32, v33
v_cvt_pk_bf16_f32 v89, v34, v35
v_cvt_pk_bf16_f32 v90, v36, v37
v_cvt_pk_bf16_f32 v91, v38, v39
v_cvt_pk_bf16_f32 v92, v40, v41
s_waitcnt lgkmcnt(0)
v_mfma_f32_16x16x32_bf16 v[176:179], a[72:75], v[88:91], v[176:179]
buffer_store_dwordx4 v[84:87], v4, s[28:31], s65 offen offset:3200 sc1
v_cvt_pk_bf16_f32 v93, v42, v43
v_cvt_pk_bf16_f32 v94, v44, v45
v_mfma_f32_16x16x32_bf16 v[180:183], a[76:79], v[88:91], v[180:183]
v_cvt_pk_bf16_f32 v95, v46, v47
v_exp_f32 v48, v48
v_mfma_f32_16x16x32_bf16 v[184:187], a[80:83], v[88:91], v[184:187]
v_exp_f32 v49, v49
v_mfma_f32_16x16x32_bf16 v[188:191], a[84:87], v[88:91], v[188:191]
v_exp_f32 v50, v50
v_mfma_f32_16x16x32_bf16 v[192:195], a[88:91], v[88:91], v[192:195]
v_exp_f32 v51, v51
v_mfma_f32_16x16x32_bf16 v[196:199], a[92:95], v[88:91], v[196:199]
v_exp_f32 v52, v52
v_mfma_f32_16x16x32_bf16 v[200:203], a[72:75], v[92:95], v[200:203]
ds_read_b128 a[72:75], v0 offset:49152
v_exp_f32 v53, v53
v_mfma_f32_16x16x32_bf16 v[204:207], a[76:79], v[92:95], v[204:207]
ds_read_b128 a[76:79], v0 offset:49408
v_exp_f32 v54, v54
v_mfma_f32_16x16x32_bf16 v[208:211], a[80:83], v[92:95], v[208:211]
ds_read_b128 a[80:83], v0 offset:51200
v_exp_f32 v55, v55
v_mfma_f32_16x16x32_bf16 v[212:215], a[84:87], v[92:95], v[212:215]
ds_read_b128 a[84:87], v0 offset:51456
v_exp_f32 v56, v56
v_mfma_f32_16x16x32_bf16 v[216:219], a[88:91], v[92:95], v[216:219]
ds_read_b128 a[88:91], v0 offset:53248
v_exp_f32 v57, v57
v_mfma_f32_16x16x32_bf16 v[220:223], a[92:95], v[92:95], v[220:223]
ds_read_b128 a[92:95], v0 offset:53504
v_exp_f32 v58, v58
v_exp_f32 v59, v59
v_exp_f32 v60, v60
v_exp_f32 v61, v61
v_exp_f32 v62, v62
v_exp_f32_e64 v63, v63
v_pk_add_f32 v[48:49], v[48:49], 1.0 op_sel_hi:[1,0]
v_pk_add_f32 v[50:51], v[50:51], 1.0 op_sel_hi:[1,0]
v_pk_add_f32 v[52:53], v[52:53], 1.0 op_sel_hi:[1,0]
v_pk_add_f32 v[54:55], v[54:55], 1.0 op_sel_hi:[1,0]
v_pk_add_f32 v[56:57], v[56:57], 1.0 op_sel_hi:[1,0]
v_pk_add_f32 v[58:59], v[58:59], 1.0 op_sel_hi:[1,0]
v_pk_add_f32 v[60:61], v[60:61], 1.0 op_sel_hi:[1,0]
v_pk_add_f32 v[62:63], v[62:63], 1.0 op_sel_hi:[1,0]
v_mfma_f32_16x16x32_bf16 v[32:35], a[48:51], v[224:227], 0
buffer_load_dwordx4 a[132:135], v253, s[40:43], s81 offen offset:1024 sc1
v_rcp_f32 v48, v48
v_mfma_f32_16x16x32_bf16 v[40:43], a[48:51], v[236:239], 0
ds_read_b128 a[48:51], v7 offset:4096
v_rcp_f32 v49, v49
v_mfma_f32_16x16x32_bf16 v[32:35], a[52:55], v[228:231], v[32:35]
v_rcp_f32 v50, v50
v_mfma_f32_16x16x32_bf16 v[40:43], a[52:55], v[240:243], v[40:43]
ds_read_b128 a[52:55], v7 offset:6144
v_rcp_f32 v51, v51
v_mfma_f32_16x16x32_bf16 v[32:35], a[56:59], v[232:235], v[32:35]
v_rcp_f32 v52, v52
v_mfma_f32_16x16x32_bf16 v[40:43], a[56:59], v[244:247], v[40:43]
ds_read_b128 a[56:59], v7 offset:8192
v_rcp_f32 v53, v53
v_mfma_f32_16x16x32_bf16 v[36:39], a[60:63], v[224:227], 0
v_rcp_f32 v54, v54
v_mfma_f32_16x16x32_bf16 v[44:47], a[60:63], v[236:239], 0
ds_read_b128 a[60:63], v7 offset:4352
v_rcp_f32 v55, v55
v_mfma_f32_16x16x32_bf16 v[36:39], a[64:67], v[228:231], v[36:39]
v_rcp_f32 v56, v56
v_mfma_f32_16x16x32_bf16 v[44:47], a[64:67], v[240:243], v[44:47]
ds_read_b128 a[64:67], v7 offset:6400
v_rcp_f32 v57, v57
v_mfma_f32_16x16x32_bf16 v[36:39], a[68:71], v[232:235], v[36:39]
v_rcp_f32 v58, v58
v_mfma_f32_16x16x32_bf16 v[44:47], a[68:71], v[244:247], v[44:47]
ds_read_b128 a[68:71], v7 offset:8448
v_rcp_f32 v59, v59
v_rcp_f32 v60, v60
v_rcp_f32 v61, v61
v_rcp_f32 v62, v62
v_rcp_f32 v63, v63
v_pk_mul_f32 v[16:17], v[48:49], v[16:17]
v_pk_mul_f32 v[18:19], v[50:51], v[18:19]
v_pk_mul_f32 v[20:21], v[52:53], v[20:21]
v_pk_mul_f32 v[22:23], v[54:55], v[22:23]
v_pk_mul_f32 v[24:25], v[56:57], v[24:25]
v_pk_mul_f32 v[26:27], v[58:59], v[26:27]
v_pk_mul_f32 v[28:29], v[60:61], v[28:29]
v_pk_mul_f32 v[30:31], v[62:63], v[30:31]
v_pk_fma_f32 v[48:49], v[32:33], v[32:33], s[60:61] neg_lo:[1,0,0] neg_hi:[1,0,0]
v_pk_fma_f32 v[50:51], v[34:35], v[34:35], s[60:61] neg_lo:[1,0,0] neg_hi:[1,0,0]
v_pk_fma_f32 v[52:53], v[36:37], v[36:37], s[60:61] neg_lo:[1,0,0] neg_hi:[1,0,0]
v_pk_fma_f32 v[54:55], v[38:39], v[38:39], s[60:61] neg_lo:[1,0,0] neg_hi:[1,0,0]
v_pk_fma_f32 v[56:57], v[40:41], v[40:41], s[60:61] neg_lo:[1,0,0] neg_hi:[1,0,0]
v_pk_fma_f32 v[58:59], v[42:43], v[42:43], s[60:61] neg_lo:[1,0,0] neg_hi:[1,0,0]
v_pk_fma_f32 v[60:61], v[44:45], v[44:45], s[60:61] neg_lo:[1,0,0] neg_hi:[1,0,0]
v_pk_fma_f32 v[62:63], v[46:47], v[46:47], s[60:61] neg_lo:[1,0,0] neg_hi:[1,0,0]
v_pk_mul_f32 v[48:49], v[48:49], v[32:33]
v_pk_mul_f32 v[50:51], v[50:51], v[34:35]
v_pk_mul_f32 v[52:53], v[52:53], v[36:37]
v_pk_mul_f32 v[54:55], v[54:55], v[38:39]
v_pk_mul_f32 v[56:57], v[56:57], v[40:41]
v_pk_mul_f32 v[58:59], v[58:59], v[42:43]
v_pk_mul_f32 v[60:61], v[60:61], v[44:45]
v_pk_mul_f32 v[62:63], v[62:63], v[46:47]
v_cvt_pk_bf16_f32 v88, v16, v17
v_cvt_pk_bf16_f32 v89, v18, v19
v_cvt_pk_bf16_f32 v90, v20, v21
v_cvt_pk_bf16_f32 v91, v22, v23
v_cvt_pk_bf16_f32 v92, v24, v25
s_waitcnt lgkmcnt(0)
v_mfma_f32_16x16x32_bf16 v[176:179], a[72:75], v[88:91], v[176:179]
s_add_u32 s81, s80, 16384
v_cvt_pk_bf16_f32 v93, v26, v27
v_cvt_pk_bf16_f32 v94, v28, v29
v_mfma_f32_16x16x32_bf16 v[180:183], a[76:79], v[88:91], v[180:183]
v_cvt_pk_bf16_f32 v95, v30, v31
v_exp_f32 v48, v48
v_mfma_f32_16x16x32_bf16 v[184:187], a[80:83], v[88:91], v[184:187]
v_exp_f32 v49, v49
v_mfma_f32_16x16x32_bf16 v[188:191], a[84:87], v[88:91], v[188:191]
v_exp_f32 v50, v50
v_mfma_f32_16x16x32_bf16 v[192:195], a[88:91], v[88:91], v[192:195]
v_exp_f32 v51, v51
v_mfma_f32_16x16x32_bf16 v[196:199], a[92:95], v[88:91], v[196:199]
v_exp_f32 v52, v52
v_mfma_f32_16x16x32_bf16 v[200:203], a[72:75], v[92:95], v[200:203]
ds_read_b128 a[72:75], v0 offset:55296
buffer_load_dwordx4 a[136:139], v253, s[40:43], s81 offen offset:0 sc1
v_mfma_f32_16x16x32_bf16 v[204:207], a[76:79], v[92:95], v[204:207]
ds_read_b128 a[76:79], v0 offset:55552
v_exp_f32 v53, v53
v_mfma_f32_16x16x32_bf16 v[208:211], a[80:83], v[92:95], v[208:211]
ds_read_b128 a[80:83], v0 offset:57344
v_exp_f32 v54, v54
v_mfma_f32_16x16x32_bf16 v[212:215], a[84:87], v[92:95], v[212:215]
ds_read_b128 a[84:87], v0 offset:57600
v_exp_f32 v55, v55
v_mfma_f32_16x16x32_bf16 v[216:219], a[88:91], v[92:95], v[216:219]
ds_read_b128 a[88:91], v0 offset:59392
v_exp_f32 v56, v56
v_mfma_f32_16x16x32_bf16 v[220:223], a[92:95], v[92:95], v[220:223]
ds_read_b128 a[92:95], v0 offset:59648
v_exp_f32 v57, v57
v_exp_f32 v58, v58
v_exp_f32 v59, v59
v_exp_f32 v60, v60
v_exp_f32 v61, v61
v_exp_f32 v62, v62
v_exp_f32_e64 v63, v63
v_pk_add_f32 v[48:49], v[48:49], 1.0 op_sel_hi:[1,0]
v_pk_add_f32 v[50:51], v[50:51], 1.0 op_sel_hi:[1,0]
v_pk_add_f32 v[52:53], v[52:53], 1.0 op_sel_hi:[1,0]
v_pk_add_f32 v[54:55], v[54:55], 1.0 op_sel_hi:[1,0]
v_pk_add_f32 v[56:57], v[56:57], 1.0 op_sel_hi:[1,0]
v_pk_add_f32 v[58:59], v[58:59], 1.0 op_sel_hi:[1,0]
v_pk_add_f32 v[60:61], v[60:61], 1.0 op_sel_hi:[1,0]
v_pk_add_f32 v[62:63], v[62:63], 1.0 op_sel_hi:[1,0]
v_mfma_f32_16x16x32_bf16 v[16:19], a[48:51], v[224:227], 0
buffer_load_dwordx4 a[140:143], v253, s[40:43], s81 offen offset:1024 sc1
v_rcp_f32_e64 v48, v48
v_mfma_f32_16x16x32_bf16 v[24:27], a[48:51], v[236:239], 0
ds_read_b128 a[48:51], v7 offset:10240
ds_read_b128 v[128:131], v3 offset:0
v_rcp_f32 v49, v49
v_mfma_f32_16x16x32_bf16 v[16:19], a[52:55], v[228:231], v[16:19]
v_rcp_f32 v50, v50
v_mfma_f32_16x16x32_bf16 v[24:27], a[52:55], v[240:243], v[24:27]
ds_read_b128 a[52:55], v7 offset:12288
ds_read_b128 v[132:135], v3 offset:16
v_mfma_f32_16x16x32_bf16 v[16:19], a[56:59], v[232:235], v[16:19]
v_rcp_f32_e64 v51, v51
v_mfma_f32_16x16x32_bf16 v[24:27], a[56:59], v[244:247], v[24:27]
ds_read_b128 a[56:59], v7 offset:14336
ds_read_b128 v[136:139], v3 offset:128
v_rcp_f32 v52, v52
v_mfma_f32_16x16x32_bf16 v[20:23], a[60:63], v[224:227], 0
ds_read_b128 v[140:143], v3 offset:144
v_rcp_f32 v53, v53
v_mfma_f32_16x16x32_bf16 v[28:31], a[60:63], v[236:239], 0
ds_read_b128 a[60:63], v7 offset:10496
v_rcp_f32 v54, v54
v_mfma_f32_16x16x32_bf16 v[20:23], a[64:67], v[228:231], v[20:23]
ds_read_b128 v[144:147], v3 offset:256
v_rcp_f32 v55, v55
v_mfma_f32_16x16x32_bf16 v[28:31], a[64:67], v[240:243], v[28:31]
ds_read_b128 a[64:67], v7 offset:12544
v_rcp_f32 v56, v56
v_mfma_f32_16x16x32_bf16 v[20:23], a[68:71], v[232:235], v[20:23]
ds_read_b128 v[148:151], v3 offset:272
v_rcp_f32 v57, v57
v_mfma_f32_16x16x32_bf16 v[28:31], a[68:71], v[244:247], v[28:31]
ds_read_b128 a[68:71], v7 offset:14592
v_rcp_f32 v58, v58
v_rcp_f32 v59, v59
v_rcp_f32 v60, v60
v_rcp_f32 v61, v61
v_rcp_f32 v62, v62
v_rcp_f32 v63, v63
v_pk_mul_f32 v[32:33], v[48:49], v[32:33]
v_pk_mul_f32 v[34:35], v[50:51], v[34:35]
v_pk_mul_f32 v[36:37], v[52:53], v[36:37]
v_pk_mul_f32 v[38:39], v[54:55], v[38:39]
v_pk_mul_f32 v[40:41], v[56:57], v[40:41]
v_pk_mul_f32 v[42:43], v[58:59], v[42:43]
v_pk_mul_f32 v[44:45], v[60:61], v[44:45]
v_pk_mul_f32 v[46:47], v[62:63], v[46:47]
v_pk_fma_f32 v[48:49], v[16:17], v[16:17], s[60:61] neg_lo:[1,0,0] neg_hi:[1,0,0]
v_pk_fma_f32 v[50:51], v[18:19], v[18:19], s[60:61] neg_lo:[1,0,0] neg_hi:[1,0,0]
v_pk_fma_f32 v[52:53], v[20:21], v[20:21], s[60:61] neg_lo:[1,0,0] neg_hi:[1,0,0]
v_pk_fma_f32 v[54:55], v[22:23], v[22:23], s[60:61] neg_lo:[1,0,0] neg_hi:[1,0,0]
v_pk_fma_f32 v[56:57], v[24:25], v[24:25], s[60:61] neg_lo:[1,0,0] neg_hi:[1,0,0]
v_pk_fma_f32 v[58:59], v[26:27], v[26:27], s[60:61] neg_lo:[1,0,0] neg_hi:[1,0,0]
v_pk_fma_f32 v[60:61], v[28:29], v[28:29], s[60:61] neg_lo:[1,0,0] neg_hi:[1,0,0]
v_pk_fma_f32 v[62:63], v[30:31], v[30:31], s[60:61] neg_lo:[1,0,0] neg_hi:[1,0,0]
v_pk_mul_f32 v[48:49], v[48:49], v[16:17]
v_pk_mul_f32 v[50:51], v[50:51], v[18:19]
v_pk_mul_f32 v[52:53], v[52:53], v[20:21]
v_pk_mul_f32 v[54:55], v[54:55], v[22:23]
v_pk_mul_f32 v[56:57], v[56:57], v[24:25]
v_pk_mul_f32 v[58:59], v[58:59], v[26:27]
v_pk_mul_f32 v[60:61], v[60:61], v[28:29]
v_pk_mul_f32 v[62:63], v[62:63], v[30:31]
v_cvt_pk_bf16_f32 v88, v32, v33
v_cvt_pk_bf16_f32 v89, v34, v35
v_cvt_pk_bf16_f32 v90, v36, v37
v_cvt_pk_bf16_f32 v91, v38, v39
v_cvt_pk_bf16_f32 v92, v40, v41
s_waitcnt lgkmcnt(0)
v_mfma_f32_16x16x32_bf16 v[176:179], a[72:75], v[88:91], v[176:179]
v_cvt_pk_bf16_f32 v93, v42, v43
v_cvt_pk_bf16_f32 v94, v44, v45
v_mfma_f32_16x16x32_bf16 v[180:183], a[76:79], v[88:91], v[180:183]
v_cvt_pk_bf16_f32 v95, v46, v47
v_mfma_f32_16x16x32_bf16 v[184:187], a[80:83], v[88:91], v[184:187]
v_exp_f32 v48, v48
v_mfma_f32_16x16x32_bf16 v[188:191], a[84:87], v[88:91], v[188:191]
v_exp_f32 v49, v49
v_mfma_f32_16x16x32_bf16 v[192:195], a[88:91], v[88:91], v[192:195]
v_exp_f32 v50, v50
v_mfma_f32_16x16x32_bf16 v[196:199], a[92:95], v[88:91], v[196:199]
v_exp_f32 v51, v51
v_mfma_f32_16x16x32_bf16 v[200:203], a[72:75], v[92:95], v[200:203]
ds_read_b128 a[72:75], v0 offset:61440
v_exp_f32 v52, v52
v_mfma_f32_16x16x32_bf16 v[204:207], a[76:79], v[92:95], v[204:207]
ds_read_b128 a[76:79], v0 offset:61696
v_exp_f32_e64 v53, v53
v_mfma_f32_16x16x32_bf16 v[208:211], a[80:83], v[92:95], v[208:211]
ds_read_b128 a[80:83], v0 offset:63488
v_mfma_f32_16x16x32_bf16 v[212:215], a[84:87], v[92:95], v[212:215]
ds_read_b128 a[84:87], v0 offset:63744
v_exp_f32 v54, v54
v_mfma_f32_16x16x32_bf16 v[216:219], a[88:91], v[92:95], v[216:219]
ds_read_b128 a[88:91], v1 offset:0
v_exp_f32 v55, v55
v_mfma_f32_16x16x32_bf16 v[220:223], a[92:95], v[92:95], v[220:223]
ds_read_b128 a[92:95], v1 offset:256
v_exp_f32 v56, v56
s_waitcnt vmcnt(13)
v_mfma_f32_16x16x32_bf16 v[152:155], v[8:11], a[252:255], v[128:131]
v_exp_f32 v57, v57
v_mfma_f32_16x16x32_bf16 v[128:131], v[8:11], a[240:243], v[128:131]
v_exp_f32 v58, v58
v_mfma_f32_16x16x32_bf16 v[156:159], v[12:15], a[252:255], v[132:135]
v_exp_f32 v59, v59
v_mfma_f32_16x16x32_bf16 v[132:135], v[12:15], a[240:243], v[132:135]
v_exp_f32 v60, v60
v_mfma_f32_16x16x32_bf16 v[160:163], v[8:11], a[216:219], v[136:139]
v_exp_f32 v61, v61
v_mfma_f32_16x16x32_bf16 v[136:139], v[8:11], a[244:247], v[136:139]
v_exp_f32 v62, v62
v_exp_f32_e64 v63, v63
v_pk_add_f32 v[48:49], v[48:49], 1.0 op_sel_hi:[1,0]
v_pk_add_f32 v[50:51], v[50:51], 1.0 op_sel_hi:[1,0]
v_pk_add_f32 v[52:53], v[52:53], 1.0 op_sel_hi:[1,0]
v_pk_add_f32 v[54:55], v[54:55], 1.0 op_sel_hi:[1,0]
v_pk_add_f32 v[56:57], v[56:57], 1.0 op_sel_hi:[1,0]
v_pk_add_f32 v[58:59], v[58:59], 1.0 op_sel_hi:[1,0]
v_pk_add_f32 v[60:61], v[60:61], 1.0 op_sel_hi:[1,0]
v_pk_add_f32 v[62:63], v[62:63], 1.0 op_sel_hi:[1,0]
v_mfma_f32_16x16x32_bf16 v[32:35], a[48:51], v[224:227], 0
v_rcp_f32 v48, v48
v_mfma_f32_16x16x32_bf16 v[40:43], a[48:51], v[236:239], 0
v_rcp_f32 v49, v49
v_mfma_f32_16x16x32_bf16 v[32:35], a[52:55], v[228:231], v[32:35]
v_mfma_f32_16x16x32_bf16 v[40:43], a[52:55], v[240:243], v[40:43]
v_rcp_f32 v50, v50
v_mfma_f32_16x16x32_bf16 v[32:35], a[56:59], v[232:235], v[32:35]
v_rcp_f32 v51, v51
v_mfma_f32_16x16x32_bf16 v[40:43], a[56:59], v[244:247], v[40:43]
v_rcp_f32 v52, v52
v_mfma_f32_16x16x32_bf16 v[36:39], a[60:63], v[224:227], 0
v_rcp_f32 v53, v53
v_mfma_f32_16x16x32_bf16 v[44:47], a[60:63], v[236:239], 0
v_mfma_f32_16x16x32_bf16 v[36:39], a[64:67], v[228:231], v[36:39]
v_rcp_f32 v54, v54
v_mfma_f32_16x16x32_bf16 v[44:47], a[64:67], v[240:243], v[44:47]
v_rcp_f32 v55, v55
v_mfma_f32_16x16x32_bf16 v[36:39], a[68:71], v[232:235], v[36:39]
v_rcp_f32 v56, v56
v_mfma_f32_16x16x32_bf16 v[44:47], a[68:71], v[244:247], v[44:47]
v_rcp_f32 v57, v57
v_mfma_f32_16x16x32_bf16 v[164:167], v[12:15], a[216:219], v[140:143]
v_mfma_f32_16x16x32_bf16 v[140:143], v[12:15], a[244:247], v[140:143]
v_rcp_f32 v58, v58
v_mfma_f32_16x16x32_bf16 v[168:171], v[8:11], a[220:223], v[144:147]
v_rcp_f32 v59, v59
v_mfma_f32_16x16x32_bf16 v[144:147], v[8:11], a[248:251], v[144:147]
v_rcp_f32 v60, v60
v_mfma_f32_16x16x32_bf16 v[172:175], v[12:15], a[220:223], v[148:151]
v_rcp_f32 v61, v61
v_mfma_f32_16x16x32_bf16 v[148:151], v[12:15], a[248:251], v[148:151]
v_rcp_f32 v62, v62
v_rcp_f32 v63, v63
v_pk_mul_f32 v[16:17], v[48:49], v[16:17]
v_pk_mul_f32 v[18:19], v[50:51], v[18:19]
v_pk_mul_f32 v[20:21], v[52:53], v[20:21]
v_pk_mul_f32 v[22:23], v[54:55], v[22:23]
v_pk_mul_f32 v[24:25], v[56:57], v[24:25]
v_pk_mul_f32 v[26:27], v[58:59], v[26:27]
v_pk_mul_f32 v[28:29], v[60:61], v[28:29]
v_pk_mul_f32 v[30:31], v[62:63], v[30:31]
v_pk_fma_f32 v[48:49], v[32:33], v[32:33], s[60:61] neg_lo:[1,0,0] neg_hi:[1,0,0]
v_pk_fma_f32 v[50:51], v[34:35], v[34:35], s[60:61] neg_lo:[1,0,0] neg_hi:[1,0,0]
v_pk_fma_f32 v[52:53], v[36:37], v[36:37], s[60:61] neg_lo:[1,0,0] neg_hi:[1,0,0]
v_pk_fma_f32 v[54:55], v[38:39], v[38:39], s[60:61] neg_lo:[1,0,0] neg_hi:[1,0,0]
v_pk_fma_f32 v[56:57], v[40:41], v[40:41], s[60:61] neg_lo:[1,0,0] neg_hi:[1,0,0]
v_pk_fma_f32 v[58:59], v[42:43], v[42:43], s[60:61] neg_lo:[1,0,0] neg_hi:[1,0,0]
v_pk_fma_f32 v[60:61], v[44:45], v[44:45], s[60:61] neg_lo:[1,0,0] neg_hi:[1,0,0]
v_pk_fma_f32 v[62:63], v[46:47], v[46:47], s[60:61] neg_lo:[1,0,0] neg_hi:[1,0,0]
v_pk_mul_f32 v[48:49], v[48:49], v[32:33]
v_pk_mul_f32 v[50:51], v[50:51], v[34:35]
v_pk_mul_f32 v[52:53], v[52:53], v[36:37]
v_pk_mul_f32 v[54:55], v[54:55], v[38:39]
v_pk_mul_f32 v[56:57], v[56:57], v[40:41]
v_pk_mul_f32 v[58:59], v[58:59], v[42:43]
v_pk_mul_f32 v[60:61], v[60:61], v[44:45]
v_pk_mul_f32 v[62:63], v[62:63], v[46:47]
v_cvt_pk_bf16_f32 v88, v16, v17
v_cvt_pk_bf16_f32 v89, v18, v19
v_cvt_pk_bf16_f32 v90, v20, v21
v_cvt_pk_bf16_f32 v91, v22, v23
v_cvt_pk_bf16_f32 v92, v24, v25
s_waitcnt lgkmcnt(0)
v_mfma_f32_16x16x32_bf16 v[176:179], a[72:75], v[88:91], v[176:179]
v_cvt_pk_bf16_f32 v93, v26, v27
v_cvt_pk_bf16_f32 v94, v28, v29
v_mfma_f32_16x16x32_bf16 v[180:183], a[76:79], v[88:91], v[180:183]
v_cvt_pk_bf16_f32 v95, v30, v31
v_exp_f32 v48, v48
v_mfma_f32_16x16x32_bf16 v[184:187], a[80:83], v[88:91], v[184:187]
v_exp_f32 v49, v49
v_mfma_f32_16x16x32_bf16 v[188:191], a[84:87], v[88:91], v[188:191]
v_exp_f32 v50, v50
v_mfma_f32_16x16x32_bf16 v[192:195], a[88:91], v[88:91], v[192:195]
v_exp_f32 v51, v51
v_mfma_f32_16x16x32_bf16 v[196:199], a[92:95], v[88:91], v[196:199]
v_exp_f32 v52, v52
v_mfma_f32_16x16x32_bf16 v[200:203], a[72:75], v[92:95], v[200:203]
ds_read_b128 a[72:75], v1 offset:2048
v_exp_f32 v53, v53
v_mfma_f32_16x16x32_bf16 v[204:207], a[76:79], v[92:95], v[204:207]
ds_read_b128 a[76:79], v1 offset:2304
v_exp_f32 v54, v54
v_mfma_f32_16x16x32_bf16 v[208:211], a[80:83], v[92:95], v[208:211]
ds_read_b128 a[80:83], v1 offset:4096
v_exp_f32 v55, v55
v_mfma_f32_16x16x32_bf16 v[212:215], a[84:87], v[92:95], v[212:215]
ds_read_b128 a[84:87], v1 offset:4352
v_exp_f32 v56, v56
v_mfma_f32_16x16x32_bf16 v[216:219], a[88:91], v[92:95], v[216:219]
ds_read_b128 a[88:91], v1 offset:6144
v_exp_f32 v57, v57
v_mfma_f32_16x16x32_bf16 v[220:223], a[92:95], v[92:95], v[220:223]
ds_read_b128 a[92:95], v1 offset:6400
v_exp_f32 v58, v58
v_exp_f32 v59, v59
v_exp_f32 v60, v60
v_exp_f32 v61, v61
v_exp_f32 v62, v62
v_exp_f32_e64 v63, v63
v_pk_add_f32 v[48:49], v[48:49], 1.0 op_sel_hi:[1,0]
v_pk_add_f32 v[50:51], v[50:51], 1.0 op_sel_hi:[1,0]
v_pk_add_f32 v[52:53], v[52:53], 1.0 op_sel_hi:[1,0]
v_pk_add_f32 v[54:55], v[54:55], 1.0 op_sel_hi:[1,0]
v_pk_add_f32 v[56:57], v[56:57], 1.0 op_sel_hi:[1,0]
v_pk_add_f32 v[58:59], v[58:59], 1.0 op_sel_hi:[1,0]
v_pk_add_f32 v[60:61], v[60:61], 1.0 op_sel_hi:[1,0]
v_pk_add_f32 v[62:63], v[62:63], 1.0 op_sel_hi:[1,0]
v_rcp_f32 v48, v48
v_rcp_f32 v49, v49
v_rcp_f32 v50, v50
v_rcp_f32 v51, v51
v_rcp_f32 v52, v52
v_rcp_f32 v53, v53
v_rcp_f32 v54, v54
v_rcp_f32 v55, v55
v_rcp_f32 v56, v56
v_rcp_f32 v57, v57
v_rcp_f32 v58, v58
v_rcp_f32 v59, v59
v_rcp_f32 v60, v60
v_rcp_f32 v61, v61
v_rcp_f32 v62, v62
v_rcp_f32 v63, v63
v_pk_mul_f32 v[32:33], v[48:49], v[32:33]
v_pk_mul_f32 v[34:35], v[50:51], v[34:35]
v_pk_mul_f32 v[36:37], v[52:53], v[36:37]
v_pk_mul_f32 v[38:39], v[54:55], v[38:39]
v_pk_mul_f32 v[40:41], v[56:57], v[40:41]
v_pk_mul_f32 v[42:43], v[58:59], v[42:43]
v_pk_mul_f32 v[44:45], v[60:61], v[44:45]
v_pk_mul_f32 v[46:47], v[62:63], v[46:47]
L_tail:
v_cvt_pk_bf16_f32 v88, v32, v33
v_cvt_pk_bf16_f32 v89, v34, v35
v_cvt_pk_bf16_f32 v90, v36, v37
v_cvt_pk_bf16_f32 v91, v38, v39
v_cvt_pk_bf16_f32 v92, v40, v41
v_cvt_pk_bf16_f32 v93, v42, v43
v_cvt_pk_bf16_f32 v94, v44, v45
v_cvt_pk_bf16_f32 v95, v46, v47
s_waitcnt lgkmcnt(0)
v_mfma_f32_16x16x32_bf16 v[176:179], a[72:75], v[88:91], v[176:179]
ds_read_b128 a[48:51], v0 offset:36864
v_mfma_f32_16x16x32_bf16 v[180:183], a[76:79], v[88:91], v[180:183]
ds_read_b128 a[52:55], v0 offset:37120
v_mfma_f32_16x16x32_bf16 v[184:187], a[80:83], v[88:91], v[184:187]
ds_read_b128 a[56:59], v0 offset:43008
v_mfma_f32_16x16x32_bf16 v[188:191], a[84:87], v[88:91], v[188:191]
ds_read_b128 a[60:63], v0 offset:43264
v_mfma_f32_16x16x32_bf16 v[192:195], a[88:91], v[88:91], v[192:195]
ds_read_b128 a[64:67], v0 offset:49152
v_mfma_f32_16x16x32_bf16 v[196:199], a[92:95], v[88:91], v[196:199]
ds_read_b128 a[68:71], v0 offset:49408
v_mfma_f32_16x16x32_bf16 v[200:203], a[72:75], v[92:95], v[200:203]
v_mfma_f32_16x16x32_bf16 v[204:207], a[76:79], v[92:95], v[204:207]
v_mfma_f32_16x16x32_bf16 v[208:211], a[80:83], v[92:95], v[208:211]
v_mfma_f32_16x16x32_bf16 v[212:215], a[84:87], v[92:95], v[212:215]
v_mfma_f32_16x16x32_bf16 v[216:219], a[88:91], v[92:95], v[216:219]
v_mfma_f32_16x16x32_bf16 v[220:223], a[92:95], v[92:95], v[220:223]
s_waitcnt lgkmcnt(1)
v_mfma_f32_16x16x32_bf16 v[128:131], a[48:51], a[144:147], v[128:131]
ds_read_b128 a[72:75], v0 offset:55296
v_mfma_f32_16x16x32_bf16 v[152:155], a[48:51], a[148:151], v[152:155]
v_mfma_f32_16x16x32_bf16 v[132:135], a[52:55], a[144:147], v[132:135]
ds_read_b128 a[76:79], v0 offset:55552
v_mfma_f32_16x16x32_bf16 v[156:159], a[52:55], a[148:151], v[156:159]
v_mfma_f32_16x16x32_bf16 v[128:131], a[56:59], a[152:155], v[128:131]
ds_read_b128 a[80:83], v0 offset:61440
v_cvt_pk_bf16_f32 v176, v176, v177
v_mfma_f32_16x16x32_bf16 v[152:155], a[56:59], a[156:159], v[152:155]
v_cvt_pk_bf16_f32 v177, v178, v179
v_mfma_f32_16x16x32_bf16 v[132:135], a[60:63], a[152:155], v[132:135]
ds_read_b128 a[84:87], v0 offset:61696
v_cvt_pk_bf16_f32 v178, v180, v181
v_mfma_f32_16x16x32_bf16 v[156:159], a[60:63], a[156:159], v[156:159]
v_cvt_pk_bf16_f32 v179, v182, v183
v_mfma_f32_16x16x32_bf16 v[128:131], a[64:67], a[160:163], v[128:131]
ds_read_b128 a[88:91], v1 offset:2048
s_mov_b32 s65, 6291456
buffer_store_dwordx4 v[176:179], v4, s[28:31], s65 offen offset:0 sc1
v_cvt_pk_bf16_f32 v180, v184, v185
v_mfma_f32_16x16x32_bf16 v[152:155], a[64:67], a[164:167], v[152:155]
v_cvt_pk_bf16_f32 v181, v186, v187
s_waitcnt lgkmcnt(2)
v_mfma_f32_16x16x32_bf16 v[132:135], a[68:71], a[160:163], v[132:135]
ds_read_b128 a[92:95], v1 offset:2304
v_cvt_pk_bf16_f32 v182, v188, v189
v_mfma_f32_16x16x32_bf16 v[156:159], a[68:71], a[164:167], v[156:159]
v_cvt_pk_bf16_f32 v183, v190, v191
v_mfma_f32_16x16x32_bf16 v[128:131], a[72:75], a[168:171], v[128:131]
ds_read_b128 a[48:51], v0 offset:0
v_cvt_pk_bf16_f32 v184, v192, v193
v_mfma_f32_16x16x32_bf16 v[152:155], a[72:75], a[172:175], v[152:155]
v_cvt_pk_bf16_f32 v185, v194, v195
v_mfma_f32_16x16x32_bf16 v[132:135], a[76:79], a[168:171], v[132:135]
ds_read_b128 a[52:55], v0 offset:256
v_cvt_pk_bf16_f32 v186, v196, v197
v_mfma_f32_16x16x32_bf16 v[156:159], a[76:79], a[172:175], v[156:159]
buffer_store_dwordx4 v[180:183], v4, s[28:31], s65 offen offset:64 sc1
v_cvt_pk_bf16_f32 v187, v198, v199
v_mfma_f32_16x16x32_bf16 v[128:131], a[80:83], a[176:179], v[128:131]
ds_read_b128 a[56:59], v0 offset:6144
v_cvt_pk_bf16_f32 v188, v200, v201
v_mfma_f32_16x16x32_bf16 v[152:155], a[80:83], a[180:183], v[152:155]
v_cvt_pk_bf16_f32 v189, v202, v203
s_waitcnt lgkmcnt(2)
v_mfma_f32_16x16x32_bf16 v[132:135], a[84:87], a[176:179], v[132:135]
ds_read_b128 a[60:63], v0 offset:6400
v_cvt_pk_bf16_f32 v190, v204, v205
v_mfma_f32_16x16x32_bf16 v[156:159], a[84:87], a[180:183], v[156:159]
v_cvt_pk_bf16_f32 v191, v206, v207
v_mfma_f32_16x16x32_bf16 v[128:131], a[88:91], a[184:187], v[128:131]
ds_read_b128 a[64:67], v0 offset:12288
v_cvt_pk_bf16_f32 v192, v208, v209
v_mfma_f32_16x16x32_bf16 v[152:155], a[88:91], a[188:191], v[152:155]
v_cvt_pk_bf16_f32 v193, v210, v211
v_mfma_f32_16x16x32_bf16 v[132:135], a[92:95], a[184:187], v[132:135]
ds_read_b128 a[68:71], v0 offset:12544
buffer_store_dwordx4 v[184:187], v4, s[28:31], s65 offen offset:128 sc1
v_cvt_pk_bf16_f32 v194, v212, v213
v_mfma_f32_16x16x32_bf16 v[156:159], a[92:95], a[188:191], v[156:159]
v_cvt_pk_bf16_f32 v195, v214, v215
v_mfma_f32_16x16x32_bf16 v[128:131], a[48:51], a[96:99], v[128:131]
ds_read_b128 a[72:75], v0 offset:18432
v_cvt_pk_bf16_f32 v196, v216, v217
v_mfma_f32_16x16x32_bf16 v[152:155], a[48:51], a[100:103], v[152:155]
v_cvt_pk_bf16_f32 v197, v218, v219
s_waitcnt lgkmcnt(2)
v_mfma_f32_16x16x32_bf16 v[132:135], a[52:55], a[96:99], v[132:135]
ds_read_b128 a[76:79], v0 offset:18688
v_cvt_pk_bf16_f32 v198, v220, v221
v_mfma_f32_16x16x32_bf16 v[156:159], a[52:55], a[100:103], v[156:159]
v_cvt_pk_bf16_f32 v199, v222, v223
v_mfma_f32_16x16x32_bf16 v[128:131], a[56:59], a[104:107], v[128:131]
ds_read_b128 a[80:83], v0 offset:24576
s_waitcnt vmcnt(8)
v_mfma_f32_16x16x32_bf16 v[152:155], a[56:59], a[108:111], v[152:155]
buffer_store_dwordx4 v[188:191], v4, s[28:31], s65 offen offset:3072 sc1
v_mfma_f32_16x16x32_bf16 v[132:135], a[60:63], a[104:107], v[132:135]
ds_read_b128 a[84:87], v0 offset:24832
v_mfma_f32_16x16x32_bf16 v[156:159], a[60:63], a[108:111], v[156:159]
v_mfma_f32_16x16x32_bf16 v[128:131], a[64:67], a[112:115], v[128:131]
ds_read_b128 a[88:91], v0 offset:30720
v_mfma_f32_16x16x32_bf16 v[152:155], a[64:67], a[116:119], v[152:155]
s_waitcnt lgkmcnt(2)
v_mfma_f32_16x16x32_bf16 v[132:135], a[68:71], a[112:115], v[132:135]
ds_read_b128 a[92:95], v0 offset:30976
v_mfma_f32_16x16x32_bf16 v[156:159], a[68:71], a[116:119], v[156:159]
v_mfma_f32_16x16x32_bf16 v[128:131], a[72:75], a[120:123], v[128:131]
ds_read_b128 a[48:51], v0 offset:38912
buffer_store_dwordx4 v[192:195], v4, s[28:31], s65 offen offset:3136 sc1
v_mfma_f32_16x16x32_bf16 v[152:155], a[72:75], a[124:127], v[152:155]
v_mfma_f32_16x16x32_bf16 v[132:135], a[76:79], a[120:123], v[132:135]
ds_read_b128 a[52:55], v0 offset:39168
v_mfma_f32_16x16x32_bf16 v[156:159], a[76:79], a[124:127], v[156:159]
s_waitcnt vmcnt(9)
v_mfma_f32_16x16x32_bf16 v[128:131], a[80:83], a[128:131], v[128:131]
ds_read_b128 a[56:59], v0 offset:45056
s_waitcnt vmcnt(7)
v_mfma_f32_16x16x32_bf16 v[152:155], a[80:83], a[132:135], v[152:155]
s_waitcnt lgkmcnt(2)
v_mfma_f32_16x16x32_bf16 v[132:135], a[84:87], a[128:131], v[132:135]
ds_read_b128 a[60:63], v0 offset:45312
v_mfma_f32_16x16x32_bf16 v[156:159], a[84:87], a[132:135], v[156:159]
buffer_store_dwordx4 v[196:199], v4, s[28:31], s65 offen offset:3200 sc1
s_waitcnt vmcnt(7)
v_mfma_f32_16x16x32_bf16 v[128:131], a[88:91], a[136:139], v[128:131]
ds_read_b128 a[64:67], v0 offset:51200
s_waitcnt vmcnt(6)
v_mfma_f32_16x16x32_bf16 v[152:155], a[88:91], a[140:143], v[152:155]
v_mfma_f32_16x16x32_bf16 v[132:135], a[92:95], a[136:139], v[132:135]
ds_read_b128 a[68:71], v0 offset:51456
v_mfma_f32_16x16x32_bf16 v[156:159], a[92:95], a[140:143], v[156:159]
v_mfma_f32_16x16x32_bf16 v[136:139], a[48:51], a[144:147], v[136:139]
ds_read_b128 a[72:75], v0 offset:57344
v_mfma_f32_16x16x32_bf16 v[160:163], a[48:51], a[148:151], v[160:163]
s_waitcnt lgkmcnt(3)
v_mfma_f32_16x16x32_bf16 v[140:143], a[52:55], a[144:147], v[140:143]
ds_read_b128 a[76:79], v0 offset:57600
s_mov_b32 s65, 18874368
v_mfma_f32_16x16x32_bf16 v[164:167], a[52:55], a[148:151], v[164:167]
v_mfma_f32_16x16x32_bf16 v[136:139], a[56:59], a[152:155], v[136:139]
ds_read_b128 a[80:83], v0 offset:63488
v_cvt_pk_bf16_f32 v64, v128, v129
v_mfma_f32_16x16x32_bf16 v[160:163], a[56:59], a[156:159], v[160:163]
v_cvt_pk_bf16_f32 v65, v130, v131
v_mfma_f32_16x16x32_bf16 v[140:143], a[60:63], a[152:155], v[140:143]
ds_read_b128 a[84:87], v0 offset:63744
v_cvt_pk_bf16_f32 v66, v132, v133
v_mfma_f32_16x16x32_bf16 v[164:167], a[60:63], a[156:159], v[164:167]
v_cvt_pk_bf16_f32 v67, v134, v135
s_waitcnt lgkmcnt(2)
v_mfma_f32_16x16x32_bf16 v[136:139], a[64:67], a[160:163], v[136:139]
ds_read_b128 a[88:91], v1 offset:4096
v_cvt_pk_bf16_f32 v76, v152, v153
v_mfma_f32_16x16x32_bf16 v[160:163], a[64:67], a[164:167], v[160:163]
v_cvt_pk_bf16_f32 v77, v154, v155
v_mfma_f32_16x16x32_bf16 v[140:143], a[68:71], a[160:163], v[140:143]
ds_read_b128 a[92:95], v1 offset:4352
buffer_store_dwordx4 v[64:67], v4, s[28:31], s65 offen offset:0 sc1
v_cvt_pk_bf16_f32 v78, v156, v157
v_mfma_f32_16x16x32_bf16 v[164:167], a[68:71], a[164:167], v[164:167]
v_cvt_pk_bf16_f32 v79, v158, v159
v_mfma_f32_16x16x32_bf16 v[136:139], a[72:75], a[168:171], v[136:139]
ds_read_b128 a[48:51], v0 offset:2048
v_mfma_f32_16x16x32_bf16 v[160:163], a[72:75], a[172:175], v[160:163]
v_mfma_f32_16x16x32_bf16 v[140:143], a[76:79], a[168:171], v[140:143]
ds_read_b128 a[52:55], v0 offset:2304
v_mfma_f32_16x16x32_bf16 v[164:167], a[76:79], a[172:175], v[164:167]
s_waitcnt lgkmcnt(2)
v_mfma_f32_16x16x32_bf16 v[136:139], a[80:83], a[176:179], v[136:139]
ds_read_b128 a[56:59], v0 offset:8192
v_mfma_f32_16x16x32_bf16 v[160:163], a[80:83], a[180:183], v[160:163]
v_mfma_f32_16x16x32_bf16 v[140:143], a[84:87], a[176:179], v[140:143]
ds_read_b128 a[60:63], v0 offset:8448
v_mfma_f32_16x16x32_bf16 v[164:167], a[84:87], a[180:183], v[164:167]
v_mfma_f32_16x16x32_bf16 v[136:139], a[88:91], a[184:187], v[136:139]
ds_read_b128 a[64:67], v0 offset:14336
v_mfma_f32_16x16x32_bf16 v[160:163], a[88:91], a[188:191], v[160:163]
v_mfma_f32_16x16x32_bf16 v[140:143], a[92:95], a[184:187], v[140:143]
ds_read_b128 a[68:71], v0 offset:14592
buffer_store_dwordx4 v[76:79], v4, s[28:31], s65 offen offset:3072 sc1
v_mfma_f32_16x16x32_bf16 v[164:167], a[92:95], a[188:191], v[164:167]
s_waitcnt lgkmcnt(3)
v_mfma_f32_16x16x32_bf16 v[136:139], a[48:51], a[96:99], v[136:139]
ds_read_b128 a[72:75], v0 offset:20480
v_mfma_f32_16x16x32_bf16 v[160:163], a[48:51], a[100:103], v[160:163]
v_mfma_f32_16x16x32_bf16 v[140:143], a[52:55], a[96:99], v[140:143]
ds_read_b128 a[76:79], v0 offset:20736
v_mfma_f32_16x16x32_bf16 v[164:167], a[52:55], a[100:103], v[164:167]
v_mfma_f32_16x16x32_bf16 v[136:139], a[56:59], a[104:107], v[136:139]
ds_read_b128 a[80:83], v0 offset:26624
v_mfma_f32_16x16x32_bf16 v[160:163], a[56:59], a[108:111], v[160:163]
s_waitcnt lgkmcnt(3)
v_mfma_f32_16x16x32_bf16 v[140:143], a[60:63], a[104:107], v[140:143]
ds_read_b128 a[84:87], v0 offset:26880
v_mfma_f32_16x16x32_bf16 v[164:167], a[60:63], a[108:111], v[164:167]
v_mfma_f32_16x16x32_bf16 v[136:139], a[64:67], a[112:115], v[136:139]
ds_read_b128 a[88:91], v0 offset:32768
v_mfma_f32_16x16x32_bf16 v[160:163], a[64:67], a[116:119], v[160:163]
v_mfma_f32_16x16x32_bf16 v[140:143], a[68:71], a[112:115], v[140:143]
ds_read_b128 a[92:95], v0 offset:33024
v_mfma_f32_16x16x32_bf16 v[164:167], a[68:71], a[116:119], v[164:167]
s_waitcnt lgkmcnt(3)
v_mfma_f32_16x16x32_bf16 v[136:139], a[72:75], a[120:123], v[136:139]
ds_read_b128 a[48:51], v0 offset:40960
v_mfma_f32_16x16x32_bf16 v[160:163], a[72:75], a[124:127], v[160:163]
v_mfma_f32_16x16x32_bf16 v[140:143], a[76:79], a[120:123], v[140:143]
ds_read_b128 a[52:55], v0 offset:41216
v_mfma_f32_16x16x32_bf16 v[164:167], a[76:79], a[124:127], v[164:167]
v_mfma_f32_16x16x32_bf16 v[136:139], a[80:83], a[128:131], v[136:139]
ds_read_b128 a[56:59], v0 offset:47104
v_mfma_f32_16x16x32_bf16 v[160:163], a[80:83], a[132:135], v[160:163]
s_waitcnt lgkmcnt(3)
v_mfma_f32_16x16x32_bf16 v[140:143], a[84:87], a[128:131], v[140:143]
ds_read_b128 a[60:63], v0 offset:47360
v_mfma_f32_16x16x32_bf16 v[164:167], a[84:87], a[132:135], v[164:167]
v_mfma_f32_16x16x32_bf16 v[136:139], a[88:91], a[136:139], v[136:139]
ds_read_b128 a[64:67], v0 offset:53248
v_mfma_f32_16x16x32_bf16 v[160:163], a[88:91], a[140:143], v[160:163]
v_mfma_f32_16x16x32_bf16 v[140:143], a[92:95], a[136:139], v[140:143]
ds_read_b128 a[68:71], v0 offset:53504
v_mfma_f32_16x16x32_bf16 v[164:167], a[92:95], a[140:143], v[164:167]
s_waitcnt lgkmcnt(3)
v_mfma_f32_16x16x32_bf16 v[144:147], a[48:51], a[144:147], v[144:147]
ds_read_b128 a[72:75], v0 offset:59392
v_mfma_f32_16x16x32_bf16 v[168:171], a[48:51], a[148:151], v[168:171]
v_mfma_f32_16x16x32_bf16 v[148:151], a[52:55], a[144:147], v[148:151]
ds_read_b128 a[76:79], v0 offset:59648
v_mfma_f32_16x16x32_bf16 v[172:175], a[52:55], a[148:151], v[172:175]
v_mfma_f32_16x16x32_bf16 v[144:147], a[56:59], a[152:155], v[144:147]
ds_read_b128 a[80:83], v1 offset:0
v_cvt_pk_bf16_f32 v68, v136, v137
v_mfma_f32_16x16x32_bf16 v[168:171], a[56:59], a[156:159], v[168:171]
v_cvt_pk_bf16_f32 v69, v138, v139
s_waitcnt lgkmcnt(2)
v_mfma_f32_16x16x32_bf16 v[148:151], a[60:63], a[152:155], v[148:151]
ds_read_b128 a[84:87], v1 offset:256
v_cvt_pk_bf16_f32 v70, v140, v141
v_mfma_f32_16x16x32_bf16 v[172:175], a[60:63], a[156:159], v[172:175]
v_cvt_pk_bf16_f32 v71, v142, v143
v_mfma_f32_16x16x32_bf16 v[144:147], a[64:67], a[160:163], v[144:147]
ds_read_b128 a[88:91], v1 offset:6144
v_cvt_pk_bf16_f32 v80, v160, v161
v_mfma_f32_16x16x32_bf16 v[168:171], a[64:67], a[164:167], v[168:171]
v_cvt_pk_bf16_f32 v81, v162, v163
v_mfma_f32_16x16x32_bf16 v[148:151], a[68:71], a[160:163], v[148:151]
ds_read_b128 a[92:95], v1 offset:6400
buffer_store_dwordx4 v[68:71], v4, s[28:31], s65 offen offset:64 sc1
v_cvt_pk_bf16_f32 v82, v164, v165
v_mfma_f32_16x16x32_bf16 v[172:175], a[68:71], a[164:167], v[172:175]
v_cvt_pk_bf16_f32 v83, v166, v167
v_mfma_f32_16x16x32_bf16 v[144:147], a[72:75], a[168:171], v[144:147]
ds_read_b128 a[48:51], v0 offset:4096
v_mfma_f32_16x16x32_bf16 v[168:171], a[72:75], a[172:175], v[168:171]
s_waitcnt lgkmcnt(2)
v_mfma_f32_16x16x32_bf16 v[148:151], a[76:79], a[168:171], v[148:151]
ds_read_b128 a[52:55], v0 offset:4352
v_mfma_f32_16x16x32_bf16 v[172:175], a[76:79], a[172:175], v[172:175]
v_mfma_f32_16x16x32_bf16 v[144:147], a[80:83], a[176:179], v[144:147]
ds_read_b128 a[56:59], v0 offset:10240
v_mfma_f32_16x16x32_bf16 v[168:171], a[80:83], a[180:183], v[168:171]
v_mfma_f32_16x16x32_bf16 v[148:151], a[84:87], a[176:179], v[148:151]
ds_read_b128 a[60:63], v0 offset:10496
v_mfma_f32_16x16x32_bf16 v[172:175], a[84:87], a[180:183], v[172:175]
v_mfma_f32_16x16x32_bf16 v[144:147], a[88:91], a[184:187], v[144:147]
ds_read_b128 a[64:67], v0 offset:16384
v_mfma_f32_16x16x32_bf16 v[168:171], a[88:91], a[188:191], v[168:171]
s_waitcnt lgkmcnt(3)
v_mfma_f32_16x16x32_bf16 v[148:151], a[92:95], a[184:187], v[148:151]
ds_read_b128 a[68:71], v0 offset:16640
buffer_store_dwordx4 v[80:83], v4, s[28:31], s65 offen offset:3136 sc1
v_mfma_f32_16x16x32_bf16 v[172:175], a[92:95], a[188:191], v[172:175]
v_mfma_f32_16x16x32_bf16 v[144:147], a[48:51], a[96:99], v[144:147]
ds_read_b128 a[72:75], v0 offset:22528
v_mfma_f32_16x16x32_bf16 v[168:171], a[48:51], a[100:103], v[168:171]
v_mfma_f32_16x16x32_bf16 v[148:151], a[52:55], a[96:99], v[148:151]
ds_read_b128 a[76:79], v0 offset:22784
v_mfma_f32_16x16x32_bf16 v[172:175], a[52:55], a[100:103], v[172:175]
s_waitcnt lgkmcnt(3)
v_mfma_f32_16x16x32_bf16 v[144:147], a[56:59], a[104:107], v[144:147]
ds_read_b128 a[80:83], v0 offset:28672
v_mfma_f32_16x16x32_bf16 v[168:171], a[56:59], a[108:111], v[168:171]
v_mfma_f32_16x16x32_bf16 v[148:151], a[60:63], a[104:107], v[148:151]
ds_read_b128 a[84:87], v0 offset:28928
v_mfma_f32_16x16x32_bf16 v[172:175], a[60:63], a[108:111], v[172:175]
v_mfma_f32_16x16x32_bf16 v[144:147], a[64:67], a[112:115], v[144:147]
ds_read_b128 a[88:91], v0 offset:34816
v_mfma_f32_16x16x32_bf16 v[168:171], a[64:67], a[116:119], v[168:171]
s_waitcnt lgkmcnt(3)
v_mfma_f32_16x16x32_bf16 v[148:151], a[68:71], a[112:115], v[148:151]
ds_read_b128 a[92:95], v0 offset:35072
v_mfma_f32_16x16x32_bf16 v[172:175], a[68:71], a[116:119], v[172:175]
v_mfma_f32_16x16x32_bf16 v[144:147], a[72:75], a[120:123], v[144:147]
v_mfma_f32_16x16x32_bf16 v[168:171], a[72:75], a[124:127], v[168:171]
v_mfma_f32_16x16x32_bf16 v[148:151], a[76:79], a[120:123], v[148:151]
v_mfma_f32_16x16x32_bf16 v[172:175], a[76:79], a[124:127], v[172:175]
s_waitcnt lgkmcnt(1)
v_mfma_f32_16x16x32_bf16 v[144:147], a[80:83], a[128:131], v[144:147]
v_mfma_f32_16x16x32_bf16 v[168:171], a[80:83], a[132:135], v[168:171]
v_mfma_f32_16x16x32_bf16 v[148:151], a[84:87], a[128:131], v[148:151]
v_mfma_f32_16x16x32_bf16 v[172:175], a[84:87], a[132:135], v[172:175]
v_mfma_f32_16x16x32_bf16 v[144:147], a[88:91], a[136:139], v[144:147]
v_mfma_f32_16x16x32_bf16 v[168:171], a[88:91], a[140:143], v[168:171]
s_waitcnt lgkmcnt(0)
v_mfma_f32_16x16x32_bf16 v[148:151], a[92:95], a[136:139], v[148:151]
v_mfma_f32_16x16x32_bf16 v[172:175], a[92:95], a[140:143], v[172:175]
s_nop 3
v_cvt_pk_bf16_f32 v72, v144, v145
v_cvt_pk_bf16_f32 v73, v146, v147
s_nop 0
v_cvt_pk_bf16_f32 v74, v148, v149
v_cvt_pk_bf16_f32 v75, v150, v151
buffer_store_dwordx4 v[72:75], v4, s[28:31], s65 offen offset:128 sc1
v_cvt_pk_bf16_f32 v84, v168, v169
v_cvt_pk_bf16_f32 v85, v170, v171
v_cvt_pk_bf16_f32 v86, v172, v173
v_cvt_pk_bf16_f32 v87, v174, v175
buffer_store_dwordx4 v[84:87], v4, s[28:31], s65 offen offset:3200 sc1
L_pf1:
L_end:
s_endpgm
.section .rodata,"a"
.p2align 6
.amdhsa_kernel standalone__modern_conv_block_convnext_v2__vision_kernel
  .amdhsa_next_free_vgpr 512
  .amdhsa_next_free_sgpr 102
  .amdhsa_accum_offset 256
  .amdhsa_group_segment_fixed_size 0
  .amdhsa_kernarg_size 72
  .amdhsa_user_sgpr_count 2
  .amdhsa_user_sgpr_kernarg_segment_ptr 1
  .amdhsa_system_sgpr_workgroup_id_x 1
  .amdhsa_float_denorm_mode_32 3
.end_amdhsa_kernel
```
